```python
import torch

def _softmax(x, axis=-1):
    return torch.softmax(x, dim=axis)

def _gelu(x):
    return torch.nn.functional.gelu(x, approximate='tanh')

def _silu(x):
    return torch.nn.functional.silu(x)

def _sigmoid(x):
    return torch.sigmoid(x)

def _layernorm(x, axis=-1, eps=1e-05):
    m = x.mean(dim=axis, keepdim=True)
    v = x.var(dim=axis, keepdim=True, unbiased=False)
    return (x - m) / torch.sqrt(v + eps)

def _scatter_add(tgt, idx, src, axis=0):
    return tgt.clone().index_add_(axis, idx, src)

def _segment_sum(src, seg, n):
    out = torch.zeros((n,) + src.shape[1:], dtype=src.dtype)
    return out.index_add_(0, seg, src)

def _pad(x, pw):
    flat = tuple((v for pair in reversed(pw) for v in pair))
    return torch.nn.functional.pad(x, flat)
kernel_name = 'adaLN_cond__compressed_kv_cla__dense_activation_silu__prompt'

def setup_inputs():

    _w = lambda a: (lambda t: t.to(torch.bfloat16) if t.is_floating_point() else t)(torch.as_tensor(a))

    def _A_setup():
        B, H, Sq, Sk, D, M = (1, 32, 2048, 2048, 128, 512)
        Dc = 4 * D
        return {'x': _w((lambda *s: torch.randn(*s, dtype=torch.bfloat16) * 0.05)(B, Sq, M)), 'c_kv': _w((lambda *s: torch.randn(*s, dtype=torch.bfloat16) * 0.8)(B, Sk, Dc)), 'w_q': _w((lambda *s: torch.randn(*s, dtype=torch.bfloat16) * 1.6)(M, H, D) * M ** (-0.5)), 'w_uk': _w((lambda *s: torch.randn(*s, dtype=torch.bfloat16) * 1.6)(Dc, H, D) * Dc ** (-0.5)), 'w_uv': _w((lambda *s: torch.randn(*s, dtype=torch.bfloat16) * 0.8)(Dc, H, D) * Dc ** (-0.5)), 'w_o': _w((lambda *s: torch.randn(*s, dtype=torch.bfloat16) * 0.8)(H, D, M) * (H * D) ** (-0.5))}
    _A_in = _A_setup()

    def _B_setup():
        B, S, D, F = (1, 2048, 512, 1792)
        return {'x': _w((lambda *s: torch.randn(*s, dtype=torch.bfloat16) * 0.05)(B, S, D)), 'w1': _w((lambda *s: torch.randn(*s, dtype=torch.bfloat16) * 1.6)(D, F) * D ** (-0.5)), 'w2': _w((lambda *s: torch.randn(*s, dtype=torch.bfloat16) * 0.2)(F, D) * F ** (-0.5))}
    _B_in = _B_setup()
    return {'A_x': _A_in['x'], 'A_c_kv': _A_in['c_kv'], 'A_w_q': _A_in['w_q'], 'A_w_uk': _A_in['w_uk'], 'A_w_uv': _A_in['w_uv'], 'A_w_o': _A_in['w_o'], 'B_x': _B_in['x'], 'B_w1': _B_in['w1'], 'B_w2': _B_in['w2'], 'c': _w((lambda *s: torch.randn(*s, dtype=torch.bfloat16) * 0.1)(1, 512) * 8.0), 'w_mod': _w((lambda *s: torch.randn(*s, dtype=torch.bfloat16) * 0.1)(512, 6 * 512) * 512 ** (-0.5) * 8.0)}

def reference(A_x, A_c_kv, A_w_q, A_w_uk, A_w_uv, A_w_o, B_x, B_w1, B_w2, c, w_mod):

    def _A_ref(x, c_kv, w_q, w_uk, w_uv, w_o):
        B, Sq, M = (x.shape[0], x.shape[1], x.shape[2])
        Sk = c_kv.shape[1]
        H, D = (w_q.shape[1], w_q.shape[2])
        q = torch.einsum('bqm,mhd->bhqd', x, w_q)
        k = torch.einsum('bkc,chd->bhkd', c_kv, w_uk)
        v = torch.einsum('bkc,chd->bhkd', c_kv, w_uv)
        scores = torch.einsum('bhqd,bhkd->bhqk', q, k) * D ** (-0.5)
        off = Sk - Sq
        qi = torch.arange(Sq)[:, None]
        kj = torch.arange(Sk)[None, :]
        cmask = kj <= qi + off
        scores = torch.where(cmask[None, None], scores, -1000000000.0)
        p = _softmax(scores, axis=-1)
        ctx = torch.einsum('bhqk,bhkd->bhqd', p, v)
        return torch.einsum('bhqd,hdm->bqm', ctx, w_o)

    def _B_ref(x, w1, w2):
        h = torch.einsum('bsd,df->bsf', x, w1)
        h = _silu(h)
        out = torch.einsum('bsf,fd->bsd', h, w2)
        return out
    x = A_x
    mod = (_silu(c) @ w_mod).reshape(c.shape[0], 6, 1, -1)
    sa, ca, ga, sb, cb, gb = (mod[:, 0].clone(), mod[:, 1].clone(), mod[:, 2].clone(), mod[:, 3].clone(), mod[:, 4].clone(), mod[:, 5].clone())
    h = _layernorm(x, axis=-1) * (1 + ca) + sa
    x = x + ga * _A_ref(h, A_c_kv, A_w_q, A_w_uk, A_w_uv, A_w_o)
    h = _layernorm(x, axis=-1) * (1 + cb) + sb
    x = x + gb * _B_ref(h, B_w1, B_w2)
    return x
```

```asm
; @launch kernel=mod_kernel grid=(256,1,1) block=(256,1,1) lds=12288
; @launch kernel=kv_kernel grid=(256,1,1) block=(256,1,1) lds=131072
; @launch kernel=attn_kernel grid=(256,1,1) block=(512,1,1) lds=163840
; @launch kernel=tail_kernel grid=(256,1,1) block=(256,1,1) lds=132096
.amdgcn_target "amdgcn-amd-amdhsa--gfx950"
.text
.globl mod_kernel
.p2align 8
.type mod_kernel,@function
mod_kernel:
    s_cmp_ge_u32 s2, 256
    s_cbranch_scc1 mod_kernel_end
    s_load_dwordx2 s[28:29], s[0:1], 24
    s_load_dwordx2 s[30:31], s[0:1], 32
    v_lshrrev_b32 v120, 6, v0
    v_and_b32 v121, 63, v0
    v_lshlrev_b32 v121, 4, v121
    v_lshlrev_b32 v120, 15, v120
    v_add_u32 v120, v120, v121
    s_lshr_b32 s36, s2, 3
    s_lshl_b32 s36, s36, 17
    s_and_b32 s37, s2, 7
    s_lshl_b32 s37, s37, 10
    s_add_u32 s36, s36, s37
    s_waitcnt lgkmcnt(0)
    s_mov_b32 s40, s28
    s_and_b32 s41, s29, 0xffff
    s_mov_b32 s42, 4194304
    s_mov_b32 s43, 0x20000
    s_mov_b32 s44, s30
    s_and_b32 s45, s31, 0xffff
    s_mov_b32 s46, 4194304
    s_mov_b32 s47, 0x20000
    s_cmp_ge_u32 s2, 176
    s_cbranch_scc0 mod_kernel_go
    s_mov_b32 s37, s36
    buffer_load_dwordx4 v[96:99], v120, s[40:43], s37 offen
    buffer_load_dwordx4 v[116:119], v120, s[44:47], s37 offen
    s_add_u32 s37, s37, 8192
    buffer_load_dwordx4 v[96:99], v120, s[40:43], s37 offen
    buffer_load_dwordx4 v[116:119], v120, s[44:47], s37 offen
    s_add_u32 s37, s37, 8192
    buffer_load_dwordx4 v[96:99], v120, s[40:43], s37 offen
    buffer_load_dwordx4 v[116:119], v120, s[44:47], s37 offen
    s_add_u32 s37, s37, 8192
    buffer_load_dwordx4 v[96:99], v120, s[40:43], s37 offen
    buffer_load_dwordx4 v[116:119], v120, s[44:47], s37 offen
    s_getpc_b64 s[50:51]
pc_1:
    s_add_u32 s50, s50, kv_kernel-pc_1
    s_addc_u32 s51, s51, 0
    s_mov_b32 s52, kv_kernel_end-kv_kernel-4
    v_lshlrev_b32 v126, 6, v0
    v_min_u32 v126, s52, v126
    v_and_b32 v126, -4, v126
    v_mov_b32 v125, s51
    v_add_co_u32 v124, vcc, s50, v126
    v_addc_co_u32 v125, vcc, 0, v125, vcc
    global_load_dword v127, v[124:125], off
    v_lshlrev_b32 v126, 6, v0
    v_add_u32 v126, 16384, v126
    v_min_u32 v126, s52, v126
    v_and_b32 v126, -4, v126
    v_mov_b32 v125, s51
    v_add_co_u32 v124, vcc, s50, v126
    v_addc_co_u32 v125, vcc, 0, v125, vcc
    global_load_dword v127, v[124:125], off
    v_lshlrev_b32 v126, 6, v0
    v_add_u32 v126, 32768, v126
    v_min_u32 v126, s52, v126
    v_and_b32 v126, -4, v126
    v_mov_b32 v125, s51
    v_add_co_u32 v124, vcc, s50, v126
    v_addc_co_u32 v125, vcc, 0, v125, vcc
    global_load_dword v127, v[124:125], off
    s_cmp_lg_u32 s2, 255
    s_cbranch_scc1 mod_kernel_end
    s_load_dwordx2 s[20:21], s[0:1], 104
    s_waitcnt lgkmcnt(0)
    s_mov_b32 s16, s20
    s_and_b32 s17, s21, 0xffff
    s_mov_b32 s18, 268435456
    s_mov_b32 s19, 0x20000
    v_lshlrev_b32 v2, 4, v0
    v_mov_b32 v8, 0
    v_mov_b32 v9, 0
    v_mov_b32 v10, 0
    v_mov_b32 v11, 0
    s_mov_b32 s22, 3145728
    buffer_store_dwordx4 v[8:11], v2, s[16:19], s22 offen
    s_mov_b32 s22, 3149824
    buffer_store_dwordx4 v[8:11], v2, s[16:19], s22 offen
    s_endpgm
mod_kernel_go:
    s_cmp_ge_u32 s2, 48
    s_cbranch_scc1 mod_kernel_pack
    s_load_dwordx2 s[4:5], s[0:1], 72
    s_load_dwordx2 s[6:7], s[0:1], 80
    s_load_dwordx2 s[20:21], s[0:1], 104
    s_waitcnt lgkmcnt(0)
    s_mov_b32 s8, s4
    s_and_b32 s9, s5, 0xffff
    s_mov_b32 s10, 1024
    s_mov_b32 s11, 0x20000
    s_mov_b32 s12, s6
    s_and_b32 s13, s7, 0xffff
    s_mov_b32 s14, 3145728
    s_mov_b32 s15, 0x20000
    s_mov_b32 s16, s20
    s_and_b32 s17, s21, 0xffff
    s_mov_b32 s18, 268435456
    s_mov_b32 s19, 0x20000
    v_and_b32 v1, 7, v0
    v_lshrrev_b32 v2, 3, v0
    v_lshlrev_b32 v3, 4, v1
    s_mov_b32 s3, 6144
    v_mul_lo_u32 v4, v2, s3
    v_add_u32 v3, v3, v4
    s_lshl_b32 s22, s2, 7
    s_add_u32 s23, s22, 0
    buffer_load_dwordx4 v[32:35], v3, s[12:15], s23 offen
    s_add_u32 s23, s22, 196608
    buffer_load_dwordx4 v[36:39], v3, s[12:15], s23 offen
    s_add_u32 s23, s22, 393216
    buffer_load_dwordx4 v[40:43], v3, s[12:15], s23 offen
    s_add_u32 s23, s22, 589824
    buffer_load_dwordx4 v[44:47], v3, s[12:15], s23 offen
    s_add_u32 s23, s22, 786432
    buffer_load_dwordx4 v[48:51], v3, s[12:15], s23 offen
    s_add_u32 s23, s22, 983040
    buffer_load_dwordx4 v[52:55], v3, s[12:15], s23 offen
    s_add_u32 s23, s22, 1179648
    buffer_load_dwordx4 v[56:59], v3, s[12:15], s23 offen
    s_add_u32 s23, s22, 1376256
    buffer_load_dwordx4 v[60:63], v3, s[12:15], s23 offen
    s_add_u32 s23, s22, 1572864
    buffer_load_dwordx4 v[64:67], v3, s[12:15], s23 offen
    s_add_u32 s23, s22, 1769472
    buffer_load_dwordx4 v[68:71], v3, s[12:15], s23 offen
    s_add_u32 s23, s22, 1966080
    buffer_load_dwordx4 v[72:75], v3, s[12:15], s23 offen
    s_add_u32 s23, s22, 2162688
    buffer_load_dwordx4 v[76:79], v3, s[12:15], s23 offen
    s_add_u32 s23, s22, 2359296
    buffer_load_dwordx4 v[80:83], v3, s[12:15], s23 offen
    s_add_u32 s23, s22, 2555904
    buffer_load_dwordx4 v[84:87], v3, s[12:15], s23 offen
    s_add_u32 s23, s22, 2752512
    buffer_load_dwordx4 v[88:91], v3, s[12:15], s23 offen
    s_add_u32 s23, s22, 2949120
    buffer_load_dwordx4 v[92:95], v3, s[12:15], s23 offen
    v_lshlrev_b32 v5, 2, v0
    buffer_load_dword v6, v5, s[8:11], 0 offen
    s_mov_b32 s37, s36
    buffer_load_dwordx4 v[96:99], v120, s[40:43], s37 offen
    buffer_load_dwordx4 v[116:119], v120, s[44:47], s37 offen
    s_add_u32 s37, s37, 8192
    buffer_load_dwordx4 v[96:99], v120, s[40:43], s37 offen
    buffer_load_dwordx4 v[116:119], v120, s[44:47], s37 offen
    s_add_u32 s37, s37, 8192
    buffer_load_dwordx4 v[96:99], v120, s[40:43], s37 offen
    buffer_load_dwordx4 v[116:119], v120, s[44:47], s37 offen
    s_add_u32 s37, s37, 8192
    buffer_load_dwordx4 v[96:99], v120, s[40:43], s37 offen
    buffer_load_dwordx4 v[116:119], v120, s[44:47], s37 offen
    s_waitcnt vmcnt(8)
    v_lshlrev_b32 v8, 16, v6
    v_and_b32 v9, 0xffff0000, v6
    v_mul_f32 v10, 0xbfb8aa3b, v8
    v_exp_f32 v10, v10
    s_nop 0
    v_add_f32 v10, 1.0, v10
    v_rcp_f32 v10, v10
    s_nop 0
    v_mul_f32 v8, v8, v10
    v_mul_f32 v10, 0xbfb8aa3b, v9
    v_exp_f32 v10, v10
    s_nop 0
    v_add_f32 v10, 1.0, v10
    v_rcp_f32 v10, v10
    s_nop 0
    v_mul_f32 v9, v9, v10
    v_cvt_pk_bf16_f32 v10, v8, v9
    v_lshlrev_b32 v8, 16, v10
    v_and_b32 v9, 0xffff0000, v10
    v_lshlrev_b32 v5, 3, v0
    ds_write_b64 v5, v[8:9]
    s_waitcnt lgkmcnt(0)
    s_barrier
    v_lshlrev_b32 v5, 2, v2
    ds_read_b32 v12, v5 offset:0
    ds_read_b32 v13, v5 offset:128
    ds_read_b32 v14, v5 offset:256
    ds_read_b32 v15, v5 offset:384
    ds_read_b32 v16, v5 offset:512
    ds_read_b32 v17, v5 offset:640
    ds_read_b32 v18, v5 offset:768
    ds_read_b32 v19, v5 offset:896
    ds_read_b32 v20, v5 offset:1024
    ds_read_b32 v21, v5 offset:1152
    ds_read_b32 v22, v5 offset:1280
    ds_read_b32 v23, v5 offset:1408
    ds_read_b32 v24, v5 offset:1536
    ds_read_b32 v25, v5 offset:1664
    ds_read_b32 v26, v5 offset:1792
    ds_read_b32 v27, v5 offset:1920
    s_waitcnt lgkmcnt(0)
    v_mov_b32 v100, 0
    v_mov_b32 v101, 0
    v_mov_b32 v102, 0
    v_mov_b32 v103, 0
    v_mov_b32 v104, 0
    v_mov_b32 v105, 0
    v_mov_b32 v106, 0
    v_mov_b32 v107, 0
    v_lshlrev_b32 v108, 16, v32
    v_and_b32 v109, 0xffff0000, v32
    v_lshlrev_b32 v110, 16, v33
    v_and_b32 v111, 0xffff0000, v33
    v_lshlrev_b32 v112, 16, v34
    v_and_b32 v113, 0xffff0000, v34
    v_lshlrev_b32 v114, 16, v35
    v_and_b32 v115, 0xffff0000, v35
    v_fmac_f32 v100, v108, v12
    v_fmac_f32 v101, v109, v12
    v_fmac_f32 v102, v110, v12
    v_fmac_f32 v103, v111, v12
    v_fmac_f32 v104, v112, v12
    v_fmac_f32 v105, v113, v12
    v_fmac_f32 v106, v114, v12
    v_fmac_f32 v107, v115, v12
    v_lshlrev_b32 v108, 16, v36
    v_and_b32 v109, 0xffff0000, v36
    v_lshlrev_b32 v110, 16, v37
    v_and_b32 v111, 0xffff0000, v37
    v_lshlrev_b32 v112, 16, v38
    v_and_b32 v113, 0xffff0000, v38
    v_lshlrev_b32 v114, 16, v39
    v_and_b32 v115, 0xffff0000, v39
    v_fmac_f32 v100, v108, v13
    v_fmac_f32 v101, v109, v13
    v_fmac_f32 v102, v110, v13
    v_fmac_f32 v103, v111, v13
    v_fmac_f32 v104, v112, v13
    v_fmac_f32 v105, v113, v13
    v_fmac_f32 v106, v114, v13
    v_fmac_f32 v107, v115, v13
    v_lshlrev_b32 v108, 16, v40
    v_and_b32 v109, 0xffff0000, v40
    v_lshlrev_b32 v110, 16, v41
    v_and_b32 v111, 0xffff0000, v41
    v_lshlrev_b32 v112, 16, v42
    v_and_b32 v113, 0xffff0000, v42
    v_lshlrev_b32 v114, 16, v43
    v_and_b32 v115, 0xffff0000, v43
    v_fmac_f32 v100, v108, v14
    v_fmac_f32 v101, v109, v14
    v_fmac_f32 v102, v110, v14
    v_fmac_f32 v103, v111, v14
    v_fmac_f32 v104, v112, v14
    v_fmac_f32 v105, v113, v14
    v_fmac_f32 v106, v114, v14
    v_fmac_f32 v107, v115, v14
    v_lshlrev_b32 v108, 16, v44
    v_and_b32 v109, 0xffff0000, v44
    v_lshlrev_b32 v110, 16, v45
    v_and_b32 v111, 0xffff0000, v45
    v_lshlrev_b32 v112, 16, v46
    v_and_b32 v113, 0xffff0000, v46
    v_lshlrev_b32 v114, 16, v47
    v_and_b32 v115, 0xffff0000, v47
    v_fmac_f32 v100, v108, v15
    v_fmac_f32 v101, v109, v15
    v_fmac_f32 v102, v110, v15
    v_fmac_f32 v103, v111, v15
    v_fmac_f32 v104, v112, v15
    v_fmac_f32 v105, v113, v15
    v_fmac_f32 v106, v114, v15
    v_fmac_f32 v107, v115, v15
    v_lshlrev_b32 v108, 16, v48
    v_and_b32 v109, 0xffff0000, v48
    v_lshlrev_b32 v110, 16, v49
    v_and_b32 v111, 0xffff0000, v49
    v_lshlrev_b32 v112, 16, v50
    v_and_b32 v113, 0xffff0000, v50
    v_lshlrev_b32 v114, 16, v51
    v_and_b32 v115, 0xffff0000, v51
    v_fmac_f32 v100, v108, v16
    v_fmac_f32 v101, v109, v16
    v_fmac_f32 v102, v110, v16
    v_fmac_f32 v103, v111, v16
    v_fmac_f32 v104, v112, v16
    v_fmac_f32 v105, v113, v16
    v_fmac_f32 v106, v114, v16
    v_fmac_f32 v107, v115, v16
    v_lshlrev_b32 v108, 16, v52
    v_and_b32 v109, 0xffff0000, v52
    v_lshlrev_b32 v110, 16, v53
    v_and_b32 v111, 0xffff0000, v53
    v_lshlrev_b32 v112, 16, v54
    v_and_b32 v113, 0xffff0000, v54
    v_lshlrev_b32 v114, 16, v55
    v_and_b32 v115, 0xffff0000, v55
    v_fmac_f32 v100, v108, v17
    v_fmac_f32 v101, v109, v17
    v_fmac_f32 v102, v110, v17
    v_fmac_f32 v103, v111, v17
    v_fmac_f32 v104, v112, v17
    v_fmac_f32 v105, v113, v17
    v_fmac_f32 v106, v114, v17
    v_fmac_f32 v107, v115, v17
    v_lshlrev_b32 v108, 16, v56
    v_and_b32 v109, 0xffff0000, v56
    v_lshlrev_b32 v110, 16, v57
    v_and_b32 v111, 0xffff0000, v57
    v_lshlrev_b32 v112, 16, v58
    v_and_b32 v113, 0xffff0000, v58
    v_lshlrev_b32 v114, 16, v59
    v_and_b32 v115, 0xffff0000, v59
    v_fmac_f32 v100, v108, v18
    v_fmac_f32 v101, v109, v18
    v_fmac_f32 v102, v110, v18
    v_fmac_f32 v103, v111, v18
    v_fmac_f32 v104, v112, v18
    v_fmac_f32 v105, v113, v18
    v_fmac_f32 v106, v114, v18
    v_fmac_f32 v107, v115, v18
    v_lshlrev_b32 v108, 16, v60
    v_and_b32 v109, 0xffff0000, v60
    v_lshlrev_b32 v110, 16, v61
    v_and_b32 v111, 0xffff0000, v61
    v_lshlrev_b32 v112, 16, v62
    v_and_b32 v113, 0xffff0000, v62
    v_lshlrev_b32 v114, 16, v63
    v_and_b32 v115, 0xffff0000, v63
    v_fmac_f32 v100, v108, v19
    v_fmac_f32 v101, v109, v19
    v_fmac_f32 v102, v110, v19
    v_fmac_f32 v103, v111, v19
    v_fmac_f32 v104, v112, v19
    v_fmac_f32 v105, v113, v19
    v_fmac_f32 v106, v114, v19
    v_fmac_f32 v107, v115, v19
    v_lshlrev_b32 v108, 16, v64
    v_and_b32 v109, 0xffff0000, v64
    v_lshlrev_b32 v110, 16, v65
    v_and_b32 v111, 0xffff0000, v65
    v_lshlrev_b32 v112, 16, v66
    v_and_b32 v113, 0xffff0000, v66
    v_lshlrev_b32 v114, 16, v67
    v_and_b32 v115, 0xffff0000, v67
    v_fmac_f32 v100, v108, v20
    v_fmac_f32 v101, v109, v20
    v_fmac_f32 v102, v110, v20
    v_fmac_f32 v103, v111, v20
    v_fmac_f32 v104, v112, v20
    v_fmac_f32 v105, v113, v20
    v_fmac_f32 v106, v114, v20
    v_fmac_f32 v107, v115, v20
    v_lshlrev_b32 v108, 16, v68
    v_and_b32 v109, 0xffff0000, v68
    v_lshlrev_b32 v110, 16, v69
    v_and_b32 v111, 0xffff0000, v69
    v_lshlrev_b32 v112, 16, v70
    v_and_b32 v113, 0xffff0000, v70
    v_lshlrev_b32 v114, 16, v71
    v_and_b32 v115, 0xffff0000, v71
    v_fmac_f32 v100, v108, v21
    v_fmac_f32 v101, v109, v21
    v_fmac_f32 v102, v110, v21
    v_fmac_f32 v103, v111, v21
    v_fmac_f32 v104, v112, v21
    v_fmac_f32 v105, v113, v21
    v_fmac_f32 v106, v114, v21
    v_fmac_f32 v107, v115, v21
    v_lshlrev_b32 v108, 16, v72
    v_and_b32 v109, 0xffff0000, v72
    v_lshlrev_b32 v110, 16, v73
    v_and_b32 v111, 0xffff0000, v73
    v_lshlrev_b32 v112, 16, v74
    v_and_b32 v113, 0xffff0000, v74
    v_lshlrev_b32 v114, 16, v75
    v_and_b32 v115, 0xffff0000, v75
    v_fmac_f32 v100, v108, v22
    v_fmac_f32 v101, v109, v22
    v_fmac_f32 v102, v110, v22
    v_fmac_f32 v103, v111, v22
    v_fmac_f32 v104, v112, v22
    v_fmac_f32 v105, v113, v22
    v_fmac_f32 v106, v114, v22
    v_fmac_f32 v107, v115, v22
    v_lshlrev_b32 v108, 16, v76
    v_and_b32 v109, 0xffff0000, v76
    v_lshlrev_b32 v110, 16, v77
    v_and_b32 v111, 0xffff0000, v77
    v_lshlrev_b32 v112, 16, v78
    v_and_b32 v113, 0xffff0000, v78
    v_lshlrev_b32 v114, 16, v79
    v_and_b32 v115, 0xffff0000, v79
    v_fmac_f32 v100, v108, v23
    v_fmac_f32 v101, v109, v23
    v_fmac_f32 v102, v110, v23
    v_fmac_f32 v103, v111, v23
    v_fmac_f32 v104, v112, v23
    v_fmac_f32 v105, v113, v23
    v_fmac_f32 v106, v114, v23
    v_fmac_f32 v107, v115, v23
    v_lshlrev_b32 v108, 16, v80
    v_and_b32 v109, 0xffff0000, v80
    v_lshlrev_b32 v110, 16, v81
    v_and_b32 v111, 0xffff0000, v81
    v_lshlrev_b32 v112, 16, v82
    v_and_b32 v113, 0xffff0000, v82
    v_lshlrev_b32 v114, 16, v83
    v_and_b32 v115, 0xffff0000, v83
    v_fmac_f32 v100, v108, v24
    v_fmac_f32 v101, v109, v24
    v_fmac_f32 v102, v110, v24
    v_fmac_f32 v103, v111, v24
    v_fmac_f32 v104, v112, v24
    v_fmac_f32 v105, v113, v24
    v_fmac_f32 v106, v114, v24
    v_fmac_f32 v107, v115, v24
    v_lshlrev_b32 v108, 16, v84
    v_and_b32 v109, 0xffff0000, v84
    v_lshlrev_b32 v110, 16, v85
    v_and_b32 v111, 0xffff0000, v85
    v_lshlrev_b32 v112, 16, v86
    v_and_b32 v113, 0xffff0000, v86
    v_lshlrev_b32 v114, 16, v87
    v_and_b32 v115, 0xffff0000, v87
    v_fmac_f32 v100, v108, v25
    v_fmac_f32 v101, v109, v25
    v_fmac_f32 v102, v110, v25
    v_fmac_f32 v103, v111, v25
    v_fmac_f32 v104, v112, v25
    v_fmac_f32 v105, v113, v25
    v_fmac_f32 v106, v114, v25
    v_fmac_f32 v107, v115, v25
    v_lshlrev_b32 v108, 16, v88
    v_and_b32 v109, 0xffff0000, v88
    v_lshlrev_b32 v110, 16, v89
    v_and_b32 v111, 0xffff0000, v89
    v_lshlrev_b32 v112, 16, v90
    v_and_b32 v113, 0xffff0000, v90
    v_lshlrev_b32 v114, 16, v91
    v_and_b32 v115, 0xffff0000, v91
    v_fmac_f32 v100, v108, v26
    v_fmac_f32 v101, v109, v26
    v_fmac_f32 v102, v110, v26
    v_fmac_f32 v103, v111, v26
    v_fmac_f32 v104, v112, v26
    v_fmac_f32 v105, v113, v26
    v_fmac_f32 v106, v114, v26
    v_fmac_f32 v107, v115, v26
    v_lshlrev_b32 v108, 16, v92
    v_and_b32 v109, 0xffff0000, v92
    v_lshlrev_b32 v110, 16, v93
    v_and_b32 v111, 0xffff0000, v93
    v_lshlrev_b32 v112, 16, v94
    v_and_b32 v113, 0xffff0000, v94
    v_lshlrev_b32 v114, 16, v95
    v_and_b32 v115, 0xffff0000, v95
    v_fmac_f32 v100, v108, v27
    v_fmac_f32 v101, v109, v27
    v_fmac_f32 v102, v110, v27
    v_fmac_f32 v103, v111, v27
    v_fmac_f32 v104, v112, v27
    v_fmac_f32 v105, v113, v27
    v_fmac_f32 v106, v114, v27
    v_fmac_f32 v107, v115, v27
    s_barrier
    v_lshlrev_b32 v5, 5, v0
    v_add_u32 v5, 2048, v5
    ds_write_b128 v5, v[100:103]
    ds_write_b128 v5, v[104:107] offset:16
    s_waitcnt lgkmcnt(0)
    s_barrier
    v_cmp_gt_u32 vcc, 64, v0
    s_and_saveexec_b64 s[24:25], vcc
    s_cbranch_execz mod_kernel_end
    v_lshlrev_b32 v5, 2, v0
    ds_read_b32 v32, v5 offset:2048
    ds_read_b32 v33, v5 offset:2304
    ds_read_b32 v34, v5 offset:2560
    ds_read_b32 v35, v5 offset:2816
    ds_read_b32 v36, v5 offset:3072
    ds_read_b32 v37, v5 offset:3328
    ds_read_b32 v38, v5 offset:3584
    ds_read_b32 v39, v5 offset:3840
    ds_read_b32 v40, v5 offset:4096
    ds_read_b32 v41, v5 offset:4352
    ds_read_b32 v42, v5 offset:4608
    ds_read_b32 v43, v5 offset:4864
    ds_read_b32 v44, v5 offset:5120
    ds_read_b32 v45, v5 offset:5376
    ds_read_b32 v46, v5 offset:5632
    ds_read_b32 v47, v5 offset:5888
    ds_read_b32 v48, v5 offset:6144
    ds_read_b32 v49, v5 offset:6400
    ds_read_b32 v50, v5 offset:6656
    ds_read_b32 v51, v5 offset:6912
    ds_read_b32 v52, v5 offset:7168
    ds_read_b32 v53, v5 offset:7424
    ds_read_b32 v54, v5 offset:7680
    ds_read_b32 v55, v5 offset:7936
    ds_read_b32 v56, v5 offset:8192
    ds_read_b32 v57, v5 offset:8448
    ds_read_b32 v58, v5 offset:8704
    ds_read_b32 v59, v5 offset:8960
    ds_read_b32 v60, v5 offset:9216
    ds_read_b32 v61, v5 offset:9472
    ds_read_b32 v62, v5 offset:9728
    ds_read_b32 v63, v5 offset:9984
    s_waitcnt lgkmcnt(0)
    v_add_f32 v32, v32, v33
    v_add_f32 v32, v32, v34
    v_add_f32 v32, v32, v35
    v_add_f32 v32, v32, v36
    v_add_f32 v32, v32, v37
    v_add_f32 v32, v32, v38
    v_add_f32 v32, v32, v39
    v_add_f32 v32, v32, v40
    v_add_f32 v32, v32, v41
    v_add_f32 v32, v32, v42
    v_add_f32 v32, v32, v43
    v_add_f32 v32, v32, v44
    v_add_f32 v32, v32, v45
    v_add_f32 v32, v32, v46
    v_add_f32 v32, v32, v47
    v_add_f32 v32, v32, v48
    v_add_f32 v32, v32, v49
    v_add_f32 v32, v32, v50
    v_add_f32 v32, v32, v51
    v_add_f32 v32, v32, v52
    v_add_f32 v32, v32, v53
    v_add_f32 v32, v32, v54
    v_add_f32 v32, v32, v55
    v_add_f32 v32, v32, v56
    v_add_f32 v32, v32, v57
    v_add_f32 v32, v32, v58
    v_add_f32 v32, v32, v59
    v_add_f32 v32, v32, v60
    v_add_f32 v32, v32, v61
    v_add_f32 v32, v32, v62
    v_add_f32 v32, v32, v63
    v_cvt_pk_bf16_f32 v33, v32, v32
    v_lshlrev_b32 v33, 16, v33
    s_lshl_b32 s22, s2, 8
    s_add_u32 s22, s22, 0
    buffer_store_dword v33, v5, s[16:19], s22 offen
    s_waitcnt vmcnt(0)
    s_endpgm
mod_kernel_pack:
    s_load_dwordx2 s[4:5], s[0:1], 8
    s_load_dwordx2 s[20:21], s[0:1], 104
    v_lshrrev_b32 v1, 6, v0
    s_nop 0
    v_readfirstlane_b32 s16, v1
    v_and_b32 v1, 63, v0
    s_sub_u32 s3, s2, 48
    s_lshl_b32 s3, s3, 2
    s_add_u32 s3, s3, s16
    s_waitcnt lgkmcnt(0)
    s_mov_b32 s8, s4
    s_and_b32 s9, s5, 0xffff
    s_mov_b32 s10, 2097152
    s_mov_b32 s11, 0x20000
    s_mov_b32 s16, s20
    s_and_b32 s17, s21, 0xffff
    s_mov_b32 s18, 268435456
    s_mov_b32 s19, 0x20000
    v_and_b32 v4, 31, v1
    v_lshrrev_b32 v5, 5, v1
    v_lshlrev_b32 v4, 10, v4
    v_lshlrev_b32 v5, 4, v5
    v_add_u32 v4, v4, v5
    s_lshr_b32 s22, s3, 3
    s_lshl_b32 s22, s22, 15
    s_and_b32 s23, s3, 7
    s_lshl_b32 s24, s23, 7
    s_add_u32 s24, s24, s22
    buffer_load_dwordx4 v[8:11], v4, s[8:11], s24 offen offset:0
    buffer_load_dwordx4 v[12:15], v4, s[8:11], s24 offen offset:32
    buffer_load_dwordx4 v[16:19], v4, s[8:11], s24 offen offset:64
    buffer_load_dwordx4 v[20:23], v4, s[8:11], s24 offen offset:96
    s_lshl_b32 s23, s23, 12
    s_add_u32 s22, s22, s23
    s_add_u32 s22, s22, 4194304
    v_lshlrev_b32 v2, 4, v1
    s_mov_b32 s37, s36
    buffer_load_dwordx4 v[96:99], v120, s[40:43], s37 offen
    buffer_load_dwordx4 v[116:119], v120, s[44:47], s37 offen
    s_add_u32 s37, s37, 8192
    buffer_load_dwordx4 v[96:99], v120, s[40:43], s37 offen
    buffer_load_dwordx4 v[116:119], v120, s[44:47], s37 offen
    s_add_u32 s37, s37, 8192
    buffer_load_dwordx4 v[96:99], v120, s[40:43], s37 offen
    buffer_load_dwordx4 v[116:119], v120, s[44:47], s37 offen
    s_add_u32 s37, s37, 8192
    buffer_load_dwordx4 v[96:99], v120, s[40:43], s37 offen
    buffer_load_dwordx4 v[116:119], v120, s[44:47], s37 offen
    s_waitcnt vmcnt(11)
    buffer_store_dwordx4 v[8:11], v2, s[16:19], s22 offen offset:0
    s_waitcnt vmcnt(11)
    buffer_store_dwordx4 v[12:15], v2, s[16:19], s22 offen offset:1024
    s_waitcnt vmcnt(11)
    buffer_store_dwordx4 v[16:19], v2, s[16:19], s22 offen offset:2048
    s_waitcnt vmcnt(11)
    buffer_store_dwordx4 v[20:23], v2, s[16:19], s22 offen offset:3072
mod_kernel_end:
    s_endpgm
.section .rodata,"a"
.p2align 6
.amdhsa_kernel mod_kernel
  .amdhsa_next_free_vgpr 128
  .amdhsa_next_free_sgpr 102
  .amdhsa_accum_offset 128
  .amdhsa_group_segment_fixed_size 0
  .amdhsa_kernarg_size 112
  .amdhsa_user_sgpr_count 2
  .amdhsa_user_sgpr_kernarg_segment_ptr 1
  .amdhsa_system_sgpr_workgroup_id_x 1
.end_amdhsa_kernel
.text
.globl kv_kernel
.p2align 8
.type kv_kernel,@function
kv_kernel:
    s_cmp_ge_u32 s2, 256
    s_cbranch_scc1 kv_kernel_end
    s_load_dwordx2 s[4:5], s[0:1], 8
    s_load_dwordx2 s[6:7], s[0:1], 24
    s_load_dwordx2 s[8:9], s[0:1], 32
    s_load_dwordx2 s[10:11], s[0:1], 104
    s_load_dwordx2 s[12:13], s[0:1], 0
    s_load_dwordx2 s[48:49], s[0:1], 16
    s_and_b32 s14, s2, 7
    s_lshl_b32 s14, s14, 2
    s_lshr_b32 s15, s2, 3
    s_and_b32 s15, s15, 3
    s_add_u32 s14, s14, s15
    s_bfe_u32 s17, s2, 0x10005
    s_lshr_b32 s15, s2, 6
    v_lshrrev_b32 v1, 6, v0
    s_nop 0
    v_readfirstlane_b32 s16, v1
    v_and_b32 v1, 63, v0
    s_waitcnt lgkmcnt(0)
    s_cmp_eq_u32 s17, 0
    s_cselect_b32 s6, s6, s8
    s_cselect_b32 s7, s7, s9
    s_mov_b32 s20, s4
    s_and_b32 s21, s5, 0xffff
    s_mov_b32 s22, 2097152
    s_mov_b32 s23, 0x20000
    s_mov_b32 s24, s6
    s_and_b32 s25, s7, 0xffff
    s_mov_b32 s26, 4194304
    s_mov_b32 s27, 0x20000
    s_mov_b32 s32, s10
    s_and_b32 s33, s11, 0xffff
    s_mov_b32 s34, 268435456
    s_mov_b32 s35, 0x20000
    s_mov_b32 s36, s12
    s_and_b32 s37, s13, 0xffff
    s_mov_b32 s38, 2097152
    s_mov_b32 s39, 0x20000
    v_lshrrev_b32 v6, 4, v1
    v_and_b32 v5, 15, v1
    v_lshlrev_b32 v7, 2, v6
    v_xor_b32 v5, v5, v7
    v_lshlrev_b32 v5, 4, v5
    s_lshl_b32 s18, s16, 5
    v_add_u32 v7, s18, v6
    v_lshlrev_b32 v7, 13, v7
    s_lshl_b32 s18, s14, 8
    v_add_u32 v7, s18, v7
    v_add_u32 v10, v7, v5
    v_add_u32 v11, 31744, v10
    v_add_u32 v12, 63488, v10
    v_add_u32 v13, 95232, v10
    v_lshlrev_b32 v14, 4, v1
    s_lshl_b32 s40, s15, 9
    s_lshl_b32 s18, s16, 7
    s_add_u32 s40, s40, s18
    s_lshl_b32 s40, s40, 10
    s_add_u32 s40, s40, 4194304
    v_lshrrev_b32 v4, 4, v1
    v_bfe_u32 v5, v1, 2, 2
    v_and_b32 v6, 3, v1
    v_lshrrev_b32 v7, 1, v4
    v_lshlrev_b32 v7, 3, v7
    v_add_u32 v7, v7, v5
    v_lshlrev_b32 v7, 8, v7
    v_and_b32 v8, 1, v4
    v_lshlrev_b32 v8, 1, v8
    v_lshrrev_b32 v9, 1, v6
    v_add_u32 v8, v8, v9
    v_lshlrev_b32 v8, 4, v8
    v_and_b32 v9, 1, v6
    v_lshlrev_b32 v9, 3, v9
    v_add_u32 v8, v8, v9
    v_add_u32 v7, v7, v8
    v_xor_b32 v8, 0, v5
    v_lshlrev_b32 v8, 6, v8
    v_add_u32 v16, v7, v8
    v_add_u32 v20, 0x10000, v16
    v_xor_b32 v8, 1, v5
    v_lshlrev_b32 v8, 6, v8
    v_add_u32 v17, v7, v8
    v_add_u32 v21, 0x10000, v17
    v_xor_b32 v8, 2, v5
    v_lshlrev_b32 v8, 6, v8
    v_add_u32 v18, v7, v8
    v_add_u32 v22, 0x10000, v18
    v_xor_b32 v8, 3, v5
    v_lshlrev_b32 v8, 6, v8
    v_add_u32 v19, v7, v8
    v_add_u32 v23, 0x10000, v19
    v_lshlrev_b32 v2, 4, v1
    s_lshl_b32 s41, s14, 6
    s_lshl_b32 s18, s15, 4
    s_add_u32 s41, s41, s18
    s_lshl_b32 s18, s16, 2
    s_add_u32 s41, s41, s18
    s_lshl_b32 s41, s41, 14
    s_add_u32 s41, s41, 16777216
    s_lshl_b32 s18, s17, 13
    s_add_u32 s41, s41, s18
    s_cmp_eq_u32 s17, 1
    s_cbranch_scc1 kv_kernel_v
    s_lshl_b32 s18, s16, 13
    s_mov_b32 s19, 0
    s_add_u32 m0, s18, 0
    s_nop 0
    buffer_load_dwordx4 v10, s[24:27], s19 offen offset:0 lds
    buffer_load_dwordx4 v11, s[24:27], s19 offen offset:1024 lds
    buffer_load_dwordx4 v12, s[24:27], s19 offen offset:2048 lds
    buffer_load_dwordx4 v13, s[24:27], s19 offen offset:3072 lds
    s_lshl_b32 s18, s16, 13
    s_mov_b32 s19, 131072
    s_add_u32 m0, s18, 4096
    s_nop 0
    buffer_load_dwordx4 v10, s[24:27], s19 offen offset:0 lds
    buffer_load_dwordx4 v11, s[24:27], s19 offen offset:1024 lds
    buffer_load_dwordx4 v12, s[24:27], s19 offen offset:2048 lds
    buffer_load_dwordx4 v13, s[24:27], s19 offen offset:3072 lds
    s_add_u32 s47, s40, 0
    buffer_load_dwordx4 a[0:3], v14, s[32:35], s47 offen offset:0
    s_add_u32 s47, s40, 0
    buffer_load_dwordx4 a[4:7], v14, s[32:35], s47 offen offset:1024
    s_add_u32 s47, s40, 0
    buffer_load_dwordx4 a[8:11], v14, s[32:35], s47 offen offset:2048
    s_add_u32 s47, s40, 0
    buffer_load_dwordx4 a[12:15], v14, s[32:35], s47 offen offset:3072
    s_add_u32 s47, s40, 4096
    buffer_load_dwordx4 a[16:19], v14, s[32:35], s47 offen offset:0
    s_add_u32 s47, s40, 4096
    buffer_load_dwordx4 a[20:23], v14, s[32:35], s47 offen offset:1024
    s_add_u32 s47, s40, 4096
    buffer_load_dwordx4 a[24:27], v14, s[32:35], s47 offen offset:2048
    s_add_u32 s47, s40, 4096
    buffer_load_dwordx4 a[28:31], v14, s[32:35], s47 offen offset:3072
    s_lshl_b32 s18, s16, 13
    s_mov_b32 s19, 1048576
    s_add_u32 m0, s18, 32768
    s_nop 0
    buffer_load_dwordx4 v10, s[24:27], s19 offen offset:0 lds
    buffer_load_dwordx4 v11, s[24:27], s19 offen offset:1024 lds
    buffer_load_dwordx4 v12, s[24:27], s19 offen offset:2048 lds
    buffer_load_dwordx4 v13, s[24:27], s19 offen offset:3072 lds
    s_lshl_b32 s18, s16, 13
    s_mov_b32 s19, 1179648
    s_add_u32 m0, s18, 36864
    s_nop 0
    buffer_load_dwordx4 v10, s[24:27], s19 offen offset:0 lds
    buffer_load_dwordx4 v11, s[24:27], s19 offen offset:1024 lds
    buffer_load_dwordx4 v12, s[24:27], s19 offen offset:2048 lds
    buffer_load_dwordx4 v13, s[24:27], s19 offen offset:3072 lds
    s_add_u32 s44, s40, 32768
    s_waitcnt vmcnt(16)
    s_barrier
    ds_read_b64_tr_b16 v[32:33], v16 offset:0
    ds_read_b64_tr_b16 v[34:35], v16 offset:1024
    ds_read_b64_tr_b16 v[36:37], v17 offset:0
    ds_read_b64_tr_b16 v[38:39], v17 offset:1024
    ds_read_b64_tr_b16 v[40:41], v18 offset:0
    ds_read_b64_tr_b16 v[42:43], v18 offset:1024
    ds_read_b64_tr_b16 v[44:45], v19 offset:0
    ds_read_b64_tr_b16 v[46:47], v19 offset:1024
    s_waitcnt vmcnt(15)
    s_waitcnt lgkmcnt(6)
    v_mfma_f32_32x32x16_bf16 v[128:143], v[32:35], a[0:3], 0
    ds_read_b64_tr_b16 v[48:49], v16 offset:4096
    ds_read_b64_tr_b16 v[50:51], v16 offset:5120
    s_add_u32 s47, s40, 8192
    buffer_load_dwordx4 a[32:35], v14, s[32:35], s47 offen offset:0
    s_waitcnt lgkmcnt(6)
    v_mfma_f32_32x32x16_bf16 v[144:159], v[36:39], a[0:3], 0
    ds_read_b64_tr_b16 v[52:53], v17 offset:4096
    ds_read_b64_tr_b16 v[54:55], v17 offset:5120
    s_waitcnt lgkmcnt(6)
    v_mfma_f32_32x32x16_bf16 v[160:175], v[40:43], a[0:3], 0
    ds_read_b64_tr_b16 v[56:57], v18 offset:4096
    ds_read_b64_tr_b16 v[58:59], v18 offset:5120
    s_lshl_b32 s18, s16, 13
    s_mov_b32 s19, 2097152
    s_add_u32 m0, s18, 65536
    s_nop 0
    buffer_load_dwordx4 v10, s[24:27], s19 offen offset:0 lds
    s_waitcnt lgkmcnt(6)
    v_mfma_f32_32x32x16_bf16 v[176:191], v[44:47], a[0:3], 0
    ds_read_b64_tr_b16 v[60:61], v19 offset:4096
    ds_read_b64_tr_b16 v[62:63], v19 offset:5120
    buffer_load_dwordx4 v11, s[24:27], s19 offen offset:1024 lds
    s_waitcnt vmcnt(17)
    s_waitcnt lgkmcnt(6)
    v_mfma_f32_32x32x16_bf16 v[128:143], v[48:51], a[4:7], v[128:143]
    ds_read_b64_tr_b16 v[32:33], v16 offset:8192
    ds_read_b64_tr_b16 v[34:35], v16 offset:9216
    s_add_u32 s47, s40, 8192
    buffer_load_dwordx4 a[36:39], v14, s[32:35], s47 offen offset:1024
    s_waitcnt lgkmcnt(6)
    v_mfma_f32_32x32x16_bf16 v[144:159], v[52:55], a[4:7], v[144:159]
    ds_read_b64_tr_b16 v[36:37], v17 offset:8192
    ds_read_b64_tr_b16 v[38:39], v17 offset:9216
    s_add_u32 s47, s44, 0
    buffer_load_dwordx4 a[0:3], v14, s[32:35], s47 offen offset:0
    s_waitcnt lgkmcnt(6)
    v_mfma_f32_32x32x16_bf16 v[160:175], v[56:59], a[4:7], v[160:175]
    ds_read_b64_tr_b16 v[40:41], v18 offset:8192
    ds_read_b64_tr_b16 v[42:43], v18 offset:9216
    buffer_load_dwordx4 v12, s[24:27], s19 offen offset:2048 lds
    s_waitcnt lgkmcnt(6)
    v_mfma_f32_32x32x16_bf16 v[176:191], v[60:63], a[4:7], v[176:191]
    ds_read_b64_tr_b16 v[44:45], v19 offset:8192
    ds_read_b64_tr_b16 v[46:47], v19 offset:9216
    buffer_load_dwordx4 v13, s[24:27], s19 offen offset:3072 lds
    s_waitcnt vmcnt(20)
    s_waitcnt lgkmcnt(6)
    v_mfma_f32_32x32x16_bf16 v[128:143], v[32:35], a[8:11], v[128:143]
    ds_read_b64_tr_b16 v[48:49], v16 offset:12288
    ds_read_b64_tr_b16 v[50:51], v16 offset:13312
    s_add_u32 s47, s40, 8192
    buffer_load_dwordx4 a[40:43], v14, s[32:35], s47 offen offset:2048
    s_waitcnt lgkmcnt(6)
    v_mfma_f32_32x32x16_bf16 v[144:159], v[36:39], a[8:11], v[144:159]
    ds_read_b64_tr_b16 v[52:53], v17 offset:12288
    ds_read_b64_tr_b16 v[54:55], v17 offset:13312
    s_add_u32 s47, s44, 0
    buffer_load_dwordx4 a[4:7], v14, s[32:35], s47 offen offset:1024
    s_waitcnt lgkmcnt(6)
    v_mfma_f32_32x32x16_bf16 v[160:175], v[40:43], a[8:11], v[160:175]
    ds_read_b64_tr_b16 v[56:57], v18 offset:12288
    ds_read_b64_tr_b16 v[58:59], v18 offset:13312
    s_lshl_b32 s18, s16, 13
    s_mov_b32 s19, 2228224
    s_add_u32 m0, s18, 69632
    s_nop 0
    buffer_load_dwordx4 v10, s[24:27], s19 offen offset:0 lds
    s_waitcnt lgkmcnt(6)
    v_mfma_f32_32x32x16_bf16 v[176:191], v[44:47], a[8:11], v[176:191]
    ds_read_b64_tr_b16 v[60:61], v19 offset:12288
    ds_read_b64_tr_b16 v[62:63], v19 offset:13312
    buffer_load_dwordx4 v11, s[24:27], s19 offen offset:1024 lds
    s_waitcnt vmcnt(23)
    s_waitcnt lgkmcnt(6)
    v_mfma_f32_32x32x16_bf16 v[128:143], v[48:51], a[12:15], v[128:143]
    ds_read_b64_tr_b16 v[32:33], v16 offset:16384
    ds_read_b64_tr_b16 v[34:35], v16 offset:17408
    s_add_u32 s47, s40, 8192
    buffer_load_dwordx4 a[44:47], v14, s[32:35], s47 offen offset:3072
    s_waitcnt lgkmcnt(6)
    v_mfma_f32_32x32x16_bf16 v[144:159], v[52:55], a[12:15], v[144:159]
    ds_read_b64_tr_b16 v[36:37], v17 offset:16384
    ds_read_b64_tr_b16 v[38:39], v17 offset:17408
    s_add_u32 s47, s44, 0
    buffer_load_dwordx4 a[8:11], v14, s[32:35], s47 offen offset:2048
    s_waitcnt lgkmcnt(6)
    v_mfma_f32_32x32x16_bf16 v[160:175], v[56:59], a[12:15], v[160:175]
    ds_read_b64_tr_b16 v[40:41], v18 offset:16384
    ds_read_b64_tr_b16 v[42:43], v18 offset:17408
    buffer_load_dwordx4 v12, s[24:27], s19 offen offset:2048 lds
    s_waitcnt lgkmcnt(6)
    v_mfma_f32_32x32x16_bf16 v[176:191], v[60:63], a[12:15], v[176:191]
    ds_read_b64_tr_b16 v[44:45], v19 offset:16384
    ds_read_b64_tr_b16 v[46:47], v19 offset:17408
    buffer_load_dwordx4 v13, s[24:27], s19 offen offset:3072 lds
    s_waitcnt vmcnt(26)
    s_waitcnt lgkmcnt(6)
    v_mfma_f32_32x32x16_bf16 v[128:143], v[32:35], a[16:19], v[128:143]
    ds_read_b64_tr_b16 v[48:49], v16 offset:20480
    ds_read_b64_tr_b16 v[50:51], v16 offset:21504
    s_add_u32 s47, s40, 12288
    buffer_load_dwordx4 a[48:51], v14, s[32:35], s47 offen offset:0
    s_waitcnt lgkmcnt(6)
    v_mfma_f32_32x32x16_bf16 v[144:159], v[36:39], a[16:19], v[144:159]
    ds_read_b64_tr_b16 v[52:53], v17 offset:20480
    ds_read_b64_tr_b16 v[54:55], v17 offset:21504
    s_add_u32 s47, s44, 0
    buffer_load_dwordx4 a[12:15], v14, s[32:35], s47 offen offset:3072
    s_waitcnt lgkmcnt(6)
    v_mfma_f32_32x32x16_bf16 v[160:175], v[40:43], a[16:19], v[160:175]
    ds_read_b64_tr_b16 v[56:57], v18 offset:20480
    ds_read_b64_tr_b16 v[58:59], v18 offset:21504
    s_lshl_b32 s18, s16, 13
    s_mov_b32 s19, 3145728
    s_add_u32 m0, s18, 98304
    s_nop 0
    buffer_load_dwordx4 v10, s[24:27], s19 offen offset:0 lds
    s_waitcnt lgkmcnt(6)
    v_mfma_f32_32x32x16_bf16 v[176:191], v[44:47], a[16:19], v[176:191]
    ds_read_b64_tr_b16 v[60:61], v19 offset:20480
    ds_read_b64_tr_b16 v[62:63], v19 offset:21504
    buffer_load_dwordx4 v11, s[24:27], s19 offen offset:1024 lds
    s_waitcnt vmcnt(29)
    s_waitcnt lgkmcnt(6)
    v_mfma_f32_32x32x16_bf16 v[128:143], v[48:51], a[20:23], v[128:143]
    ds_read_b64_tr_b16 v[32:33], v16 offset:24576
    ds_read_b64_tr_b16 v[34:35], v16 offset:25600
    s_add_u32 s47, s40, 12288
    buffer_load_dwordx4 a[52:55], v14, s[32:35], s47 offen offset:1024
    s_waitcnt lgkmcnt(6)
    v_mfma_f32_32x32x16_bf16 v[144:159], v[52:55], a[20:23], v[144:159]
    ds_read_b64_tr_b16 v[36:37], v17 offset:24576
    ds_read_b64_tr_b16 v[38:39], v17 offset:25600
    s_add_u32 s47, s44, 4096
    buffer_load_dwordx4 a[16:19], v14, s[32:35], s47 offen offset:0
    s_waitcnt lgkmcnt(6)
    v_mfma_f32_32x32x16_bf16 v[160:175], v[56:59], a[20:23], v[160:175]
    ds_read_b64_tr_b16 v[40:41], v18 offset:24576
    ds_read_b64_tr_b16 v[42:43], v18 offset:25600
    buffer_load_dwordx4 v12, s[24:27], s19 offen offset:2048 lds
    s_waitcnt lgkmcnt(6)
    v_mfma_f32_32x32x16_bf16 v[176:191], v[60:63], a[20:23], v[176:191]
    ds_read_b64_tr_b16 v[44:45], v19 offset:24576
    ds_read_b64_tr_b16 v[46:47], v19 offset:25600
    buffer_load_dwordx4 v13, s[24:27], s19 offen offset:3072 lds
    s_waitcnt vmcnt(32)
    s_waitcnt lgkmcnt(6)
    v_mfma_f32_32x32x16_bf16 v[128:143], v[32:35], a[24:27], v[128:143]
    ds_read_b64_tr_b16 v[48:49], v16 offset:28672
    ds_read_b64_tr_b16 v[50:51], v16 offset:29696
    s_add_u32 s47, s40, 12288
    buffer_load_dwordx4 a[56:59], v14, s[32:35], s47 offen offset:2048
    s_waitcnt lgkmcnt(6)
    v_mfma_f32_32x32x16_bf16 v[144:159], v[36:39], a[24:27], v[144:159]
    ds_read_b64_tr_b16 v[52:53], v17 offset:28672
    ds_read_b64_tr_b16 v[54:55], v17 offset:29696
    s_add_u32 s47, s44, 4096
    buffer_load_dwordx4 a[20:23], v14, s[32:35], s47 offen offset:1024
    s_waitcnt lgkmcnt(6)
    v_mfma_f32_32x32x16_bf16 v[160:175], v[40:43], a[24:27], v[160:175]
    ds_read_b64_tr_b16 v[56:57], v18 offset:28672
    ds_read_b64_tr_b16 v[58:59], v18 offset:29696
    s_lshl_b32 s18, s16, 13
    s_mov_b32 s19, 3276800
    s_add_u32 m0, s18, 102400
    s_nop 0
    buffer_load_dwordx4 v10, s[24:27], s19 offen offset:0 lds
    s_waitcnt lgkmcnt(6)
    v_mfma_f32_32x32x16_bf16 v[176:191], v[44:47], a[24:27], v[176:191]
    ds_read_b64_tr_b16 v[60:61], v19 offset:28672
    ds_read_b64_tr_b16 v[62:63], v19 offset:29696
    buffer_load_dwordx4 v11, s[24:27], s19 offen offset:1024 lds
    s_waitcnt vmcnt(27)
    s_barrier
    s_waitcnt lgkmcnt(6)
    v_mfma_f32_32x32x16_bf16 v[128:143], v[48:51], a[28:31], v[128:143]
    ds_read_b64_tr_b16 v[32:33], v16 offset:32768
    ds_read_b64_tr_b16 v[34:35], v16 offset:33792
    s_add_u32 s47, s40, 12288
    buffer_load_dwordx4 a[60:63], v14, s[32:35], s47 offen offset:3072
    s_waitcnt lgkmcnt(6)
    v_mfma_f32_32x32x16_bf16 v[144:159], v[52:55], a[28:31], v[144:159]
    ds_read_b64_tr_b16 v[36:37], v17 offset:32768
    ds_read_b64_tr_b16 v[38:39], v17 offset:33792
    s_add_u32 s47, s44, 4096
    buffer_load_dwordx4 a[24:27], v14, s[32:35], s47 offen offset:2048
    s_waitcnt lgkmcnt(6)
    v_mfma_f32_32x32x16_bf16 v[160:175], v[56:59], a[28:31], v[160:175]
    ds_read_b64_tr_b16 v[40:41], v18 offset:32768
    ds_read_b64_tr_b16 v[42:43], v18 offset:33792
    buffer_load_dwordx4 v12, s[24:27], s19 offen offset:2048 lds
    s_waitcnt lgkmcnt(6)
    v_mfma_f32_32x32x16_bf16 v[176:191], v[60:63], a[28:31], v[176:191]
    ds_read_b64_tr_b16 v[44:45], v19 offset:32768
    ds_read_b64_tr_b16 v[46:47], v19 offset:33792
    buffer_load_dwordx4 v13, s[24:27], s19 offen offset:3072 lds
    s_waitcnt vmcnt(30)
    s_waitcnt lgkmcnt(6)
    v_mfma_f32_32x32x16_bf16 v[128:143], v[32:35], a[32:35], v[128:143]
    ds_read_b64_tr_b16 v[48:49], v16 offset:36864
    ds_read_b64_tr_b16 v[50:51], v16 offset:37888
    s_add_u32 s47, s40, 16384
    buffer_load_dwordx4 a[64:67], v14, s[32:35], s47 offen offset:0
    s_waitcnt lgkmcnt(6)
    v_mfma_f32_32x32x16_bf16 v[144:159], v[36:39], a[32:35], v[144:159]
    ds_read_b64_tr_b16 v[52:53], v17 offset:36864
    ds_read_b64_tr_b16 v[54:55], v17 offset:37888
    s_add_u32 s47, s44, 4096
    buffer_load_dwordx4 a[28:31], v14, s[32:35], s47 offen offset:3072
    s_waitcnt lgkmcnt(6)
    v_mfma_f32_32x32x16_bf16 v[160:175], v[40:43], a[32:35], v[160:175]
    ds_read_b64_tr_b16 v[56:57], v18 offset:36864
    ds_read_b64_tr_b16 v[58:59], v18 offset:37888
    s_waitcnt lgkmcnt(6)
    v_mfma_f32_32x32x16_bf16 v[176:191], v[44:47], a[32:35], v[176:191]
    ds_read_b64_tr_b16 v[60:61], v19 offset:36864
    ds_read_b64_tr_b16 v[62:63], v19 offset:37888
    s_waitcnt vmcnt(29)
    s_waitcnt lgkmcnt(6)
    v_mfma_f32_32x32x16_bf16 v[128:143], v[48:51], a[36:39], v[128:143]
    ds_read_b64_tr_b16 v[32:33], v16 offset:40960
    ds_read_b64_tr_b16 v[34:35], v16 offset:41984
    s_add_u32 s47, s40, 16384
    buffer_load_dwordx4 a[68:71], v14, s[32:35], s47 offen offset:1024
    s_waitcnt lgkmcnt(6)
    v_mfma_f32_32x32x16_bf16 v[144:159], v[52:55], a[36:39], v[144:159]
    ds_read_b64_tr_b16 v[36:37], v17 offset:40960
    ds_read_b64_tr_b16 v[38:39], v17 offset:41984
    s_add_u32 s47, s44, 8192
    buffer_load_dwordx4 a[32:35], v14, s[32:35], s47 offen offset:0
    s_waitcnt lgkmcnt(6)
    v_mfma_f32_32x32x16_bf16 v[160:175], v[56:59], a[36:39], v[160:175]
    ds_read_b64_tr_b16 v[40:41], v18 offset:40960
    ds_read_b64_tr_b16 v[42:43], v18 offset:41984
    s_waitcnt lgkmcnt(6)
    v_mfma_f32_32x32x16_bf16 v[176:191], v[60:63], a[36:39], v[176:191]
    ds_read_b64_tr_b16 v[44:45], v19 offset:40960
    ds_read_b64_tr_b16 v[46:47], v19 offset:41984
    s_waitcnt vmcnt(27)
    s_waitcnt lgkmcnt(6)
    v_mfma_f32_32x32x16_bf16 v[128:143], v[32:35], a[40:43], v[128:143]
    ds_read_b64_tr_b16 v[48:49], v16 offset:45056
    ds_read_b64_tr_b16 v[50:51], v16 offset:46080
    s_add_u32 s47, s40, 16384
    buffer_load_dwordx4 a[72:75], v14, s[32:35], s47 offen offset:2048
    s_waitcnt lgkmcnt(6)
    v_mfma_f32_32x32x16_bf16 v[144:159], v[36:39], a[40:43], v[144:159]
    ds_read_b64_tr_b16 v[52:53], v17 offset:45056
    ds_read_b64_tr_b16 v[54:55], v17 offset:46080
    s_add_u32 s47, s44, 8192
    buffer_load_dwordx4 a[36:39], v14, s[32:35], s47 offen offset:1024
    s_waitcnt lgkmcnt(6)
    v_mfma_f32_32x32x16_bf16 v[160:175], v[40:43], a[40:43], v[160:175]
    ds_read_b64_tr_b16 v[56:57], v18 offset:45056
    ds_read_b64_tr_b16 v[58:59], v18 offset:46080
    s_waitcnt lgkmcnt(6)
    v_mfma_f32_32x32x16_bf16 v[176:191], v[44:47], a[40:43], v[176:191]
    ds_read_b64_tr_b16 v[60:61], v19 offset:45056
    ds_read_b64_tr_b16 v[62:63], v19 offset:46080
    s_waitcnt vmcnt(25)
    s_waitcnt lgkmcnt(6)
    v_mfma_f32_32x32x16_bf16 v[128:143], v[48:51], a[44:47], v[128:143]
    ds_read_b64_tr_b16 v[32:33], v16 offset:49152
    ds_read_b64_tr_b16 v[34:35], v16 offset:50176
    s_add_u32 s47, s40, 16384
    buffer_load_dwordx4 a[76:79], v14, s[32:35], s47 offen offset:3072
    s_waitcnt lgkmcnt(6)
    v_mfma_f32_32x32x16_bf16 v[144:159], v[52:55], a[44:47], v[144:159]
    ds_read_b64_tr_b16 v[36:37], v17 offset:49152
    ds_read_b64_tr_b16 v[38:39], v17 offset:50176
    s_add_u32 s47, s44, 8192
    buffer_load_dwordx4 a[40:43], v14, s[32:35], s47 offen offset:2048
    s_waitcnt lgkmcnt(6)
    v_mfma_f32_32x32x16_bf16 v[160:175], v[56:59], a[44:47], v[160:175]
    ds_read_b64_tr_b16 v[40:41], v18 offset:49152
    ds_read_b64_tr_b16 v[42:43], v18 offset:50176
    s_waitcnt lgkmcnt(6)
    v_mfma_f32_32x32x16_bf16 v[176:191], v[60:63], a[44:47], v[176:191]
    ds_read_b64_tr_b16 v[44:45], v19 offset:49152
    ds_read_b64_tr_b16 v[46:47], v19 offset:50176
    s_waitcnt vmcnt(23)
    s_waitcnt lgkmcnt(6)
    v_mfma_f32_32x32x16_bf16 v[128:143], v[32:35], a[48:51], v[128:143]
    ds_read_b64_tr_b16 v[48:49], v16 offset:53248
    ds_read_b64_tr_b16 v[50:51], v16 offset:54272
    s_add_u32 s47, s40, 20480
    buffer_load_dwordx4 a[80:83], v14, s[32:35], s47 offen offset:0
    s_waitcnt lgkmcnt(6)
    v_mfma_f32_32x32x16_bf16 v[144:159], v[36:39], a[48:51], v[144:159]
    ds_read_b64_tr_b16 v[52:53], v17 offset:53248
    ds_read_b64_tr_b16 v[54:55], v17 offset:54272
    s_add_u32 s47, s44, 8192
    buffer_load_dwordx4 a[44:47], v14, s[32:35], s47 offen offset:3072
    s_waitcnt lgkmcnt(6)
    v_mfma_f32_32x32x16_bf16 v[160:175], v[40:43], a[48:51], v[160:175]
    ds_read_b64_tr_b16 v[56:57], v18 offset:53248
    ds_read_b64_tr_b16 v[58:59], v18 offset:54272
    s_waitcnt lgkmcnt(6)
    v_mfma_f32_32x32x16_bf16 v[176:191], v[44:47], a[48:51], v[176:191]
    ds_read_b64_tr_b16 v[60:61], v19 offset:53248
    ds_read_b64_tr_b16 v[62:63], v19 offset:54272
    s_waitcnt vmcnt(21)
    s_waitcnt lgkmcnt(6)
    v_mfma_f32_32x32x16_bf16 v[128:143], v[48:51], a[52:55], v[128:143]
    ds_read_b64_tr_b16 v[32:33], v16 offset:57344
    ds_read_b64_tr_b16 v[34:35], v16 offset:58368
    s_add_u32 s47, s40, 20480
    buffer_load_dwordx4 a[84:87], v14, s[32:35], s47 offen offset:1024
    s_waitcnt lgkmcnt(6)
    v_mfma_f32_32x32x16_bf16 v[144:159], v[52:55], a[52:55], v[144:159]
    ds_read_b64_tr_b16 v[36:37], v17 offset:57344
    ds_read_b64_tr_b16 v[38:39], v17 offset:58368
    s_add_u32 s47, s44, 12288
    buffer_load_dwordx4 a[48:51], v14, s[32:35], s47 offen offset:0
    s_waitcnt lgkmcnt(6)
    v_mfma_f32_32x32x16_bf16 v[160:175], v[56:59], a[52:55], v[160:175]
    ds_read_b64_tr_b16 v[40:41], v18 offset:57344
    ds_read_b64_tr_b16 v[42:43], v18 offset:58368
    s_waitcnt lgkmcnt(6)
    v_mfma_f32_32x32x16_bf16 v[176:191], v[60:63], a[52:55], v[176:191]
    ds_read_b64_tr_b16 v[44:45], v19 offset:57344
    ds_read_b64_tr_b16 v[46:47], v19 offset:58368
    s_waitcnt vmcnt(19)
    s_waitcnt lgkmcnt(6)
    v_mfma_f32_32x32x16_bf16 v[128:143], v[32:35], a[56:59], v[128:143]
    ds_read_b64_tr_b16 v[48:49], v16 offset:61440
    ds_read_b64_tr_b16 v[50:51], v16 offset:62464
    s_add_u32 s47, s40, 20480
    buffer_load_dwordx4 a[88:91], v14, s[32:35], s47 offen offset:2048
    s_waitcnt lgkmcnt(6)
    v_mfma_f32_32x32x16_bf16 v[144:159], v[36:39], a[56:59], v[144:159]
    ds_read_b64_tr_b16 v[52:53], v17 offset:61440
    ds_read_b64_tr_b16 v[54:55], v17 offset:62464
    s_add_u32 s47, s44, 12288
    buffer_load_dwordx4 a[52:55], v14, s[32:35], s47 offen offset:1024
    s_waitcnt lgkmcnt(6)
    v_mfma_f32_32x32x16_bf16 v[160:175], v[40:43], a[56:59], v[160:175]
    ds_read_b64_tr_b16 v[56:57], v18 offset:61440
    ds_read_b64_tr_b16 v[58:59], v18 offset:62464
    s_waitcnt lgkmcnt(6)
    v_mfma_f32_32x32x16_bf16 v[176:191], v[44:47], a[56:59], v[176:191]
    ds_read_b64_tr_b16 v[60:61], v19 offset:61440
    ds_read_b64_tr_b16 v[62:63], v19 offset:62464
    s_barrier
    s_waitcnt vmcnt(17)
    s_waitcnt lgkmcnt(6)
    v_mfma_f32_32x32x16_bf16 v[128:143], v[48:51], a[60:63], v[128:143]
    ds_read_b64_tr_b16 v[32:33], v20 offset:0
    ds_read_b64_tr_b16 v[34:35], v20 offset:1024
    s_add_u32 s47, s40, 20480
    buffer_load_dwordx4 a[92:95], v14, s[32:35], s47 offen offset:3072
    s_waitcnt lgkmcnt(6)
    v_mfma_f32_32x32x16_bf16 v[144:159], v[52:55], a[60:63], v[144:159]
    ds_read_b64_tr_b16 v[36:37], v21 offset:0
    ds_read_b64_tr_b16 v[38:39], v21 offset:1024
    s_add_u32 s47, s44, 12288
    buffer_load_dwordx4 a[56:59], v14, s[32:35], s47 offen offset:2048
    s_waitcnt lgkmcnt(6)
    v_mfma_f32_32x32x16_bf16 v[160:175], v[56:59], a[60:63], v[160:175]
    ds_read_b64_tr_b16 v[40:41], v22 offset:0
    ds_read_b64_tr_b16 v[42:43], v22 offset:1024
    s_waitcnt lgkmcnt(6)
    v_mfma_f32_32x32x16_bf16 v[176:191], v[60:63], a[60:63], v[176:191]
    ds_read_b64_tr_b16 v[44:45], v23 offset:0
    ds_read_b64_tr_b16 v[46:47], v23 offset:1024
    s_waitcnt vmcnt(15)
    s_waitcnt lgkmcnt(6)
    v_mfma_f32_32x32x16_bf16 v[128:143], v[32:35], a[64:67], v[128:143]
    ds_read_b64_tr_b16 v[48:49], v20 offset:4096
    ds_read_b64_tr_b16 v[50:51], v20 offset:5120
    s_add_u32 s47, s40, 24576
    buffer_load_dwordx4 a[96:99], v14, s[32:35], s47 offen offset:0
    s_waitcnt lgkmcnt(6)
    v_mfma_f32_32x32x16_bf16 v[144:159], v[36:39], a[64:67], v[144:159]
    ds_read_b64_tr_b16 v[52:53], v21 offset:4096
    ds_read_b64_tr_b16 v[54:55], v21 offset:5120
    s_add_u32 s47, s44, 12288
    buffer_load_dwordx4 a[60:63], v14, s[32:35], s47 offen offset:3072
    s_waitcnt lgkmcnt(6)
    v_mfma_f32_32x32x16_bf16 v[160:175], v[40:43], a[64:67], v[160:175]
    ds_read_b64_tr_b16 v[56:57], v22 offset:4096
    ds_read_b64_tr_b16 v[58:59], v22 offset:5120
    s_waitcnt lgkmcnt(6)
    v_mfma_f32_32x32x16_bf16 v[176:191], v[44:47], a[64:67], v[176:191]
    ds_read_b64_tr_b16 v[60:61], v23 offset:4096
    ds_read_b64_tr_b16 v[62:63], v23 offset:5120
    s_waitcnt vmcnt(15)
    s_waitcnt lgkmcnt(6)
    v_mfma_f32_32x32x16_bf16 v[128:143], v[48:51], a[68:71], v[128:143]
    ds_read_b64_tr_b16 v[32:33], v20 offset:8192
    ds_read_b64_tr_b16 v[34:35], v20 offset:9216
    s_add_u32 s47, s40, 24576
    buffer_load_dwordx4 a[100:103], v14, s[32:35], s47 offen offset:1024
    s_waitcnt lgkmcnt(6)
    v_mfma_f32_32x32x16_bf16 v[144:159], v[52:55], a[68:71], v[144:159]
    ds_read_b64_tr_b16 v[36:37], v21 offset:8192
    ds_read_b64_tr_b16 v[38:39], v21 offset:9216
    s_add_u32 s47, s44, 16384
    buffer_load_dwordx4 a[64:67], v14, s[32:35], s47 offen offset:0
    s_waitcnt lgkmcnt(6)
    v_mfma_f32_32x32x16_bf16 v[160:175], v[56:59], a[68:71], v[160:175]
    ds_read_b64_tr_b16 v[40:41], v22 offset:8192
    ds_read_b64_tr_b16 v[42:43], v22 offset:9216
    s_waitcnt lgkmcnt(6)
    v_mfma_f32_32x32x16_bf16 v[176:191], v[60:63], a[68:71], v[176:191]
    ds_read_b64_tr_b16 v[44:45], v23 offset:8192
    ds_read_b64_tr_b16 v[46:47], v23 offset:9216
    s_waitcnt vmcnt(15)
    s_waitcnt lgkmcnt(6)
    v_mfma_f32_32x32x16_bf16 v[128:143], v[32:35], a[72:75], v[128:143]
    ds_read_b64_tr_b16 v[48:49], v20 offset:12288
    ds_read_b64_tr_b16 v[50:51], v20 offset:13312
    s_add_u32 s47, s40, 24576
    buffer_load_dwordx4 a[104:107], v14, s[32:35], s47 offen offset:2048
    s_waitcnt lgkmcnt(6)
    v_mfma_f32_32x32x16_bf16 v[144:159], v[36:39], a[72:75], v[144:159]
    ds_read_b64_tr_b16 v[52:53], v21 offset:12288
    ds_read_b64_tr_b16 v[54:55], v21 offset:13312
    s_add_u32 s47, s44, 16384
    buffer_load_dwordx4 a[68:71], v14, s[32:35], s47 offen offset:1024
    s_waitcnt lgkmcnt(6)
    v_mfma_f32_32x32x16_bf16 v[160:175], v[40:43], a[72:75], v[160:175]
    ds_read_b64_tr_b16 v[56:57], v22 offset:12288
    ds_read_b64_tr_b16 v[58:59], v22 offset:13312
    s_waitcnt lgkmcnt(6)
    v_mfma_f32_32x32x16_bf16 v[176:191], v[44:47], a[72:75], v[176:191]
    ds_read_b64_tr_b16 v[60:61], v23 offset:12288
    ds_read_b64_tr_b16 v[62:63], v23 offset:13312
    s_waitcnt vmcnt(15)
    s_waitcnt lgkmcnt(6)
    v_mfma_f32_32x32x16_bf16 v[128:143], v[48:51], a[76:79], v[128:143]
    ds_read_b64_tr_b16 v[32:33], v20 offset:16384
    ds_read_b64_tr_b16 v[34:35], v20 offset:17408
    s_add_u32 s47, s40, 24576
    buffer_load_dwordx4 a[108:111], v14, s[32:35], s47 offen offset:3072
    s_waitcnt lgkmcnt(6)
    v_mfma_f32_32x32x16_bf16 v[144:159], v[52:55], a[76:79], v[144:159]
    ds_read_b64_tr_b16 v[36:37], v21 offset:16384
    ds_read_b64_tr_b16 v[38:39], v21 offset:17408
    s_add_u32 s47, s44, 16384
    buffer_load_dwordx4 a[72:75], v14, s[32:35], s47 offen offset:2048
    s_waitcnt lgkmcnt(6)
    v_mfma_f32_32x32x16_bf16 v[160:175], v[56:59], a[76:79], v[160:175]
    ds_read_b64_tr_b16 v[40:41], v22 offset:16384
    ds_read_b64_tr_b16 v[42:43], v22 offset:17408
    s_waitcnt lgkmcnt(6)
    v_mfma_f32_32x32x16_bf16 v[176:191], v[60:63], a[76:79], v[176:191]
    ds_read_b64_tr_b16 v[44:45], v23 offset:16384
    ds_read_b64_tr_b16 v[46:47], v23 offset:17408
    s_waitcnt vmcnt(15)
    s_waitcnt lgkmcnt(6)
    v_mfma_f32_32x32x16_bf16 v[128:143], v[32:35], a[80:83], v[128:143]
    ds_read_b64_tr_b16 v[48:49], v20 offset:20480
    ds_read_b64_tr_b16 v[50:51], v20 offset:21504
    s_add_u32 s47, s40, 28672
    buffer_load_dwordx4 a[112:115], v14, s[32:35], s47 offen offset:0
    s_waitcnt lgkmcnt(6)
    v_mfma_f32_32x32x16_bf16 v[144:159], v[36:39], a[80:83], v[144:159]
    ds_read_b64_tr_b16 v[52:53], v21 offset:20480
    ds_read_b64_tr_b16 v[54:55], v21 offset:21504
    s_add_u32 s47, s44, 16384
    buffer_load_dwordx4 a[76:79], v14, s[32:35], s47 offen offset:3072
    s_waitcnt lgkmcnt(6)
    v_mfma_f32_32x32x16_bf16 v[160:175], v[40:43], a[80:83], v[160:175]
    ds_read_b64_tr_b16 v[56:57], v22 offset:20480
    ds_read_b64_tr_b16 v[58:59], v22 offset:21504
    s_waitcnt lgkmcnt(6)
    v_mfma_f32_32x32x16_bf16 v[176:191], v[44:47], a[80:83], v[176:191]
    ds_read_b64_tr_b16 v[60:61], v23 offset:20480
    ds_read_b64_tr_b16 v[62:63], v23 offset:21504
    s_waitcnt vmcnt(15)
    s_waitcnt lgkmcnt(6)
    v_mfma_f32_32x32x16_bf16 v[128:143], v[48:51], a[84:87], v[128:143]
    ds_read_b64_tr_b16 v[32:33], v20 offset:24576
    ds_read_b64_tr_b16 v[34:35], v20 offset:25600
    s_add_u32 s47, s40, 28672
    buffer_load_dwordx4 a[116:119], v14, s[32:35], s47 offen offset:1024
    s_waitcnt lgkmcnt(6)
    v_mfma_f32_32x32x16_bf16 v[144:159], v[52:55], a[84:87], v[144:159]
    ds_read_b64_tr_b16 v[36:37], v21 offset:24576
    ds_read_b64_tr_b16 v[38:39], v21 offset:25600
    s_add_u32 s47, s44, 20480
    buffer_load_dwordx4 a[80:83], v14, s[32:35], s47 offen offset:0
    s_waitcnt lgkmcnt(6)
    v_mfma_f32_32x32x16_bf16 v[160:175], v[56:59], a[84:87], v[160:175]
    ds_read_b64_tr_b16 v[40:41], v22 offset:24576
    ds_read_b64_tr_b16 v[42:43], v22 offset:25600
    s_waitcnt lgkmcnt(6)
    v_mfma_f32_32x32x16_bf16 v[176:191], v[60:63], a[84:87], v[176:191]
    ds_read_b64_tr_b16 v[44:45], v23 offset:24576
    ds_read_b64_tr_b16 v[46:47], v23 offset:25600
    s_waitcnt vmcnt(15)
    s_waitcnt lgkmcnt(6)
    v_mfma_f32_32x32x16_bf16 v[128:143], v[32:35], a[88:91], v[128:143]
    ds_read_b64_tr_b16 v[48:49], v20 offset:28672
    ds_read_b64_tr_b16 v[50:51], v20 offset:29696
    s_add_u32 s47, s40, 28672
    buffer_load_dwordx4 a[120:123], v14, s[32:35], s47 offen offset:2048
    s_waitcnt lgkmcnt(6)
    v_mfma_f32_32x32x16_bf16 v[144:159], v[36:39], a[88:91], v[144:159]
    ds_read_b64_tr_b16 v[52:53], v21 offset:28672
    ds_read_b64_tr_b16 v[54:55], v21 offset:29696
    s_add_u32 s47, s44, 20480
    buffer_load_dwordx4 a[84:87], v14, s[32:35], s47 offen offset:1024
    s_waitcnt lgkmcnt(6)
    v_mfma_f32_32x32x16_bf16 v[160:175], v[40:43], a[88:91], v[160:175]
    ds_read_b64_tr_b16 v[56:57], v22 offset:28672
    ds_read_b64_tr_b16 v[58:59], v22 offset:29696
    s_waitcnt lgkmcnt(6)
    v_mfma_f32_32x32x16_bf16 v[176:191], v[44:47], a[88:91], v[176:191]
    ds_read_b64_tr_b16 v[60:61], v23 offset:28672
    ds_read_b64_tr_b16 v[62:63], v23 offset:29696
    s_barrier
    s_waitcnt vmcnt(15)
    s_waitcnt lgkmcnt(6)
    v_mfma_f32_32x32x16_bf16 v[128:143], v[48:51], a[92:95], v[128:143]
    ds_read_b64_tr_b16 v[32:33], v20 offset:32768
    ds_read_b64_tr_b16 v[34:35], v20 offset:33792
    s_add_u32 s47, s40, 28672
    buffer_load_dwordx4 a[124:127], v14, s[32:35], s47 offen offset:3072
    s_waitcnt lgkmcnt(6)
    v_mfma_f32_32x32x16_bf16 v[144:159], v[52:55], a[92:95], v[144:159]
    ds_read_b64_tr_b16 v[36:37], v21 offset:32768
    ds_read_b64_tr_b16 v[38:39], v21 offset:33792
    s_add_u32 s47, s44, 20480
    buffer_load_dwordx4 a[88:91], v14, s[32:35], s47 offen offset:2048
    s_waitcnt lgkmcnt(6)
    v_mfma_f32_32x32x16_bf16 v[160:175], v[56:59], a[92:95], v[160:175]
    ds_read_b64_tr_b16 v[40:41], v22 offset:32768
    ds_read_b64_tr_b16 v[42:43], v22 offset:33792
    s_waitcnt lgkmcnt(6)
    v_mfma_f32_32x32x16_bf16 v[176:191], v[60:63], a[92:95], v[176:191]
    ds_read_b64_tr_b16 v[44:45], v23 offset:32768
    ds_read_b64_tr_b16 v[46:47], v23 offset:33792
    s_waitcnt vmcnt(15)
    s_waitcnt lgkmcnt(6)
    v_mfma_f32_32x32x16_bf16 v[128:143], v[32:35], a[96:99], v[128:143]
    ds_read_b64_tr_b16 v[48:49], v20 offset:36864
    ds_read_b64_tr_b16 v[50:51], v20 offset:37888
    s_waitcnt lgkmcnt(6)
    v_mfma_f32_32x32x16_bf16 v[144:159], v[36:39], a[96:99], v[144:159]
    ds_read_b64_tr_b16 v[52:53], v21 offset:36864
    ds_read_b64_tr_b16 v[54:55], v21 offset:37888
    s_add_u32 s47, s44, 20480
    buffer_load_dwordx4 a[92:95], v14, s[32:35], s47 offen offset:3072
    s_waitcnt lgkmcnt(6)
    v_mfma_f32_32x32x16_bf16 v[160:175], v[40:43], a[96:99], v[160:175]
    ds_read_b64_tr_b16 v[56:57], v22 offset:36864
    ds_read_b64_tr_b16 v[58:59], v22 offset:37888
    s_waitcnt lgkmcnt(6)
    v_mfma_f32_32x32x16_bf16 v[176:191], v[44:47], a[96:99], v[176:191]
    ds_read_b64_tr_b16 v[60:61], v23 offset:36864
    ds_read_b64_tr_b16 v[62:63], v23 offset:37888
    s_waitcnt vmcnt(14)
    s_waitcnt lgkmcnt(6)
    v_mfma_f32_32x32x16_bf16 v[128:143], v[48:51], a[100:103], v[128:143]
    ds_read_b64_tr_b16 v[32:33], v20 offset:40960
    ds_read_b64_tr_b16 v[34:35], v20 offset:41984
    s_waitcnt lgkmcnt(6)
    v_mfma_f32_32x32x16_bf16 v[144:159], v[52:55], a[100:103], v[144:159]
    ds_read_b64_tr_b16 v[36:37], v21 offset:40960
    ds_read_b64_tr_b16 v[38:39], v21 offset:41984
    s_add_u32 s47, s44, 24576
    buffer_load_dwordx4 a[96:99], v14, s[32:35], s47 offen offset:0
    s_waitcnt lgkmcnt(6)
    v_mfma_f32_32x32x16_bf16 v[160:175], v[56:59], a[100:103], v[160:175]
    ds_read_b64_tr_b16 v[40:41], v22 offset:40960
    ds_read_b64_tr_b16 v[42:43], v22 offset:41984
    s_waitcnt lgkmcnt(6)
    v_mfma_f32_32x32x16_bf16 v[176:191], v[60:63], a[100:103], v[176:191]
    ds_read_b64_tr_b16 v[44:45], v23 offset:40960
    ds_read_b64_tr_b16 v[46:47], v23 offset:41984
    s_waitcnt vmcnt(13)
    s_waitcnt lgkmcnt(6)
    v_mfma_f32_32x32x16_bf16 v[128:143], v[32:35], a[104:107], v[128:143]
    ds_read_b64_tr_b16 v[48:49], v20 offset:45056
    ds_read_b64_tr_b16 v[50:51], v20 offset:46080
    s_waitcnt lgkmcnt(6)
    v_mfma_f32_32x32x16_bf16 v[144:159], v[36:39], a[104:107], v[144:159]
    ds_read_b64_tr_b16 v[52:53], v21 offset:45056
    ds_read_b64_tr_b16 v[54:55], v21 offset:46080
    s_add_u32 s47, s44, 24576
    buffer_load_dwordx4 a[100:103], v14, s[32:35], s47 offen offset:1024
    s_waitcnt lgkmcnt(6)
    v_mfma_f32_32x32x16_bf16 v[160:175], v[40:43], a[104:107], v[160:175]
    ds_read_b64_tr_b16 v[56:57], v22 offset:45056
    ds_read_b64_tr_b16 v[58:59], v22 offset:46080
    s_waitcnt lgkmcnt(6)
    v_mfma_f32_32x32x16_bf16 v[176:191], v[44:47], a[104:107], v[176:191]
    ds_read_b64_tr_b16 v[60:61], v23 offset:45056
    ds_read_b64_tr_b16 v[62:63], v23 offset:46080
    s_waitcnt vmcnt(12)
    s_waitcnt lgkmcnt(6)
    v_mfma_f32_32x32x16_bf16 v[128:143], v[48:51], a[108:111], v[128:143]
    ds_read_b64_tr_b16 v[32:33], v20 offset:49152
    ds_read_b64_tr_b16 v[34:35], v20 offset:50176
    s_waitcnt lgkmcnt(6)
    v_mfma_f32_32x32x16_bf16 v[144:159], v[52:55], a[108:111], v[144:159]
    ds_read_b64_tr_b16 v[36:37], v21 offset:49152
    ds_read_b64_tr_b16 v[38:39], v21 offset:50176
    s_add_u32 s47, s44, 24576
    buffer_load_dwordx4 a[104:107], v14, s[32:35], s47 offen offset:2048
    s_waitcnt lgkmcnt(6)
    v_mfma_f32_32x32x16_bf16 v[160:175], v[56:59], a[108:111], v[160:175]
    ds_read_b64_tr_b16 v[40:41], v22 offset:49152
    ds_read_b64_tr_b16 v[42:43], v22 offset:50176
    s_waitcnt lgkmcnt(6)
    v_mfma_f32_32x32x16_bf16 v[176:191], v[60:63], a[108:111], v[176:191]
    ds_read_b64_tr_b16 v[44:45], v23 offset:49152
    ds_read_b64_tr_b16 v[46:47], v23 offset:50176
    s_waitcnt vmcnt(11)
    s_waitcnt lgkmcnt(6)
    v_mfma_f32_32x32x16_bf16 v[128:143], v[32:35], a[112:115], v[128:143]
    ds_read_b64_tr_b16 v[48:49], v20 offset:53248
    ds_read_b64_tr_b16 v[50:51], v20 offset:54272
    s_waitcnt lgkmcnt(6)
    v_mfma_f32_32x32x16_bf16 v[144:159], v[36:39], a[112:115], v[144:159]
    ds_read_b64_tr_b16 v[52:53], v21 offset:53248
    ds_read_b64_tr_b16 v[54:55], v21 offset:54272
    s_add_u32 s47, s44, 24576
    buffer_load_dwordx4 a[108:111], v14, s[32:35], s47 offen offset:3072
    s_waitcnt lgkmcnt(6)
    v_mfma_f32_32x32x16_bf16 v[160:175], v[40:43], a[112:115], v[160:175]
    ds_read_b64_tr_b16 v[56:57], v22 offset:53248
    ds_read_b64_tr_b16 v[58:59], v22 offset:54272
    s_waitcnt lgkmcnt(6)
    v_mfma_f32_32x32x16_bf16 v[176:191], v[44:47], a[112:115], v[176:191]
    ds_read_b64_tr_b16 v[60:61], v23 offset:53248
    ds_read_b64_tr_b16 v[62:63], v23 offset:54272
    s_waitcnt vmcnt(10)
    s_waitcnt lgkmcnt(6)
    v_mfma_f32_32x32x16_bf16 v[128:143], v[48:51], a[116:119], v[128:143]
    ds_read_b64_tr_b16 v[32:33], v20 offset:57344
    ds_read_b64_tr_b16 v[34:35], v20 offset:58368
    s_waitcnt lgkmcnt(6)
    v_mfma_f32_32x32x16_bf16 v[144:159], v[52:55], a[116:119], v[144:159]
    ds_read_b64_tr_b16 v[36:37], v21 offset:57344
    ds_read_b64_tr_b16 v[38:39], v21 offset:58368
    s_add_u32 s47, s44, 28672
    buffer_load_dwordx4 a[112:115], v14, s[32:35], s47 offen offset:0
    s_waitcnt lgkmcnt(6)
    v_mfma_f32_32x32x16_bf16 v[160:175], v[56:59], a[116:119], v[160:175]
    ds_read_b64_tr_b16 v[40:41], v22 offset:57344
    ds_read_b64_tr_b16 v[42:43], v22 offset:58368
    s_waitcnt lgkmcnt(6)
    v_mfma_f32_32x32x16_bf16 v[176:191], v[60:63], a[116:119], v[176:191]
    ds_read_b64_tr_b16 v[44:45], v23 offset:57344
    ds_read_b64_tr_b16 v[46:47], v23 offset:58368
    s_waitcnt vmcnt(9)
    s_waitcnt lgkmcnt(6)
    v_mfma_f32_32x32x16_bf16 v[128:143], v[32:35], a[120:123], v[128:143]
    ds_read_b64_tr_b16 v[48:49], v20 offset:61440
    ds_read_b64_tr_b16 v[50:51], v20 offset:62464
    s_waitcnt lgkmcnt(6)
    v_mfma_f32_32x32x16_bf16 v[144:159], v[36:39], a[120:123], v[144:159]
    ds_read_b64_tr_b16 v[52:53], v21 offset:61440
    ds_read_b64_tr_b16 v[54:55], v21 offset:62464
    s_add_u32 s47, s44, 28672
    buffer_load_dwordx4 a[116:119], v14, s[32:35], s47 offen offset:1024
    s_waitcnt lgkmcnt(6)
    v_mfma_f32_32x32x16_bf16 v[160:175], v[40:43], a[120:123], v[160:175]
    ds_read_b64_tr_b16 v[56:57], v22 offset:61440
    ds_read_b64_tr_b16 v[58:59], v22 offset:62464
    s_waitcnt lgkmcnt(6)
    v_mfma_f32_32x32x16_bf16 v[176:191], v[44:47], a[120:123], v[176:191]
    ds_read_b64_tr_b16 v[60:61], v23 offset:61440
    ds_read_b64_tr_b16 v[62:63], v23 offset:62464
    s_waitcnt vmcnt(8)
    s_waitcnt lgkmcnt(6)
    v_mfma_f32_32x32x16_bf16 v[128:143], v[48:51], a[124:127], v[128:143]
    ds_read_b64_tr_b16 v[32:33], v16 offset:0
    ds_read_b64_tr_b16 v[34:35], v16 offset:1024
    s_waitcnt lgkmcnt(6)
    v_mfma_f32_32x32x16_bf16 v[144:159], v[52:55], a[124:127], v[144:159]
    ds_read_b64_tr_b16 v[36:37], v17 offset:0
    ds_read_b64_tr_b16 v[38:39], v17 offset:1024
    s_add_u32 s47, s44, 28672
    buffer_load_dwordx4 a[120:123], v14, s[32:35], s47 offen offset:2048
    s_waitcnt lgkmcnt(6)
    v_mfma_f32_32x32x16_bf16 v[160:175], v[56:59], a[124:127], v[160:175]
    ds_read_b64_tr_b16 v[40:41], v18 offset:0
    ds_read_b64_tr_b16 v[42:43], v18 offset:1024
    s_waitcnt lgkmcnt(6)
    v_mfma_f32_32x32x16_bf16 v[176:191], v[60:63], a[124:127], v[176:191]
    ds_read_b64_tr_b16 v[44:45], v19 offset:0
    ds_read_b64_tr_b16 v[46:47], v19 offset:1024
    s_add_u32 s47, s44, 28672
    buffer_load_dwordx4 a[124:127], v14, s[32:35], s47 offen offset:3072
    s_add_u32 s42, s41, 0
    s_add_u32 s43, s41, 4096
    s_add_u32 s44, s40, 65536
    s_waitcnt lgkmcnt(6)
    v_mfma_f32_32x32x16_bf16 v[192:207], v[32:35], a[0:3], 0
    ds_read_b64_tr_b16 v[48:49], v16 offset:4096
    ds_read_b64_tr_b16 v[50:51], v16 offset:5120
    s_waitcnt lgkmcnt(6)
    v_mfma_f32_32x32x16_bf16 v[208:223], v[36:39], a[0:3], 0
    ds_read_b64_tr_b16 v[52:53], v17 offset:4096
    ds_read_b64_tr_b16 v[54:55], v17 offset:5120
    s_waitcnt lgkmcnt(6)
    v_mfma_f32_32x32x16_bf16 v[224:239], v[40:43], a[0:3], 0
    ds_read_b64_tr_b16 v[56:57], v18 offset:4096
    ds_read_b64_tr_b16 v[58:59], v18 offset:5120
    s_waitcnt lgkmcnt(6)
    v_mfma_f32_32x32x16_bf16 v[240:255], v[44:47], a[0:3], 0
    ds_read_b64_tr_b16 v[60:61], v19 offset:4096
    ds_read_b64_tr_b16 v[62:63], v19 offset:5120
    s_waitcnt lgkmcnt(6)
    v_mfma_f32_32x32x16_bf16 v[192:207], v[48:51], a[4:7], v[192:207]
    ds_read_b64_tr_b16 v[32:33], v16 offset:8192
    ds_read_b64_tr_b16 v[34:35], v16 offset:9216
    s_waitcnt lgkmcnt(6)
    v_mfma_f32_32x32x16_bf16 v[208:223], v[52:55], a[4:7], v[208:223]
    ds_read_b64_tr_b16 v[36:37], v17 offset:8192
    ds_read_b64_tr_b16 v[38:39], v17 offset:9216
    s_add_u32 s47, s44, 0
    buffer_load_dwordx4 a[0:3], v14, s[32:35], s47 offen offset:0
    s_waitcnt lgkmcnt(6)
    v_mfma_f32_32x32x16_bf16 v[224:239], v[56:59], a[4:7], v[224:239]
    ds_read_b64_tr_b16 v[40:41], v18 offset:8192
    ds_read_b64_tr_b16 v[42:43], v18 offset:9216
    v_cvt_pk_bf16_f32 v128, v128, v129
    s_waitcnt lgkmcnt(6)
    v_mfma_f32_32x32x16_bf16 v[240:255], v[60:63], a[4:7], v[240:255]
    ds_read_b64_tr_b16 v[44:45], v19 offset:8192
    ds_read_b64_tr_b16 v[46:47], v19 offset:9216
    v_cvt_pk_bf16_f32 v129, v130, v131
    s_waitcnt lgkmcnt(6)
    v_mfma_f32_32x32x16_bf16 v[192:207], v[32:35], a[8:11], v[192:207]
    ds_read_b64_tr_b16 v[48:49], v16 offset:12288
    ds_read_b64_tr_b16 v[50:51], v16 offset:13312
    s_waitcnt lgkmcnt(6)
    v_mfma_f32_32x32x16_bf16 v[208:223], v[36:39], a[8:11], v[208:223]
    ds_read_b64_tr_b16 v[52:53], v17 offset:12288
    ds_read_b64_tr_b16 v[54:55], v17 offset:13312
    s_add_u32 s47, s44, 0
    buffer_load_dwordx4 a[4:7], v14, s[32:35], s47 offen offset:1024
    s_waitcnt lgkmcnt(6)
    v_mfma_f32_32x32x16_bf16 v[224:239], v[40:43], a[8:11], v[224:239]
    ds_read_b64_tr_b16 v[56:57], v18 offset:12288
    ds_read_b64_tr_b16 v[58:59], v18 offset:13312
    v_cvt_pk_bf16_f32 v130, v132, v133
    s_waitcnt lgkmcnt(6)
    v_mfma_f32_32x32x16_bf16 v[240:255], v[44:47], a[8:11], v[240:255]
    ds_read_b64_tr_b16 v[60:61], v19 offset:12288
    ds_read_b64_tr_b16 v[62:63], v19 offset:13312
    v_cvt_pk_bf16_f32 v131, v134, v135
    s_waitcnt lgkmcnt(6)
    v_mfma_f32_32x32x16_bf16 v[192:207], v[48:51], a[12:15], v[192:207]
    ds_read_b64_tr_b16 v[32:33], v16 offset:16384
    ds_read_b64_tr_b16 v[34:35], v16 offset:17408
    s_waitcnt lgkmcnt(6)
    v_mfma_f32_32x32x16_bf16 v[208:223], v[52:55], a[12:15], v[208:223]
    ds_read_b64_tr_b16 v[36:37], v17 offset:16384
    ds_read_b64_tr_b16 v[38:39], v17 offset:17408
    s_add_u32 s47, s44, 0
    buffer_load_dwordx4 a[8:11], v14, s[32:35], s47 offen offset:2048
    s_waitcnt lgkmcnt(6)
    v_mfma_f32_32x32x16_bf16 v[224:239], v[56:59], a[12:15], v[224:239]
    ds_read_b64_tr_b16 v[40:41], v18 offset:16384
    ds_read_b64_tr_b16 v[42:43], v18 offset:17408
    v_cvt_pk_bf16_f32 v132, v136, v137
    s_waitcnt lgkmcnt(6)
    v_mfma_f32_32x32x16_bf16 v[240:255], v[60:63], a[12:15], v[240:255]
    ds_read_b64_tr_b16 v[44:45], v19 offset:16384
    ds_read_b64_tr_b16 v[46:47], v19 offset:17408
    v_cvt_pk_bf16_f32 v133, v138, v139
    s_waitcnt lgkmcnt(6)
    v_mfma_f32_32x32x16_bf16 v[192:207], v[32:35], a[16:19], v[192:207]
    ds_read_b64_tr_b16 v[48:49], v16 offset:20480
    ds_read_b64_tr_b16 v[50:51], v16 offset:21504
    s_waitcnt lgkmcnt(6)
    v_mfma_f32_32x32x16_bf16 v[208:223], v[36:39], a[16:19], v[208:223]
    ds_read_b64_tr_b16 v[52:53], v17 offset:20480
    ds_read_b64_tr_b16 v[54:55], v17 offset:21504
    s_add_u32 s47, s44, 0
    buffer_load_dwordx4 a[12:15], v14, s[32:35], s47 offen offset:3072
    s_waitcnt lgkmcnt(6)
    v_mfma_f32_32x32x16_bf16 v[224:239], v[40:43], a[16:19], v[224:239]
    ds_read_b64_tr_b16 v[56:57], v18 offset:20480
    ds_read_b64_tr_b16 v[58:59], v18 offset:21504
    v_cvt_pk_bf16_f32 v134, v140, v141
    s_waitcnt lgkmcnt(6)
    v_mfma_f32_32x32x16_bf16 v[240:255], v[44:47], a[16:19], v[240:255]
    ds_read_b64_tr_b16 v[60:61], v19 offset:20480
    ds_read_b64_tr_b16 v[62:63], v19 offset:21504
    v_cvt_pk_bf16_f32 v135, v142, v143
    s_waitcnt lgkmcnt(6)
    v_mfma_f32_32x32x16_bf16 v[192:207], v[48:51], a[20:23], v[192:207]
    ds_read_b64_tr_b16 v[32:33], v16 offset:24576
    ds_read_b64_tr_b16 v[34:35], v16 offset:25600
    s_waitcnt lgkmcnt(6)
    v_mfma_f32_32x32x16_bf16 v[208:223], v[52:55], a[20:23], v[208:223]
    ds_read_b64_tr_b16 v[36:37], v17 offset:24576
    ds_read_b64_tr_b16 v[38:39], v17 offset:25600
    s_add_u32 s47, s44, 4096
    buffer_load_dwordx4 a[16:19], v14, s[32:35], s47 offen offset:0
    s_waitcnt lgkmcnt(6)
    v_mfma_f32_32x32x16_bf16 v[224:239], v[56:59], a[20:23], v[224:239]
    ds_read_b64_tr_b16 v[40:41], v18 offset:24576
    ds_read_b64_tr_b16 v[42:43], v18 offset:25600
    buffer_store_dwordx4 v[128:131], v2, s[32:35], s42 offen offset:0 sc1
    s_waitcnt lgkmcnt(6)
    v_mfma_f32_32x32x16_bf16 v[240:255], v[60:63], a[20:23], v[240:255]
    ds_read_b64_tr_b16 v[44:45], v19 offset:24576
    ds_read_b64_tr_b16 v[46:47], v19 offset:25600
    buffer_store_dwordx4 v[132:135], v2, s[32:35], s42 offen offset:1024 sc1
    s_waitcnt lgkmcnt(6)
    v_mfma_f32_32x32x16_bf16 v[192:207], v[32:35], a[24:27], v[192:207]
    ds_read_b64_tr_b16 v[48:49], v16 offset:28672
    ds_read_b64_tr_b16 v[50:51], v16 offset:29696
    s_waitcnt lgkmcnt(6)
    v_mfma_f32_32x32x16_bf16 v[208:223], v[36:39], a[24:27], v[208:223]
    ds_read_b64_tr_b16 v[52:53], v17 offset:28672
    ds_read_b64_tr_b16 v[54:55], v17 offset:29696
    s_add_u32 s47, s44, 4096
    buffer_load_dwordx4 a[20:23], v14, s[32:35], s47 offen offset:1024
    s_waitcnt lgkmcnt(6)
    v_mfma_f32_32x32x16_bf16 v[224:239], v[40:43], a[24:27], v[224:239]
    ds_read_b64_tr_b16 v[56:57], v18 offset:28672
    ds_read_b64_tr_b16 v[58:59], v18 offset:29696
    v_cvt_pk_bf16_f32 v144, v144, v145
    s_waitcnt lgkmcnt(6)
    v_mfma_f32_32x32x16_bf16 v[240:255], v[44:47], a[24:27], v[240:255]
    ds_read_b64_tr_b16 v[60:61], v19 offset:28672
    ds_read_b64_tr_b16 v[62:63], v19 offset:29696
    v_cvt_pk_bf16_f32 v145, v146, v147
    s_waitcnt lgkmcnt(6)
    v_mfma_f32_32x32x16_bf16 v[192:207], v[48:51], a[28:31], v[192:207]
    ds_read_b64_tr_b16 v[32:33], v16 offset:32768
    ds_read_b64_tr_b16 v[34:35], v16 offset:33792
    s_waitcnt lgkmcnt(6)
    v_mfma_f32_32x32x16_bf16 v[208:223], v[52:55], a[28:31], v[208:223]
    ds_read_b64_tr_b16 v[36:37], v17 offset:32768
    ds_read_b64_tr_b16 v[38:39], v17 offset:33792
    s_add_u32 s47, s44, 4096
    buffer_load_dwordx4 a[24:27], v14, s[32:35], s47 offen offset:2048
    s_waitcnt lgkmcnt(6)
    v_mfma_f32_32x32x16_bf16 v[224:239], v[56:59], a[28:31], v[224:239]
    ds_read_b64_tr_b16 v[40:41], v18 offset:32768
    ds_read_b64_tr_b16 v[42:43], v18 offset:33792
    v_cvt_pk_bf16_f32 v146, v148, v149
    s_waitcnt lgkmcnt(6)
    v_mfma_f32_32x32x16_bf16 v[240:255], v[60:63], a[28:31], v[240:255]
    ds_read_b64_tr_b16 v[44:45], v19 offset:32768
    ds_read_b64_tr_b16 v[46:47], v19 offset:33792
    v_cvt_pk_bf16_f32 v147, v150, v151
    s_waitcnt lgkmcnt(6)
    v_mfma_f32_32x32x16_bf16 v[192:207], v[32:35], a[32:35], v[192:207]
    ds_read_b64_tr_b16 v[48:49], v16 offset:36864
    ds_read_b64_tr_b16 v[50:51], v16 offset:37888
    s_waitcnt lgkmcnt(6)
    v_mfma_f32_32x32x16_bf16 v[208:223], v[36:39], a[32:35], v[208:223]
    ds_read_b64_tr_b16 v[52:53], v17 offset:36864
    ds_read_b64_tr_b16 v[54:55], v17 offset:37888
    s_add_u32 s47, s44, 4096
    buffer_load_dwordx4 a[28:31], v14, s[32:35], s47 offen offset:3072
    s_waitcnt lgkmcnt(6)
    v_mfma_f32_32x32x16_bf16 v[224:239], v[40:43], a[32:35], v[224:239]
    ds_read_b64_tr_b16 v[56:57], v18 offset:36864
    ds_read_b64_tr_b16 v[58:59], v18 offset:37888
    v_cvt_pk_bf16_f32 v148, v152, v153
    s_waitcnt lgkmcnt(6)
    v_mfma_f32_32x32x16_bf16 v[240:255], v[44:47], a[32:35], v[240:255]
    ds_read_b64_tr_b16 v[60:61], v19 offset:36864
    ds_read_b64_tr_b16 v[62:63], v19 offset:37888
    v_cvt_pk_bf16_f32 v149, v154, v155
    s_waitcnt lgkmcnt(6)
    v_mfma_f32_32x32x16_bf16 v[192:207], v[48:51], a[36:39], v[192:207]
    ds_read_b64_tr_b16 v[32:33], v16 offset:40960
    ds_read_b64_tr_b16 v[34:35], v16 offset:41984
    s_waitcnt lgkmcnt(6)
    v_mfma_f32_32x32x16_bf16 v[208:223], v[52:55], a[36:39], v[208:223]
    ds_read_b64_tr_b16 v[36:37], v17 offset:40960
    ds_read_b64_tr_b16 v[38:39], v17 offset:41984
    s_add_u32 s47, s44, 8192
    buffer_load_dwordx4 a[32:35], v14, s[32:35], s47 offen offset:0
    s_waitcnt lgkmcnt(6)
    v_mfma_f32_32x32x16_bf16 v[224:239], v[56:59], a[36:39], v[224:239]
    ds_read_b64_tr_b16 v[40:41], v18 offset:40960
    ds_read_b64_tr_b16 v[42:43], v18 offset:41984
    v_cvt_pk_bf16_f32 v150, v156, v157
    s_waitcnt lgkmcnt(6)
    v_mfma_f32_32x32x16_bf16 v[240:255], v[60:63], a[36:39], v[240:255]
    ds_read_b64_tr_b16 v[44:45], v19 offset:40960
    ds_read_b64_tr_b16 v[46:47], v19 offset:41984
    v_cvt_pk_bf16_f32 v151, v158, v159
    s_waitcnt lgkmcnt(6)
    v_mfma_f32_32x32x16_bf16 v[192:207], v[32:35], a[40:43], v[192:207]
    ds_read_b64_tr_b16 v[48:49], v16 offset:45056
    ds_read_b64_tr_b16 v[50:51], v16 offset:46080
    s_waitcnt lgkmcnt(6)
    v_mfma_f32_32x32x16_bf16 v[208:223], v[36:39], a[40:43], v[208:223]
    ds_read_b64_tr_b16 v[52:53], v17 offset:45056
    ds_read_b64_tr_b16 v[54:55], v17 offset:46080
    s_add_u32 s47, s44, 8192
    buffer_load_dwordx4 a[36:39], v14, s[32:35], s47 offen offset:1024
    s_waitcnt lgkmcnt(6)
    v_mfma_f32_32x32x16_bf16 v[224:239], v[40:43], a[40:43], v[224:239]
    ds_read_b64_tr_b16 v[56:57], v18 offset:45056
    ds_read_b64_tr_b16 v[58:59], v18 offset:46080
    buffer_store_dwordx4 v[144:147], v2, s[32:35], s42 offen offset:2048 sc1
    s_waitcnt lgkmcnt(6)
    v_mfma_f32_32x32x16_bf16 v[240:255], v[44:47], a[40:43], v[240:255]
    ds_read_b64_tr_b16 v[60:61], v19 offset:45056
    ds_read_b64_tr_b16 v[62:63], v19 offset:46080
    buffer_store_dwordx4 v[148:151], v2, s[32:35], s42 offen offset:3072 sc1
    s_waitcnt lgkmcnt(6)
    v_mfma_f32_32x32x16_bf16 v[192:207], v[48:51], a[44:47], v[192:207]
    ds_read_b64_tr_b16 v[32:33], v16 offset:49152
    ds_read_b64_tr_b16 v[34:35], v16 offset:50176
    s_waitcnt lgkmcnt(6)
    v_mfma_f32_32x32x16_bf16 v[208:223], v[52:55], a[44:47], v[208:223]
    ds_read_b64_tr_b16 v[36:37], v17 offset:49152
    ds_read_b64_tr_b16 v[38:39], v17 offset:50176
    s_add_u32 s47, s44, 8192
    buffer_load_dwordx4 a[40:43], v14, s[32:35], s47 offen offset:2048
    s_waitcnt lgkmcnt(6)
    v_mfma_f32_32x32x16_bf16 v[224:239], v[56:59], a[44:47], v[224:239]
    ds_read_b64_tr_b16 v[40:41], v18 offset:49152
    ds_read_b64_tr_b16 v[42:43], v18 offset:50176
    v_cvt_pk_bf16_f32 v160, v160, v161
    s_waitcnt lgkmcnt(6)
    v_mfma_f32_32x32x16_bf16 v[240:255], v[60:63], a[44:47], v[240:255]
    ds_read_b64_tr_b16 v[44:45], v19 offset:49152
    ds_read_b64_tr_b16 v[46:47], v19 offset:50176
    v_cvt_pk_bf16_f32 v161, v162, v163
    s_waitcnt lgkmcnt(6)
    v_mfma_f32_32x32x16_bf16 v[192:207], v[32:35], a[48:51], v[192:207]
    ds_read_b64_tr_b16 v[48:49], v16 offset:53248
    ds_read_b64_tr_b16 v[50:51], v16 offset:54272
    s_waitcnt lgkmcnt(6)
    v_mfma_f32_32x32x16_bf16 v[208:223], v[36:39], a[48:51], v[208:223]
    ds_read_b64_tr_b16 v[52:53], v17 offset:53248
    ds_read_b64_tr_b16 v[54:55], v17 offset:54272
    s_add_u32 s47, s44, 8192
    buffer_load_dwordx4 a[44:47], v14, s[32:35], s47 offen offset:3072
    s_waitcnt lgkmcnt(6)
    v_mfma_f32_32x32x16_bf16 v[224:239], v[40:43], a[48:51], v[224:239]
    ds_read_b64_tr_b16 v[56:57], v18 offset:53248
    ds_read_b64_tr_b16 v[58:59], v18 offset:54272
    v_cvt_pk_bf16_f32 v162, v164, v165
    s_waitcnt lgkmcnt(6)
    v_mfma_f32_32x32x16_bf16 v[240:255], v[44:47], a[48:51], v[240:255]
    ds_read_b64_tr_b16 v[60:61], v19 offset:53248
    ds_read_b64_tr_b16 v[62:63], v19 offset:54272
    v_cvt_pk_bf16_f32 v163, v166, v167
    s_waitcnt lgkmcnt(6)
    v_mfma_f32_32x32x16_bf16 v[192:207], v[48:51], a[52:55], v[192:207]
    ds_read_b64_tr_b16 v[32:33], v16 offset:57344
    ds_read_b64_tr_b16 v[34:35], v16 offset:58368
    s_waitcnt lgkmcnt(6)
    v_mfma_f32_32x32x16_bf16 v[208:223], v[52:55], a[52:55], v[208:223]
    ds_read_b64_tr_b16 v[36:37], v17 offset:57344
    ds_read_b64_tr_b16 v[38:39], v17 offset:58368
    s_add_u32 s47, s44, 12288
    buffer_load_dwordx4 a[48:51], v14, s[32:35], s47 offen offset:0
    s_waitcnt lgkmcnt(6)
    v_mfma_f32_32x32x16_bf16 v[224:239], v[56:59], a[52:55], v[224:239]
    ds_read_b64_tr_b16 v[40:41], v18 offset:57344
    ds_read_b64_tr_b16 v[42:43], v18 offset:58368
    v_cvt_pk_bf16_f32 v164, v168, v169
    s_waitcnt lgkmcnt(6)
    v_mfma_f32_32x32x16_bf16 v[240:255], v[60:63], a[52:55], v[240:255]
    ds_read_b64_tr_b16 v[44:45], v19 offset:57344
    ds_read_b64_tr_b16 v[46:47], v19 offset:58368
    v_cvt_pk_bf16_f32 v165, v170, v171
    s_waitcnt lgkmcnt(6)
    v_mfma_f32_32x32x16_bf16 v[192:207], v[32:35], a[56:59], v[192:207]
    ds_read_b64_tr_b16 v[48:49], v16 offset:61440
    ds_read_b64_tr_b16 v[50:51], v16 offset:62464
    s_waitcnt lgkmcnt(6)
    v_mfma_f32_32x32x16_bf16 v[208:223], v[36:39], a[56:59], v[208:223]
    ds_read_b64_tr_b16 v[52:53], v17 offset:61440
    ds_read_b64_tr_b16 v[54:55], v17 offset:62464
    s_add_u32 s47, s44, 12288
    buffer_load_dwordx4 a[52:55], v14, s[32:35], s47 offen offset:1024
    s_waitcnt lgkmcnt(6)
    v_mfma_f32_32x32x16_bf16 v[224:239], v[40:43], a[56:59], v[224:239]
    ds_read_b64_tr_b16 v[56:57], v18 offset:61440
    ds_read_b64_tr_b16 v[58:59], v18 offset:62464
    v_cvt_pk_bf16_f32 v166, v172, v173
    s_waitcnt lgkmcnt(6)
    v_mfma_f32_32x32x16_bf16 v[240:255], v[44:47], a[56:59], v[240:255]
    ds_read_b64_tr_b16 v[60:61], v19 offset:61440
    ds_read_b64_tr_b16 v[62:63], v19 offset:62464
    v_cvt_pk_bf16_f32 v167, v174, v175
    s_waitcnt lgkmcnt(6)
    v_mfma_f32_32x32x16_bf16 v[192:207], v[48:51], a[60:63], v[192:207]
    ds_read_b64_tr_b16 v[32:33], v20 offset:0
    ds_read_b64_tr_b16 v[34:35], v20 offset:1024
    s_waitcnt lgkmcnt(6)
    v_mfma_f32_32x32x16_bf16 v[208:223], v[52:55], a[60:63], v[208:223]
    ds_read_b64_tr_b16 v[36:37], v21 offset:0
    ds_read_b64_tr_b16 v[38:39], v21 offset:1024
    s_add_u32 s47, s44, 12288
    buffer_load_dwordx4 a[56:59], v14, s[32:35], s47 offen offset:2048
    s_waitcnt lgkmcnt(6)
    v_mfma_f32_32x32x16_bf16 v[224:239], v[56:59], a[60:63], v[224:239]
    ds_read_b64_tr_b16 v[40:41], v22 offset:0
    ds_read_b64_tr_b16 v[42:43], v22 offset:1024
    buffer_store_dwordx4 v[160:163], v2, s[32:35], s43 offen offset:0 sc1
    s_waitcnt lgkmcnt(6)
    v_mfma_f32_32x32x16_bf16 v[240:255], v[60:63], a[60:63], v[240:255]
    ds_read_b64_tr_b16 v[44:45], v23 offset:0
    ds_read_b64_tr_b16 v[46:47], v23 offset:1024
    buffer_store_dwordx4 v[164:167], v2, s[32:35], s43 offen offset:1024 sc1
    s_waitcnt lgkmcnt(6)
    v_mfma_f32_32x32x16_bf16 v[192:207], v[32:35], a[64:67], v[192:207]
    ds_read_b64_tr_b16 v[48:49], v20 offset:4096
    ds_read_b64_tr_b16 v[50:51], v20 offset:5120
    s_waitcnt lgkmcnt(6)
    v_mfma_f32_32x32x16_bf16 v[208:223], v[36:39], a[64:67], v[208:223]
    ds_read_b64_tr_b16 v[52:53], v21 offset:4096
    ds_read_b64_tr_b16 v[54:55], v21 offset:5120
    s_add_u32 s47, s44, 12288
    buffer_load_dwordx4 a[60:63], v14, s[32:35], s47 offen offset:3072
    s_waitcnt lgkmcnt(6)
    v_mfma_f32_32x32x16_bf16 v[224:239], v[40:43], a[64:67], v[224:239]
    ds_read_b64_tr_b16 v[56:57], v22 offset:4096
    ds_read_b64_tr_b16 v[58:59], v22 offset:5120
    v_cvt_pk_bf16_f32 v176, v176, v177
    s_waitcnt lgkmcnt(6)
    v_mfma_f32_32x32x16_bf16 v[240:255], v[44:47], a[64:67], v[240:255]
    ds_read_b64_tr_b16 v[60:61], v23 offset:4096
    ds_read_b64_tr_b16 v[62:63], v23 offset:5120
    v_cvt_pk_bf16_f32 v177, v178, v179
    s_waitcnt lgkmcnt(6)
    v_mfma_f32_32x32x16_bf16 v[192:207], v[48:51], a[68:71], v[192:207]
    ds_read_b64_tr_b16 v[32:33], v20 offset:8192
    ds_read_b64_tr_b16 v[34:35], v20 offset:9216
    s_waitcnt lgkmcnt(6)
    v_mfma_f32_32x32x16_bf16 v[208:223], v[52:55], a[68:71], v[208:223]
    ds_read_b64_tr_b16 v[36:37], v21 offset:8192
    ds_read_b64_tr_b16 v[38:39], v21 offset:9216
    s_add_u32 s47, s44, 16384
    buffer_load_dwordx4 a[64:67], v14, s[32:35], s47 offen offset:0
    s_waitcnt lgkmcnt(6)
    v_mfma_f32_32x32x16_bf16 v[224:239], v[56:59], a[68:71], v[224:239]
    ds_read_b64_tr_b16 v[40:41], v22 offset:8192
    ds_read_b64_tr_b16 v[42:43], v22 offset:9216
    v_cvt_pk_bf16_f32 v178, v180, v181
    s_waitcnt lgkmcnt(6)
    v_mfma_f32_32x32x16_bf16 v[240:255], v[60:63], a[68:71], v[240:255]
    ds_read_b64_tr_b16 v[44:45], v23 offset:8192
    ds_read_b64_tr_b16 v[46:47], v23 offset:9216
    v_cvt_pk_bf16_f32 v179, v182, v183
    s_waitcnt lgkmcnt(6)
    v_mfma_f32_32x32x16_bf16 v[192:207], v[32:35], a[72:75], v[192:207]
    ds_read_b64_tr_b16 v[48:49], v20 offset:12288
    ds_read_b64_tr_b16 v[50:51], v20 offset:13312
    s_waitcnt lgkmcnt(6)
    v_mfma_f32_32x32x16_bf16 v[208:223], v[36:39], a[72:75], v[208:223]
    ds_read_b64_tr_b16 v[52:53], v21 offset:12288
    ds_read_b64_tr_b16 v[54:55], v21 offset:13312
    s_add_u32 s47, s44, 16384
    buffer_load_dwordx4 a[68:71], v14, s[32:35], s47 offen offset:1024
    s_waitcnt lgkmcnt(6)
    v_mfma_f32_32x32x16_bf16 v[224:239], v[40:43], a[72:75], v[224:239]
    ds_read_b64_tr_b16 v[56:57], v22 offset:12288
    ds_read_b64_tr_b16 v[58:59], v22 offset:13312
    v_cvt_pk_bf16_f32 v180, v184, v185
    s_waitcnt lgkmcnt(6)
    v_mfma_f32_32x32x16_bf16 v[240:255], v[44:47], a[72:75], v[240:255]
    ds_read_b64_tr_b16 v[60:61], v23 offset:12288
    ds_read_b64_tr_b16 v[62:63], v23 offset:13312
    v_cvt_pk_bf16_f32 v181, v186, v187
    s_waitcnt lgkmcnt(6)
    v_mfma_f32_32x32x16_bf16 v[192:207], v[48:51], a[76:79], v[192:207]
    ds_read_b64_tr_b16 v[32:33], v20 offset:16384
    ds_read_b64_tr_b16 v[34:35], v20 offset:17408
    s_waitcnt lgkmcnt(6)
    v_mfma_f32_32x32x16_bf16 v[208:223], v[52:55], a[76:79], v[208:223]
    ds_read_b64_tr_b16 v[36:37], v21 offset:16384
    ds_read_b64_tr_b16 v[38:39], v21 offset:17408
    s_add_u32 s47, s44, 16384
    buffer_load_dwordx4 a[72:75], v14, s[32:35], s47 offen offset:2048
    s_waitcnt lgkmcnt(6)
    v_mfma_f32_32x32x16_bf16 v[224:239], v[56:59], a[76:79], v[224:239]
    ds_read_b64_tr_b16 v[40:41], v22 offset:16384
    ds_read_b64_tr_b16 v[42:43], v22 offset:17408
    v_cvt_pk_bf16_f32 v182, v188, v189
    s_waitcnt lgkmcnt(6)
    v_mfma_f32_32x32x16_bf16 v[240:255], v[60:63], a[76:79], v[240:255]
    ds_read_b64_tr_b16 v[44:45], v23 offset:16384
    ds_read_b64_tr_b16 v[46:47], v23 offset:17408
    v_cvt_pk_bf16_f32 v183, v190, v191
    s_waitcnt lgkmcnt(6)
    v_mfma_f32_32x32x16_bf16 v[192:207], v[32:35], a[80:83], v[192:207]
    ds_read_b64_tr_b16 v[48:49], v20 offset:20480
    ds_read_b64_tr_b16 v[50:51], v20 offset:21504
    s_waitcnt lgkmcnt(6)
    v_mfma_f32_32x32x16_bf16 v[208:223], v[36:39], a[80:83], v[208:223]
    ds_read_b64_tr_b16 v[52:53], v21 offset:20480
    ds_read_b64_tr_b16 v[54:55], v21 offset:21504
    s_add_u32 s47, s44, 16384
    buffer_load_dwordx4 a[76:79], v14, s[32:35], s47 offen offset:3072
    s_waitcnt lgkmcnt(6)
    v_mfma_f32_32x32x16_bf16 v[224:239], v[40:43], a[80:83], v[224:239]
    ds_read_b64_tr_b16 v[56:57], v22 offset:20480
    ds_read_b64_tr_b16 v[58:59], v22 offset:21504
    buffer_store_dwordx4 v[176:179], v2, s[32:35], s43 offen offset:2048 sc1
    s_waitcnt lgkmcnt(6)
    v_mfma_f32_32x32x16_bf16 v[240:255], v[44:47], a[80:83], v[240:255]
    ds_read_b64_tr_b16 v[60:61], v23 offset:20480
    ds_read_b64_tr_b16 v[62:63], v23 offset:21504
    buffer_store_dwordx4 v[180:183], v2, s[32:35], s43 offen offset:3072 sc1
    s_waitcnt lgkmcnt(6)
    v_mfma_f32_32x32x16_bf16 v[192:207], v[48:51], a[84:87], v[192:207]
    ds_read_b64_tr_b16 v[32:33], v20 offset:24576
    ds_read_b64_tr_b16 v[34:35], v20 offset:25600
    s_waitcnt lgkmcnt(6)
    v_mfma_f32_32x32x16_bf16 v[208:223], v[52:55], a[84:87], v[208:223]
    ds_read_b64_tr_b16 v[36:37], v21 offset:24576
    ds_read_b64_tr_b16 v[38:39], v21 offset:25600
    s_add_u32 s47, s44, 20480
    buffer_load_dwordx4 a[80:83], v14, s[32:35], s47 offen offset:0
    s_waitcnt lgkmcnt(6)
    v_mfma_f32_32x32x16_bf16 v[224:239], v[56:59], a[84:87], v[224:239]
    ds_read_b64_tr_b16 v[40:41], v22 offset:24576
    ds_read_b64_tr_b16 v[42:43], v22 offset:25600
    s_waitcnt lgkmcnt(6)
    v_mfma_f32_32x32x16_bf16 v[240:255], v[60:63], a[84:87], v[240:255]
    ds_read_b64_tr_b16 v[44:45], v23 offset:24576
    ds_read_b64_tr_b16 v[46:47], v23 offset:25600
    s_waitcnt vmcnt(38)
    s_waitcnt lgkmcnt(6)
    v_mfma_f32_32x32x16_bf16 v[192:207], v[32:35], a[88:91], v[192:207]
    ds_read_b64_tr_b16 v[48:49], v20 offset:28672
    ds_read_b64_tr_b16 v[50:51], v20 offset:29696
    s_waitcnt lgkmcnt(6)
    v_mfma_f32_32x32x16_bf16 v[208:223], v[36:39], a[88:91], v[208:223]
    ds_read_b64_tr_b16 v[52:53], v21 offset:28672
    ds_read_b64_tr_b16 v[54:55], v21 offset:29696
    s_add_u32 s47, s44, 20480
    buffer_load_dwordx4 a[84:87], v14, s[32:35], s47 offen offset:1024
    s_waitcnt lgkmcnt(6)
    v_mfma_f32_32x32x16_bf16 v[224:239], v[40:43], a[88:91], v[224:239]
    ds_read_b64_tr_b16 v[56:57], v22 offset:28672
    ds_read_b64_tr_b16 v[58:59], v22 offset:29696
    s_waitcnt lgkmcnt(6)
    v_mfma_f32_32x32x16_bf16 v[240:255], v[44:47], a[88:91], v[240:255]
    ds_read_b64_tr_b16 v[60:61], v23 offset:28672
    ds_read_b64_tr_b16 v[62:63], v23 offset:29696
    s_waitcnt vmcnt(38)
    s_waitcnt lgkmcnt(6)
    v_mfma_f32_32x32x16_bf16 v[192:207], v[48:51], a[92:95], v[192:207]
    ds_read_b64_tr_b16 v[32:33], v20 offset:32768
    ds_read_b64_tr_b16 v[34:35], v20 offset:33792
    s_waitcnt lgkmcnt(6)
    v_mfma_f32_32x32x16_bf16 v[208:223], v[52:55], a[92:95], v[208:223]
    ds_read_b64_tr_b16 v[36:37], v21 offset:32768
    ds_read_b64_tr_b16 v[38:39], v21 offset:33792
    s_add_u32 s47, s44, 20480
    buffer_load_dwordx4 a[88:91], v14, s[32:35], s47 offen offset:2048
    s_waitcnt lgkmcnt(6)
    v_mfma_f32_32x32x16_bf16 v[224:239], v[56:59], a[92:95], v[224:239]
    ds_read_b64_tr_b16 v[40:41], v22 offset:32768
    ds_read_b64_tr_b16 v[42:43], v22 offset:33792
    s_waitcnt lgkmcnt(6)
    v_mfma_f32_32x32x16_bf16 v[240:255], v[60:63], a[92:95], v[240:255]
    ds_read_b64_tr_b16 v[44:45], v23 offset:32768
    ds_read_b64_tr_b16 v[46:47], v23 offset:33792
    s_waitcnt vmcnt(38)
    s_waitcnt lgkmcnt(6)
    v_mfma_f32_32x32x16_bf16 v[192:207], v[32:35], a[96:99], v[192:207]
    ds_read_b64_tr_b16 v[48:49], v20 offset:36864
    ds_read_b64_tr_b16 v[50:51], v20 offset:37888
    s_waitcnt lgkmcnt(6)
    v_mfma_f32_32x32x16_bf16 v[208:223], v[36:39], a[96:99], v[208:223]
    ds_read_b64_tr_b16 v[52:53], v21 offset:36864
    ds_read_b64_tr_b16 v[54:55], v21 offset:37888
    s_add_u32 s47, s44, 20480
    buffer_load_dwordx4 a[92:95], v14, s[32:35], s47 offen offset:3072
    s_waitcnt lgkmcnt(6)
    v_mfma_f32_32x32x16_bf16 v[224:239], v[40:43], a[96:99], v[224:239]
    ds_read_b64_tr_b16 v[56:57], v22 offset:36864
    ds_read_b64_tr_b16 v[58:59], v22 offset:37888
    s_waitcnt lgkmcnt(6)
    v_mfma_f32_32x32x16_bf16 v[240:255], v[44:47], a[96:99], v[240:255]
    ds_read_b64_tr_b16 v[60:61], v23 offset:36864
    ds_read_b64_tr_b16 v[62:63], v23 offset:37888
    s_waitcnt vmcnt(38)
    s_waitcnt lgkmcnt(6)
    v_mfma_f32_32x32x16_bf16 v[192:207], v[48:51], a[100:103], v[192:207]
    ds_read_b64_tr_b16 v[32:33], v20 offset:40960
    ds_read_b64_tr_b16 v[34:35], v20 offset:41984
    s_waitcnt lgkmcnt(6)
    v_mfma_f32_32x32x16_bf16 v[208:223], v[52:55], a[100:103], v[208:223]
    ds_read_b64_tr_b16 v[36:37], v21 offset:40960
    ds_read_b64_tr_b16 v[38:39], v21 offset:41984
    s_add_u32 s47, s44, 24576
    buffer_load_dwordx4 a[96:99], v14, s[32:35], s47 offen offset:0
    s_waitcnt lgkmcnt(6)
    v_mfma_f32_32x32x16_bf16 v[224:239], v[56:59], a[100:103], v[224:239]
    ds_read_b64_tr_b16 v[40:41], v22 offset:40960
    ds_read_b64_tr_b16 v[42:43], v22 offset:41984
    s_waitcnt lgkmcnt(6)
    v_mfma_f32_32x32x16_bf16 v[240:255], v[60:63], a[100:103], v[240:255]
    ds_read_b64_tr_b16 v[44:45], v23 offset:40960
    ds_read_b64_tr_b16 v[46:47], v23 offset:41984
    s_waitcnt vmcnt(38)
    s_waitcnt lgkmcnt(6)
    v_mfma_f32_32x32x16_bf16 v[192:207], v[32:35], a[104:107], v[192:207]
    ds_read_b64_tr_b16 v[48:49], v20 offset:45056
    ds_read_b64_tr_b16 v[50:51], v20 offset:46080
    s_waitcnt lgkmcnt(6)
    v_mfma_f32_32x32x16_bf16 v[208:223], v[36:39], a[104:107], v[208:223]
    ds_read_b64_tr_b16 v[52:53], v21 offset:45056
    ds_read_b64_tr_b16 v[54:55], v21 offset:46080
    s_add_u32 s47, s44, 24576
    buffer_load_dwordx4 a[100:103], v14, s[32:35], s47 offen offset:1024
    s_waitcnt lgkmcnt(6)
    v_mfma_f32_32x32x16_bf16 v[224:239], v[40:43], a[104:107], v[224:239]
    ds_read_b64_tr_b16 v[56:57], v22 offset:45056
    ds_read_b64_tr_b16 v[58:59], v22 offset:46080
    s_waitcnt lgkmcnt(6)
    v_mfma_f32_32x32x16_bf16 v[240:255], v[44:47], a[104:107], v[240:255]
    ds_read_b64_tr_b16 v[60:61], v23 offset:45056
    ds_read_b64_tr_b16 v[62:63], v23 offset:46080
    s_waitcnt vmcnt(38)
    s_waitcnt lgkmcnt(6)
    v_mfma_f32_32x32x16_bf16 v[192:207], v[48:51], a[108:111], v[192:207]
    ds_read_b64_tr_b16 v[32:33], v20 offset:49152
    ds_read_b64_tr_b16 v[34:35], v20 offset:50176
    s_waitcnt lgkmcnt(6)
    v_mfma_f32_32x32x16_bf16 v[208:223], v[52:55], a[108:111], v[208:223]
    ds_read_b64_tr_b16 v[36:37], v21 offset:49152
    ds_read_b64_tr_b16 v[38:39], v21 offset:50176
    s_add_u32 s47, s44, 24576
    buffer_load_dwordx4 a[104:107], v14, s[32:35], s47 offen offset:2048
    s_waitcnt lgkmcnt(6)
    v_mfma_f32_32x32x16_bf16 v[224:239], v[56:59], a[108:111], v[224:239]
    ds_read_b64_tr_b16 v[40:41], v22 offset:49152
    ds_read_b64_tr_b16 v[42:43], v22 offset:50176
    s_waitcnt lgkmcnt(6)
    v_mfma_f32_32x32x16_bf16 v[240:255], v[60:63], a[108:111], v[240:255]
    ds_read_b64_tr_b16 v[44:45], v23 offset:49152
    ds_read_b64_tr_b16 v[46:47], v23 offset:50176
    s_waitcnt vmcnt(38)
    s_waitcnt lgkmcnt(6)
    v_mfma_f32_32x32x16_bf16 v[192:207], v[32:35], a[112:115], v[192:207]
    ds_read_b64_tr_b16 v[48:49], v20 offset:53248
    ds_read_b64_tr_b16 v[50:51], v20 offset:54272
    s_waitcnt lgkmcnt(6)
    v_mfma_f32_32x32x16_bf16 v[208:223], v[36:39], a[112:115], v[208:223]
    ds_read_b64_tr_b16 v[52:53], v21 offset:53248
    ds_read_b64_tr_b16 v[54:55], v21 offset:54272
    s_add_u32 s47, s44, 24576
    buffer_load_dwordx4 a[108:111], v14, s[32:35], s47 offen offset:3072
    s_waitcnt lgkmcnt(6)
    v_mfma_f32_32x32x16_bf16 v[224:239], v[40:43], a[112:115], v[224:239]
    ds_read_b64_tr_b16 v[56:57], v22 offset:53248
    ds_read_b64_tr_b16 v[58:59], v22 offset:54272
    s_waitcnt lgkmcnt(6)
    v_mfma_f32_32x32x16_bf16 v[240:255], v[44:47], a[112:115], v[240:255]
    ds_read_b64_tr_b16 v[60:61], v23 offset:53248
    ds_read_b64_tr_b16 v[62:63], v23 offset:54272
    s_waitcnt vmcnt(38)
    s_waitcnt lgkmcnt(6)
    v_mfma_f32_32x32x16_bf16 v[192:207], v[48:51], a[116:119], v[192:207]
    ds_read_b64_tr_b16 v[32:33], v20 offset:57344
    ds_read_b64_tr_b16 v[34:35], v20 offset:58368
    s_waitcnt lgkmcnt(6)
    v_mfma_f32_32x32x16_bf16 v[208:223], v[52:55], a[116:119], v[208:223]
    ds_read_b64_tr_b16 v[36:37], v21 offset:57344
    ds_read_b64_tr_b16 v[38:39], v21 offset:58368
    s_add_u32 s47, s44, 28672
    buffer_load_dwordx4 a[112:115], v14, s[32:35], s47 offen offset:0
    s_waitcnt lgkmcnt(6)
    v_mfma_f32_32x32x16_bf16 v[224:239], v[56:59], a[116:119], v[224:239]
    ds_read_b64_tr_b16 v[40:41], v22 offset:57344
    ds_read_b64_tr_b16 v[42:43], v22 offset:58368
    s_waitcnt lgkmcnt(6)
    v_mfma_f32_32x32x16_bf16 v[240:255], v[60:63], a[116:119], v[240:255]
    ds_read_b64_tr_b16 v[44:45], v23 offset:57344
    ds_read_b64_tr_b16 v[46:47], v23 offset:58368
    s_waitcnt vmcnt(38)
    s_waitcnt lgkmcnt(6)
    v_mfma_f32_32x32x16_bf16 v[192:207], v[32:35], a[120:123], v[192:207]
    ds_read_b64_tr_b16 v[48:49], v20 offset:61440
    ds_read_b64_tr_b16 v[50:51], v20 offset:62464
    s_waitcnt lgkmcnt(6)
    v_mfma_f32_32x32x16_bf16 v[208:223], v[36:39], a[120:123], v[208:223]
    ds_read_b64_tr_b16 v[52:53], v21 offset:61440
    ds_read_b64_tr_b16 v[54:55], v21 offset:62464
    s_add_u32 s47, s44, 28672
    buffer_load_dwordx4 a[116:119], v14, s[32:35], s47 offen offset:1024
    s_waitcnt lgkmcnt(6)
    v_mfma_f32_32x32x16_bf16 v[224:239], v[40:43], a[120:123], v[224:239]
    ds_read_b64_tr_b16 v[56:57], v22 offset:61440
    ds_read_b64_tr_b16 v[58:59], v22 offset:62464
    s_waitcnt lgkmcnt(6)
    v_mfma_f32_32x32x16_bf16 v[240:255], v[44:47], a[120:123], v[240:255]
    ds_read_b64_tr_b16 v[60:61], v23 offset:61440
    ds_read_b64_tr_b16 v[62:63], v23 offset:62464
    s_waitcnt vmcnt(38)
    s_waitcnt lgkmcnt(6)
    v_mfma_f32_32x32x16_bf16 v[192:207], v[48:51], a[124:127], v[192:207]
    ds_read_b64_tr_b16 v[32:33], v16 offset:0
    ds_read_b64_tr_b16 v[34:35], v16 offset:1024
    s_waitcnt lgkmcnt(6)
    v_mfma_f32_32x32x16_bf16 v[208:223], v[52:55], a[124:127], v[208:223]
    ds_read_b64_tr_b16 v[36:37], v17 offset:0
    ds_read_b64_tr_b16 v[38:39], v17 offset:1024
    s_add_u32 s47, s44, 28672
    buffer_load_dwordx4 a[120:123], v14, s[32:35], s47 offen offset:2048
    s_waitcnt lgkmcnt(6)
    v_mfma_f32_32x32x16_bf16 v[224:239], v[56:59], a[124:127], v[224:239]
    ds_read_b64_tr_b16 v[40:41], v18 offset:0
    ds_read_b64_tr_b16 v[42:43], v18 offset:1024
    s_waitcnt lgkmcnt(6)
    v_mfma_f32_32x32x16_bf16 v[240:255], v[60:63], a[124:127], v[240:255]
    ds_read_b64_tr_b16 v[44:45], v19 offset:0
    ds_read_b64_tr_b16 v[46:47], v19 offset:1024
    s_add_u32 s47, s44, 28672
    buffer_load_dwordx4 a[124:127], v14, s[32:35], s47 offen offset:3072
    s_add_u32 s42, s41, 16384
    s_add_u32 s43, s41, 20480
    s_add_u32 s44, s40, 98304
    s_waitcnt vmcnt(39)
    s_waitcnt lgkmcnt(6)
    v_mfma_f32_32x32x16_bf16 v[128:143], v[32:35], a[0:3], 0
    ds_read_b64_tr_b16 v[48:49], v16 offset:4096
    ds_read_b64_tr_b16 v[50:51], v16 offset:5120
    s_waitcnt lgkmcnt(6)
    v_mfma_f32_32x32x16_bf16 v[144:159], v[36:39], a[0:3], 0
    ds_read_b64_tr_b16 v[52:53], v17 offset:4096
    ds_read_b64_tr_b16 v[54:55], v17 offset:5120
    s_waitcnt lgkmcnt(6)
    v_mfma_f32_32x32x16_bf16 v[160:175], v[40:43], a[0:3], 0
    ds_read_b64_tr_b16 v[56:57], v18 offset:4096
    ds_read_b64_tr_b16 v[58:59], v18 offset:5120
    s_waitcnt lgkmcnt(6)
    v_mfma_f32_32x32x16_bf16 v[176:191], v[44:47], a[0:3], 0
    ds_read_b64_tr_b16 v[60:61], v19 offset:4096
    ds_read_b64_tr_b16 v[62:63], v19 offset:5120
    s_waitcnt vmcnt(38)
    s_waitcnt lgkmcnt(6)
    v_mfma_f32_32x32x16_bf16 v[128:143], v[48:51], a[4:7], v[128:143]
    ds_read_b64_tr_b16 v[32:33], v16 offset:8192
    ds_read_b64_tr_b16 v[34:35], v16 offset:9216
    s_waitcnt lgkmcnt(6)
    v_mfma_f32_32x32x16_bf16 v[144:159], v[52:55], a[4:7], v[144:159]
    ds_read_b64_tr_b16 v[36:37], v17 offset:8192
    ds_read_b64_tr_b16 v[38:39], v17 offset:9216
    s_add_u32 s47, s44, 0
    buffer_load_dwordx4 a[0:3], v14, s[32:35], s47 offen offset:0
    s_waitcnt lgkmcnt(6)
    v_mfma_f32_32x32x16_bf16 v[160:175], v[56:59], a[4:7], v[160:175]
    ds_read_b64_tr_b16 v[40:41], v18 offset:8192
    ds_read_b64_tr_b16 v[42:43], v18 offset:9216
    v_cvt_pk_bf16_f32 v192, v192, v193
    s_waitcnt lgkmcnt(6)
    v_mfma_f32_32x32x16_bf16 v[176:191], v[60:63], a[4:7], v[176:191]
    ds_read_b64_tr_b16 v[44:45], v19 offset:8192
    ds_read_b64_tr_b16 v[46:47], v19 offset:9216
    v_cvt_pk_bf16_f32 v193, v194, v195
    s_waitcnt vmcnt(38)
    s_waitcnt lgkmcnt(6)
    v_mfma_f32_32x32x16_bf16 v[128:143], v[32:35], a[8:11], v[128:143]
    ds_read_b64_tr_b16 v[48:49], v16 offset:12288
    ds_read_b64_tr_b16 v[50:51], v16 offset:13312
    s_waitcnt lgkmcnt(6)
    v_mfma_f32_32x32x16_bf16 v[144:159], v[36:39], a[8:11], v[144:159]
    ds_read_b64_tr_b16 v[52:53], v17 offset:12288
    ds_read_b64_tr_b16 v[54:55], v17 offset:13312
    s_add_u32 s47, s44, 0
    buffer_load_dwordx4 a[4:7], v14, s[32:35], s47 offen offset:1024
    s_waitcnt lgkmcnt(6)
    v_mfma_f32_32x32x16_bf16 v[160:175], v[40:43], a[8:11], v[160:175]
    ds_read_b64_tr_b16 v[56:57], v18 offset:12288
    ds_read_b64_tr_b16 v[58:59], v18 offset:13312
    v_cvt_pk_bf16_f32 v194, v196, v197
    s_waitcnt lgkmcnt(6)
    v_mfma_f32_32x32x16_bf16 v[176:191], v[44:47], a[8:11], v[176:191]
    ds_read_b64_tr_b16 v[60:61], v19 offset:12288
    ds_read_b64_tr_b16 v[62:63], v19 offset:13312
    v_cvt_pk_bf16_f32 v195, v198, v199
    s_waitcnt vmcnt(38)
    s_waitcnt lgkmcnt(6)
    v_mfma_f32_32x32x16_bf16 v[128:143], v[48:51], a[12:15], v[128:143]
    ds_read_b64_tr_b16 v[32:33], v16 offset:16384
    ds_read_b64_tr_b16 v[34:35], v16 offset:17408
    s_waitcnt lgkmcnt(6)
    v_mfma_f32_32x32x16_bf16 v[144:159], v[52:55], a[12:15], v[144:159]
    ds_read_b64_tr_b16 v[36:37], v17 offset:16384
    ds_read_b64_tr_b16 v[38:39], v17 offset:17408
    s_add_u32 s47, s44, 0
    buffer_load_dwordx4 a[8:11], v14, s[32:35], s47 offen offset:2048
    s_waitcnt lgkmcnt(6)
    v_mfma_f32_32x32x16_bf16 v[160:175], v[56:59], a[12:15], v[160:175]
    ds_read_b64_tr_b16 v[40:41], v18 offset:16384
    ds_read_b64_tr_b16 v[42:43], v18 offset:17408
    v_cvt_pk_bf16_f32 v196, v200, v201
    s_waitcnt lgkmcnt(6)
    v_mfma_f32_32x32x16_bf16 v[176:191], v[60:63], a[12:15], v[176:191]
    ds_read_b64_tr_b16 v[44:45], v19 offset:16384
    ds_read_b64_tr_b16 v[46:47], v19 offset:17408
    v_cvt_pk_bf16_f32 v197, v202, v203
    s_waitcnt vmcnt(38)
    s_waitcnt lgkmcnt(6)
    v_mfma_f32_32x32x16_bf16 v[128:143], v[32:35], a[16:19], v[128:143]
    ds_read_b64_tr_b16 v[48:49], v16 offset:20480
    ds_read_b64_tr_b16 v[50:51], v16 offset:21504
    s_waitcnt lgkmcnt(6)
    v_mfma_f32_32x32x16_bf16 v[144:159], v[36:39], a[16:19], v[144:159]
    ds_read_b64_tr_b16 v[52:53], v17 offset:20480
    ds_read_b64_tr_b16 v[54:55], v17 offset:21504
    s_add_u32 s47, s44, 0
    buffer_load_dwordx4 a[12:15], v14, s[32:35], s47 offen offset:3072
    s_waitcnt lgkmcnt(6)
    v_mfma_f32_32x32x16_bf16 v[160:175], v[40:43], a[16:19], v[160:175]
    ds_read_b64_tr_b16 v[56:57], v18 offset:20480
    ds_read_b64_tr_b16 v[58:59], v18 offset:21504
    v_cvt_pk_bf16_f32 v198, v204, v205
    s_waitcnt lgkmcnt(6)
    v_mfma_f32_32x32x16_bf16 v[176:191], v[44:47], a[16:19], v[176:191]
    ds_read_b64_tr_b16 v[60:61], v19 offset:20480
    ds_read_b64_tr_b16 v[62:63], v19 offset:21504
    v_cvt_pk_bf16_f32 v199, v206, v207
    s_waitcnt vmcnt(36)
    s_waitcnt lgkmcnt(6)
    v_mfma_f32_32x32x16_bf16 v[128:143], v[48:51], a[20:23], v[128:143]
    ds_read_b64_tr_b16 v[32:33], v16 offset:24576
    ds_read_b64_tr_b16 v[34:35], v16 offset:25600
    s_waitcnt lgkmcnt(6)
    v_mfma_f32_32x32x16_bf16 v[144:159], v[52:55], a[20:23], v[144:159]
    ds_read_b64_tr_b16 v[36:37], v17 offset:24576
    ds_read_b64_tr_b16 v[38:39], v17 offset:25600
    s_add_u32 s47, s44, 4096
    buffer_load_dwordx4 a[16:19], v14, s[32:35], s47 offen offset:0
    s_waitcnt lgkmcnt(6)
    v_mfma_f32_32x32x16_bf16 v[160:175], v[56:59], a[20:23], v[160:175]
    ds_read_b64_tr_b16 v[40:41], v18 offset:24576
    ds_read_b64_tr_b16 v[42:43], v18 offset:25600
    buffer_store_dwordx4 v[192:195], v2, s[32:35], s42 offen offset:0 sc1
    s_waitcnt lgkmcnt(6)
    v_mfma_f32_32x32x16_bf16 v[176:191], v[60:63], a[20:23], v[176:191]
    ds_read_b64_tr_b16 v[44:45], v19 offset:24576
    ds_read_b64_tr_b16 v[46:47], v19 offset:25600
    buffer_store_dwordx4 v[196:199], v2, s[32:35], s42 offen offset:1024 sc1
    s_waitcnt vmcnt(38)
    s_waitcnt lgkmcnt(6)
    v_mfma_f32_32x32x16_bf16 v[128:143], v[32:35], a[24:27], v[128:143]
    ds_read_b64_tr_b16 v[48:49], v16 offset:28672
    ds_read_b64_tr_b16 v[50:51], v16 offset:29696
    s_waitcnt lgkmcnt(6)
    v_mfma_f32_32x32x16_bf16 v[144:159], v[36:39], a[24:27], v[144:159]
    ds_read_b64_tr_b16 v[52:53], v17 offset:28672
    ds_read_b64_tr_b16 v[54:55], v17 offset:29696
    s_add_u32 s47, s44, 4096
    buffer_load_dwordx4 a[20:23], v14, s[32:35], s47 offen offset:1024
    s_waitcnt lgkmcnt(6)
    v_mfma_f32_32x32x16_bf16 v[160:175], v[40:43], a[24:27], v[160:175]
    ds_read_b64_tr_b16 v[56:57], v18 offset:28672
    ds_read_b64_tr_b16 v[58:59], v18 offset:29696
    v_cvt_pk_bf16_f32 v208, v208, v209
    s_waitcnt lgkmcnt(6)
    v_mfma_f32_32x32x16_bf16 v[176:191], v[44:47], a[24:27], v[176:191]
    ds_read_b64_tr_b16 v[60:61], v19 offset:28672
    ds_read_b64_tr_b16 v[62:63], v19 offset:29696
    v_cvt_pk_bf16_f32 v209, v210, v211
    s_waitcnt vmcnt(38)
    s_waitcnt lgkmcnt(6)
    v_mfma_f32_32x32x16_bf16 v[128:143], v[48:51], a[28:31], v[128:143]
    ds_read_b64_tr_b16 v[32:33], v16 offset:32768
    ds_read_b64_tr_b16 v[34:35], v16 offset:33792
    s_waitcnt lgkmcnt(6)
    v_mfma_f32_32x32x16_bf16 v[144:159], v[52:55], a[28:31], v[144:159]
    ds_read_b64_tr_b16 v[36:37], v17 offset:32768
    ds_read_b64_tr_b16 v[38:39], v17 offset:33792
    s_add_u32 s47, s44, 4096
    buffer_load_dwordx4 a[24:27], v14, s[32:35], s47 offen offset:2048
    s_waitcnt lgkmcnt(6)
    v_mfma_f32_32x32x16_bf16 v[160:175], v[56:59], a[28:31], v[160:175]
    ds_read_b64_tr_b16 v[40:41], v18 offset:32768
    ds_read_b64_tr_b16 v[42:43], v18 offset:33792
    v_cvt_pk_bf16_f32 v210, v212, v213
    s_waitcnt lgkmcnt(6)
    v_mfma_f32_32x32x16_bf16 v[176:191], v[60:63], a[28:31], v[176:191]
    ds_read_b64_tr_b16 v[44:45], v19 offset:32768
    ds_read_b64_tr_b16 v[46:47], v19 offset:33792
    v_cvt_pk_bf16_f32 v211, v214, v215
    s_waitcnt vmcnt(38)
    s_waitcnt lgkmcnt(6)
    v_mfma_f32_32x32x16_bf16 v[128:143], v[32:35], a[32:35], v[128:143]
    ds_read_b64_tr_b16 v[48:49], v16 offset:36864
    ds_read_b64_tr_b16 v[50:51], v16 offset:37888
    s_waitcnt lgkmcnt(6)
    v_mfma_f32_32x32x16_bf16 v[144:159], v[36:39], a[32:35], v[144:159]
    ds_read_b64_tr_b16 v[52:53], v17 offset:36864
    ds_read_b64_tr_b16 v[54:55], v17 offset:37888
    s_add_u32 s47, s44, 4096
    buffer_load_dwordx4 a[28:31], v14, s[32:35], s47 offen offset:3072
    s_waitcnt lgkmcnt(6)
    v_mfma_f32_32x32x16_bf16 v[160:175], v[40:43], a[32:35], v[160:175]
    ds_read_b64_tr_b16 v[56:57], v18 offset:36864
    ds_read_b64_tr_b16 v[58:59], v18 offset:37888
    v_cvt_pk_bf16_f32 v212, v216, v217
    s_waitcnt lgkmcnt(6)
    v_mfma_f32_32x32x16_bf16 v[176:191], v[44:47], a[32:35], v[176:191]
    ds_read_b64_tr_b16 v[60:61], v19 offset:36864
    ds_read_b64_tr_b16 v[62:63], v19 offset:37888
    v_cvt_pk_bf16_f32 v213, v218, v219
    s_waitcnt vmcnt(38)
    s_waitcnt lgkmcnt(6)
    v_mfma_f32_32x32x16_bf16 v[128:143], v[48:51], a[36:39], v[128:143]
    ds_read_b64_tr_b16 v[32:33], v16 offset:40960
    ds_read_b64_tr_b16 v[34:35], v16 offset:41984
    s_waitcnt lgkmcnt(6)
    v_mfma_f32_32x32x16_bf16 v[144:159], v[52:55], a[36:39], v[144:159]
    ds_read_b64_tr_b16 v[36:37], v17 offset:40960
    ds_read_b64_tr_b16 v[38:39], v17 offset:41984
    s_add_u32 s47, s44, 8192
    buffer_load_dwordx4 a[32:35], v14, s[32:35], s47 offen offset:0
    s_waitcnt lgkmcnt(6)
    v_mfma_f32_32x32x16_bf16 v[160:175], v[56:59], a[36:39], v[160:175]
    ds_read_b64_tr_b16 v[40:41], v18 offset:40960
    ds_read_b64_tr_b16 v[42:43], v18 offset:41984
    v_cvt_pk_bf16_f32 v214, v220, v221
    s_waitcnt lgkmcnt(6)
    v_mfma_f32_32x32x16_bf16 v[176:191], v[60:63], a[36:39], v[176:191]
    ds_read_b64_tr_b16 v[44:45], v19 offset:40960
    ds_read_b64_tr_b16 v[46:47], v19 offset:41984
    v_cvt_pk_bf16_f32 v215, v222, v223
    s_waitcnt vmcnt(36)
    s_waitcnt lgkmcnt(6)
    v_mfma_f32_32x32x16_bf16 v[128:143], v[32:35], a[40:43], v[128:143]
    ds_read_b64_tr_b16 v[48:49], v16 offset:45056
    ds_read_b64_tr_b16 v[50:51], v16 offset:46080
    s_waitcnt lgkmcnt(6)
    v_mfma_f32_32x32x16_bf16 v[144:159], v[36:39], a[40:43], v[144:159]
    ds_read_b64_tr_b16 v[52:53], v17 offset:45056
    ds_read_b64_tr_b16 v[54:55], v17 offset:46080
    s_add_u32 s47, s44, 8192
    buffer_load_dwordx4 a[36:39], v14, s[32:35], s47 offen offset:1024
    s_waitcnt lgkmcnt(6)
    v_mfma_f32_32x32x16_bf16 v[160:175], v[40:43], a[40:43], v[160:175]
    ds_read_b64_tr_b16 v[56:57], v18 offset:45056
    ds_read_b64_tr_b16 v[58:59], v18 offset:46080
    buffer_store_dwordx4 v[208:211], v2, s[32:35], s42 offen offset:2048 sc1
    s_waitcnt lgkmcnt(6)
    v_mfma_f32_32x32x16_bf16 v[176:191], v[44:47], a[40:43], v[176:191]
    ds_read_b64_tr_b16 v[60:61], v19 offset:45056
    ds_read_b64_tr_b16 v[62:63], v19 offset:46080
    buffer_store_dwordx4 v[212:215], v2, s[32:35], s42 offen offset:3072 sc1
    s_waitcnt vmcnt(38)
    s_waitcnt lgkmcnt(6)
    v_mfma_f32_32x32x16_bf16 v[128:143], v[48:51], a[44:47], v[128:143]
    ds_read_b64_tr_b16 v[32:33], v16 offset:49152
    ds_read_b64_tr_b16 v[34:35], v16 offset:50176
    s_waitcnt lgkmcnt(6)
    v_mfma_f32_32x32x16_bf16 v[144:159], v[52:55], a[44:47], v[144:159]
    ds_read_b64_tr_b16 v[36:37], v17 offset:49152
    ds_read_b64_tr_b16 v[38:39], v17 offset:50176
    s_add_u32 s47, s44, 8192
    buffer_load_dwordx4 a[40:43], v14, s[32:35], s47 offen offset:2048
    s_waitcnt lgkmcnt(6)
    v_mfma_f32_32x32x16_bf16 v[160:175], v[56:59], a[44:47], v[160:175]
    ds_read_b64_tr_b16 v[40:41], v18 offset:49152
    ds_read_b64_tr_b16 v[42:43], v18 offset:50176
    v_cvt_pk_bf16_f32 v224, v224, v225
    s_waitcnt lgkmcnt(6)
    v_mfma_f32_32x32x16_bf16 v[176:191], v[60:63], a[44:47], v[176:191]
    ds_read_b64_tr_b16 v[44:45], v19 offset:49152
    ds_read_b64_tr_b16 v[46:47], v19 offset:50176
    v_cvt_pk_bf16_f32 v225, v226, v227
    s_waitcnt vmcnt(38)
    s_waitcnt lgkmcnt(6)
    v_mfma_f32_32x32x16_bf16 v[128:143], v[32:35], a[48:51], v[128:143]
    ds_read_b64_tr_b16 v[48:49], v16 offset:53248
    ds_read_b64_tr_b16 v[50:51], v16 offset:54272
    s_waitcnt lgkmcnt(6)
    v_mfma_f32_32x32x16_bf16 v[144:159], v[36:39], a[48:51], v[144:159]
    ds_read_b64_tr_b16 v[52:53], v17 offset:53248
    ds_read_b64_tr_b16 v[54:55], v17 offset:54272
    s_add_u32 s47, s44, 8192
    buffer_load_dwordx4 a[44:47], v14, s[32:35], s47 offen offset:3072
    s_waitcnt lgkmcnt(6)
    v_mfma_f32_32x32x16_bf16 v[160:175], v[40:43], a[48:51], v[160:175]
    ds_read_b64_tr_b16 v[56:57], v18 offset:53248
    ds_read_b64_tr_b16 v[58:59], v18 offset:54272
    v_cvt_pk_bf16_f32 v226, v228, v229
    s_waitcnt lgkmcnt(6)
    v_mfma_f32_32x32x16_bf16 v[176:191], v[44:47], a[48:51], v[176:191]
    ds_read_b64_tr_b16 v[60:61], v19 offset:53248
    ds_read_b64_tr_b16 v[62:63], v19 offset:54272
    v_cvt_pk_bf16_f32 v227, v230, v231
    s_waitcnt vmcnt(38)
    s_waitcnt lgkmcnt(6)
    v_mfma_f32_32x32x16_bf16 v[128:143], v[48:51], a[52:55], v[128:143]
    ds_read_b64_tr_b16 v[32:33], v16 offset:57344
    ds_read_b64_tr_b16 v[34:35], v16 offset:58368
    s_waitcnt lgkmcnt(6)
    v_mfma_f32_32x32x16_bf16 v[144:159], v[52:55], a[52:55], v[144:159]
    ds_read_b64_tr_b16 v[36:37], v17 offset:57344
    ds_read_b64_tr_b16 v[38:39], v17 offset:58368
    s_add_u32 s47, s44, 12288
    buffer_load_dwordx4 a[48:51], v14, s[32:35], s47 offen offset:0
    s_waitcnt lgkmcnt(6)
    v_mfma_f32_32x32x16_bf16 v[160:175], v[56:59], a[52:55], v[160:175]
    ds_read_b64_tr_b16 v[40:41], v18 offset:57344
    ds_read_b64_tr_b16 v[42:43], v18 offset:58368
    v_cvt_pk_bf16_f32 v228, v232, v233
    s_waitcnt lgkmcnt(6)
    v_mfma_f32_32x32x16_bf16 v[176:191], v[60:63], a[52:55], v[176:191]
    ds_read_b64_tr_b16 v[44:45], v19 offset:57344
    ds_read_b64_tr_b16 v[46:47], v19 offset:58368
    v_cvt_pk_bf16_f32 v229, v234, v235
    s_waitcnt vmcnt(38)
    s_waitcnt lgkmcnt(6)
    v_mfma_f32_32x32x16_bf16 v[128:143], v[32:35], a[56:59], v[128:143]
    ds_read_b64_tr_b16 v[48:49], v16 offset:61440
    ds_read_b64_tr_b16 v[50:51], v16 offset:62464
    s_waitcnt lgkmcnt(6)
    v_mfma_f32_32x32x16_bf16 v[144:159], v[36:39], a[56:59], v[144:159]
    ds_read_b64_tr_b16 v[52:53], v17 offset:61440
    ds_read_b64_tr_b16 v[54:55], v17 offset:62464
    s_add_u32 s47, s44, 12288
    buffer_load_dwordx4 a[52:55], v14, s[32:35], s47 offen offset:1024
    s_waitcnt lgkmcnt(6)
    v_mfma_f32_32x32x16_bf16 v[160:175], v[40:43], a[56:59], v[160:175]
    ds_read_b64_tr_b16 v[56:57], v18 offset:61440
    ds_read_b64_tr_b16 v[58:59], v18 offset:62464
    v_cvt_pk_bf16_f32 v230, v236, v237
    s_waitcnt lgkmcnt(6)
    v_mfma_f32_32x32x16_bf16 v[176:191], v[44:47], a[56:59], v[176:191]
    ds_read_b64_tr_b16 v[60:61], v19 offset:61440
    ds_read_b64_tr_b16 v[62:63], v19 offset:62464
    v_cvt_pk_bf16_f32 v231, v238, v239
    s_waitcnt vmcnt(36)
    s_waitcnt lgkmcnt(6)
    v_mfma_f32_32x32x16_bf16 v[128:143], v[48:51], a[60:63], v[128:143]
    ds_read_b64_tr_b16 v[32:33], v20 offset:0
    ds_read_b64_tr_b16 v[34:35], v20 offset:1024
    s_waitcnt lgkmcnt(6)
    v_mfma_f32_32x32x16_bf16 v[144:159], v[52:55], a[60:63], v[144:159]
    ds_read_b64_tr_b16 v[36:37], v21 offset:0
    ds_read_b64_tr_b16 v[38:39], v21 offset:1024
    s_add_u32 s47, s44, 12288
    buffer_load_dwordx4 a[56:59], v14, s[32:35], s47 offen offset:2048
    s_waitcnt lgkmcnt(6)
    v_mfma_f32_32x32x16_bf16 v[160:175], v[56:59], a[60:63], v[160:175]
    ds_read_b64_tr_b16 v[40:41], v22 offset:0
    ds_read_b64_tr_b16 v[42:43], v22 offset:1024
    buffer_store_dwordx4 v[224:227], v2, s[32:35], s43 offen offset:0 sc1
    s_waitcnt lgkmcnt(6)
    v_mfma_f32_32x32x16_bf16 v[176:191], v[60:63], a[60:63], v[176:191]
    ds_read_b64_tr_b16 v[44:45], v23 offset:0
    ds_read_b64_tr_b16 v[46:47], v23 offset:1024
    buffer_store_dwordx4 v[228:231], v2, s[32:35], s43 offen offset:1024 sc1
    s_waitcnt vmcnt(38)
    s_waitcnt lgkmcnt(6)
    v_mfma_f32_32x32x16_bf16 v[128:143], v[32:35], a[64:67], v[128:143]
    ds_read_b64_tr_b16 v[48:49], v20 offset:4096
    ds_read_b64_tr_b16 v[50:51], v20 offset:5120
    s_waitcnt lgkmcnt(6)
    v_mfma_f32_32x32x16_bf16 v[144:159], v[36:39], a[64:67], v[144:159]
    ds_read_b64_tr_b16 v[52:53], v21 offset:4096
    ds_read_b64_tr_b16 v[54:55], v21 offset:5120
    s_add_u32 s47, s44, 12288
    buffer_load_dwordx4 a[60:63], v14, s[32:35], s47 offen offset:3072
    s_waitcnt lgkmcnt(6)
    v_mfma_f32_32x32x16_bf16 v[160:175], v[40:43], a[64:67], v[160:175]
    ds_read_b64_tr_b16 v[56:57], v22 offset:4096
    ds_read_b64_tr_b16 v[58:59], v22 offset:5120
    v_cvt_pk_bf16_f32 v240, v240, v241
    s_waitcnt lgkmcnt(6)
    v_mfma_f32_32x32x16_bf16 v[176:191], v[44:47], a[64:67], v[176:191]
    ds_read_b64_tr_b16 v[60:61], v23 offset:4096
    ds_read_b64_tr_b16 v[62:63], v23 offset:5120
    v_cvt_pk_bf16_f32 v241, v242, v243
    s_waitcnt vmcnt(38)
    s_waitcnt lgkmcnt(6)
    v_mfma_f32_32x32x16_bf16 v[128:143], v[48:51], a[68:71], v[128:143]
    ds_read_b64_tr_b16 v[32:33], v20 offset:8192
    ds_read_b64_tr_b16 v[34:35], v20 offset:9216
    s_waitcnt lgkmcnt(6)
    v_mfma_f32_32x32x16_bf16 v[144:159], v[52:55], a[68:71], v[144:159]
    ds_read_b64_tr_b16 v[36:37], v21 offset:8192
    ds_read_b64_tr_b16 v[38:39], v21 offset:9216
    s_add_u32 s47, s44, 16384
    buffer_load_dwordx4 a[64:67], v14, s[32:35], s47 offen offset:0
    s_waitcnt lgkmcnt(6)
    v_mfma_f32_32x32x16_bf16 v[160:175], v[56:59], a[68:71], v[160:175]
    ds_read_b64_tr_b16 v[40:41], v22 offset:8192
    ds_read_b64_tr_b16 v[42:43], v22 offset:9216
    v_cvt_pk_bf16_f32 v242, v244, v245
    s_waitcnt lgkmcnt(6)
    v_mfma_f32_32x32x16_bf16 v[176:191], v[60:63], a[68:71], v[176:191]
    ds_read_b64_tr_b16 v[44:45], v23 offset:8192
    ds_read_b64_tr_b16 v[46:47], v23 offset:9216
    v_cvt_pk_bf16_f32 v243, v246, v247
    s_waitcnt vmcnt(38)
    s_waitcnt lgkmcnt(6)
    v_mfma_f32_32x32x16_bf16 v[128:143], v[32:35], a[72:75], v[128:143]
    ds_read_b64_tr_b16 v[48:49], v20 offset:12288
    ds_read_b64_tr_b16 v[50:51], v20 offset:13312
    s_waitcnt lgkmcnt(6)
    v_mfma_f32_32x32x16_bf16 v[144:159], v[36:39], a[72:75], v[144:159]
    ds_read_b64_tr_b16 v[52:53], v21 offset:12288
    ds_read_b64_tr_b16 v[54:55], v21 offset:13312
    s_add_u32 s47, s44, 16384
    buffer_load_dwordx4 a[68:71], v14, s[32:35], s47 offen offset:1024
    s_waitcnt lgkmcnt(6)
    v_mfma_f32_32x32x16_bf16 v[160:175], v[40:43], a[72:75], v[160:175]
    ds_read_b64_tr_b16 v[56:57], v22 offset:12288
    ds_read_b64_tr_b16 v[58:59], v22 offset:13312
    v_cvt_pk_bf16_f32 v244, v248, v249
    s_waitcnt lgkmcnt(6)
    v_mfma_f32_32x32x16_bf16 v[176:191], v[44:47], a[72:75], v[176:191]
    ds_read_b64_tr_b16 v[60:61], v23 offset:12288
    ds_read_b64_tr_b16 v[62:63], v23 offset:13312
    v_cvt_pk_bf16_f32 v245, v250, v251
    s_waitcnt vmcnt(38)
    s_waitcnt lgkmcnt(6)
    v_mfma_f32_32x32x16_bf16 v[128:143], v[48:51], a[76:79], v[128:143]
    ds_read_b64_tr_b16 v[32:33], v20 offset:16384
    ds_read_b64_tr_b16 v[34:35], v20 offset:17408
    s_waitcnt lgkmcnt(6)
    v_mfma_f32_32x32x16_bf16 v[144:159], v[52:55], a[76:79], v[144:159]
    ds_read_b64_tr_b16 v[36:37], v21 offset:16384
    ds_read_b64_tr_b16 v[38:39], v21 offset:17408
    s_add_u32 s47, s44, 16384
    buffer_load_dwordx4 a[72:75], v14, s[32:35], s47 offen offset:2048
    s_waitcnt lgkmcnt(6)
    v_mfma_f32_32x32x16_bf16 v[160:175], v[56:59], a[76:79], v[160:175]
    ds_read_b64_tr_b16 v[40:41], v22 offset:16384
    ds_read_b64_tr_b16 v[42:43], v22 offset:17408
    v_cvt_pk_bf16_f32 v246, v252, v253
    s_waitcnt lgkmcnt(6)
    v_mfma_f32_32x32x16_bf16 v[176:191], v[60:63], a[76:79], v[176:191]
    ds_read_b64_tr_b16 v[44:45], v23 offset:16384
    ds_read_b64_tr_b16 v[46:47], v23 offset:17408
    v_cvt_pk_bf16_f32 v247, v254, v255
    s_waitcnt vmcnt(36)
    s_waitcnt lgkmcnt(6)
    v_mfma_f32_32x32x16_bf16 v[128:143], v[32:35], a[80:83], v[128:143]
    ds_read_b64_tr_b16 v[48:49], v20 offset:20480
    ds_read_b64_tr_b16 v[50:51], v20 offset:21504
    s_waitcnt lgkmcnt(6)
    v_mfma_f32_32x32x16_bf16 v[144:159], v[36:39], a[80:83], v[144:159]
    ds_read_b64_tr_b16 v[52:53], v21 offset:20480
    ds_read_b64_tr_b16 v[54:55], v21 offset:21504
    s_add_u32 s47, s44, 16384
    buffer_load_dwordx4 a[76:79], v14, s[32:35], s47 offen offset:3072
    s_waitcnt lgkmcnt(6)
    v_mfma_f32_32x32x16_bf16 v[160:175], v[40:43], a[80:83], v[160:175]
    ds_read_b64_tr_b16 v[56:57], v22 offset:20480
    ds_read_b64_tr_b16 v[58:59], v22 offset:21504
    buffer_store_dwordx4 v[240:243], v2, s[32:35], s43 offen offset:2048 sc1
    s_waitcnt lgkmcnt(6)
    v_mfma_f32_32x32x16_bf16 v[176:191], v[44:47], a[80:83], v[176:191]
    ds_read_b64_tr_b16 v[60:61], v23 offset:20480
    ds_read_b64_tr_b16 v[62:63], v23 offset:21504
    buffer_store_dwordx4 v[244:247], v2, s[32:35], s43 offen offset:3072 sc1
    s_waitcnt vmcnt(38)
    s_waitcnt lgkmcnt(6)
    v_mfma_f32_32x32x16_bf16 v[128:143], v[48:51], a[84:87], v[128:143]
    ds_read_b64_tr_b16 v[32:33], v20 offset:24576
    ds_read_b64_tr_b16 v[34:35], v20 offset:25600
    s_waitcnt lgkmcnt(6)
    v_mfma_f32_32x32x16_bf16 v[144:159], v[52:55], a[84:87], v[144:159]
    ds_read_b64_tr_b16 v[36:37], v21 offset:24576
    ds_read_b64_tr_b16 v[38:39], v21 offset:25600
    s_add_u32 s47, s44, 20480
    buffer_load_dwordx4 a[80:83], v14, s[32:35], s47 offen offset:0
    s_waitcnt lgkmcnt(6)
    v_mfma_f32_32x32x16_bf16 v[160:175], v[56:59], a[84:87], v[160:175]
    ds_read_b64_tr_b16 v[40:41], v22 offset:24576
    ds_read_b64_tr_b16 v[42:43], v22 offset:25600
    s_waitcnt lgkmcnt(6)
    v_mfma_f32_32x32x16_bf16 v[176:191], v[60:63], a[84:87], v[176:191]
    ds_read_b64_tr_b16 v[44:45], v23 offset:24576
    ds_read_b64_tr_b16 v[46:47], v23 offset:25600
    s_waitcnt vmcnt(38)
    s_waitcnt lgkmcnt(6)
    v_mfma_f32_32x32x16_bf16 v[128:143], v[32:35], a[88:91], v[128:143]
    ds_read_b64_tr_b16 v[48:49], v20 offset:28672
    ds_read_b64_tr_b16 v[50:51], v20 offset:29696
    s_waitcnt lgkmcnt(6)
    v_mfma_f32_32x32x16_bf16 v[144:159], v[36:39], a[88:91], v[144:159]
    ds_read_b64_tr_b16 v[52:53], v21 offset:28672
    ds_read_b64_tr_b16 v[54:55], v21 offset:29696
    s_add_u32 s47, s44, 20480
    buffer_load_dwordx4 a[84:87], v14, s[32:35], s47 offen offset:1024
    s_waitcnt lgkmcnt(6)
    v_mfma_f32_32x32x16_bf16 v[160:175], v[40:43], a[88:91], v[160:175]
    ds_read_b64_tr_b16 v[56:57], v22 offset:28672
    ds_read_b64_tr_b16 v[58:59], v22 offset:29696
    s_waitcnt lgkmcnt(6)
    v_mfma_f32_32x32x16_bf16 v[176:191], v[44:47], a[88:91], v[176:191]
    ds_read_b64_tr_b16 v[60:61], v23 offset:28672
    ds_read_b64_tr_b16 v[62:63], v23 offset:29696
    s_waitcnt vmcnt(38)
    s_waitcnt lgkmcnt(6)
    v_mfma_f32_32x32x16_bf16 v[128:143], v[48:51], a[92:95], v[128:143]
    ds_read_b64_tr_b16 v[32:33], v20 offset:32768
    ds_read_b64_tr_b16 v[34:35], v20 offset:33792
    s_waitcnt lgkmcnt(6)
    v_mfma_f32_32x32x16_bf16 v[144:159], v[52:55], a[92:95], v[144:159]
    ds_read_b64_tr_b16 v[36:37], v21 offset:32768
    ds_read_b64_tr_b16 v[38:39], v21 offset:33792
    s_add_u32 s47, s44, 20480
    buffer_load_dwordx4 a[88:91], v14, s[32:35], s47 offen offset:2048
    s_waitcnt lgkmcnt(6)
    v_mfma_f32_32x32x16_bf16 v[160:175], v[56:59], a[92:95], v[160:175]
    ds_read_b64_tr_b16 v[40:41], v22 offset:32768
    ds_read_b64_tr_b16 v[42:43], v22 offset:33792
    s_waitcnt lgkmcnt(6)
    v_mfma_f32_32x32x16_bf16 v[176:191], v[60:63], a[92:95], v[176:191]
    ds_read_b64_tr_b16 v[44:45], v23 offset:32768
    ds_read_b64_tr_b16 v[46:47], v23 offset:33792
    s_waitcnt vmcnt(38)
    s_waitcnt lgkmcnt(6)
    v_mfma_f32_32x32x16_bf16 v[128:143], v[32:35], a[96:99], v[128:143]
    ds_read_b64_tr_b16 v[48:49], v20 offset:36864
    ds_read_b64_tr_b16 v[50:51], v20 offset:37888
    s_waitcnt lgkmcnt(6)
    v_mfma_f32_32x32x16_bf16 v[144:159], v[36:39], a[96:99], v[144:159]
    ds_read_b64_tr_b16 v[52:53], v21 offset:36864
    ds_read_b64_tr_b16 v[54:55], v21 offset:37888
    s_add_u32 s47, s44, 20480
    buffer_load_dwordx4 a[92:95], v14, s[32:35], s47 offen offset:3072
    s_waitcnt lgkmcnt(6)
    v_mfma_f32_32x32x16_bf16 v[160:175], v[40:43], a[96:99], v[160:175]
    ds_read_b64_tr_b16 v[56:57], v22 offset:36864
    ds_read_b64_tr_b16 v[58:59], v22 offset:37888
    s_waitcnt lgkmcnt(6)
    v_mfma_f32_32x32x16_bf16 v[176:191], v[44:47], a[96:99], v[176:191]
    ds_read_b64_tr_b16 v[60:61], v23 offset:36864
    ds_read_b64_tr_b16 v[62:63], v23 offset:37888
    s_waitcnt vmcnt(38)
    s_waitcnt lgkmcnt(6)
    v_mfma_f32_32x32x16_bf16 v[128:143], v[48:51], a[100:103], v[128:143]
    ds_read_b64_tr_b16 v[32:33], v20 offset:40960
    ds_read_b64_tr_b16 v[34:35], v20 offset:41984
    s_waitcnt lgkmcnt(6)
    v_mfma_f32_32x32x16_bf16 v[144:159], v[52:55], a[100:103], v[144:159]
    ds_read_b64_tr_b16 v[36:37], v21 offset:40960
    ds_read_b64_tr_b16 v[38:39], v21 offset:41984
    s_add_u32 s47, s44, 24576
    buffer_load_dwordx4 a[96:99], v14, s[32:35], s47 offen offset:0
    s_waitcnt lgkmcnt(6)
    v_mfma_f32_32x32x16_bf16 v[160:175], v[56:59], a[100:103], v[160:175]
    ds_read_b64_tr_b16 v[40:41], v22 offset:40960
    ds_read_b64_tr_b16 v[42:43], v22 offset:41984
    s_waitcnt lgkmcnt(6)
    v_mfma_f32_32x32x16_bf16 v[176:191], v[60:63], a[100:103], v[176:191]
    ds_read_b64_tr_b16 v[44:45], v23 offset:40960
    ds_read_b64_tr_b16 v[46:47], v23 offset:41984
    s_waitcnt vmcnt(38)
    s_waitcnt lgkmcnt(6)
    v_mfma_f32_32x32x16_bf16 v[128:143], v[32:35], a[104:107], v[128:143]
    ds_read_b64_tr_b16 v[48:49], v20 offset:45056
    ds_read_b64_tr_b16 v[50:51], v20 offset:46080
    s_waitcnt lgkmcnt(6)
    v_mfma_f32_32x32x16_bf16 v[144:159], v[36:39], a[104:107], v[144:159]
    ds_read_b64_tr_b16 v[52:53], v21 offset:45056
    ds_read_b64_tr_b16 v[54:55], v21 offset:46080
    s_add_u32 s47, s44, 24576
    buffer_load_dwordx4 a[100:103], v14, s[32:35], s47 offen offset:1024
    s_waitcnt lgkmcnt(6)
    v_mfma_f32_32x32x16_bf16 v[160:175], v[40:43], a[104:107], v[160:175]
    ds_read_b64_tr_b16 v[56:57], v22 offset:45056
    ds_read_b64_tr_b16 v[58:59], v22 offset:46080
    s_waitcnt lgkmcnt(6)
    v_mfma_f32_32x32x16_bf16 v[176:191], v[44:47], a[104:107], v[176:191]
    ds_read_b64_tr_b16 v[60:61], v23 offset:45056
    ds_read_b64_tr_b16 v[62:63], v23 offset:46080
    s_waitcnt vmcnt(38)
    s_waitcnt lgkmcnt(6)
    v_mfma_f32_32x32x16_bf16 v[128:143], v[48:51], a[108:111], v[128:143]
    ds_read_b64_tr_b16 v[32:33], v20 offset:49152
    ds_read_b64_tr_b16 v[34:35], v20 offset:50176
    s_waitcnt lgkmcnt(6)
    v_mfma_f32_32x32x16_bf16 v[144:159], v[52:55], a[108:111], v[144:159]
    ds_read_b64_tr_b16 v[36:37], v21 offset:49152
    ds_read_b64_tr_b16 v[38:39], v21 offset:50176
    s_add_u32 s47, s44, 24576
    buffer_load_dwordx4 a[104:107], v14, s[32:35], s47 offen offset:2048
    s_waitcnt lgkmcnt(6)
    v_mfma_f32_32x32x16_bf16 v[160:175], v[56:59], a[108:111], v[160:175]
    ds_read_b64_tr_b16 v[40:41], v22 offset:49152
    ds_read_b64_tr_b16 v[42:43], v22 offset:50176
    s_waitcnt lgkmcnt(6)
    v_mfma_f32_32x32x16_bf16 v[176:191], v[60:63], a[108:111], v[176:191]
    ds_read_b64_tr_b16 v[44:45], v23 offset:49152
    ds_read_b64_tr_b16 v[46:47], v23 offset:50176
    s_waitcnt vmcnt(38)
    s_waitcnt lgkmcnt(6)
    v_mfma_f32_32x32x16_bf16 v[128:143], v[32:35], a[112:115], v[128:143]
    ds_read_b64_tr_b16 v[48:49], v20 offset:53248
    ds_read_b64_tr_b16 v[50:51], v20 offset:54272
    s_waitcnt lgkmcnt(6)
    v_mfma_f32_32x32x16_bf16 v[144:159], v[36:39], a[112:115], v[144:159]
    ds_read_b64_tr_b16 v[52:53], v21 offset:53248
    ds_read_b64_tr_b16 v[54:55], v21 offset:54272
    s_add_u32 s47, s44, 24576
    buffer_load_dwordx4 a[108:111], v14, s[32:35], s47 offen offset:3072
    s_waitcnt lgkmcnt(6)
    v_mfma_f32_32x32x16_bf16 v[160:175], v[40:43], a[112:115], v[160:175]
    ds_read_b64_tr_b16 v[56:57], v22 offset:53248
    ds_read_b64_tr_b16 v[58:59], v22 offset:54272
    s_waitcnt lgkmcnt(6)
    v_mfma_f32_32x32x16_bf16 v[176:191], v[44:47], a[112:115], v[176:191]
    ds_read_b64_tr_b16 v[60:61], v23 offset:53248
    ds_read_b64_tr_b16 v[62:63], v23 offset:54272
    s_waitcnt vmcnt(38)
    s_waitcnt lgkmcnt(6)
    v_mfma_f32_32x32x16_bf16 v[128:143], v[48:51], a[116:119], v[128:143]
    ds_read_b64_tr_b16 v[32:33], v20 offset:57344
    ds_read_b64_tr_b16 v[34:35], v20 offset:58368
    s_waitcnt lgkmcnt(6)
    v_mfma_f32_32x32x16_bf16 v[144:159], v[52:55], a[116:119], v[144:159]
    ds_read_b64_tr_b16 v[36:37], v21 offset:57344
    ds_read_b64_tr_b16 v[38:39], v21 offset:58368
    s_add_u32 s47, s44, 28672
    buffer_load_dwordx4 a[112:115], v14, s[32:35], s47 offen offset:0
    s_waitcnt lgkmcnt(6)
    v_mfma_f32_32x32x16_bf16 v[160:175], v[56:59], a[116:119], v[160:175]
    ds_read_b64_tr_b16 v[40:41], v22 offset:57344
    ds_read_b64_tr_b16 v[42:43], v22 offset:58368
    s_waitcnt lgkmcnt(6)
    v_mfma_f32_32x32x16_bf16 v[176:191], v[60:63], a[116:119], v[176:191]
    ds_read_b64_tr_b16 v[44:45], v23 offset:57344
    ds_read_b64_tr_b16 v[46:47], v23 offset:58368
    s_waitcnt vmcnt(38)
    s_waitcnt lgkmcnt(6)
    v_mfma_f32_32x32x16_bf16 v[128:143], v[32:35], a[120:123], v[128:143]
    ds_read_b64_tr_b16 v[48:49], v20 offset:61440
    ds_read_b64_tr_b16 v[50:51], v20 offset:62464
    s_waitcnt lgkmcnt(6)
    v_mfma_f32_32x32x16_bf16 v[144:159], v[36:39], a[120:123], v[144:159]
    ds_read_b64_tr_b16 v[52:53], v21 offset:61440
    ds_read_b64_tr_b16 v[54:55], v21 offset:62464
    s_add_u32 s47, s44, 28672
    buffer_load_dwordx4 a[116:119], v14, s[32:35], s47 offen offset:1024
    s_waitcnt lgkmcnt(6)
    v_mfma_f32_32x32x16_bf16 v[160:175], v[40:43], a[120:123], v[160:175]
    ds_read_b64_tr_b16 v[56:57], v22 offset:61440
    ds_read_b64_tr_b16 v[58:59], v22 offset:62464
    s_waitcnt lgkmcnt(6)
    v_mfma_f32_32x32x16_bf16 v[176:191], v[44:47], a[120:123], v[176:191]
    ds_read_b64_tr_b16 v[60:61], v23 offset:61440
    ds_read_b64_tr_b16 v[62:63], v23 offset:62464
    s_waitcnt vmcnt(38)
    s_waitcnt lgkmcnt(6)
    v_mfma_f32_32x32x16_bf16 v[128:143], v[48:51], a[124:127], v[128:143]
    ds_read_b64_tr_b16 v[32:33], v16 offset:0
    ds_read_b64_tr_b16 v[34:35], v16 offset:1024
    s_waitcnt lgkmcnt(6)
    v_mfma_f32_32x32x16_bf16 v[144:159], v[52:55], a[124:127], v[144:159]
    ds_read_b64_tr_b16 v[36:37], v17 offset:0
    ds_read_b64_tr_b16 v[38:39], v17 offset:1024
    s_add_u32 s47, s44, 28672
    buffer_load_dwordx4 a[120:123], v14, s[32:35], s47 offen offset:2048
    s_waitcnt lgkmcnt(6)
    v_mfma_f32_32x32x16_bf16 v[160:175], v[56:59], a[124:127], v[160:175]
    ds_read_b64_tr_b16 v[40:41], v18 offset:0
    ds_read_b64_tr_b16 v[42:43], v18 offset:1024
    s_waitcnt lgkmcnt(6)
    v_mfma_f32_32x32x16_bf16 v[176:191], v[60:63], a[124:127], v[176:191]
    ds_read_b64_tr_b16 v[44:45], v19 offset:0
    ds_read_b64_tr_b16 v[46:47], v19 offset:1024
    s_add_u32 s47, s44, 28672
    buffer_load_dwordx4 a[124:127], v14, s[32:35], s47 offen offset:3072
    s_add_u32 s42, s41, 32768
    s_add_u32 s43, s41, 36864
    s_waitcnt vmcnt(39)
    s_waitcnt lgkmcnt(6)
    v_mfma_f32_32x32x16_bf16 v[192:207], v[32:35], a[0:3], 0
    ds_read_b64_tr_b16 v[48:49], v16 offset:4096
    ds_read_b64_tr_b16 v[50:51], v16 offset:5120
    s_waitcnt lgkmcnt(6)
    v_mfma_f32_32x32x16_bf16 v[208:223], v[36:39], a[0:3], 0
    ds_read_b64_tr_b16 v[52:53], v17 offset:4096
    ds_read_b64_tr_b16 v[54:55], v17 offset:5120
    s_waitcnt lgkmcnt(6)
    v_mfma_f32_32x32x16_bf16 v[224:239], v[40:43], a[0:3], 0
    ds_read_b64_tr_b16 v[56:57], v18 offset:4096
    ds_read_b64_tr_b16 v[58:59], v18 offset:5120
    s_waitcnt lgkmcnt(6)
    v_mfma_f32_32x32x16_bf16 v[240:255], v[44:47], a[0:3], 0
    ds_read_b64_tr_b16 v[60:61], v19 offset:4096
    ds_read_b64_tr_b16 v[62:63], v19 offset:5120
    s_waitcnt vmcnt(38)
    s_waitcnt lgkmcnt(6)
    v_mfma_f32_32x32x16_bf16 v[192:207], v[48:51], a[4:7], v[192:207]
    ds_read_b64_tr_b16 v[32:33], v16 offset:8192
    ds_read_b64_tr_b16 v[34:35], v16 offset:9216
    s_waitcnt lgkmcnt(6)
    v_mfma_f32_32x32x16_bf16 v[208:223], v[52:55], a[4:7], v[208:223]
    ds_read_b64_tr_b16 v[36:37], v17 offset:8192
    ds_read_b64_tr_b16 v[38:39], v17 offset:9216
    s_waitcnt lgkmcnt(6)
    v_mfma_f32_32x32x16_bf16 v[224:239], v[56:59], a[4:7], v[224:239]
    ds_read_b64_tr_b16 v[40:41], v18 offset:8192
    ds_read_b64_tr_b16 v[42:43], v18 offset:9216
    v_cvt_pk_bf16_f32 v128, v128, v129
    s_waitcnt lgkmcnt(6)
    v_mfma_f32_32x32x16_bf16 v[240:255], v[60:63], a[4:7], v[240:255]
    ds_read_b64_tr_b16 v[44:45], v19 offset:8192
    ds_read_b64_tr_b16 v[46:47], v19 offset:9216
    v_cvt_pk_bf16_f32 v129, v130, v131
    s_waitcnt vmcnt(37)
    s_waitcnt lgkmcnt(6)
    v_mfma_f32_32x32x16_bf16 v[192:207], v[32:35], a[8:11], v[192:207]
    ds_read_b64_tr_b16 v[48:49], v16 offset:12288
    ds_read_b64_tr_b16 v[50:51], v16 offset:13312
    s_waitcnt lgkmcnt(6)
    v_mfma_f32_32x32x16_bf16 v[208:223], v[36:39], a[8:11], v[208:223]
    ds_read_b64_tr_b16 v[52:53], v17 offset:12288
    ds_read_b64_tr_b16 v[54:55], v17 offset:13312
    s_waitcnt lgkmcnt(6)
    v_mfma_f32_32x32x16_bf16 v[224:239], v[40:43], a[8:11], v[224:239]
    ds_read_b64_tr_b16 v[56:57], v18 offset:12288
    ds_read_b64_tr_b16 v[58:59], v18 offset:13312
    v_cvt_pk_bf16_f32 v130, v132, v133
    s_waitcnt lgkmcnt(6)
    v_mfma_f32_32x32x16_bf16 v[240:255], v[44:47], a[8:11], v[240:255]
    ds_read_b64_tr_b16 v[60:61], v19 offset:12288
    ds_read_b64_tr_b16 v[62:63], v19 offset:13312
    v_cvt_pk_bf16_f32 v131, v134, v135
    s_waitcnt vmcnt(36)
    s_waitcnt lgkmcnt(6)
    v_mfma_f32_32x32x16_bf16 v[192:207], v[48:51], a[12:15], v[192:207]
    ds_read_b64_tr_b16 v[32:33], v16 offset:16384
    ds_read_b64_tr_b16 v[34:35], v16 offset:17408
    s_waitcnt lgkmcnt(6)
    v_mfma_f32_32x32x16_bf16 v[208:223], v[52:55], a[12:15], v[208:223]
    ds_read_b64_tr_b16 v[36:37], v17 offset:16384
    ds_read_b64_tr_b16 v[38:39], v17 offset:17408
    s_waitcnt lgkmcnt(6)
    v_mfma_f32_32x32x16_bf16 v[224:239], v[56:59], a[12:15], v[224:239]
    ds_read_b64_tr_b16 v[40:41], v18 offset:16384
    ds_read_b64_tr_b16 v[42:43], v18 offset:17408
    v_cvt_pk_bf16_f32 v132, v136, v137
    s_waitcnt lgkmcnt(6)
    v_mfma_f32_32x32x16_bf16 v[240:255], v[60:63], a[12:15], v[240:255]
    ds_read_b64_tr_b16 v[44:45], v19 offset:16384
    ds_read_b64_tr_b16 v[46:47], v19 offset:17408
    v_cvt_pk_bf16_f32 v133, v138, v139
    s_waitcnt vmcnt(35)
    s_waitcnt lgkmcnt(6)
    v_mfma_f32_32x32x16_bf16 v[192:207], v[32:35], a[16:19], v[192:207]
    ds_read_b64_tr_b16 v[48:49], v16 offset:20480
    ds_read_b64_tr_b16 v[50:51], v16 offset:21504
    s_waitcnt lgkmcnt(6)
    v_mfma_f32_32x32x16_bf16 v[208:223], v[36:39], a[16:19], v[208:223]
    ds_read_b64_tr_b16 v[52:53], v17 offset:20480
    ds_read_b64_tr_b16 v[54:55], v17 offset:21504
    s_waitcnt lgkmcnt(6)
    v_mfma_f32_32x32x16_bf16 v[224:239], v[40:43], a[16:19], v[224:239]
    ds_read_b64_tr_b16 v[56:57], v18 offset:20480
    ds_read_b64_tr_b16 v[58:59], v18 offset:21504
    v_cvt_pk_bf16_f32 v134, v140, v141
    s_waitcnt lgkmcnt(6)
    v_mfma_f32_32x32x16_bf16 v[240:255], v[44:47], a[16:19], v[240:255]
    ds_read_b64_tr_b16 v[60:61], v19 offset:20480
    ds_read_b64_tr_b16 v[62:63], v19 offset:21504
    v_cvt_pk_bf16_f32 v135, v142, v143
    s_waitcnt vmcnt(32)
    s_waitcnt lgkmcnt(6)
    v_mfma_f32_32x32x16_bf16 v[192:207], v[48:51], a[20:23], v[192:207]
    ds_read_b64_tr_b16 v[32:33], v16 offset:24576
    ds_read_b64_tr_b16 v[34:35], v16 offset:25600
    s_waitcnt lgkmcnt(6)
    v_mfma_f32_32x32x16_bf16 v[208:223], v[52:55], a[20:23], v[208:223]
    ds_read_b64_tr_b16 v[36:37], v17 offset:24576
    ds_read_b64_tr_b16 v[38:39], v17 offset:25600
    s_waitcnt lgkmcnt(6)
    v_mfma_f32_32x32x16_bf16 v[224:239], v[56:59], a[20:23], v[224:239]
    ds_read_b64_tr_b16 v[40:41], v18 offset:24576
    ds_read_b64_tr_b16 v[42:43], v18 offset:25600
    buffer_store_dwordx4 v[128:131], v2, s[32:35], s42 offen offset:0 sc1
    s_waitcnt lgkmcnt(6)
    v_mfma_f32_32x32x16_bf16 v[240:255], v[60:63], a[20:23], v[240:255]
    ds_read_b64_tr_b16 v[44:45], v19 offset:24576
    ds_read_b64_tr_b16 v[46:47], v19 offset:25600
    buffer_store_dwordx4 v[132:135], v2, s[32:35], s42 offen offset:1024 sc1
    s_waitcnt vmcnt(33)
    s_waitcnt lgkmcnt(6)
    v_mfma_f32_32x32x16_bf16 v[192:207], v[32:35], a[24:27], v[192:207]
    ds_read_b64_tr_b16 v[48:49], v16 offset:28672
    ds_read_b64_tr_b16 v[50:51], v16 offset:29696
    s_waitcnt lgkmcnt(6)
    v_mfma_f32_32x32x16_bf16 v[208:223], v[36:39], a[24:27], v[208:223]
    ds_read_b64_tr_b16 v[52:53], v17 offset:28672
    ds_read_b64_tr_b16 v[54:55], v17 offset:29696
    s_waitcnt lgkmcnt(6)
    v_mfma_f32_32x32x16_bf16 v[224:239], v[40:43], a[24:27], v[224:239]
    ds_read_b64_tr_b16 v[56:57], v18 offset:28672
    ds_read_b64_tr_b16 v[58:59], v18 offset:29696
    v_cvt_pk_bf16_f32 v144, v144, v145
    s_waitcnt lgkmcnt(6)
    v_mfma_f32_32x32x16_bf16 v[240:255], v[44:47], a[24:27], v[240:255]
    ds_read_b64_tr_b16 v[60:61], v19 offset:28672
    ds_read_b64_tr_b16 v[62:63], v19 offset:29696
    v_cvt_pk_bf16_f32 v145, v146, v147
    s_waitcnt vmcnt(32)
    s_waitcnt lgkmcnt(6)
    v_mfma_f32_32x32x16_bf16 v[192:207], v[48:51], a[28:31], v[192:207]
    ds_read_b64_tr_b16 v[32:33], v16 offset:32768
    ds_read_b64_tr_b16 v[34:35], v16 offset:33792
    s_waitcnt lgkmcnt(6)
    v_mfma_f32_32x32x16_bf16 v[208:223], v[52:55], a[28:31], v[208:223]
    ds_read_b64_tr_b16 v[36:37], v17 offset:32768
    ds_read_b64_tr_b16 v[38:39], v17 offset:33792
    s_waitcnt lgkmcnt(6)
    v_mfma_f32_32x32x16_bf16 v[224:239], v[56:59], a[28:31], v[224:239]
    ds_read_b64_tr_b16 v[40:41], v18 offset:32768
    ds_read_b64_tr_b16 v[42:43], v18 offset:33792
    v_cvt_pk_bf16_f32 v146, v148, v149
    s_waitcnt lgkmcnt(6)
    v_mfma_f32_32x32x16_bf16 v[240:255], v[60:63], a[28:31], v[240:255]
    ds_read_b64_tr_b16 v[44:45], v19 offset:32768
    ds_read_b64_tr_b16 v[46:47], v19 offset:33792
    v_cvt_pk_bf16_f32 v147, v150, v151
    s_waitcnt vmcnt(31)
    s_waitcnt lgkmcnt(6)
    v_mfma_f32_32x32x16_bf16 v[192:207], v[32:35], a[32:35], v[192:207]
    ds_read_b64_tr_b16 v[48:49], v16 offset:36864
    ds_read_b64_tr_b16 v[50:51], v16 offset:37888
    s_waitcnt lgkmcnt(6)
    v_mfma_f32_32x32x16_bf16 v[208:223], v[36:39], a[32:35], v[208:223]
    ds_read_b64_tr_b16 v[52:53], v17 offset:36864
    ds_read_b64_tr_b16 v[54:55], v17 offset:37888
    s_waitcnt lgkmcnt(6)
    v_mfma_f32_32x32x16_bf16 v[224:239], v[40:43], a[32:35], v[224:239]
    ds_read_b64_tr_b16 v[56:57], v18 offset:36864
    ds_read_b64_tr_b16 v[58:59], v18 offset:37888
    v_cvt_pk_bf16_f32 v148, v152, v153
    s_waitcnt lgkmcnt(6)
    v_mfma_f32_32x32x16_bf16 v[240:255], v[44:47], a[32:35], v[240:255]
    ds_read_b64_tr_b16 v[60:61], v19 offset:36864
    ds_read_b64_tr_b16 v[62:63], v19 offset:37888
    v_cvt_pk_bf16_f32 v149, v154, v155
    s_waitcnt vmcnt(30)
    s_waitcnt lgkmcnt(6)
    v_mfma_f32_32x32x16_bf16 v[192:207], v[48:51], a[36:39], v[192:207]
    ds_read_b64_tr_b16 v[32:33], v16 offset:40960
    ds_read_b64_tr_b16 v[34:35], v16 offset:41984
    s_waitcnt lgkmcnt(6)
    v_mfma_f32_32x32x16_bf16 v[208:223], v[52:55], a[36:39], v[208:223]
    ds_read_b64_tr_b16 v[36:37], v17 offset:40960
    ds_read_b64_tr_b16 v[38:39], v17 offset:41984
    s_waitcnt lgkmcnt(6)
    v_mfma_f32_32x32x16_bf16 v[224:239], v[56:59], a[36:39], v[224:239]
    ds_read_b64_tr_b16 v[40:41], v18 offset:40960
    ds_read_b64_tr_b16 v[42:43], v18 offset:41984
    v_cvt_pk_bf16_f32 v150, v156, v157
    s_waitcnt lgkmcnt(6)
    v_mfma_f32_32x32x16_bf16 v[240:255], v[60:63], a[36:39], v[240:255]
    ds_read_b64_tr_b16 v[44:45], v19 offset:40960
    ds_read_b64_tr_b16 v[46:47], v19 offset:41984
    v_cvt_pk_bf16_f32 v151, v158, v159
    s_waitcnt vmcnt(27)
    s_waitcnt lgkmcnt(6)
    v_mfma_f32_32x32x16_bf16 v[192:207], v[32:35], a[40:43], v[192:207]
    ds_read_b64_tr_b16 v[48:49], v16 offset:45056
    ds_read_b64_tr_b16 v[50:51], v16 offset:46080
    s_waitcnt lgkmcnt(6)
    v_mfma_f32_32x32x16_bf16 v[208:223], v[36:39], a[40:43], v[208:223]
    ds_read_b64_tr_b16 v[52:53], v17 offset:45056
    ds_read_b64_tr_b16 v[54:55], v17 offset:46080
    s_waitcnt lgkmcnt(6)
    v_mfma_f32_32x32x16_bf16 v[224:239], v[40:43], a[40:43], v[224:239]
    ds_read_b64_tr_b16 v[56:57], v18 offset:45056
    ds_read_b64_tr_b16 v[58:59], v18 offset:46080
    buffer_store_dwordx4 v[144:147], v2, s[32:35], s42 offen offset:2048 sc1
    s_waitcnt lgkmcnt(6)
    v_mfma_f32_32x32x16_bf16 v[240:255], v[44:47], a[40:43], v[240:255]
    ds_read_b64_tr_b16 v[60:61], v19 offset:45056
    ds_read_b64_tr_b16 v[62:63], v19 offset:46080
    buffer_store_dwordx4 v[148:151], v2, s[32:35], s42 offen offset:3072 sc1
    s_waitcnt vmcnt(28)
    s_waitcnt lgkmcnt(6)
    v_mfma_f32_32x32x16_bf16 v[192:207], v[48:51], a[44:47], v[192:207]
    ds_read_b64_tr_b16 v[32:33], v16 offset:49152
    ds_read_b64_tr_b16 v[34:35], v16 offset:50176
    s_waitcnt lgkmcnt(6)
    v_mfma_f32_32x32x16_bf16 v[208:223], v[52:55], a[44:47], v[208:223]
    ds_read_b64_tr_b16 v[36:37], v17 offset:49152
    ds_read_b64_tr_b16 v[38:39], v17 offset:50176
    s_waitcnt lgkmcnt(6)
    v_mfma_f32_32x32x16_bf16 v[224:239], v[56:59], a[44:47], v[224:239]
    ds_read_b64_tr_b16 v[40:41], v18 offset:49152
    ds_read_b64_tr_b16 v[42:43], v18 offset:50176
    v_cvt_pk_bf16_f32 v160, v160, v161
    s_waitcnt lgkmcnt(6)
    v_mfma_f32_32x32x16_bf16 v[240:255], v[60:63], a[44:47], v[240:255]
    ds_read_b64_tr_b16 v[44:45], v19 offset:49152
    ds_read_b64_tr_b16 v[46:47], v19 offset:50176
    v_cvt_pk_bf16_f32 v161, v162, v163
    s_waitcnt vmcnt(27)
    s_waitcnt lgkmcnt(6)
    v_mfma_f32_32x32x16_bf16 v[192:207], v[32:35], a[48:51], v[192:207]
    ds_read_b64_tr_b16 v[48:49], v16 offset:53248
    ds_read_b64_tr_b16 v[50:51], v16 offset:54272
    s_waitcnt lgkmcnt(6)
    v_mfma_f32_32x32x16_bf16 v[208:223], v[36:39], a[48:51], v[208:223]
    ds_read_b64_tr_b16 v[52:53], v17 offset:53248
    ds_read_b64_tr_b16 v[54:55], v17 offset:54272
    s_waitcnt lgkmcnt(6)
    v_mfma_f32_32x32x16_bf16 v[224:239], v[40:43], a[48:51], v[224:239]
    ds_read_b64_tr_b16 v[56:57], v18 offset:53248
    ds_read_b64_tr_b16 v[58:59], v18 offset:54272
    v_cvt_pk_bf16_f32 v162, v164, v165
    s_waitcnt lgkmcnt(6)
    v_mfma_f32_32x32x16_bf16 v[240:255], v[44:47], a[48:51], v[240:255]
    ds_read_b64_tr_b16 v[60:61], v19 offset:53248
    ds_read_b64_tr_b16 v[62:63], v19 offset:54272
    v_cvt_pk_bf16_f32 v163, v166, v167
    s_waitcnt vmcnt(26)
    s_waitcnt lgkmcnt(6)
    v_mfma_f32_32x32x16_bf16 v[192:207], v[48:51], a[52:55], v[192:207]
    ds_read_b64_tr_b16 v[32:33], v16 offset:57344
    ds_read_b64_tr_b16 v[34:35], v16 offset:58368
    s_waitcnt lgkmcnt(6)
    v_mfma_f32_32x32x16_bf16 v[208:223], v[52:55], a[52:55], v[208:223]
    ds_read_b64_tr_b16 v[36:37], v17 offset:57344
    ds_read_b64_tr_b16 v[38:39], v17 offset:58368
    s_waitcnt lgkmcnt(6)
    v_mfma_f32_32x32x16_bf16 v[224:239], v[56:59], a[52:55], v[224:239]
    ds_read_b64_tr_b16 v[40:41], v18 offset:57344
    ds_read_b64_tr_b16 v[42:43], v18 offset:58368
    v_cvt_pk_bf16_f32 v164, v168, v169
    s_waitcnt lgkmcnt(6)
    v_mfma_f32_32x32x16_bf16 v[240:255], v[60:63], a[52:55], v[240:255]
    ds_read_b64_tr_b16 v[44:45], v19 offset:57344
    ds_read_b64_tr_b16 v[46:47], v19 offset:58368
    v_cvt_pk_bf16_f32 v165, v170, v171
    s_waitcnt vmcnt(25)
    s_waitcnt lgkmcnt(6)
    v_mfma_f32_32x32x16_bf16 v[192:207], v[32:35], a[56:59], v[192:207]
    ds_read_b64_tr_b16 v[48:49], v16 offset:61440
    ds_read_b64_tr_b16 v[50:51], v16 offset:62464
    s_waitcnt lgkmcnt(6)
    v_mfma_f32_32x32x16_bf16 v[208:223], v[36:39], a[56:59], v[208:223]
    ds_read_b64_tr_b16 v[52:53], v17 offset:61440
    ds_read_b64_tr_b16 v[54:55], v17 offset:62464
    s_waitcnt lgkmcnt(6)
    v_mfma_f32_32x32x16_bf16 v[224:239], v[40:43], a[56:59], v[224:239]
    ds_read_b64_tr_b16 v[56:57], v18 offset:61440
    ds_read_b64_tr_b16 v[58:59], v18 offset:62464
    v_cvt_pk_bf16_f32 v166, v172, v173
    s_waitcnt lgkmcnt(6)
    v_mfma_f32_32x32x16_bf16 v[240:255], v[44:47], a[56:59], v[240:255]
    ds_read_b64_tr_b16 v[60:61], v19 offset:61440
    ds_read_b64_tr_b16 v[62:63], v19 offset:62464
    v_cvt_pk_bf16_f32 v167, v174, v175
    s_waitcnt vmcnt(22)
    s_waitcnt lgkmcnt(6)
    v_mfma_f32_32x32x16_bf16 v[192:207], v[48:51], a[60:63], v[192:207]
    ds_read_b64_tr_b16 v[32:33], v20 offset:0
    ds_read_b64_tr_b16 v[34:35], v20 offset:1024
    s_waitcnt lgkmcnt(6)
    v_mfma_f32_32x32x16_bf16 v[208:223], v[52:55], a[60:63], v[208:223]
    ds_read_b64_tr_b16 v[36:37], v21 offset:0
    ds_read_b64_tr_b16 v[38:39], v21 offset:1024
    s_waitcnt lgkmcnt(6)
    v_mfma_f32_32x32x16_bf16 v[224:239], v[56:59], a[60:63], v[224:239]
    ds_read_b64_tr_b16 v[40:41], v22 offset:0
    ds_read_b64_tr_b16 v[42:43], v22 offset:1024
    buffer_store_dwordx4 v[160:163], v2, s[32:35], s43 offen offset:0 sc1
    s_waitcnt lgkmcnt(6)
    v_mfma_f32_32x32x16_bf16 v[240:255], v[60:63], a[60:63], v[240:255]
    ds_read_b64_tr_b16 v[44:45], v23 offset:0
    ds_read_b64_tr_b16 v[46:47], v23 offset:1024
    buffer_store_dwordx4 v[164:167], v2, s[32:35], s43 offen offset:1024 sc1
    s_waitcnt vmcnt(23)
    s_waitcnt lgkmcnt(6)
    v_mfma_f32_32x32x16_bf16 v[192:207], v[32:35], a[64:67], v[192:207]
    ds_read_b64_tr_b16 v[48:49], v20 offset:4096
    ds_read_b64_tr_b16 v[50:51], v20 offset:5120
    s_waitcnt lgkmcnt(6)
    v_mfma_f32_32x32x16_bf16 v[208:223], v[36:39], a[64:67], v[208:223]
    ds_read_b64_tr_b16 v[52:53], v21 offset:4096
    ds_read_b64_tr_b16 v[54:55], v21 offset:5120
    s_waitcnt lgkmcnt(6)
    v_mfma_f32_32x32x16_bf16 v[224:239], v[40:43], a[64:67], v[224:239]
    ds_read_b64_tr_b16 v[56:57], v22 offset:4096
    ds_read_b64_tr_b16 v[58:59], v22 offset:5120
    v_cvt_pk_bf16_f32 v176, v176, v177
    s_waitcnt lgkmcnt(6)
    v_mfma_f32_32x32x16_bf16 v[240:255], v[44:47], a[64:67], v[240:255]
    ds_read_b64_tr_b16 v[60:61], v23 offset:4096
    ds_read_b64_tr_b16 v[62:63], v23 offset:5120
    v_cvt_pk_bf16_f32 v177, v178, v179
    s_waitcnt vmcnt(22)
    s_waitcnt lgkmcnt(6)
    v_mfma_f32_32x32x16_bf16 v[192:207], v[48:51], a[68:71], v[192:207]
    ds_read_b64_tr_b16 v[32:33], v20 offset:8192
    ds_read_b64_tr_b16 v[34:35], v20 offset:9216
    s_waitcnt lgkmcnt(6)
    v_mfma_f32_32x32x16_bf16 v[208:223], v[52:55], a[68:71], v[208:223]
    ds_read_b64_tr_b16 v[36:37], v21 offset:8192
    ds_read_b64_tr_b16 v[38:39], v21 offset:9216
    s_waitcnt lgkmcnt(6)
    v_mfma_f32_32x32x16_bf16 v[224:239], v[56:59], a[68:71], v[224:239]
    ds_read_b64_tr_b16 v[40:41], v22 offset:8192
    ds_read_b64_tr_b16 v[42:43], v22 offset:9216
    v_cvt_pk_bf16_f32 v178, v180, v181
    s_waitcnt lgkmcnt(6)
    v_mfma_f32_32x32x16_bf16 v[240:255], v[60:63], a[68:71], v[240:255]
    ds_read_b64_tr_b16 v[44:45], v23 offset:8192
    ds_read_b64_tr_b16 v[46:47], v23 offset:9216
    v_cvt_pk_bf16_f32 v179, v182, v183
    s_waitcnt vmcnt(21)
    s_waitcnt lgkmcnt(6)
    v_mfma_f32_32x32x16_bf16 v[192:207], v[32:35], a[72:75], v[192:207]
    ds_read_b64_tr_b16 v[48:49], v20 offset:12288
    ds_read_b64_tr_b16 v[50:51], v20 offset:13312
    s_waitcnt lgkmcnt(6)
    v_mfma_f32_32x32x16_bf16 v[208:223], v[36:39], a[72:75], v[208:223]
    ds_read_b64_tr_b16 v[52:53], v21 offset:12288
    ds_read_b64_tr_b16 v[54:55], v21 offset:13312
    s_waitcnt lgkmcnt(6)
    v_mfma_f32_32x32x16_bf16 v[224:239], v[40:43], a[72:75], v[224:239]
    ds_read_b64_tr_b16 v[56:57], v22 offset:12288
    ds_read_b64_tr_b16 v[58:59], v22 offset:13312
    v_cvt_pk_bf16_f32 v180, v184, v185
    s_waitcnt lgkmcnt(6)
    v_mfma_f32_32x32x16_bf16 v[240:255], v[44:47], a[72:75], v[240:255]
    ds_read_b64_tr_b16 v[60:61], v23 offset:12288
    ds_read_b64_tr_b16 v[62:63], v23 offset:13312
    v_cvt_pk_bf16_f32 v181, v186, v187
    s_waitcnt vmcnt(20)
    s_waitcnt lgkmcnt(6)
    v_mfma_f32_32x32x16_bf16 v[192:207], v[48:51], a[76:79], v[192:207]
    ds_read_b64_tr_b16 v[32:33], v20 offset:16384
    ds_read_b64_tr_b16 v[34:35], v20 offset:17408
    s_waitcnt lgkmcnt(6)
    v_mfma_f32_32x32x16_bf16 v[208:223], v[52:55], a[76:79], v[208:223]
    ds_read_b64_tr_b16 v[36:37], v21 offset:16384
    ds_read_b64_tr_b16 v[38:39], v21 offset:17408
    s_waitcnt lgkmcnt(6)
    v_mfma_f32_32x32x16_bf16 v[224:239], v[56:59], a[76:79], v[224:239]
    ds_read_b64_tr_b16 v[40:41], v22 offset:16384
    ds_read_b64_tr_b16 v[42:43], v22 offset:17408
    v_cvt_pk_bf16_f32 v182, v188, v189
    s_waitcnt lgkmcnt(6)
    v_mfma_f32_32x32x16_bf16 v[240:255], v[60:63], a[76:79], v[240:255]
    ds_read_b64_tr_b16 v[44:45], v23 offset:16384
    ds_read_b64_tr_b16 v[46:47], v23 offset:17408
    v_cvt_pk_bf16_f32 v183, v190, v191
    s_waitcnt vmcnt(17)
    s_waitcnt lgkmcnt(6)
    v_mfma_f32_32x32x16_bf16 v[192:207], v[32:35], a[80:83], v[192:207]
    ds_read_b64_tr_b16 v[48:49], v20 offset:20480
    ds_read_b64_tr_b16 v[50:51], v20 offset:21504
    s_waitcnt lgkmcnt(6)
    v_mfma_f32_32x32x16_bf16 v[208:223], v[36:39], a[80:83], v[208:223]
    ds_read_b64_tr_b16 v[52:53], v21 offset:20480
    ds_read_b64_tr_b16 v[54:55], v21 offset:21504
    s_waitcnt lgkmcnt(6)
    v_mfma_f32_32x32x16_bf16 v[224:239], v[40:43], a[80:83], v[224:239]
    ds_read_b64_tr_b16 v[56:57], v22 offset:20480
    ds_read_b64_tr_b16 v[58:59], v22 offset:21504
    buffer_store_dwordx4 v[176:179], v2, s[32:35], s43 offen offset:2048 sc1
    s_waitcnt lgkmcnt(6)
    v_mfma_f32_32x32x16_bf16 v[240:255], v[44:47], a[80:83], v[240:255]
    ds_read_b64_tr_b16 v[60:61], v23 offset:20480
    ds_read_b64_tr_b16 v[62:63], v23 offset:21504
    buffer_store_dwordx4 v[180:183], v2, s[32:35], s43 offen offset:3072 sc1
    s_waitcnt vmcnt(18)
    s_waitcnt lgkmcnt(6)
    v_mfma_f32_32x32x16_bf16 v[192:207], v[48:51], a[84:87], v[192:207]
    ds_read_b64_tr_b16 v[32:33], v20 offset:24576
    ds_read_b64_tr_b16 v[34:35], v20 offset:25600
    s_waitcnt lgkmcnt(6)
    v_mfma_f32_32x32x16_bf16 v[208:223], v[52:55], a[84:87], v[208:223]
    ds_read_b64_tr_b16 v[36:37], v21 offset:24576
    ds_read_b64_tr_b16 v[38:39], v21 offset:25600
    s_waitcnt lgkmcnt(6)
    v_mfma_f32_32x32x16_bf16 v[224:239], v[56:59], a[84:87], v[224:239]
    ds_read_b64_tr_b16 v[40:41], v22 offset:24576
    ds_read_b64_tr_b16 v[42:43], v22 offset:25600
    s_waitcnt lgkmcnt(6)
    v_mfma_f32_32x32x16_bf16 v[240:255], v[60:63], a[84:87], v[240:255]
    ds_read_b64_tr_b16 v[44:45], v23 offset:24576
    ds_read_b64_tr_b16 v[46:47], v23 offset:25600
    s_waitcnt vmcnt(17)
    s_waitcnt lgkmcnt(6)
    v_mfma_f32_32x32x16_bf16 v[192:207], v[32:35], a[88:91], v[192:207]
    ds_read_b64_tr_b16 v[48:49], v20 offset:28672
    ds_read_b64_tr_b16 v[50:51], v20 offset:29696
    s_waitcnt lgkmcnt(6)
    v_mfma_f32_32x32x16_bf16 v[208:223], v[36:39], a[88:91], v[208:223]
    ds_read_b64_tr_b16 v[52:53], v21 offset:28672
    ds_read_b64_tr_b16 v[54:55], v21 offset:29696
    s_waitcnt lgkmcnt(6)
    v_mfma_f32_32x32x16_bf16 v[224:239], v[40:43], a[88:91], v[224:239]
    ds_read_b64_tr_b16 v[56:57], v22 offset:28672
    ds_read_b64_tr_b16 v[58:59], v22 offset:29696
    s_waitcnt lgkmcnt(6)
    v_mfma_f32_32x32x16_bf16 v[240:255], v[44:47], a[88:91], v[240:255]
    ds_read_b64_tr_b16 v[60:61], v23 offset:28672
    ds_read_b64_tr_b16 v[62:63], v23 offset:29696
    s_waitcnt vmcnt(16)
    s_waitcnt lgkmcnt(6)
    v_mfma_f32_32x32x16_bf16 v[192:207], v[48:51], a[92:95], v[192:207]
    ds_read_b64_tr_b16 v[32:33], v20 offset:32768
    ds_read_b64_tr_b16 v[34:35], v20 offset:33792
    s_waitcnt lgkmcnt(6)
    v_mfma_f32_32x32x16_bf16 v[208:223], v[52:55], a[92:95], v[208:223]
    ds_read_b64_tr_b16 v[36:37], v21 offset:32768
    ds_read_b64_tr_b16 v[38:39], v21 offset:33792
    s_waitcnt lgkmcnt(6)
    v_mfma_f32_32x32x16_bf16 v[224:239], v[56:59], a[92:95], v[224:239]
    ds_read_b64_tr_b16 v[40:41], v22 offset:32768
    ds_read_b64_tr_b16 v[42:43], v22 offset:33792
    s_waitcnt lgkmcnt(6)
    v_mfma_f32_32x32x16_bf16 v[240:255], v[60:63], a[92:95], v[240:255]
    ds_read_b64_tr_b16 v[44:45], v23 offset:32768
    ds_read_b64_tr_b16 v[46:47], v23 offset:33792
    s_waitcnt vmcnt(15)
    s_waitcnt lgkmcnt(6)
    v_mfma_f32_32x32x16_bf16 v[192:207], v[32:35], a[96:99], v[192:207]
    ds_read_b64_tr_b16 v[48:49], v20 offset:36864
    ds_read_b64_tr_b16 v[50:51], v20 offset:37888
    v_lshlrev_b32 v3, 5, v1
    s_mov_b32 s18, 0
    s_lshl_b32 s17, s2, 3
    s_lshl_b32 s19, s16, 1
    s_add_u32 s17, s17, s19
    s_lshl_b32 s19, s17, 10
    buffer_load_dwordx4 v[24:27], v2, s[36:39], s19 offen
    buffer_load_dwordx4 v[64:67], v2, s[36:39], s19 offen offset:1024
    buffer_load_dwordx4 v[72:75], v3, s[32:35], s18 offen
    buffer_load_dwordx4 v[76:79], v3, s[32:35], s18 offen offset:16
    buffer_load_dwordx4 v[80:83], v3, s[32:35], s18 offen offset:2048
    buffer_load_dwordx4 v[84:87], v3, s[32:35], s18 offen offset:2064
    s_waitcnt lgkmcnt(6)
    v_mfma_f32_32x32x16_bf16 v[208:223], v[36:39], a[96:99], v[208:223]
    ds_read_b64_tr_b16 v[52:53], v21 offset:36864
    ds_read_b64_tr_b16 v[54:55], v21 offset:37888
    s_waitcnt lgkmcnt(6)
    v_mfma_f32_32x32x16_bf16 v[224:239], v[40:43], a[96:99], v[224:239]
    ds_read_b64_tr_b16 v[56:57], v22 offset:36864
    ds_read_b64_tr_b16 v[58:59], v22 offset:37888
    s_waitcnt lgkmcnt(6)
    v_mfma_f32_32x32x16_bf16 v[240:255], v[44:47], a[96:99], v[240:255]
    ds_read_b64_tr_b16 v[60:61], v23 offset:36864
    ds_read_b64_tr_b16 v[62:63], v23 offset:37888
    s_waitcnt vmcnt(20)
    s_waitcnt lgkmcnt(6)
    v_mfma_f32_32x32x16_bf16 v[192:207], v[48:51], a[100:103], v[192:207]
    ds_read_b64_tr_b16 v[32:33], v20 offset:40960
    ds_read_b64_tr_b16 v[34:35], v20 offset:41984
    s_waitcnt lgkmcnt(6)
    v_mfma_f32_32x32x16_bf16 v[208:223], v[52:55], a[100:103], v[208:223]
    ds_read_b64_tr_b16 v[36:37], v21 offset:40960
    ds_read_b64_tr_b16 v[38:39], v21 offset:41984
    s_waitcnt lgkmcnt(6)
    v_mfma_f32_32x32x16_bf16 v[224:239], v[56:59], a[100:103], v[224:239]
    ds_read_b64_tr_b16 v[40:41], v22 offset:40960
    ds_read_b64_tr_b16 v[42:43], v22 offset:41984
    s_waitcnt lgkmcnt(6)
    v_mfma_f32_32x32x16_bf16 v[240:255], v[60:63], a[100:103], v[240:255]
    ds_read_b64_tr_b16 v[44:45], v23 offset:40960
    ds_read_b64_tr_b16 v[46:47], v23 offset:41984
    s_waitcnt vmcnt(19)
    s_waitcnt lgkmcnt(6)
    v_mfma_f32_32x32x16_bf16 v[192:207], v[32:35], a[104:107], v[192:207]
    ds_read_b64_tr_b16 v[48:49], v20 offset:45056
    ds_read_b64_tr_b16 v[50:51], v20 offset:46080
    s_waitcnt lgkmcnt(6)
    v_mfma_f32_32x32x16_bf16 v[208:223], v[36:39], a[104:107], v[208:223]
    ds_read_b64_tr_b16 v[52:53], v21 offset:45056
    ds_read_b64_tr_b16 v[54:55], v21 offset:46080
    s_waitcnt lgkmcnt(6)
    v_mfma_f32_32x32x16_bf16 v[224:239], v[40:43], a[104:107], v[224:239]
    ds_read_b64_tr_b16 v[56:57], v22 offset:45056
    ds_read_b64_tr_b16 v[58:59], v22 offset:46080
    s_waitcnt lgkmcnt(6)
    v_mfma_f32_32x32x16_bf16 v[240:255], v[44:47], a[104:107], v[240:255]
    ds_read_b64_tr_b16 v[60:61], v23 offset:45056
    ds_read_b64_tr_b16 v[62:63], v23 offset:46080
    s_waitcnt vmcnt(18)
    s_waitcnt lgkmcnt(6)
    v_mfma_f32_32x32x16_bf16 v[192:207], v[48:51], a[108:111], v[192:207]
    ds_read_b64_tr_b16 v[32:33], v20 offset:49152
    ds_read_b64_tr_b16 v[34:35], v20 offset:50176
    s_waitcnt lgkmcnt(6)
    v_mfma_f32_32x32x16_bf16 v[208:223], v[52:55], a[108:111], v[208:223]
    ds_read_b64_tr_b16 v[36:37], v21 offset:49152
    ds_read_b64_tr_b16 v[38:39], v21 offset:50176
    s_waitcnt lgkmcnt(6)
    v_mfma_f32_32x32x16_bf16 v[224:239], v[56:59], a[108:111], v[224:239]
    ds_read_b64_tr_b16 v[40:41], v22 offset:49152
    ds_read_b64_tr_b16 v[42:43], v22 offset:50176
    s_waitcnt lgkmcnt(6)
    v_mfma_f32_32x32x16_bf16 v[240:255], v[60:63], a[108:111], v[240:255]
    ds_read_b64_tr_b16 v[44:45], v23 offset:49152
    ds_read_b64_tr_b16 v[46:47], v23 offset:50176
    s_waitcnt vmcnt(17)
    s_waitcnt lgkmcnt(6)
    v_mfma_f32_32x32x16_bf16 v[192:207], v[32:35], a[112:115], v[192:207]
    ds_read_b64_tr_b16 v[48:49], v20 offset:53248
    ds_read_b64_tr_b16 v[50:51], v20 offset:54272
    s_waitcnt lgkmcnt(6)
    v_mfma_f32_32x32x16_bf16 v[208:223], v[36:39], a[112:115], v[208:223]
    ds_read_b64_tr_b16 v[52:53], v21 offset:53248
    ds_read_b64_tr_b16 v[54:55], v21 offset:54272
    s_waitcnt lgkmcnt(6)
    v_mfma_f32_32x32x16_bf16 v[224:239], v[40:43], a[112:115], v[224:239]
    ds_read_b64_tr_b16 v[56:57], v22 offset:53248
    ds_read_b64_tr_b16 v[58:59], v22 offset:54272
    s_waitcnt lgkmcnt(6)
    v_mfma_f32_32x32x16_bf16 v[240:255], v[44:47], a[112:115], v[240:255]
    ds_read_b64_tr_b16 v[60:61], v23 offset:53248
    ds_read_b64_tr_b16 v[62:63], v23 offset:54272
    s_waitcnt vmcnt(16)
    s_waitcnt lgkmcnt(6)
    v_mfma_f32_32x32x16_bf16 v[192:207], v[48:51], a[116:119], v[192:207]
    ds_read_b64_tr_b16 v[32:33], v20 offset:57344
    ds_read_b64_tr_b16 v[34:35], v20 offset:58368
    s_waitcnt lgkmcnt(6)
    v_mfma_f32_32x32x16_bf16 v[208:223], v[52:55], a[116:119], v[208:223]
    ds_read_b64_tr_b16 v[36:37], v21 offset:57344
    ds_read_b64_tr_b16 v[38:39], v21 offset:58368
    s_waitcnt lgkmcnt(6)
    v_mfma_f32_32x32x16_bf16 v[224:239], v[56:59], a[116:119], v[224:239]
    ds_read_b64_tr_b16 v[40:41], v22 offset:57344
    ds_read_b64_tr_b16 v[42:43], v22 offset:58368
    s_waitcnt lgkmcnt(6)
    v_mfma_f32_32x32x16_bf16 v[240:255], v[60:63], a[116:119], v[240:255]
    ds_read_b64_tr_b16 v[44:45], v23 offset:57344
    ds_read_b64_tr_b16 v[46:47], v23 offset:58368
    s_waitcnt vmcnt(15)
    s_waitcnt lgkmcnt(6)
    v_mfma_f32_32x32x16_bf16 v[192:207], v[32:35], a[120:123], v[192:207]
    ds_read_b64_tr_b16 v[48:49], v20 offset:61440
    ds_read_b64_tr_b16 v[50:51], v20 offset:62464
    s_waitcnt lgkmcnt(6)
    v_mfma_f32_32x32x16_bf16 v[208:223], v[36:39], a[120:123], v[208:223]
    ds_read_b64_tr_b16 v[52:53], v21 offset:61440
    ds_read_b64_tr_b16 v[54:55], v21 offset:62464
    s_waitcnt lgkmcnt(6)
    v_mfma_f32_32x32x16_bf16 v[224:239], v[40:43], a[120:123], v[224:239]
    ds_read_b64_tr_b16 v[56:57], v22 offset:61440
    ds_read_b64_tr_b16 v[58:59], v22 offset:62464
    s_waitcnt lgkmcnt(6)
    v_mfma_f32_32x32x16_bf16 v[240:255], v[44:47], a[120:123], v[240:255]
    ds_read_b64_tr_b16 v[60:61], v23 offset:61440
    ds_read_b64_tr_b16 v[62:63], v23 offset:62464
    s_waitcnt vmcnt(14)
    s_waitcnt lgkmcnt(6)
    v_mfma_f32_32x32x16_bf16 v[192:207], v[48:51], a[124:127], v[192:207]
    s_waitcnt lgkmcnt(4)
    v_mfma_f32_32x32x16_bf16 v[208:223], v[52:55], a[124:127], v[208:223]
    s_waitcnt lgkmcnt(2)
    v_mfma_f32_32x32x16_bf16 v[224:239], v[56:59], a[124:127], v[224:239]
    s_waitcnt lgkmcnt(0)
    v_mfma_f32_32x32x16_bf16 v[240:255], v[60:63], a[124:127], v[240:255]
    s_nop 7
    s_nop 7
    s_add_u32 s42, s41, 49152
    s_add_u32 s43, s41, 53248
    v_cvt_pk_bf16_f32 v192, v192, v193
    v_cvt_pk_bf16_f32 v193, v194, v195
    v_cvt_pk_bf16_f32 v194, v196, v197
    v_cvt_pk_bf16_f32 v195, v198, v199
    v_cvt_pk_bf16_f32 v196, v200, v201
    v_cvt_pk_bf16_f32 v197, v202, v203
    v_cvt_pk_bf16_f32 v198, v204, v205
    v_cvt_pk_bf16_f32 v199, v206, v207
    buffer_store_dwordx4 v[192:195], v2, s[32:35], s42 offen offset:0 sc1
    buffer_store_dwordx4 v[196:199], v2, s[32:35], s42 offen offset:1024 sc1
    v_cvt_pk_bf16_f32 v208, v208, v209
    v_cvt_pk_bf16_f32 v209, v210, v211
    v_cvt_pk_bf16_f32 v210, v212, v213
    v_cvt_pk_bf16_f32 v211, v214, v215
    v_cvt_pk_bf16_f32 v212, v216, v217
    v_cvt_pk_bf16_f32 v213, v218, v219
    v_cvt_pk_bf16_f32 v214, v220, v221
    v_cvt_pk_bf16_f32 v215, v222, v223
    buffer_store_dwordx4 v[208:211], v2, s[32:35], s42 offen offset:2048 sc1
    buffer_store_dwordx4 v[212:215], v2, s[32:35], s42 offen offset:3072 sc1
    v_cvt_pk_bf16_f32 v224, v224, v225
    v_cvt_pk_bf16_f32 v225, v226, v227
    v_cvt_pk_bf16_f32 v226, v228, v229
    v_cvt_pk_bf16_f32 v227, v230, v231
    v_cvt_pk_bf16_f32 v228, v232, v233
    v_cvt_pk_bf16_f32 v229, v234, v235
    v_cvt_pk_bf16_f32 v230, v236, v237
    v_cvt_pk_bf16_f32 v231, v238, v239
    buffer_store_dwordx4 v[224:227], v2, s[32:35], s43 offen offset:0 sc1
    buffer_store_dwordx4 v[228:231], v2, s[32:35], s43 offen offset:1024 sc1
    v_cvt_pk_bf16_f32 v240, v240, v241
    v_cvt_pk_bf16_f32 v241, v242, v243
    v_cvt_pk_bf16_f32 v242, v244, v245
    v_cvt_pk_bf16_f32 v243, v246, v247
    v_cvt_pk_bf16_f32 v244, v248, v249
    v_cvt_pk_bf16_f32 v245, v250, v251
    v_cvt_pk_bf16_f32 v246, v252, v253
    v_cvt_pk_bf16_f32 v247, v254, v255
    buffer_store_dwordx4 v[240:243], v2, s[32:35], s43 offen offset:2048 sc1
    buffer_store_dwordx4 v[244:247], v2, s[32:35], s43 offen offset:3072 sc1
    s_mov_b32 s52, s48
    s_and_b32 s53, s49, 0xffff
    s_mov_b32 s54, 4194304
    s_mov_b32 s55, 0x20000
    s_lshr_b32 s50, s2, 3
    s_lshl_b32 s50, s50, 2
    s_add_u32 s50, s50, s16
    s_lshl_b32 s50, s50, 15
    s_and_b32 s51, s2, 7
    s_lshl_b32 s51, s51, 10
    s_add_u32 s50, s50, s51
    buffer_load_dwordx4 a[0:3], v2, s[52:55], s50 offen
    s_add_u32 s50, s50, 8192
    buffer_load_dwordx4 a[4:7], v2, s[52:55], s50 offen
    s_add_u32 s50, s50, 8192
    buffer_load_dwordx4 a[8:11], v2, s[52:55], s50 offen
    s_add_u32 s50, s50, 8192
    buffer_load_dwordx4 a[12:15], v2, s[52:55], s50 offen
    s_add_u32 s50, s50, 8192
    s_waitcnt vmcnt(12)
    s_branch kv_kernel_ln
kv_kernel_v:
    s_lshl_b32 s18, s16, 13
    s_mov_b32 s19, 0
    s_add_u32 m0, s18, 0
    s_nop 0
    buffer_load_dwordx4 v10, s[24:27], s19 offen offset:0 lds
    buffer_load_dwordx4 v11, s[24:27], s19 offen offset:1024 lds
    buffer_load_dwordx4 v12, s[24:27], s19 offen offset:2048 lds
    buffer_load_dwordx4 v13, s[24:27], s19 offen offset:3072 lds
    s_lshl_b32 s18, s16, 13
    s_mov_b32 s19, 131072
    s_add_u32 m0, s18, 4096
    s_nop 0
    buffer_load_dwordx4 v10, s[24:27], s19 offen offset:0 lds
    buffer_load_dwordx4 v11, s[24:27], s19 offen offset:1024 lds
    buffer_load_dwordx4 v12, s[24:27], s19 offen offset:2048 lds
    buffer_load_dwordx4 v13, s[24:27], s19 offen offset:3072 lds
    s_add_u32 s47, s40, 0
    buffer_load_dwordx4 a[0:3], v14, s[32:35], s47 offen offset:0
    s_add_u32 s47, s40, 0
    buffer_load_dwordx4 a[4:7], v14, s[32:35], s47 offen offset:1024
    s_add_u32 s47, s40, 0
    buffer_load_dwordx4 a[8:11], v14, s[32:35], s47 offen offset:2048
    s_add_u32 s47, s40, 0
    buffer_load_dwordx4 a[12:15], v14, s[32:35], s47 offen offset:3072
    s_add_u32 s47, s40, 4096
    buffer_load_dwordx4 a[16:19], v14, s[32:35], s47 offen offset:0
    s_add_u32 s47, s40, 4096
    buffer_load_dwordx4 a[20:23], v14, s[32:35], s47 offen offset:1024
    s_add_u32 s47, s40, 4096
    buffer_load_dwordx4 a[24:27], v14, s[32:35], s47 offen offset:2048
    s_add_u32 s47, s40, 4096
    buffer_load_dwordx4 a[28:31], v14, s[32:35], s47 offen offset:3072
    s_lshl_b32 s18, s16, 13
    s_mov_b32 s19, 1048576
    s_add_u32 m0, s18, 32768
    s_nop 0
    buffer_load_dwordx4 v10, s[24:27], s19 offen offset:0 lds
    buffer_load_dwordx4 v11, s[24:27], s19 offen offset:1024 lds
    buffer_load_dwordx4 v12, s[24:27], s19 offen offset:2048 lds
    buffer_load_dwordx4 v13, s[24:27], s19 offen offset:3072 lds
    s_lshl_b32 s18, s16, 13
    s_mov_b32 s19, 1179648
    s_add_u32 m0, s18, 36864
    s_nop 0
    buffer_load_dwordx4 v10, s[24:27], s19 offen offset:0 lds
    buffer_load_dwordx4 v11, s[24:27], s19 offen offset:1024 lds
    buffer_load_dwordx4 v12, s[24:27], s19 offen offset:2048 lds
    buffer_load_dwordx4 v13, s[24:27], s19 offen offset:3072 lds
    s_add_u32 s44, s40, 32768
    s_waitcnt vmcnt(16)
    s_barrier
    ds_read_b64_tr_b16 v[32:33], v16 offset:0
    ds_read_b64_tr_b16 v[34:35], v16 offset:1024
    ds_read_b64_tr_b16 v[36:37], v17 offset:0
    ds_read_b64_tr_b16 v[38:39], v17 offset:1024
    ds_read_b64_tr_b16 v[40:41], v18 offset:0
    ds_read_b64_tr_b16 v[42:43], v18 offset:1024
    ds_read_b64_tr_b16 v[44:45], v19 offset:0
    ds_read_b64_tr_b16 v[46:47], v19 offset:1024
    s_waitcnt vmcnt(15)
    s_waitcnt lgkmcnt(6)
    v_mfma_f32_32x32x16_bf16 v[128:143], a[0:3], v[32:35], 0
    ds_read_b64_tr_b16 v[48:49], v16 offset:4096
    ds_read_b64_tr_b16 v[50:51], v16 offset:5120
    s_add_u32 s47, s40, 8192
    buffer_load_dwordx4 a[32:35], v14, s[32:35], s47 offen offset:0
    s_waitcnt lgkmcnt(6)
    v_mfma_f32_32x32x16_bf16 v[144:159], a[0:3], v[36:39], 0
    ds_read_b64_tr_b16 v[52:53], v17 offset:4096
    ds_read_b64_tr_b16 v[54:55], v17 offset:5120
    s_waitcnt lgkmcnt(6)
    v_mfma_f32_32x32x16_bf16 v[160:175], a[0:3], v[40:43], 0
    ds_read_b64_tr_b16 v[56:57], v18 offset:4096
    ds_read_b64_tr_b16 v[58:59], v18 offset:5120
    s_lshl_b32 s18, s16, 13
    s_mov_b32 s19, 2097152
    s_add_u32 m0, s18, 65536
    s_nop 0
    buffer_load_dwordx4 v10, s[24:27], s19 offen offset:0 lds
    s_waitcnt lgkmcnt(6)
    v_mfma_f32_32x32x16_bf16 v[176:191], a[0:3], v[44:47], 0
    ds_read_b64_tr_b16 v[60:61], v19 offset:4096
    ds_read_b64_tr_b16 v[62:63], v19 offset:5120
    buffer_load_dwordx4 v11, s[24:27], s19 offen offset:1024 lds
    s_waitcnt vmcnt(17)
    s_waitcnt lgkmcnt(6)
    v_mfma_f32_32x32x16_bf16 v[128:143], a[4:7], v[48:51], v[128:143]
    ds_read_b64_tr_b16 v[32:33], v16 offset:8192
    ds_read_b64_tr_b16 v[34:35], v16 offset:9216
    s_add_u32 s47, s40, 8192
    buffer_load_dwordx4 a[36:39], v14, s[32:35], s47 offen offset:1024
    s_waitcnt lgkmcnt(6)
    v_mfma_f32_32x32x16_bf16 v[144:159], a[4:7], v[52:55], v[144:159]
    ds_read_b64_tr_b16 v[36:37], v17 offset:8192
    ds_read_b64_tr_b16 v[38:39], v17 offset:9216
    s_add_u32 s47, s44, 0
    buffer_load_dwordx4 a[0:3], v14, s[32:35], s47 offen offset:0
    s_waitcnt lgkmcnt(6)
    v_mfma_f32_32x32x16_bf16 v[160:175], a[4:7], v[56:59], v[160:175]
    ds_read_b64_tr_b16 v[40:41], v18 offset:8192
    ds_read_b64_tr_b16 v[42:43], v18 offset:9216
    buffer_load_dwordx4 v12, s[24:27], s19 offen offset:2048 lds
    s_waitcnt lgkmcnt(6)
    v_mfma_f32_32x32x16_bf16 v[176:191], a[4:7], v[60:63], v[176:191]
    ds_read_b64_tr_b16 v[44:45], v19 offset:8192
    ds_read_b64_tr_b16 v[46:47], v19 offset:9216
    buffer_load_dwordx4 v13, s[24:27], s19 offen offset:3072 lds
    s_waitcnt vmcnt(20)
    s_waitcnt lgkmcnt(6)
    v_mfma_f32_32x32x16_bf16 v[128:143], a[8:11], v[32:35], v[128:143]
    ds_read_b64_tr_b16 v[48:49], v16 offset:12288
    ds_read_b64_tr_b16 v[50:51], v16 offset:13312
    s_add_u32 s47, s40, 8192
    buffer_load_dwordx4 a[40:43], v14, s[32:35], s47 offen offset:2048
    s_waitcnt lgkmcnt(6)
    v_mfma_f32_32x32x16_bf16 v[144:159], a[8:11], v[36:39], v[144:159]
    ds_read_b64_tr_b16 v[52:53], v17 offset:12288
    ds_read_b64_tr_b16 v[54:55], v17 offset:13312
    s_add_u32 s47, s44, 0
    buffer_load_dwordx4 a[4:7], v14, s[32:35], s47 offen offset:1024
    s_waitcnt lgkmcnt(6)
    v_mfma_f32_32x32x16_bf16 v[160:175], a[8:11], v[40:43], v[160:175]
    ds_read_b64_tr_b16 v[56:57], v18 offset:12288
    ds_read_b64_tr_b16 v[58:59], v18 offset:13312
    s_lshl_b32 s18, s16, 13
    s_mov_b32 s19, 2228224
    s_add_u32 m0, s18, 69632
    s_nop 0
    buffer_load_dwordx4 v10, s[24:27], s19 offen offset:0 lds
    s_waitcnt lgkmcnt(6)
    v_mfma_f32_32x32x16_bf16 v[176:191], a[8:11], v[44:47], v[176:191]
    ds_read_b64_tr_b16 v[60:61], v19 offset:12288
    ds_read_b64_tr_b16 v[62:63], v19 offset:13312
    buffer_load_dwordx4 v11, s[24:27], s19 offen offset:1024 lds
    s_waitcnt vmcnt(23)
    s_waitcnt lgkmcnt(6)
    v_mfma_f32_32x32x16_bf16 v[128:143], a[12:15], v[48:51], v[128:143]
    ds_read_b64_tr_b16 v[32:33], v16 offset:16384
    ds_read_b64_tr_b16 v[34:35], v16 offset:17408
    s_add_u32 s47, s40, 8192
    buffer_load_dwordx4 a[44:47], v14, s[32:35], s47 offen offset:3072
    s_waitcnt lgkmcnt(6)
    v_mfma_f32_32x32x16_bf16 v[144:159], a[12:15], v[52:55], v[144:159]
    ds_read_b64_tr_b16 v[36:37], v17 offset:16384
    ds_read_b64_tr_b16 v[38:39], v17 offset:17408
    s_add_u32 s47, s44, 0
    buffer_load_dwordx4 a[8:11], v14, s[32:35], s47 offen offset:2048
    s_waitcnt lgkmcnt(6)
    v_mfma_f32_32x32x16_bf16 v[160:175], a[12:15], v[56:59], v[160:175]
    ds_read_b64_tr_b16 v[40:41], v18 offset:16384
    ds_read_b64_tr_b16 v[42:43], v18 offset:17408
    buffer_load_dwordx4 v12, s[24:27], s19 offen offset:2048 lds
    s_waitcnt lgkmcnt(6)
    v_mfma_f32_32x32x16_bf16 v[176:191], a[12:15], v[60:63], v[176:191]
    ds_read_b64_tr_b16 v[44:45], v19 offset:16384
    ds_read_b64_tr_b16 v[46:47], v19 offset:17408
    buffer_load_dwordx4 v13, s[24:27], s19 offen offset:3072 lds
    s_waitcnt vmcnt(26)
    s_waitcnt lgkmcnt(6)
    v_mfma_f32_32x32x16_bf16 v[128:143], a[16:19], v[32:35], v[128:143]
    ds_read_b64_tr_b16 v[48:49], v16 offset:20480
    ds_read_b64_tr_b16 v[50:51], v16 offset:21504
    s_add_u32 s47, s40, 12288
    buffer_load_dwordx4 a[48:51], v14, s[32:35], s47 offen offset:0
    s_waitcnt lgkmcnt(6)
    v_mfma_f32_32x32x16_bf16 v[144:159], a[16:19], v[36:39], v[144:159]
    ds_read_b64_tr_b16 v[52:53], v17 offset:20480
    ds_read_b64_tr_b16 v[54:55], v17 offset:21504
    s_add_u32 s47, s44, 0
    buffer_load_dwordx4 a[12:15], v14, s[32:35], s47 offen offset:3072
    s_waitcnt lgkmcnt(6)
    v_mfma_f32_32x32x16_bf16 v[160:175], a[16:19], v[40:43], v[160:175]
    ds_read_b64_tr_b16 v[56:57], v18 offset:20480
    ds_read_b64_tr_b16 v[58:59], v18 offset:21504
    s_lshl_b32 s18, s16, 13
    s_mov_b32 s19, 3145728
    s_add_u32 m0, s18, 98304
    s_nop 0
    buffer_load_dwordx4 v10, s[24:27], s19 offen offset:0 lds
    s_waitcnt lgkmcnt(6)
    v_mfma_f32_32x32x16_bf16 v[176:191], a[16:19], v[44:47], v[176:191]
    ds_read_b64_tr_b16 v[60:61], v19 offset:20480
    ds_read_b64_tr_b16 v[62:63], v19 offset:21504
    buffer_load_dwordx4 v11, s[24:27], s19 offen offset:1024 lds
    s_waitcnt vmcnt(29)
    s_waitcnt lgkmcnt(6)
    v_mfma_f32_32x32x16_bf16 v[128:143], a[20:23], v[48:51], v[128:143]
    ds_read_b64_tr_b16 v[32:33], v16 offset:24576
    ds_read_b64_tr_b16 v[34:35], v16 offset:25600
    s_add_u32 s47, s40, 12288
    buffer_load_dwordx4 a[52:55], v14, s[32:35], s47 offen offset:1024
    s_waitcnt lgkmcnt(6)
    v_mfma_f32_32x32x16_bf16 v[144:159], a[20:23], v[52:55], v[144:159]
    ds_read_b64_tr_b16 v[36:37], v17 offset:24576
    ds_read_b64_tr_b16 v[38:39], v17 offset:25600
    s_add_u32 s47, s44, 4096
    buffer_load_dwordx4 a[16:19], v14, s[32:35], s47 offen offset:0
    s_waitcnt lgkmcnt(6)
    v_mfma_f32_32x32x16_bf16 v[160:175], a[20:23], v[56:59], v[160:175]
    ds_read_b64_tr_b16 v[40:41], v18 offset:24576
    ds_read_b64_tr_b16 v[42:43], v18 offset:25600
    buffer_load_dwordx4 v12, s[24:27], s19 offen offset:2048 lds
    s_waitcnt lgkmcnt(6)
    v_mfma_f32_32x32x16_bf16 v[176:191], a[20:23], v[60:63], v[176:191]
    ds_read_b64_tr_b16 v[44:45], v19 offset:24576
    ds_read_b64_tr_b16 v[46:47], v19 offset:25600
    buffer_load_dwordx4 v13, s[24:27], s19 offen offset:3072 lds
    s_waitcnt vmcnt(32)
    s_waitcnt lgkmcnt(6)
    v_mfma_f32_32x32x16_bf16 v[128:143], a[24:27], v[32:35], v[128:143]
    ds_read_b64_tr_b16 v[48:49], v16 offset:28672
    ds_read_b64_tr_b16 v[50:51], v16 offset:29696
    s_add_u32 s47, s40, 12288
    buffer_load_dwordx4 a[56:59], v14, s[32:35], s47 offen offset:2048
    s_waitcnt lgkmcnt(6)
    v_mfma_f32_32x32x16_bf16 v[144:159], a[24:27], v[36:39], v[144:159]
    ds_read_b64_tr_b16 v[52:53], v17 offset:28672
    ds_read_b64_tr_b16 v[54:55], v17 offset:29696
    s_add_u32 s47, s44, 4096
    buffer_load_dwordx4 a[20:23], v14, s[32:35], s47 offen offset:1024
    s_waitcnt lgkmcnt(6)
    v_mfma_f32_32x32x16_bf16 v[160:175], a[24:27], v[40:43], v[160:175]
    ds_read_b64_tr_b16 v[56:57], v18 offset:28672
    ds_read_b64_tr_b16 v[58:59], v18 offset:29696
    s_lshl_b32 s18, s16, 13
    s_mov_b32 s19, 3276800
    s_add_u32 m0, s18, 102400
    s_nop 0
    buffer_load_dwordx4 v10, s[24:27], s19 offen offset:0 lds
    s_waitcnt lgkmcnt(6)
    v_mfma_f32_32x32x16_bf16 v[176:191], a[24:27], v[44:47], v[176:191]
    ds_read_b64_tr_b16 v[60:61], v19 offset:28672
    ds_read_b64_tr_b16 v[62:63], v19 offset:29696
    buffer_load_dwordx4 v11, s[24:27], s19 offen offset:1024 lds
    s_waitcnt vmcnt(27)
    s_barrier
    s_waitcnt lgkmcnt(6)
    v_mfma_f32_32x32x16_bf16 v[128:143], a[28:31], v[48:51], v[128:143]
    ds_read_b64_tr_b16 v[32:33], v16 offset:32768
    ds_read_b64_tr_b16 v[34:35], v16 offset:33792
    s_add_u32 s47, s40, 12288
    buffer_load_dwordx4 a[60:63], v14, s[32:35], s47 offen offset:3072
    s_waitcnt lgkmcnt(6)
    v_mfma_f32_32x32x16_bf16 v[144:159], a[28:31], v[52:55], v[144:159]
    ds_read_b64_tr_b16 v[36:37], v17 offset:32768
    ds_read_b64_tr_b16 v[38:39], v17 offset:33792
    s_add_u32 s47, s44, 4096
    buffer_load_dwordx4 a[24:27], v14, s[32:35], s47 offen offset:2048
    s_waitcnt lgkmcnt(6)
    v_mfma_f32_32x32x16_bf16 v[160:175], a[28:31], v[56:59], v[160:175]
    ds_read_b64_tr_b16 v[40:41], v18 offset:32768
    ds_read_b64_tr_b16 v[42:43], v18 offset:33792
    buffer_load_dwordx4 v12, s[24:27], s19 offen offset:2048 lds
    s_waitcnt lgkmcnt(6)
    v_mfma_f32_32x32x16_bf16 v[176:191], a[28:31], v[60:63], v[176:191]
    ds_read_b64_tr_b16 v[44:45], v19 offset:32768
    ds_read_b64_tr_b16 v[46:47], v19 offset:33792
    buffer_load_dwordx4 v13, s[24:27], s19 offen offset:3072 lds
    s_waitcnt vmcnt(30)
    s_waitcnt lgkmcnt(6)
    v_mfma_f32_32x32x16_bf16 v[128:143], a[32:35], v[32:35], v[128:143]
    ds_read_b64_tr_b16 v[48:49], v16 offset:36864
    ds_read_b64_tr_b16 v[50:51], v16 offset:37888
    s_add_u32 s47, s40, 16384
    buffer_load_dwordx4 a[64:67], v14, s[32:35], s47 offen offset:0
    s_waitcnt lgkmcnt(6)
    v_mfma_f32_32x32x16_bf16 v[144:159], a[32:35], v[36:39], v[144:159]
    ds_read_b64_tr_b16 v[52:53], v17 offset:36864
    ds_read_b64_tr_b16 v[54:55], v17 offset:37888
    s_add_u32 s47, s44, 4096
    buffer_load_dwordx4 a[28:31], v14, s[32:35], s47 offen offset:3072
    s_waitcnt lgkmcnt(6)
    v_mfma_f32_32x32x16_bf16 v[160:175], a[32:35], v[40:43], v[160:175]
    ds_read_b64_tr_b16 v[56:57], v18 offset:36864
    ds_read_b64_tr_b16 v[58:59], v18 offset:37888
    s_waitcnt lgkmcnt(6)
    v_mfma_f32_32x32x16_bf16 v[176:191], a[32:35], v[44:47], v[176:191]
    ds_read_b64_tr_b16 v[60:61], v19 offset:36864
    ds_read_b64_tr_b16 v[62:63], v19 offset:37888
    s_waitcnt vmcnt(29)
    s_waitcnt lgkmcnt(6)
    v_mfma_f32_32x32x16_bf16 v[128:143], a[36:39], v[48:51], v[128:143]
    ds_read_b64_tr_b16 v[32:33], v16 offset:40960
    ds_read_b64_tr_b16 v[34:35], v16 offset:41984
    s_add_u32 s47, s40, 16384
    buffer_load_dwordx4 a[68:71], v14, s[32:35], s47 offen offset:1024
    s_waitcnt lgkmcnt(6)
    v_mfma_f32_32x32x16_bf16 v[144:159], a[36:39], v[52:55], v[144:159]
    ds_read_b64_tr_b16 v[36:37], v17 offset:40960
    ds_read_b64_tr_b16 v[38:39], v17 offset:41984
    s_add_u32 s47, s44, 8192
    buffer_load_dwordx4 a[32:35], v14, s[32:35], s47 offen offset:0
    s_waitcnt lgkmcnt(6)
    v_mfma_f32_32x32x16_bf16 v[160:175], a[36:39], v[56:59], v[160:175]
    ds_read_b64_tr_b16 v[40:41], v18 offset:40960
    ds_read_b64_tr_b16 v[42:43], v18 offset:41984
    s_waitcnt lgkmcnt(6)
    v_mfma_f32_32x32x16_bf16 v[176:191], a[36:39], v[60:63], v[176:191]
    ds_read_b64_tr_b16 v[44:45], v19 offset:40960
    ds_read_b64_tr_b16 v[46:47], v19 offset:41984
    s_waitcnt vmcnt(27)
    s_waitcnt lgkmcnt(6)
    v_mfma_f32_32x32x16_bf16 v[128:143], a[40:43], v[32:35], v[128:143]
    ds_read_b64_tr_b16 v[48:49], v16 offset:45056
    ds_read_b64_tr_b16 v[50:51], v16 offset:46080
    s_add_u32 s47, s40, 16384
    buffer_load_dwordx4 a[72:75], v14, s[32:35], s47 offen offset:2048
    s_waitcnt lgkmcnt(6)
    v_mfma_f32_32x32x16_bf16 v[144:159], a[40:43], v[36:39], v[144:159]
    ds_read_b64_tr_b16 v[52:53], v17 offset:45056
    ds_read_b64_tr_b16 v[54:55], v17 offset:46080
    s_add_u32 s47, s44, 8192
    buffer_load_dwordx4 a[36:39], v14, s[32:35], s47 offen offset:1024
    s_waitcnt lgkmcnt(6)
    v_mfma_f32_32x32x16_bf16 v[160:175], a[40:43], v[40:43], v[160:175]
    ds_read_b64_tr_b16 v[56:57], v18 offset:45056
    ds_read_b64_tr_b16 v[58:59], v18 offset:46080
    s_waitcnt lgkmcnt(6)
    v_mfma_f32_32x32x16_bf16 v[176:191], a[40:43], v[44:47], v[176:191]
    ds_read_b64_tr_b16 v[60:61], v19 offset:45056
    ds_read_b64_tr_b16 v[62:63], v19 offset:46080
    s_waitcnt vmcnt(25)
    s_waitcnt lgkmcnt(6)
    v_mfma_f32_32x32x16_bf16 v[128:143], a[44:47], v[48:51], v[128:143]
    ds_read_b64_tr_b16 v[32:33], v16 offset:49152
    ds_read_b64_tr_b16 v[34:35], v16 offset:50176
    s_add_u32 s47, s40, 16384
    buffer_load_dwordx4 a[76:79], v14, s[32:35], s47 offen offset:3072
    s_waitcnt lgkmcnt(6)
    v_mfma_f32_32x32x16_bf16 v[144:159], a[44:47], v[52:55], v[144:159]
    ds_read_b64_tr_b16 v[36:37], v17 offset:49152
    ds_read_b64_tr_b16 v[38:39], v17 offset:50176
    s_add_u32 s47, s44, 8192
    buffer_load_dwordx4 a[40:43], v14, s[32:35], s47 offen offset:2048
    s_waitcnt lgkmcnt(6)
    v_mfma_f32_32x32x16_bf16 v[160:175], a[44:47], v[56:59], v[160:175]
    ds_read_b64_tr_b16 v[40:41], v18 offset:49152
    ds_read_b64_tr_b16 v[42:43], v18 offset:50176
    s_waitcnt lgkmcnt(6)
    v_mfma_f32_32x32x16_bf16 v[176:191], a[44:47], v[60:63], v[176:191]
    ds_read_b64_tr_b16 v[44:45], v19 offset:49152
    ds_read_b64_tr_b16 v[46:47], v19 offset:50176
    s_waitcnt vmcnt(23)
    s_waitcnt lgkmcnt(6)
    v_mfma_f32_32x32x16_bf16 v[128:143], a[48:51], v[32:35], v[128:143]
    ds_read_b64_tr_b16 v[48:49], v16 offset:53248
    ds_read_b64_tr_b16 v[50:51], v16 offset:54272
    s_add_u32 s47, s40, 20480
    buffer_load_dwordx4 a[80:83], v14, s[32:35], s47 offen offset:0
    s_waitcnt lgkmcnt(6)
    v_mfma_f32_32x32x16_bf16 v[144:159], a[48:51], v[36:39], v[144:159]
    ds_read_b64_tr_b16 v[52:53], v17 offset:53248
    ds_read_b64_tr_b16 v[54:55], v17 offset:54272
    s_add_u32 s47, s44, 8192
    buffer_load_dwordx4 a[44:47], v14, s[32:35], s47 offen offset:3072
    s_waitcnt lgkmcnt(6)
    v_mfma_f32_32x32x16_bf16 v[160:175], a[48:51], v[40:43], v[160:175]
    ds_read_b64_tr_b16 v[56:57], v18 offset:53248
    ds_read_b64_tr_b16 v[58:59], v18 offset:54272
    s_waitcnt lgkmcnt(6)
    v_mfma_f32_32x32x16_bf16 v[176:191], a[48:51], v[44:47], v[176:191]
    ds_read_b64_tr_b16 v[60:61], v19 offset:53248
    ds_read_b64_tr_b16 v[62:63], v19 offset:54272
    s_waitcnt vmcnt(21)
    s_waitcnt lgkmcnt(6)
    v_mfma_f32_32x32x16_bf16 v[128:143], a[52:55], v[48:51], v[128:143]
    ds_read_b64_tr_b16 v[32:33], v16 offset:57344
    ds_read_b64_tr_b16 v[34:35], v16 offset:58368
    s_add_u32 s47, s40, 20480
    buffer_load_dwordx4 a[84:87], v14, s[32:35], s47 offen offset:1024
    s_waitcnt lgkmcnt(6)
    v_mfma_f32_32x32x16_bf16 v[144:159], a[52:55], v[52:55], v[144:159]
    ds_read_b64_tr_b16 v[36:37], v17 offset:57344
    ds_read_b64_tr_b16 v[38:39], v17 offset:58368
    s_add_u32 s47, s44, 12288
    buffer_load_dwordx4 a[48:51], v14, s[32:35], s47 offen offset:0
    s_waitcnt lgkmcnt(6)
    v_mfma_f32_32x32x16_bf16 v[160:175], a[52:55], v[56:59], v[160:175]
    ds_read_b64_tr_b16 v[40:41], v18 offset:57344
    ds_read_b64_tr_b16 v[42:43], v18 offset:58368
    s_waitcnt lgkmcnt(6)
    v_mfma_f32_32x32x16_bf16 v[176:191], a[52:55], v[60:63], v[176:191]
    ds_read_b64_tr_b16 v[44:45], v19 offset:57344
    ds_read_b64_tr_b16 v[46:47], v19 offset:58368
    s_waitcnt vmcnt(19)
    s_waitcnt lgkmcnt(6)
    v_mfma_f32_32x32x16_bf16 v[128:143], a[56:59], v[32:35], v[128:143]
    ds_read_b64_tr_b16 v[48:49], v16 offset:61440
    ds_read_b64_tr_b16 v[50:51], v16 offset:62464
    s_add_u32 s47, s40, 20480
    buffer_load_dwordx4 a[88:91], v14, s[32:35], s47 offen offset:2048
    s_waitcnt lgkmcnt(6)
    v_mfma_f32_32x32x16_bf16 v[144:159], a[56:59], v[36:39], v[144:159]
    ds_read_b64_tr_b16 v[52:53], v17 offset:61440
    ds_read_b64_tr_b16 v[54:55], v17 offset:62464
    s_add_u32 s47, s44, 12288
    buffer_load_dwordx4 a[52:55], v14, s[32:35], s47 offen offset:1024
    s_waitcnt lgkmcnt(6)
    v_mfma_f32_32x32x16_bf16 v[160:175], a[56:59], v[40:43], v[160:175]
    ds_read_b64_tr_b16 v[56:57], v18 offset:61440
    ds_read_b64_tr_b16 v[58:59], v18 offset:62464
    s_waitcnt lgkmcnt(6)
    v_mfma_f32_32x32x16_bf16 v[176:191], a[56:59], v[44:47], v[176:191]
    ds_read_b64_tr_b16 v[60:61], v19 offset:61440
    ds_read_b64_tr_b16 v[62:63], v19 offset:62464
    s_barrier
    s_waitcnt vmcnt(17)
    s_waitcnt lgkmcnt(6)
    v_mfma_f32_32x32x16_bf16 v[128:143], a[60:63], v[48:51], v[128:143]
    ds_read_b64_tr_b16 v[32:33], v20 offset:0
    ds_read_b64_tr_b16 v[34:35], v20 offset:1024
    s_add_u32 s47, s40, 20480
    buffer_load_dwordx4 a[92:95], v14, s[32:35], s47 offen offset:3072
    s_waitcnt lgkmcnt(6)
    v_mfma_f32_32x32x16_bf16 v[144:159], a[60:63], v[52:55], v[144:159]
    ds_read_b64_tr_b16 v[36:37], v21 offset:0
    ds_read_b64_tr_b16 v[38:39], v21 offset:1024
    s_add_u32 s47, s44, 12288
    buffer_load_dwordx4 a[56:59], v14, s[32:35], s47 offen offset:2048
    s_waitcnt lgkmcnt(6)
    v_mfma_f32_32x32x16_bf16 v[160:175], a[60:63], v[56:59], v[160:175]
    ds_read_b64_tr_b16 v[40:41], v22 offset:0
    ds_read_b64_tr_b16 v[42:43], v22 offset:1024
    s_waitcnt lgkmcnt(6)
    v_mfma_f32_32x32x16_bf16 v[176:191], a[60:63], v[60:63], v[176:191]
    ds_read_b64_tr_b16 v[44:45], v23 offset:0
    ds_read_b64_tr_b16 v[46:47], v23 offset:1024
    s_waitcnt vmcnt(15)
    s_waitcnt lgkmcnt(6)
    v_mfma_f32_32x32x16_bf16 v[128:143], a[64:67], v[32:35], v[128:143]
    ds_read_b64_tr_b16 v[48:49], v20 offset:4096
    ds_read_b64_tr_b16 v[50:51], v20 offset:5120
    s_add_u32 s47, s40, 24576
    buffer_load_dwordx4 a[96:99], v14, s[32:35], s47 offen offset:0
    s_waitcnt lgkmcnt(6)
    v_mfma_f32_32x32x16_bf16 v[144:159], a[64:67], v[36:39], v[144:159]
    ds_read_b64_tr_b16 v[52:53], v21 offset:4096
    ds_read_b64_tr_b16 v[54:55], v21 offset:5120
    s_add_u32 s47, s44, 12288
    buffer_load_dwordx4 a[60:63], v14, s[32:35], s47 offen offset:3072
    s_waitcnt lgkmcnt(6)
    v_mfma_f32_32x32x16_bf16 v[160:175], a[64:67], v[40:43], v[160:175]
    ds_read_b64_tr_b16 v[56:57], v22 offset:4096
    ds_read_b64_tr_b16 v[58:59], v22 offset:5120
    s_waitcnt lgkmcnt(6)
    v_mfma_f32_32x32x16_bf16 v[176:191], a[64:67], v[44:47], v[176:191]
    ds_read_b64_tr_b16 v[60:61], v23 offset:4096
    ds_read_b64_tr_b16 v[62:63], v23 offset:5120
    s_waitcnt vmcnt(15)
    s_waitcnt lgkmcnt(6)
    v_mfma_f32_32x32x16_bf16 v[128:143], a[68:71], v[48:51], v[128:143]
    ds_read_b64_tr_b16 v[32:33], v20 offset:8192
    ds_read_b64_tr_b16 v[34:35], v20 offset:9216
    s_add_u32 s47, s40, 24576
    buffer_load_dwordx4 a[100:103], v14, s[32:35], s47 offen offset:1024
    s_waitcnt lgkmcnt(6)
    v_mfma_f32_32x32x16_bf16 v[144:159], a[68:71], v[52:55], v[144:159]
    ds_read_b64_tr_b16 v[36:37], v21 offset:8192
    ds_read_b64_tr_b16 v[38:39], v21 offset:9216
    s_add_u32 s47, s44, 16384
    buffer_load_dwordx4 a[64:67], v14, s[32:35], s47 offen offset:0
    s_waitcnt lgkmcnt(6)
    v_mfma_f32_32x32x16_bf16 v[160:175], a[68:71], v[56:59], v[160:175]
    ds_read_b64_tr_b16 v[40:41], v22 offset:8192
    ds_read_b64_tr_b16 v[42:43], v22 offset:9216
    s_waitcnt lgkmcnt(6)
    v_mfma_f32_32x32x16_bf16 v[176:191], a[68:71], v[60:63], v[176:191]
    ds_read_b64_tr_b16 v[44:45], v23 offset:8192
    ds_read_b64_tr_b16 v[46:47], v23 offset:9216
    s_waitcnt vmcnt(15)
    s_waitcnt lgkmcnt(6)
    v_mfma_f32_32x32x16_bf16 v[128:143], a[72:75], v[32:35], v[128:143]
    ds_read_b64_tr_b16 v[48:49], v20 offset:12288
    ds_read_b64_tr_b16 v[50:51], v20 offset:13312
    s_add_u32 s47, s40, 24576
    buffer_load_dwordx4 a[104:107], v14, s[32:35], s47 offen offset:2048
    s_waitcnt lgkmcnt(6)
    v_mfma_f32_32x32x16_bf16 v[144:159], a[72:75], v[36:39], v[144:159]
    ds_read_b64_tr_b16 v[52:53], v21 offset:12288
    ds_read_b64_tr_b16 v[54:55], v21 offset:13312
    s_add_u32 s47, s44, 16384
    buffer_load_dwordx4 a[68:71], v14, s[32:35], s47 offen offset:1024
    s_waitcnt lgkmcnt(6)
    v_mfma_f32_32x32x16_bf16 v[160:175], a[72:75], v[40:43], v[160:175]
    ds_read_b64_tr_b16 v[56:57], v22 offset:12288
    ds_read_b64_tr_b16 v[58:59], v22 offset:13312
    s_waitcnt lgkmcnt(6)
    v_mfma_f32_32x32x16_bf16 v[176:191], a[72:75], v[44:47], v[176:191]
    ds_read_b64_tr_b16 v[60:61], v23 offset:12288
    ds_read_b64_tr_b16 v[62:63], v23 offset:13312
    s_waitcnt vmcnt(15)
    s_waitcnt lgkmcnt(6)
    v_mfma_f32_32x32x16_bf16 v[128:143], a[76:79], v[48:51], v[128:143]
    ds_read_b64_tr_b16 v[32:33], v20 offset:16384
    ds_read_b64_tr_b16 v[34:35], v20 offset:17408
    s_add_u32 s47, s40, 24576
    buffer_load_dwordx4 a[108:111], v14, s[32:35], s47 offen offset:3072
    s_waitcnt lgkmcnt(6)
    v_mfma_f32_32x32x16_bf16 v[144:159], a[76:79], v[52:55], v[144:159]
    ds_read_b64_tr_b16 v[36:37], v21 offset:16384
    ds_read_b64_tr_b16 v[38:39], v21 offset:17408
    s_add_u32 s47, s44, 16384
    buffer_load_dwordx4 a[72:75], v14, s[32:35], s47 offen offset:2048
    s_waitcnt lgkmcnt(6)
    v_mfma_f32_32x32x16_bf16 v[160:175], a[76:79], v[56:59], v[160:175]
    ds_read_b64_tr_b16 v[40:41], v22 offset:16384
    ds_read_b64_tr_b16 v[42:43], v22 offset:17408
    s_waitcnt lgkmcnt(6)
    v_mfma_f32_32x32x16_bf16 v[176:191], a[76:79], v[60:63], v[176:191]
    ds_read_b64_tr_b16 v[44:45], v23 offset:16384
    ds_read_b64_tr_b16 v[46:47], v23 offset:17408
    s_waitcnt vmcnt(15)
    s_waitcnt lgkmcnt(6)
    v_mfma_f32_32x32x16_bf16 v[128:143], a[80:83], v[32:35], v[128:143]
    ds_read_b64_tr_b16 v[48:49], v20 offset:20480
    ds_read_b64_tr_b16 v[50:51], v20 offset:21504
    s_add_u32 s47, s40, 28672
    buffer_load_dwordx4 a[112:115], v14, s[32:35], s47 offen offset:0
    s_waitcnt lgkmcnt(6)
    v_mfma_f32_32x32x16_bf16 v[144:159], a[80:83], v[36:39], v[144:159]
    ds_read_b64_tr_b16 v[52:53], v21 offset:20480
    ds_read_b64_tr_b16 v[54:55], v21 offset:21504
    s_add_u32 s47, s44, 16384
    buffer_load_dwordx4 a[76:79], v14, s[32:35], s47 offen offset:3072
    s_waitcnt lgkmcnt(6)
    v_mfma_f32_32x32x16_bf16 v[160:175], a[80:83], v[40:43], v[160:175]
    ds_read_b64_tr_b16 v[56:57], v22 offset:20480
    ds_read_b64_tr_b16 v[58:59], v22 offset:21504
    s_waitcnt lgkmcnt(6)
    v_mfma_f32_32x32x16_bf16 v[176:191], a[80:83], v[44:47], v[176:191]
    ds_read_b64_tr_b16 v[60:61], v23 offset:20480
    ds_read_b64_tr_b16 v[62:63], v23 offset:21504
    s_waitcnt vmcnt(15)
    s_waitcnt lgkmcnt(6)
    v_mfma_f32_32x32x16_bf16 v[128:143], a[84:87], v[48:51], v[128:143]
    ds_read_b64_tr_b16 v[32:33], v20 offset:24576
    ds_read_b64_tr_b16 v[34:35], v20 offset:25600
    s_add_u32 s47, s40, 28672
    buffer_load_dwordx4 a[116:119], v14, s[32:35], s47 offen offset:1024
    s_waitcnt lgkmcnt(6)
    v_mfma_f32_32x32x16_bf16 v[144:159], a[84:87], v[52:55], v[144:159]
    ds_read_b64_tr_b16 v[36:37], v21 offset:24576
    ds_read_b64_tr_b16 v[38:39], v21 offset:25600
    s_add_u32 s47, s44, 20480
    buffer_load_dwordx4 a[80:83], v14, s[32:35], s47 offen offset:0
    s_waitcnt lgkmcnt(6)
    v_mfma_f32_32x32x16_bf16 v[160:175], a[84:87], v[56:59], v[160:175]
    ds_read_b64_tr_b16 v[40:41], v22 offset:24576
    ds_read_b64_tr_b16 v[42:43], v22 offset:25600
    s_waitcnt lgkmcnt(6)
    v_mfma_f32_32x32x16_bf16 v[176:191], a[84:87], v[60:63], v[176:191]
    ds_read_b64_tr_b16 v[44:45], v23 offset:24576
    ds_read_b64_tr_b16 v[46:47], v23 offset:25600
    s_waitcnt vmcnt(15)
    s_waitcnt lgkmcnt(6)
    v_mfma_f32_32x32x16_bf16 v[128:143], a[88:91], v[32:35], v[128:143]
    ds_read_b64_tr_b16 v[48:49], v20 offset:28672
    ds_read_b64_tr_b16 v[50:51], v20 offset:29696
    s_add_u32 s47, s40, 28672
    buffer_load_dwordx4 a[120:123], v14, s[32:35], s47 offen offset:2048
    s_waitcnt lgkmcnt(6)
    v_mfma_f32_32x32x16_bf16 v[144:159], a[88:91], v[36:39], v[144:159]
    ds_read_b64_tr_b16 v[52:53], v21 offset:28672
    ds_read_b64_tr_b16 v[54:55], v21 offset:29696
    s_add_u32 s47, s44, 20480
    buffer_load_dwordx4 a[84:87], v14, s[32:35], s47 offen offset:1024
    s_waitcnt lgkmcnt(6)
    v_mfma_f32_32x32x16_bf16 v[160:175], a[88:91], v[40:43], v[160:175]
    ds_read_b64_tr_b16 v[56:57], v22 offset:28672
    ds_read_b64_tr_b16 v[58:59], v22 offset:29696
    s_waitcnt lgkmcnt(6)
    v_mfma_f32_32x32x16_bf16 v[176:191], a[88:91], v[44:47], v[176:191]
    ds_read_b64_tr_b16 v[60:61], v23 offset:28672
    ds_read_b64_tr_b16 v[62:63], v23 offset:29696
    s_barrier
    s_waitcnt vmcnt(15)
    s_waitcnt lgkmcnt(6)
    v_mfma_f32_32x32x16_bf16 v[128:143], a[92:95], v[48:51], v[128:143]
    ds_read_b64_tr_b16 v[32:33], v20 offset:32768
    ds_read_b64_tr_b16 v[34:35], v20 offset:33792
    s_add_u32 s47, s40, 28672
    buffer_load_dwordx4 a[124:127], v14, s[32:35], s47 offen offset:3072
    s_waitcnt lgkmcnt(6)
    v_mfma_f32_32x32x16_bf16 v[144:159], a[92:95], v[52:55], v[144:159]
    ds_read_b64_tr_b16 v[36:37], v21 offset:32768
    ds_read_b64_tr_b16 v[38:39], v21 offset:33792
    s_add_u32 s47, s44, 20480
    buffer_load_dwordx4 a[88:91], v14, s[32:35], s47 offen offset:2048
    s_waitcnt lgkmcnt(6)
    v_mfma_f32_32x32x16_bf16 v[160:175], a[92:95], v[56:59], v[160:175]
    ds_read_b64_tr_b16 v[40:41], v22 offset:32768
    ds_read_b64_tr_b16 v[42:43], v22 offset:33792
    s_waitcnt lgkmcnt(6)
    v_mfma_f32_32x32x16_bf16 v[176:191], a[92:95], v[60:63], v[176:191]
    ds_read_b64_tr_b16 v[44:45], v23 offset:32768
    ds_read_b64_tr_b16 v[46:47], v23 offset:33792
    s_waitcnt vmcnt(15)
    s_waitcnt lgkmcnt(6)
    v_mfma_f32_32x32x16_bf16 v[128:143], a[96:99], v[32:35], v[128:143]
    ds_read_b64_tr_b16 v[48:49], v20 offset:36864
    ds_read_b64_tr_b16 v[50:51], v20 offset:37888
    s_waitcnt lgkmcnt(6)
    v_mfma_f32_32x32x16_bf16 v[144:159], a[96:99], v[36:39], v[144:159]
    ds_read_b64_tr_b16 v[52:53], v21 offset:36864
    ds_read_b64_tr_b16 v[54:55], v21 offset:37888
    s_add_u32 s47, s44, 20480
    buffer_load_dwordx4 a[92:95], v14, s[32:35], s47 offen offset:3072
    s_waitcnt lgkmcnt(6)
    v_mfma_f32_32x32x16_bf16 v[160:175], a[96:99], v[40:43], v[160:175]
    ds_read_b64_tr_b16 v[56:57], v22 offset:36864
    ds_read_b64_tr_b16 v[58:59], v22 offset:37888
    s_waitcnt lgkmcnt(6)
    v_mfma_f32_32x32x16_bf16 v[176:191], a[96:99], v[44:47], v[176:191]
    ds_read_b64_tr_b16 v[60:61], v23 offset:36864
    ds_read_b64_tr_b16 v[62:63], v23 offset:37888
    s_waitcnt vmcnt(14)
    s_waitcnt lgkmcnt(6)
    v_mfma_f32_32x32x16_bf16 v[128:143], a[100:103], v[48:51], v[128:143]
    ds_read_b64_tr_b16 v[32:33], v20 offset:40960
    ds_read_b64_tr_b16 v[34:35], v20 offset:41984
    s_waitcnt lgkmcnt(6)
    v_mfma_f32_32x32x16_bf16 v[144:159], a[100:103], v[52:55], v[144:159]
    ds_read_b64_tr_b16 v[36:37], v21 offset:40960
    ds_read_b64_tr_b16 v[38:39], v21 offset:41984
    s_add_u32 s47, s44, 24576
    buffer_load_dwordx4 a[96:99], v14, s[32:35], s47 offen offset:0
    s_waitcnt lgkmcnt(6)
    v_mfma_f32_32x32x16_bf16 v[160:175], a[100:103], v[56:59], v[160:175]
    ds_read_b64_tr_b16 v[40:41], v22 offset:40960
    ds_read_b64_tr_b16 v[42:43], v22 offset:41984
    s_waitcnt lgkmcnt(6)
    v_mfma_f32_32x32x16_bf16 v[176:191], a[100:103], v[60:63], v[176:191]
    ds_read_b64_tr_b16 v[44:45], v23 offset:40960
    ds_read_b64_tr_b16 v[46:47], v23 offset:41984
    s_waitcnt vmcnt(13)
    s_waitcnt lgkmcnt(6)
    v_mfma_f32_32x32x16_bf16 v[128:143], a[104:107], v[32:35], v[128:143]
    ds_read_b64_tr_b16 v[48:49], v20 offset:45056
    ds_read_b64_tr_b16 v[50:51], v20 offset:46080
    s_waitcnt lgkmcnt(6)
    v_mfma_f32_32x32x16_bf16 v[144:159], a[104:107], v[36:39], v[144:159]
    ds_read_b64_tr_b16 v[52:53], v21 offset:45056
    ds_read_b64_tr_b16 v[54:55], v21 offset:46080
    s_add_u32 s47, s44, 24576
    buffer_load_dwordx4 a[100:103], v14, s[32:35], s47 offen offset:1024
    s_waitcnt lgkmcnt(6)
    v_mfma_f32_32x32x16_bf16 v[160:175], a[104:107], v[40:43], v[160:175]
    ds_read_b64_tr_b16 v[56:57], v22 offset:45056
    ds_read_b64_tr_b16 v[58:59], v22 offset:46080
    s_waitcnt lgkmcnt(6)
    v_mfma_f32_32x32x16_bf16 v[176:191], a[104:107], v[44:47], v[176:191]
    ds_read_b64_tr_b16 v[60:61], v23 offset:45056
    ds_read_b64_tr_b16 v[62:63], v23 offset:46080
    s_waitcnt vmcnt(12)
    s_waitcnt lgkmcnt(6)
    v_mfma_f32_32x32x16_bf16 v[128:143], a[108:111], v[48:51], v[128:143]
    ds_read_b64_tr_b16 v[32:33], v20 offset:49152
    ds_read_b64_tr_b16 v[34:35], v20 offset:50176
    s_waitcnt lgkmcnt(6)
    v_mfma_f32_32x32x16_bf16 v[144:159], a[108:111], v[52:55], v[144:159]
    ds_read_b64_tr_b16 v[36:37], v21 offset:49152
    ds_read_b64_tr_b16 v[38:39], v21 offset:50176
    s_add_u32 s47, s44, 24576
    buffer_load_dwordx4 a[104:107], v14, s[32:35], s47 offen offset:2048
    s_waitcnt lgkmcnt(6)
    v_mfma_f32_32x32x16_bf16 v[160:175], a[108:111], v[56:59], v[160:175]
    ds_read_b64_tr_b16 v[40:41], v22 offset:49152
    ds_read_b64_tr_b16 v[42:43], v22 offset:50176
    s_waitcnt lgkmcnt(6)
    v_mfma_f32_32x32x16_bf16 v[176:191], a[108:111], v[60:63], v[176:191]
    ds_read_b64_tr_b16 v[44:45], v23 offset:49152
    ds_read_b64_tr_b16 v[46:47], v23 offset:50176
    s_waitcnt vmcnt(11)
    s_waitcnt lgkmcnt(6)
    v_mfma_f32_32x32x16_bf16 v[128:143], a[112:115], v[32:35], v[128:143]
    ds_read_b64_tr_b16 v[48:49], v20 offset:53248
    ds_read_b64_tr_b16 v[50:51], v20 offset:54272
    s_waitcnt lgkmcnt(6)
    v_mfma_f32_32x32x16_bf16 v[144:159], a[112:115], v[36:39], v[144:159]
    ds_read_b64_tr_b16 v[52:53], v21 offset:53248
    ds_read_b64_tr_b16 v[54:55], v21 offset:54272
    s_add_u32 s47, s44, 24576
    buffer_load_dwordx4 a[108:111], v14, s[32:35], s47 offen offset:3072
    s_waitcnt lgkmcnt(6)
    v_mfma_f32_32x32x16_bf16 v[160:175], a[112:115], v[40:43], v[160:175]
    ds_read_b64_tr_b16 v[56:57], v22 offset:53248
    ds_read_b64_tr_b16 v[58:59], v22 offset:54272
    s_waitcnt lgkmcnt(6)
    v_mfma_f32_32x32x16_bf16 v[176:191], a[112:115], v[44:47], v[176:191]
    ds_read_b64_tr_b16 v[60:61], v23 offset:53248
    ds_read_b64_tr_b16 v[62:63], v23 offset:54272
    s_waitcnt vmcnt(10)
    s_waitcnt lgkmcnt(6)
    v_mfma_f32_32x32x16_bf16 v[128:143], a[116:119], v[48:51], v[128:143]
    ds_read_b64_tr_b16 v[32:33], v20 offset:57344
    ds_read_b64_tr_b16 v[34:35], v20 offset:58368
    s_waitcnt lgkmcnt(6)
    v_mfma_f32_32x32x16_bf16 v[144:159], a[116:119], v[52:55], v[144:159]
    ds_read_b64_tr_b16 v[36:37], v21 offset:57344
    ds_read_b64_tr_b16 v[38:39], v21 offset:58368
    s_add_u32 s47, s44, 28672
    buffer_load_dwordx4 a[112:115], v14, s[32:35], s47 offen offset:0
    s_waitcnt lgkmcnt(6)
    v_mfma_f32_32x32x16_bf16 v[160:175], a[116:119], v[56:59], v[160:175]
    ds_read_b64_tr_b16 v[40:41], v22 offset:57344
    ds_read_b64_tr_b16 v[42:43], v22 offset:58368
    s_waitcnt lgkmcnt(6)
    v_mfma_f32_32x32x16_bf16 v[176:191], a[116:119], v[60:63], v[176:191]
    ds_read_b64_tr_b16 v[44:45], v23 offset:57344
    ds_read_b64_tr_b16 v[46:47], v23 offset:58368
    s_waitcnt vmcnt(9)
    s_waitcnt lgkmcnt(6)
    v_mfma_f32_32x32x16_bf16 v[128:143], a[120:123], v[32:35], v[128:143]
    ds_read_b64_tr_b16 v[48:49], v20 offset:61440
    ds_read_b64_tr_b16 v[50:51], v20 offset:62464
    s_waitcnt lgkmcnt(6)
    v_mfma_f32_32x32x16_bf16 v[144:159], a[120:123], v[36:39], v[144:159]
    ds_read_b64_tr_b16 v[52:53], v21 offset:61440
    ds_read_b64_tr_b16 v[54:55], v21 offset:62464
    s_add_u32 s47, s44, 28672
    buffer_load_dwordx4 a[116:119], v14, s[32:35], s47 offen offset:1024
    s_waitcnt lgkmcnt(6)
    v_mfma_f32_32x32x16_bf16 v[160:175], a[120:123], v[40:43], v[160:175]
    ds_read_b64_tr_b16 v[56:57], v22 offset:61440
    ds_read_b64_tr_b16 v[58:59], v22 offset:62464
    s_waitcnt lgkmcnt(6)
    v_mfma_f32_32x32x16_bf16 v[176:191], a[120:123], v[44:47], v[176:191]
    ds_read_b64_tr_b16 v[60:61], v23 offset:61440
    ds_read_b64_tr_b16 v[62:63], v23 offset:62464
    s_waitcnt vmcnt(8)
    s_waitcnt lgkmcnt(6)
    v_mfma_f32_32x32x16_bf16 v[128:143], a[124:127], v[48:51], v[128:143]
    ds_read_b64_tr_b16 v[32:33], v16 offset:0
    ds_read_b64_tr_b16 v[34:35], v16 offset:1024
    s_waitcnt lgkmcnt(6)
    v_mfma_f32_32x32x16_bf16 v[144:159], a[124:127], v[52:55], v[144:159]
    ds_read_b64_tr_b16 v[36:37], v17 offset:0
    ds_read_b64_tr_b16 v[38:39], v17 offset:1024
    s_add_u32 s47, s44, 28672
    buffer_load_dwordx4 a[120:123], v14, s[32:35], s47 offen offset:2048
    s_waitcnt lgkmcnt(6)
    v_mfma_f32_32x32x16_bf16 v[160:175], a[124:127], v[56:59], v[160:175]
    ds_read_b64_tr_b16 v[40:41], v18 offset:0
    ds_read_b64_tr_b16 v[42:43], v18 offset:1024
    s_waitcnt lgkmcnt(6)
    v_mfma_f32_32x32x16_bf16 v[176:191], a[124:127], v[60:63], v[176:191]
    ds_read_b64_tr_b16 v[44:45], v19 offset:0
    ds_read_b64_tr_b16 v[46:47], v19 offset:1024
    s_add_u32 s47, s44, 28672
    buffer_load_dwordx4 a[124:127], v14, s[32:35], s47 offen offset:3072
    s_add_u32 s42, s41, 0
    s_add_u32 s43, s41, 4096
    s_add_u32 s44, s40, 65536
    s_waitcnt lgkmcnt(6)
    v_mfma_f32_32x32x16_bf16 v[192:207], a[0:3], v[32:35], 0
    ds_read_b64_tr_b16 v[48:49], v16 offset:4096
    ds_read_b64_tr_b16 v[50:51], v16 offset:5120
    s_waitcnt lgkmcnt(6)
    v_mfma_f32_32x32x16_bf16 v[208:223], a[0:3], v[36:39], 0
    ds_read_b64_tr_b16 v[52:53], v17 offset:4096
    ds_read_b64_tr_b16 v[54:55], v17 offset:5120
    s_waitcnt lgkmcnt(6)
    v_mfma_f32_32x32x16_bf16 v[224:239], a[0:3], v[40:43], 0
    ds_read_b64_tr_b16 v[56:57], v18 offset:4096
    ds_read_b64_tr_b16 v[58:59], v18 offset:5120
    s_waitcnt lgkmcnt(6)
    v_mfma_f32_32x32x16_bf16 v[240:255], a[0:3], v[44:47], 0
    ds_read_b64_tr_b16 v[60:61], v19 offset:4096
    ds_read_b64_tr_b16 v[62:63], v19 offset:5120
    s_waitcnt lgkmcnt(6)
    v_mfma_f32_32x32x16_bf16 v[192:207], a[4:7], v[48:51], v[192:207]
    ds_read_b64_tr_b16 v[32:33], v16 offset:8192
    ds_read_b64_tr_b16 v[34:35], v16 offset:9216
    s_waitcnt lgkmcnt(6)
    v_mfma_f32_32x32x16_bf16 v[208:223], a[4:7], v[52:55], v[208:223]
    ds_read_b64_tr_b16 v[36:37], v17 offset:8192
    ds_read_b64_tr_b16 v[38:39], v17 offset:9216
    s_add_u32 s47, s44, 0
    buffer_load_dwordx4 a[0:3], v14, s[32:35], s47 offen offset:0
    s_waitcnt lgkmcnt(6)
    v_mfma_f32_32x32x16_bf16 v[224:239], a[4:7], v[56:59], v[224:239]
    ds_read_b64_tr_b16 v[40:41], v18 offset:8192
    ds_read_b64_tr_b16 v[42:43], v18 offset:9216
    v_cvt_pk_bf16_f32 v128, v128, v129
    s_waitcnt lgkmcnt(6)
    v_mfma_f32_32x32x16_bf16 v[240:255], a[4:7], v[60:63], v[240:255]
    ds_read_b64_tr_b16 v[44:45], v19 offset:8192
    ds_read_b64_tr_b16 v[46:47], v19 offset:9216
    v_cvt_pk_bf16_f32 v129, v130, v131
    s_waitcnt lgkmcnt(6)
    v_mfma_f32_32x32x16_bf16 v[192:207], a[8:11], v[32:35], v[192:207]
    ds_read_b64_tr_b16 v[48:49], v16 offset:12288
    ds_read_b64_tr_b16 v[50:51], v16 offset:13312
    s_waitcnt lgkmcnt(6)
    v_mfma_f32_32x32x16_bf16 v[208:223], a[8:11], v[36:39], v[208:223]
    ds_read_b64_tr_b16 v[52:53], v17 offset:12288
    ds_read_b64_tr_b16 v[54:55], v17 offset:13312
    s_add_u32 s47, s44, 0
    buffer_load_dwordx4 a[4:7], v14, s[32:35], s47 offen offset:1024
    s_waitcnt lgkmcnt(6)
    v_mfma_f32_32x32x16_bf16 v[224:239], a[8:11], v[40:43], v[224:239]
    ds_read_b64_tr_b16 v[56:57], v18 offset:12288
    ds_read_b64_tr_b16 v[58:59], v18 offset:13312
    v_cvt_pk_bf16_f32 v130, v132, v133
    s_waitcnt lgkmcnt(6)
    v_mfma_f32_32x32x16_bf16 v[240:255], a[8:11], v[44:47], v[240:255]
    ds_read_b64_tr_b16 v[60:61], v19 offset:12288
    ds_read_b64_tr_b16 v[62:63], v19 offset:13312
    v_cvt_pk_bf16_f32 v131, v134, v135
    s_waitcnt lgkmcnt(6)
    v_mfma_f32_32x32x16_bf16 v[192:207], a[12:15], v[48:51], v[192:207]
    ds_read_b64_tr_b16 v[32:33], v16 offset:16384
    ds_read_b64_tr_b16 v[34:35], v16 offset:17408
    s_waitcnt lgkmcnt(6)
    v_mfma_f32_32x32x16_bf16 v[208:223], a[12:15], v[52:55], v[208:223]
    ds_read_b64_tr_b16 v[36:37], v17 offset:16384
    ds_read_b64_tr_b16 v[38:39], v17 offset:17408
    s_add_u32 s47, s44, 0
    buffer_load_dwordx4 a[8:11], v14, s[32:35], s47 offen offset:2048
    s_waitcnt lgkmcnt(6)
    v_mfma_f32_32x32x16_bf16 v[224:239], a[12:15], v[56:59], v[224:239]
    ds_read_b64_tr_b16 v[40:41], v18 offset:16384
    ds_read_b64_tr_b16 v[42:43], v18 offset:17408
    v_cvt_pk_bf16_f32 v132, v136, v137
    s_waitcnt lgkmcnt(6)
    v_mfma_f32_32x32x16_bf16 v[240:255], a[12:15], v[60:63], v[240:255]
    ds_read_b64_tr_b16 v[44:45], v19 offset:16384
    ds_read_b64_tr_b16 v[46:47], v19 offset:17408
    v_cvt_pk_bf16_f32 v133, v138, v139
    s_waitcnt lgkmcnt(6)
    v_mfma_f32_32x32x16_bf16 v[192:207], a[16:19], v[32:35], v[192:207]
    ds_read_b64_tr_b16 v[48:49], v16 offset:20480
    ds_read_b64_tr_b16 v[50:51], v16 offset:21504
    s_waitcnt lgkmcnt(6)
    v_mfma_f32_32x32x16_bf16 v[208:223], a[16:19], v[36:39], v[208:223]
    ds_read_b64_tr_b16 v[52:53], v17 offset:20480
    ds_read_b64_tr_b16 v[54:55], v17 offset:21504
    s_add_u32 s47, s44, 0
    buffer_load_dwordx4 a[12:15], v14, s[32:35], s47 offen offset:3072
    s_waitcnt lgkmcnt(6)
    v_mfma_f32_32x32x16_bf16 v[224:239], a[16:19], v[40:43], v[224:239]
    ds_read_b64_tr_b16 v[56:57], v18 offset:20480
    ds_read_b64_tr_b16 v[58:59], v18 offset:21504
    v_cvt_pk_bf16_f32 v134, v140, v141
    s_waitcnt lgkmcnt(6)
    v_mfma_f32_32x32x16_bf16 v[240:255], a[16:19], v[44:47], v[240:255]
    ds_read_b64_tr_b16 v[60:61], v19 offset:20480
    ds_read_b64_tr_b16 v[62:63], v19 offset:21504
    v_cvt_pk_bf16_f32 v135, v142, v143
    s_waitcnt lgkmcnt(6)
    v_mfma_f32_32x32x16_bf16 v[192:207], a[20:23], v[48:51], v[192:207]
    ds_read_b64_tr_b16 v[32:33], v16 offset:24576
    ds_read_b64_tr_b16 v[34:35], v16 offset:25600
    s_waitcnt lgkmcnt(6)
    v_mfma_f32_32x32x16_bf16 v[208:223], a[20:23], v[52:55], v[208:223]
    ds_read_b64_tr_b16 v[36:37], v17 offset:24576
    ds_read_b64_tr_b16 v[38:39], v17 offset:25600
    s_add_u32 s47, s44, 4096
    buffer_load_dwordx4 a[16:19], v14, s[32:35], s47 offen offset:0
    s_waitcnt lgkmcnt(6)
    v_mfma_f32_32x32x16_bf16 v[224:239], a[20:23], v[56:59], v[224:239]
    ds_read_b64_tr_b16 v[40:41], v18 offset:24576
    ds_read_b64_tr_b16 v[42:43], v18 offset:25600
    buffer_store_dwordx4 v[128:131], v2, s[32:35], s42 offen offset:0 sc1
    s_waitcnt lgkmcnt(6)
    v_mfma_f32_32x32x16_bf16 v[240:255], a[20:23], v[60:63], v[240:255]
    ds_read_b64_tr_b16 v[44:45], v19 offset:24576
    ds_read_b64_tr_b16 v[46:47], v19 offset:25600
    buffer_store_dwordx4 v[132:135], v2, s[32:35], s43 offen offset:0 sc1
    s_waitcnt lgkmcnt(6)
    v_mfma_f32_32x32x16_bf16 v[192:207], a[24:27], v[32:35], v[192:207]
    ds_read_b64_tr_b16 v[48:49], v16 offset:28672
    ds_read_b64_tr_b16 v[50:51], v16 offset:29696
    s_waitcnt lgkmcnt(6)
    v_mfma_f32_32x32x16_bf16 v[208:223], a[24:27], v[36:39], v[208:223]
    ds_read_b64_tr_b16 v[52:53], v17 offset:28672
    ds_read_b64_tr_b16 v[54:55], v17 offset:29696
    s_add_u32 s47, s44, 4096
    buffer_load_dwordx4 a[20:23], v14, s[32:35], s47 offen offset:1024
    s_waitcnt lgkmcnt(6)
    v_mfma_f32_32x32x16_bf16 v[224:239], a[24:27], v[40:43], v[224:239]
    ds_read_b64_tr_b16 v[56:57], v18 offset:28672
    ds_read_b64_tr_b16 v[58:59], v18 offset:29696
    v_cvt_pk_bf16_f32 v144, v144, v145
    s_waitcnt lgkmcnt(6)
    v_mfma_f32_32x32x16_bf16 v[240:255], a[24:27], v[44:47], v[240:255]
    ds_read_b64_tr_b16 v[60:61], v19 offset:28672
    ds_read_b64_tr_b16 v[62:63], v19 offset:29696
    v_cvt_pk_bf16_f32 v145, v146, v147
    s_waitcnt lgkmcnt(6)
    v_mfma_f32_32x32x16_bf16 v[192:207], a[28:31], v[48:51], v[192:207]
    ds_read_b64_tr_b16 v[32:33], v16 offset:32768
    ds_read_b64_tr_b16 v[34:35], v16 offset:33792
    s_waitcnt lgkmcnt(6)
    v_mfma_f32_32x32x16_bf16 v[208:223], a[28:31], v[52:55], v[208:223]
    ds_read_b64_tr_b16 v[36:37], v17 offset:32768
    ds_read_b64_tr_b16 v[38:39], v17 offset:33792
    s_add_u32 s47, s44, 4096
    buffer_load_dwordx4 a[24:27], v14, s[32:35], s47 offen offset:2048
    s_waitcnt lgkmcnt(6)
    v_mfma_f32_32x32x16_bf16 v[224:239], a[28:31], v[56:59], v[224:239]
    ds_read_b64_tr_b16 v[40:41], v18 offset:32768
    ds_read_b64_tr_b16 v[42:43], v18 offset:33792
    v_cvt_pk_bf16_f32 v146, v148, v149
    s_waitcnt lgkmcnt(6)
    v_mfma_f32_32x32x16_bf16 v[240:255], a[28:31], v[60:63], v[240:255]
    ds_read_b64_tr_b16 v[44:45], v19 offset:32768
    ds_read_b64_tr_b16 v[46:47], v19 offset:33792
    v_cvt_pk_bf16_f32 v147, v150, v151
    s_waitcnt lgkmcnt(6)
    v_mfma_f32_32x32x16_bf16 v[192:207], a[32:35], v[32:35], v[192:207]
    ds_read_b64_tr_b16 v[48:49], v16 offset:36864
    ds_read_b64_tr_b16 v[50:51], v16 offset:37888
    s_waitcnt lgkmcnt(6)
    v_mfma_f32_32x32x16_bf16 v[208:223], a[32:35], v[36:39], v[208:223]
    ds_read_b64_tr_b16 v[52:53], v17 offset:36864
    ds_read_b64_tr_b16 v[54:55], v17 offset:37888
    s_add_u32 s47, s44, 4096
    buffer_load_dwordx4 a[28:31], v14, s[32:35], s47 offen offset:3072
    s_waitcnt lgkmcnt(6)
    v_mfma_f32_32x32x16_bf16 v[224:239], a[32:35], v[40:43], v[224:239]
    ds_read_b64_tr_b16 v[56:57], v18 offset:36864
    ds_read_b64_tr_b16 v[58:59], v18 offset:37888
    v_cvt_pk_bf16_f32 v148, v152, v153
    s_waitcnt lgkmcnt(6)
    v_mfma_f32_32x32x16_bf16 v[240:255], a[32:35], v[44:47], v[240:255]
    ds_read_b64_tr_b16 v[60:61], v19 offset:36864
    ds_read_b64_tr_b16 v[62:63], v19 offset:37888
    v_cvt_pk_bf16_f32 v149, v154, v155
    s_waitcnt lgkmcnt(6)
    v_mfma_f32_32x32x16_bf16 v[192:207], a[36:39], v[48:51], v[192:207]
    ds_read_b64_tr_b16 v[32:33], v16 offset:40960
    ds_read_b64_tr_b16 v[34:35], v16 offset:41984
    s_waitcnt lgkmcnt(6)
    v_mfma_f32_32x32x16_bf16 v[208:223], a[36:39], v[52:55], v[208:223]
    ds_read_b64_tr_b16 v[36:37], v17 offset:40960
    ds_read_b64_tr_b16 v[38:39], v17 offset:41984
    s_add_u32 s47, s44, 8192
    buffer_load_dwordx4 a[32:35], v14, s[32:35], s47 offen offset:0
    s_waitcnt lgkmcnt(6)
    v_mfma_f32_32x32x16_bf16 v[224:239], a[36:39], v[56:59], v[224:239]
    ds_read_b64_tr_b16 v[40:41], v18 offset:40960
    ds_read_b64_tr_b16 v[42:43], v18 offset:41984
    v_cvt_pk_bf16_f32 v150, v156, v157
    s_waitcnt lgkmcnt(6)
    v_mfma_f32_32x32x16_bf16 v[240:255], a[36:39], v[60:63], v[240:255]
    ds_read_b64_tr_b16 v[44:45], v19 offset:40960
    ds_read_b64_tr_b16 v[46:47], v19 offset:41984
    v_cvt_pk_bf16_f32 v151, v158, v159
    s_waitcnt lgkmcnt(6)
    v_mfma_f32_32x32x16_bf16 v[192:207], a[40:43], v[32:35], v[192:207]
    ds_read_b64_tr_b16 v[48:49], v16 offset:45056
    ds_read_b64_tr_b16 v[50:51], v16 offset:46080
    s_waitcnt lgkmcnt(6)
    v_mfma_f32_32x32x16_bf16 v[208:223], a[40:43], v[36:39], v[208:223]
    ds_read_b64_tr_b16 v[52:53], v17 offset:45056
    ds_read_b64_tr_b16 v[54:55], v17 offset:46080
    s_add_u32 s47, s44, 8192
    buffer_load_dwordx4 a[36:39], v14, s[32:35], s47 offen offset:1024
    s_waitcnt lgkmcnt(6)
    v_mfma_f32_32x32x16_bf16 v[224:239], a[40:43], v[40:43], v[224:239]
    ds_read_b64_tr_b16 v[56:57], v18 offset:45056
    ds_read_b64_tr_b16 v[58:59], v18 offset:46080
    buffer_store_dwordx4 v[144:147], v2, s[32:35], s42 offen offset:1024 sc1
    s_waitcnt lgkmcnt(6)
    v_mfma_f32_32x32x16_bf16 v[240:255], a[40:43], v[44:47], v[240:255]
    ds_read_b64_tr_b16 v[60:61], v19 offset:45056
    ds_read_b64_tr_b16 v[62:63], v19 offset:46080
    buffer_store_dwordx4 v[148:151], v2, s[32:35], s43 offen offset:1024 sc1
    s_waitcnt lgkmcnt(6)
    v_mfma_f32_32x32x16_bf16 v[192:207], a[44:47], v[48:51], v[192:207]
    ds_read_b64_tr_b16 v[32:33], v16 offset:49152
    ds_read_b64_tr_b16 v[34:35], v16 offset:50176
    s_waitcnt lgkmcnt(6)
    v_mfma_f32_32x32x16_bf16 v[208:223], a[44:47], v[52:55], v[208:223]
    ds_read_b64_tr_b16 v[36:37], v17 offset:49152
    ds_read_b64_tr_b16 v[38:39], v17 offset:50176
    s_add_u32 s47, s44, 8192
    buffer_load_dwordx4 a[40:43], v14, s[32:35], s47 offen offset:2048
    s_waitcnt lgkmcnt(6)
    v_mfma_f32_32x32x16_bf16 v[224:239], a[44:47], v[56:59], v[224:239]
    ds_read_b64_tr_b16 v[40:41], v18 offset:49152
    ds_read_b64_tr_b16 v[42:43], v18 offset:50176
    v_cvt_pk_bf16_f32 v160, v160, v161
    s_waitcnt lgkmcnt(6)
    v_mfma_f32_32x32x16_bf16 v[240:255], a[44:47], v[60:63], v[240:255]
    ds_read_b64_tr_b16 v[44:45], v19 offset:49152
    ds_read_b64_tr_b16 v[46:47], v19 offset:50176
    v_cvt_pk_bf16_f32 v161, v162, v163
    s_waitcnt lgkmcnt(6)
    v_mfma_f32_32x32x16_bf16 v[192:207], a[48:51], v[32:35], v[192:207]
    ds_read_b64_tr_b16 v[48:49], v16 offset:53248
    ds_read_b64_tr_b16 v[50:51], v16 offset:54272
    s_waitcnt lgkmcnt(6)
    v_mfma_f32_32x32x16_bf16 v[208:223], a[48:51], v[36:39], v[208:223]
    ds_read_b64_tr_b16 v[52:53], v17 offset:53248
    ds_read_b64_tr_b16 v[54:55], v17 offset:54272
    s_add_u32 s47, s44, 8192
    buffer_load_dwordx4 a[44:47], v14, s[32:35], s47 offen offset:3072
    s_waitcnt lgkmcnt(6)
    v_mfma_f32_32x32x16_bf16 v[224:239], a[48:51], v[40:43], v[224:239]
    ds_read_b64_tr_b16 v[56:57], v18 offset:53248
    ds_read_b64_tr_b16 v[58:59], v18 offset:54272
    v_cvt_pk_bf16_f32 v162, v164, v165
    s_waitcnt lgkmcnt(6)
    v_mfma_f32_32x32x16_bf16 v[240:255], a[48:51], v[44:47], v[240:255]
    ds_read_b64_tr_b16 v[60:61], v19 offset:53248
    ds_read_b64_tr_b16 v[62:63], v19 offset:54272
    v_cvt_pk_bf16_f32 v163, v166, v167
    s_waitcnt lgkmcnt(6)
    v_mfma_f32_32x32x16_bf16 v[192:207], a[52:55], v[48:51], v[192:207]
    ds_read_b64_tr_b16 v[32:33], v16 offset:57344
    ds_read_b64_tr_b16 v[34:35], v16 offset:58368
    s_waitcnt lgkmcnt(6)
    v_mfma_f32_32x32x16_bf16 v[208:223], a[52:55], v[52:55], v[208:223]
    ds_read_b64_tr_b16 v[36:37], v17 offset:57344
    ds_read_b64_tr_b16 v[38:39], v17 offset:58368
    s_add_u32 s47, s44, 12288
    buffer_load_dwordx4 a[48:51], v14, s[32:35], s47 offen offset:0
    s_waitcnt lgkmcnt(6)
    v_mfma_f32_32x32x16_bf16 v[224:239], a[52:55], v[56:59], v[224:239]
    ds_read_b64_tr_b16 v[40:41], v18 offset:57344
    ds_read_b64_tr_b16 v[42:43], v18 offset:58368
    v_cvt_pk_bf16_f32 v164, v168, v169
    s_waitcnt lgkmcnt(6)
    v_mfma_f32_32x32x16_bf16 v[240:255], a[52:55], v[60:63], v[240:255]
    ds_read_b64_tr_b16 v[44:45], v19 offset:57344
    ds_read_b64_tr_b16 v[46:47], v19 offset:58368
    v_cvt_pk_bf16_f32 v165, v170, v171
    s_waitcnt lgkmcnt(6)
    v_mfma_f32_32x32x16_bf16 v[192:207], a[56:59], v[32:35], v[192:207]
    ds_read_b64_tr_b16 v[48:49], v16 offset:61440
    ds_read_b64_tr_b16 v[50:51], v16 offset:62464
    s_waitcnt lgkmcnt(6)
    v_mfma_f32_32x32x16_bf16 v[208:223], a[56:59], v[36:39], v[208:223]
    ds_read_b64_tr_b16 v[52:53], v17 offset:61440
    ds_read_b64_tr_b16 v[54:55], v17 offset:62464
    s_add_u32 s47, s44, 12288
    buffer_load_dwordx4 a[52:55], v14, s[32:35], s47 offen offset:1024
    s_waitcnt lgkmcnt(6)
    v_mfma_f32_32x32x16_bf16 v[224:239], a[56:59], v[40:43], v[224:239]
    ds_read_b64_tr_b16 v[56:57], v18 offset:61440
    ds_read_b64_tr_b16 v[58:59], v18 offset:62464
    v_cvt_pk_bf16_f32 v166, v172, v173
    s_waitcnt lgkmcnt(6)
    v_mfma_f32_32x32x16_bf16 v[240:255], a[56:59], v[44:47], v[240:255]
    ds_read_b64_tr_b16 v[60:61], v19 offset:61440
    ds_read_b64_tr_b16 v[62:63], v19 offset:62464
    v_cvt_pk_bf16_f32 v167, v174, v175
    s_waitcnt lgkmcnt(6)
    v_mfma_f32_32x32x16_bf16 v[192:207], a[60:63], v[48:51], v[192:207]
    ds_read_b64_tr_b16 v[32:33], v20 offset:0
    ds_read_b64_tr_b16 v[34:35], v20 offset:1024
    s_waitcnt lgkmcnt(6)
    v_mfma_f32_32x32x16_bf16 v[208:223], a[60:63], v[52:55], v[208:223]
    ds_read_b64_tr_b16 v[36:37], v21 offset:0
    ds_read_b64_tr_b16 v[38:39], v21 offset:1024
    s_add_u32 s47, s44, 12288
    buffer_load_dwordx4 a[56:59], v14, s[32:35], s47 offen offset:2048
    s_waitcnt lgkmcnt(6)
    v_mfma_f32_32x32x16_bf16 v[224:239], a[60:63], v[56:59], v[224:239]
    ds_read_b64_tr_b16 v[40:41], v22 offset:0
    ds_read_b64_tr_b16 v[42:43], v22 offset:1024
    buffer_store_dwordx4 v[160:163], v2, s[32:35], s42 offen offset:2048 sc1
    s_waitcnt lgkmcnt(6)
    v_mfma_f32_32x32x16_bf16 v[240:255], a[60:63], v[60:63], v[240:255]
    ds_read_b64_tr_b16 v[44:45], v23 offset:0
    ds_read_b64_tr_b16 v[46:47], v23 offset:1024
    buffer_store_dwordx4 v[164:167], v2, s[32:35], s43 offen offset:2048 sc1
    s_waitcnt lgkmcnt(6)
    v_mfma_f32_32x32x16_bf16 v[192:207], a[64:67], v[32:35], v[192:207]
    ds_read_b64_tr_b16 v[48:49], v20 offset:4096
    ds_read_b64_tr_b16 v[50:51], v20 offset:5120
    s_waitcnt lgkmcnt(6)
    v_mfma_f32_32x32x16_bf16 v[208:223], a[64:67], v[36:39], v[208:223]
    ds_read_b64_tr_b16 v[52:53], v21 offset:4096
    ds_read_b64_tr_b16 v[54:55], v21 offset:5120
    s_add_u32 s47, s44, 12288
    buffer_load_dwordx4 a[60:63], v14, s[32:35], s47 offen offset:3072
    s_waitcnt lgkmcnt(6)
    v_mfma_f32_32x32x16_bf16 v[224:239], a[64:67], v[40:43], v[224:239]
    ds_read_b64_tr_b16 v[56:57], v22 offset:4096
    ds_read_b64_tr_b16 v[58:59], v22 offset:5120
    v_cvt_pk_bf16_f32 v176, v176, v177
    s_waitcnt lgkmcnt(6)
    v_mfma_f32_32x32x16_bf16 v[240:255], a[64:67], v[44:47], v[240:255]
    ds_read_b64_tr_b16 v[60:61], v23 offset:4096
    ds_read_b64_tr_b16 v[62:63], v23 offset:5120
    v_cvt_pk_bf16_f32 v177, v178, v179
    s_waitcnt lgkmcnt(6)
    v_mfma_f32_32x32x16_bf16 v[192:207], a[68:71], v[48:51], v[192:207]
    ds_read_b64_tr_b16 v[32:33], v20 offset:8192
    ds_read_b64_tr_b16 v[34:35], v20 offset:9216
    s_waitcnt lgkmcnt(6)
    v_mfma_f32_32x32x16_bf16 v[208:223], a[68:71], v[52:55], v[208:223]
    ds_read_b64_tr_b16 v[36:37], v21 offset:8192
    ds_read_b64_tr_b16 v[38:39], v21 offset:9216
    s_add_u32 s47, s44, 16384
    buffer_load_dwordx4 a[64:67], v14, s[32:35], s47 offen offset:0
    s_waitcnt lgkmcnt(6)
    v_mfma_f32_32x32x16_bf16 v[224:239], a[68:71], v[56:59], v[224:239]
    ds_read_b64_tr_b16 v[40:41], v22 offset:8192
    ds_read_b64_tr_b16 v[42:43], v22 offset:9216
    v_cvt_pk_bf16_f32 v178, v180, v181
    s_waitcnt lgkmcnt(6)
    v_mfma_f32_32x32x16_bf16 v[240:255], a[68:71], v[60:63], v[240:255]
    ds_read_b64_tr_b16 v[44:45], v23 offset:8192
    ds_read_b64_tr_b16 v[46:47], v23 offset:9216
    v_cvt_pk_bf16_f32 v179, v182, v183
    s_waitcnt lgkmcnt(6)
    v_mfma_f32_32x32x16_bf16 v[192:207], a[72:75], v[32:35], v[192:207]
    ds_read_b64_tr_b16 v[48:49], v20 offset:12288
    ds_read_b64_tr_b16 v[50:51], v20 offset:13312
    s_waitcnt lgkmcnt(6)
    v_mfma_f32_32x32x16_bf16 v[208:223], a[72:75], v[36:39], v[208:223]
    ds_read_b64_tr_b16 v[52:53], v21 offset:12288
    ds_read_b64_tr_b16 v[54:55], v21 offset:13312
    s_add_u32 s47, s44, 16384
    buffer_load_dwordx4 a[68:71], v14, s[32:35], s47 offen offset:1024
    s_waitcnt lgkmcnt(6)
    v_mfma_f32_32x32x16_bf16 v[224:239], a[72:75], v[40:43], v[224:239]
    ds_read_b64_tr_b16 v[56:57], v22 offset:12288
    ds_read_b64_tr_b16 v[58:59], v22 offset:13312
    v_cvt_pk_bf16_f32 v180, v184, v185
    s_waitcnt lgkmcnt(6)
    v_mfma_f32_32x32x16_bf16 v[240:255], a[72:75], v[44:47], v[240:255]
    ds_read_b64_tr_b16 v[60:61], v23 offset:12288
    ds_read_b64_tr_b16 v[62:63], v23 offset:13312
    v_cvt_pk_bf16_f32 v181, v186, v187
    s_waitcnt lgkmcnt(6)
    v_mfma_f32_32x32x16_bf16 v[192:207], a[76:79], v[48:51], v[192:207]
    ds_read_b64_tr_b16 v[32:33], v20 offset:16384
    ds_read_b64_tr_b16 v[34:35], v20 offset:17408
    s_waitcnt lgkmcnt(6)
    v_mfma_f32_32x32x16_bf16 v[208:223], a[76:79], v[52:55], v[208:223]
    ds_read_b64_tr_b16 v[36:37], v21 offset:16384
    ds_read_b64_tr_b16 v[38:39], v21 offset:17408
    s_add_u32 s47, s44, 16384
    buffer_load_dwordx4 a[72:75], v14, s[32:35], s47 offen offset:2048
    s_waitcnt lgkmcnt(6)
    v_mfma_f32_32x32x16_bf16 v[224:239], a[76:79], v[56:59], v[224:239]
    ds_read_b64_tr_b16 v[40:41], v22 offset:16384
    ds_read_b64_tr_b16 v[42:43], v22 offset:17408
    v_cvt_pk_bf16_f32 v182, v188, v189
    s_waitcnt lgkmcnt(6)
    v_mfma_f32_32x32x16_bf16 v[240:255], a[76:79], v[60:63], v[240:255]
    ds_read_b64_tr_b16 v[44:45], v23 offset:16384
    ds_read_b64_tr_b16 v[46:47], v23 offset:17408
    v_cvt_pk_bf16_f32 v183, v190, v191
    s_waitcnt lgkmcnt(6)
    v_mfma_f32_32x32x16_bf16 v[192:207], a[80:83], v[32:35], v[192:207]
    ds_read_b64_tr_b16 v[48:49], v20 offset:20480
    ds_read_b64_tr_b16 v[50:51], v20 offset:21504
    s_waitcnt lgkmcnt(6)
    v_mfma_f32_32x32x16_bf16 v[208:223], a[80:83], v[36:39], v[208:223]
    ds_read_b64_tr_b16 v[52:53], v21 offset:20480
    ds_read_b64_tr_b16 v[54:55], v21 offset:21504
    s_add_u32 s47, s44, 16384
    buffer_load_dwordx4 a[76:79], v14, s[32:35], s47 offen offset:3072
    s_waitcnt lgkmcnt(6)
    v_mfma_f32_32x32x16_bf16 v[224:239], a[80:83], v[40:43], v[224:239]
    ds_read_b64_tr_b16 v[56:57], v22 offset:20480
    ds_read_b64_tr_b16 v[58:59], v22 offset:21504
    buffer_store_dwordx4 v[176:179], v2, s[32:35], s42 offen offset:3072 sc1
    s_waitcnt lgkmcnt(6)
    v_mfma_f32_32x32x16_bf16 v[240:255], a[80:83], v[44:47], v[240:255]
    ds_read_b64_tr_b16 v[60:61], v23 offset:20480
    ds_read_b64_tr_b16 v[62:63], v23 offset:21504
    buffer_store_dwordx4 v[180:183], v2, s[32:35], s43 offen offset:3072 sc1
    s_waitcnt lgkmcnt(6)
    v_mfma_f32_32x32x16_bf16 v[192:207], a[84:87], v[48:51], v[192:207]
    ds_read_b64_tr_b16 v[32:33], v20 offset:24576
    ds_read_b64_tr_b16 v[34:35], v20 offset:25600
    s_waitcnt lgkmcnt(6)
    v_mfma_f32_32x32x16_bf16 v[208:223], a[84:87], v[52:55], v[208:223]
    ds_read_b64_tr_b16 v[36:37], v21 offset:24576
    ds_read_b64_tr_b16 v[38:39], v21 offset:25600
    s_add_u32 s47, s44, 20480
    buffer_load_dwordx4 a[80:83], v14, s[32:35], s47 offen offset:0
    s_waitcnt lgkmcnt(6)
    v_mfma_f32_32x32x16_bf16 v[224:239], a[84:87], v[56:59], v[224:239]
    ds_read_b64_tr_b16 v[40:41], v22 offset:24576
    ds_read_b64_tr_b16 v[42:43], v22 offset:25600
    s_waitcnt lgkmcnt(6)
    v_mfma_f32_32x32x16_bf16 v[240:255], a[84:87], v[60:63], v[240:255]
    ds_read_b64_tr_b16 v[44:45], v23 offset:24576
    ds_read_b64_tr_b16 v[46:47], v23 offset:25600
    s_waitcnt vmcnt(38)
    s_waitcnt lgkmcnt(6)
    v_mfma_f32_32x32x16_bf16 v[192:207], a[88:91], v[32:35], v[192:207]
    ds_read_b64_tr_b16 v[48:49], v20 offset:28672
    ds_read_b64_tr_b16 v[50:51], v20 offset:29696
    s_waitcnt lgkmcnt(6)
    v_mfma_f32_32x32x16_bf16 v[208:223], a[88:91], v[36:39], v[208:223]
    ds_read_b64_tr_b16 v[52:53], v21 offset:28672
    ds_read_b64_tr_b16 v[54:55], v21 offset:29696
    s_add_u32 s47, s44, 20480
    buffer_load_dwordx4 a[84:87], v14, s[32:35], s47 offen offset:1024
    s_waitcnt lgkmcnt(6)
    v_mfma_f32_32x32x16_bf16 v[224:239], a[88:91], v[40:43], v[224:239]
    ds_read_b64_tr_b16 v[56:57], v22 offset:28672
    ds_read_b64_tr_b16 v[58:59], v22 offset:29696
    s_waitcnt lgkmcnt(6)
    v_mfma_f32_32x32x16_bf16 v[240:255], a[88:91], v[44:47], v[240:255]
    ds_read_b64_tr_b16 v[60:61], v23 offset:28672
    ds_read_b64_tr_b16 v[62:63], v23 offset:29696
    s_waitcnt vmcnt(38)
    s_waitcnt lgkmcnt(6)
    v_mfma_f32_32x32x16_bf16 v[192:207], a[92:95], v[48:51], v[192:207]
    ds_read_b64_tr_b16 v[32:33], v20 offset:32768
    ds_read_b64_tr_b16 v[34:35], v20 offset:33792
    s_waitcnt lgkmcnt(6)
    v_mfma_f32_32x32x16_bf16 v[208:223], a[92:95], v[52:55], v[208:223]
    ds_read_b64_tr_b16 v[36:37], v21 offset:32768
    ds_read_b64_tr_b16 v[38:39], v21 offset:33792
    s_add_u32 s47, s44, 20480
    buffer_load_dwordx4 a[88:91], v14, s[32:35], s47 offen offset:2048
    s_waitcnt lgkmcnt(6)
    v_mfma_f32_32x32x16_bf16 v[224:239], a[92:95], v[56:59], v[224:239]
    ds_read_b64_tr_b16 v[40:41], v22 offset:32768
    ds_read_b64_tr_b16 v[42:43], v22 offset:33792
    s_waitcnt lgkmcnt(6)
    v_mfma_f32_32x32x16_bf16 v[240:255], a[92:95], v[60:63], v[240:255]
    ds_read_b64_tr_b16 v[44:45], v23 offset:32768
    ds_read_b64_tr_b16 v[46:47], v23 offset:33792
    s_waitcnt vmcnt(38)
    s_waitcnt lgkmcnt(6)
    v_mfma_f32_32x32x16_bf16 v[192:207], a[96:99], v[32:35], v[192:207]
    ds_read_b64_tr_b16 v[48:49], v20 offset:36864
    ds_read_b64_tr_b16 v[50:51], v20 offset:37888
    s_waitcnt lgkmcnt(6)
    v_mfma_f32_32x32x16_bf16 v[208:223], a[96:99], v[36:39], v[208:223]
    ds_read_b64_tr_b16 v[52:53], v21 offset:36864
    ds_read_b64_tr_b16 v[54:55], v21 offset:37888
    s_add_u32 s47, s44, 20480
    buffer_load_dwordx4 a[92:95], v14, s[32:35], s47 offen offset:3072
    s_waitcnt lgkmcnt(6)
    v_mfma_f32_32x32x16_bf16 v[224:239], a[96:99], v[40:43], v[224:239]
    ds_read_b64_tr_b16 v[56:57], v22 offset:36864
    ds_read_b64_tr_b16 v[58:59], v22 offset:37888
    s_waitcnt lgkmcnt(6)
    v_mfma_f32_32x32x16_bf16 v[240:255], a[96:99], v[44:47], v[240:255]
    ds_read_b64_tr_b16 v[60:61], v23 offset:36864
    ds_read_b64_tr_b16 v[62:63], v23 offset:37888
    s_waitcnt vmcnt(38)
    s_waitcnt lgkmcnt(6)
    v_mfma_f32_32x32x16_bf16 v[192:207], a[100:103], v[48:51], v[192:207]
    ds_read_b64_tr_b16 v[32:33], v20 offset:40960
    ds_read_b64_tr_b16 v[34:35], v20 offset:41984
    s_waitcnt lgkmcnt(6)
    v_mfma_f32_32x32x16_bf16 v[208:223], a[100:103], v[52:55], v[208:223]
    ds_read_b64_tr_b16 v[36:37], v21 offset:40960
    ds_read_b64_tr_b16 v[38:39], v21 offset:41984
    s_add_u32 s47, s44, 24576
    buffer_load_dwordx4 a[96:99], v14, s[32:35], s47 offen offset:0
    s_waitcnt lgkmcnt(6)
    v_mfma_f32_32x32x16_bf16 v[224:239], a[100:103], v[56:59], v[224:239]
    ds_read_b64_tr_b16 v[40:41], v22 offset:40960
    ds_read_b64_tr_b16 v[42:43], v22 offset:41984
    s_waitcnt lgkmcnt(6)
    v_mfma_f32_32x32x16_bf16 v[240:255], a[100:103], v[60:63], v[240:255]
    ds_read_b64_tr_b16 v[44:45], v23 offset:40960
    ds_read_b64_tr_b16 v[46:47], v23 offset:41984
    s_waitcnt vmcnt(38)
    s_waitcnt lgkmcnt(6)
    v_mfma_f32_32x32x16_bf16 v[192:207], a[104:107], v[32:35], v[192:207]
    ds_read_b64_tr_b16 v[48:49], v20 offset:45056
    ds_read_b64_tr_b16 v[50:51], v20 offset:46080
    s_waitcnt lgkmcnt(6)
    v_mfma_f32_32x32x16_bf16 v[208:223], a[104:107], v[36:39], v[208:223]
    ds_read_b64_tr_b16 v[52:53], v21 offset:45056
    ds_read_b64_tr_b16 v[54:55], v21 offset:46080
    s_add_u32 s47, s44, 24576
    buffer_load_dwordx4 a[100:103], v14, s[32:35], s47 offen offset:1024
    s_waitcnt lgkmcnt(6)
    v_mfma_f32_32x32x16_bf16 v[224:239], a[104:107], v[40:43], v[224:239]
    ds_read_b64_tr_b16 v[56:57], v22 offset:45056
    ds_read_b64_tr_b16 v[58:59], v22 offset:46080
    s_waitcnt lgkmcnt(6)
    v_mfma_f32_32x32x16_bf16 v[240:255], a[104:107], v[44:47], v[240:255]
    ds_read_b64_tr_b16 v[60:61], v23 offset:45056
    ds_read_b64_tr_b16 v[62:63], v23 offset:46080
    s_waitcnt vmcnt(38)
    s_waitcnt lgkmcnt(6)
    v_mfma_f32_32x32x16_bf16 v[192:207], a[108:111], v[48:51], v[192:207]
    ds_read_b64_tr_b16 v[32:33], v20 offset:49152
    ds_read_b64_tr_b16 v[34:35], v20 offset:50176
    s_waitcnt lgkmcnt(6)
    v_mfma_f32_32x32x16_bf16 v[208:223], a[108:111], v[52:55], v[208:223]
    ds_read_b64_tr_b16 v[36:37], v21 offset:49152
    ds_read_b64_tr_b16 v[38:39], v21 offset:50176
    s_add_u32 s47, s44, 24576
    buffer_load_dwordx4 a[104:107], v14, s[32:35], s47 offen offset:2048
    s_waitcnt lgkmcnt(6)
    v_mfma_f32_32x32x16_bf16 v[224:239], a[108:111], v[56:59], v[224:239]
    ds_read_b64_tr_b16 v[40:41], v22 offset:49152
    ds_read_b64_tr_b16 v[42:43], v22 offset:50176
    s_waitcnt lgkmcnt(6)
    v_mfma_f32_32x32x16_bf16 v[240:255], a[108:111], v[60:63], v[240:255]
    ds_read_b64_tr_b16 v[44:45], v23 offset:49152
    ds_read_b64_tr_b16 v[46:47], v23 offset:50176
    s_waitcnt vmcnt(38)
    s_waitcnt lgkmcnt(6)
    v_mfma_f32_32x32x16_bf16 v[192:207], a[112:115], v[32:35], v[192:207]
    ds_read_b64_tr_b16 v[48:49], v20 offset:53248
    ds_read_b64_tr_b16 v[50:51], v20 offset:54272
    s_waitcnt lgkmcnt(6)
    v_mfma_f32_32x32x16_bf16 v[208:223], a[112:115], v[36:39], v[208:223]
    ds_read_b64_tr_b16 v[52:53], v21 offset:53248
    ds_read_b64_tr_b16 v[54:55], v21 offset:54272
    s_add_u32 s47, s44, 24576
    buffer_load_dwordx4 a[108:111], v14, s[32:35], s47 offen offset:3072
    s_waitcnt lgkmcnt(6)
    v_mfma_f32_32x32x16_bf16 v[224:239], a[112:115], v[40:43], v[224:239]
    ds_read_b64_tr_b16 v[56:57], v22 offset:53248
    ds_read_b64_tr_b16 v[58:59], v22 offset:54272
    s_waitcnt lgkmcnt(6)
    v_mfma_f32_32x32x16_bf16 v[240:255], a[112:115], v[44:47], v[240:255]
    ds_read_b64_tr_b16 v[60:61], v23 offset:53248
    ds_read_b64_tr_b16 v[62:63], v23 offset:54272
    s_waitcnt vmcnt(38)
    s_waitcnt lgkmcnt(6)
    v_mfma_f32_32x32x16_bf16 v[192:207], a[116:119], v[48:51], v[192:207]
    ds_read_b64_tr_b16 v[32:33], v20 offset:57344
    ds_read_b64_tr_b16 v[34:35], v20 offset:58368
    s_waitcnt lgkmcnt(6)
    v_mfma_f32_32x32x16_bf16 v[208:223], a[116:119], v[52:55], v[208:223]
    ds_read_b64_tr_b16 v[36:37], v21 offset:57344
    ds_read_b64_tr_b16 v[38:39], v21 offset:58368
    s_add_u32 s47, s44, 28672
    buffer_load_dwordx4 a[112:115], v14, s[32:35], s47 offen offset:0
    s_waitcnt lgkmcnt(6)
    v_mfma_f32_32x32x16_bf16 v[224:239], a[116:119], v[56:59], v[224:239]
    ds_read_b64_tr_b16 v[40:41], v22 offset:57344
    ds_read_b64_tr_b16 v[42:43], v22 offset:58368
    s_waitcnt lgkmcnt(6)
    v_mfma_f32_32x32x16_bf16 v[240:255], a[116:119], v[60:63], v[240:255]
    ds_read_b64_tr_b16 v[44:45], v23 offset:57344
    ds_read_b64_tr_b16 v[46:47], v23 offset:58368
    s_waitcnt vmcnt(38)
    s_waitcnt lgkmcnt(6)
    v_mfma_f32_32x32x16_bf16 v[192:207], a[120:123], v[32:35], v[192:207]
    ds_read_b64_tr_b16 v[48:49], v20 offset:61440
    ds_read_b64_tr_b16 v[50:51], v20 offset:62464
    s_waitcnt lgkmcnt(6)
    v_mfma_f32_32x32x16_bf16 v[208:223], a[120:123], v[36:39], v[208:223]
    ds_read_b64_tr_b16 v[52:53], v21 offset:61440
    ds_read_b64_tr_b16 v[54:55], v21 offset:62464
    s_add_u32 s47, s44, 28672
    buffer_load_dwordx4 a[116:119], v14, s[32:35], s47 offen offset:1024
    s_waitcnt lgkmcnt(6)
    v_mfma_f32_32x32x16_bf16 v[224:239], a[120:123], v[40:43], v[224:239]
    ds_read_b64_tr_b16 v[56:57], v22 offset:61440
    ds_read_b64_tr_b16 v[58:59], v22 offset:62464
    s_waitcnt lgkmcnt(6)
    v_mfma_f32_32x32x16_bf16 v[240:255], a[120:123], v[44:47], v[240:255]
    ds_read_b64_tr_b16 v[60:61], v23 offset:61440
    ds_read_b64_tr_b16 v[62:63], v23 offset:62464
    s_waitcnt vmcnt(38)
    s_waitcnt lgkmcnt(6)
    v_mfma_f32_32x32x16_bf16 v[192:207], a[124:127], v[48:51], v[192:207]
    ds_read_b64_tr_b16 v[32:33], v16 offset:0
    ds_read_b64_tr_b16 v[34:35], v16 offset:1024
    s_waitcnt lgkmcnt(6)
    v_mfma_f32_32x32x16_bf16 v[208:223], a[124:127], v[52:55], v[208:223]
    ds_read_b64_tr_b16 v[36:37], v17 offset:0
    ds_read_b64_tr_b16 v[38:39], v17 offset:1024
    s_add_u32 s47, s44, 28672
    buffer_load_dwordx4 a[120:123], v14, s[32:35], s47 offen offset:2048
    s_waitcnt lgkmcnt(6)
    v_mfma_f32_32x32x16_bf16 v[224:239], a[124:127], v[56:59], v[224:239]
    ds_read_b64_tr_b16 v[40:41], v18 offset:0
    ds_read_b64_tr_b16 v[42:43], v18 offset:1024
    s_waitcnt lgkmcnt(6)
    v_mfma_f32_32x32x16_bf16 v[240:255], a[124:127], v[60:63], v[240:255]
    ds_read_b64_tr_b16 v[44:45], v19 offset:0
    ds_read_b64_tr_b16 v[46:47], v19 offset:1024
    s_add_u32 s47, s44, 28672
    buffer_load_dwordx4 a[124:127], v14, s[32:35], s47 offen offset:3072
    s_add_u32 s42, s41, 16384
    s_add_u32 s43, s41, 20480
    s_add_u32 s44, s40, 98304
    s_waitcnt vmcnt(39)
    s_waitcnt lgkmcnt(6)
    v_mfma_f32_32x32x16_bf16 v[128:143], a[0:3], v[32:35], 0
    ds_read_b64_tr_b16 v[48:49], v16 offset:4096
    ds_read_b64_tr_b16 v[50:51], v16 offset:5120
    s_waitcnt lgkmcnt(6)
    v_mfma_f32_32x32x16_bf16 v[144:159], a[0:3], v[36:39], 0
    ds_read_b64_tr_b16 v[52:53], v17 offset:4096
    ds_read_b64_tr_b16 v[54:55], v17 offset:5120
    s_waitcnt lgkmcnt(6)
    v_mfma_f32_32x32x16_bf16 v[160:175], a[0:3], v[40:43], 0
    ds_read_b64_tr_b16 v[56:57], v18 offset:4096
    ds_read_b64_tr_b16 v[58:59], v18 offset:5120
    s_waitcnt lgkmcnt(6)
    v_mfma_f32_32x32x16_bf16 v[176:191], a[0:3], v[44:47], 0
    ds_read_b64_tr_b16 v[60:61], v19 offset:4096
    ds_read_b64_tr_b16 v[62:63], v19 offset:5120
    s_waitcnt vmcnt(38)
    s_waitcnt lgkmcnt(6)
    v_mfma_f32_32x32x16_bf16 v[128:143], a[4:7], v[48:51], v[128:143]
    ds_read_b64_tr_b16 v[32:33], v16 offset:8192
    ds_read_b64_tr_b16 v[34:35], v16 offset:9216
    s_waitcnt lgkmcnt(6)
    v_mfma_f32_32x32x16_bf16 v[144:159], a[4:7], v[52:55], v[144:159]
    ds_read_b64_tr_b16 v[36:37], v17 offset:8192
    ds_read_b64_tr_b16 v[38:39], v17 offset:9216
    s_add_u32 s47, s44, 0
    buffer_load_dwordx4 a[0:3], v14, s[32:35], s47 offen offset:0
    s_waitcnt lgkmcnt(6)
    v_mfma_f32_32x32x16_bf16 v[160:175], a[4:7], v[56:59], v[160:175]
    ds_read_b64_tr_b16 v[40:41], v18 offset:8192
    ds_read_b64_tr_b16 v[42:43], v18 offset:9216
    v_cvt_pk_bf16_f32 v192, v192, v193
    s_waitcnt lgkmcnt(6)
    v_mfma_f32_32x32x16_bf16 v[176:191], a[4:7], v[60:63], v[176:191]
    ds_read_b64_tr_b16 v[44:45], v19 offset:8192
    ds_read_b64_tr_b16 v[46:47], v19 offset:9216
    v_cvt_pk_bf16_f32 v193, v194, v195
    s_waitcnt vmcnt(38)
    s_waitcnt lgkmcnt(6)
    v_mfma_f32_32x32x16_bf16 v[128:143], a[8:11], v[32:35], v[128:143]
    ds_read_b64_tr_b16 v[48:49], v16 offset:12288
    ds_read_b64_tr_b16 v[50:51], v16 offset:13312
    s_waitcnt lgkmcnt(6)
    v_mfma_f32_32x32x16_bf16 v[144:159], a[8:11], v[36:39], v[144:159]
    ds_read_b64_tr_b16 v[52:53], v17 offset:12288
    ds_read_b64_tr_b16 v[54:55], v17 offset:13312
    s_add_u32 s47, s44, 0
    buffer_load_dwordx4 a[4:7], v14, s[32:35], s47 offen offset:1024
    s_waitcnt lgkmcnt(6)
    v_mfma_f32_32x32x16_bf16 v[160:175], a[8:11], v[40:43], v[160:175]
    ds_read_b64_tr_b16 v[56:57], v18 offset:12288
    ds_read_b64_tr_b16 v[58:59], v18 offset:13312
    v_cvt_pk_bf16_f32 v194, v196, v197
    s_waitcnt lgkmcnt(6)
    v_mfma_f32_32x32x16_bf16 v[176:191], a[8:11], v[44:47], v[176:191]
    ds_read_b64_tr_b16 v[60:61], v19 offset:12288
    ds_read_b64_tr_b16 v[62:63], v19 offset:13312
    v_cvt_pk_bf16_f32 v195, v198, v199
    s_waitcnt vmcnt(38)
    s_waitcnt lgkmcnt(6)
    v_mfma_f32_32x32x16_bf16 v[128:143], a[12:15], v[48:51], v[128:143]
    ds_read_b64_tr_b16 v[32:33], v16 offset:16384
    ds_read_b64_tr_b16 v[34:35], v16 offset:17408
    s_waitcnt lgkmcnt(6)
    v_mfma_f32_32x32x16_bf16 v[144:159], a[12:15], v[52:55], v[144:159]
    ds_read_b64_tr_b16 v[36:37], v17 offset:16384
    ds_read_b64_tr_b16 v[38:39], v17 offset:17408
    s_add_u32 s47, s44, 0
    buffer_load_dwordx4 a[8:11], v14, s[32:35], s47 offen offset:2048
    s_waitcnt lgkmcnt(6)
    v_mfma_f32_32x32x16_bf16 v[160:175], a[12:15], v[56:59], v[160:175]
    ds_read_b64_tr_b16 v[40:41], v18 offset:16384
    ds_read_b64_tr_b16 v[42:43], v18 offset:17408
    v_cvt_pk_bf16_f32 v196, v200, v201
    s_waitcnt lgkmcnt(6)
    v_mfma_f32_32x32x16_bf16 v[176:191], a[12:15], v[60:63], v[176:191]
    ds_read_b64_tr_b16 v[44:45], v19 offset:16384
    ds_read_b64_tr_b16 v[46:47], v19 offset:17408
    v_cvt_pk_bf16_f32 v197, v202, v203
    s_waitcnt vmcnt(38)
    s_waitcnt lgkmcnt(6)
    v_mfma_f32_32x32x16_bf16 v[128:143], a[16:19], v[32:35], v[128:143]
    ds_read_b64_tr_b16 v[48:49], v16 offset:20480
    ds_read_b64_tr_b16 v[50:51], v16 offset:21504
    s_waitcnt lgkmcnt(6)
    v_mfma_f32_32x32x16_bf16 v[144:159], a[16:19], v[36:39], v[144:159]
    ds_read_b64_tr_b16 v[52:53], v17 offset:20480
    ds_read_b64_tr_b16 v[54:55], v17 offset:21504
    s_add_u32 s47, s44, 0
    buffer_load_dwordx4 a[12:15], v14, s[32:35], s47 offen offset:3072
    s_waitcnt lgkmcnt(6)
    v_mfma_f32_32x32x16_bf16 v[160:175], a[16:19], v[40:43], v[160:175]
    ds_read_b64_tr_b16 v[56:57], v18 offset:20480
    ds_read_b64_tr_b16 v[58:59], v18 offset:21504
    v_cvt_pk_bf16_f32 v198, v204, v205
    s_waitcnt lgkmcnt(6)
    v_mfma_f32_32x32x16_bf16 v[176:191], a[16:19], v[44:47], v[176:191]
    ds_read_b64_tr_b16 v[60:61], v19 offset:20480
    ds_read_b64_tr_b16 v[62:63], v19 offset:21504
    v_cvt_pk_bf16_f32 v199, v206, v207
    s_waitcnt vmcnt(36)
    s_waitcnt lgkmcnt(6)
    v_mfma_f32_32x32x16_bf16 v[128:143], a[20:23], v[48:51], v[128:143]
    ds_read_b64_tr_b16 v[32:33], v16 offset:24576
    ds_read_b64_tr_b16 v[34:35], v16 offset:25600
    s_waitcnt lgkmcnt(6)
    v_mfma_f32_32x32x16_bf16 v[144:159], a[20:23], v[52:55], v[144:159]
    ds_read_b64_tr_b16 v[36:37], v17 offset:24576
    ds_read_b64_tr_b16 v[38:39], v17 offset:25600
    s_add_u32 s47, s44, 4096
    buffer_load_dwordx4 a[16:19], v14, s[32:35], s47 offen offset:0
    s_waitcnt lgkmcnt(6)
    v_mfma_f32_32x32x16_bf16 v[160:175], a[20:23], v[56:59], v[160:175]
    ds_read_b64_tr_b16 v[40:41], v18 offset:24576
    ds_read_b64_tr_b16 v[42:43], v18 offset:25600
    buffer_store_dwordx4 v[192:195], v2, s[32:35], s42 offen offset:0 sc1
    s_waitcnt lgkmcnt(6)
    v_mfma_f32_32x32x16_bf16 v[176:191], a[20:23], v[60:63], v[176:191]
    ds_read_b64_tr_b16 v[44:45], v19 offset:24576
    ds_read_b64_tr_b16 v[46:47], v19 offset:25600
    buffer_store_dwordx4 v[196:199], v2, s[32:35], s43 offen offset:0 sc1
    s_waitcnt vmcnt(38)
    s_waitcnt lgkmcnt(6)
    v_mfma_f32_32x32x16_bf16 v[128:143], a[24:27], v[32:35], v[128:143]
    ds_read_b64_tr_b16 v[48:49], v16 offset:28672
    ds_read_b64_tr_b16 v[50:51], v16 offset:29696
    s_waitcnt lgkmcnt(6)
    v_mfma_f32_32x32x16_bf16 v[144:159], a[24:27], v[36:39], v[144:159]
    ds_read_b64_tr_b16 v[52:53], v17 offset:28672
    ds_read_b64_tr_b16 v[54:55], v17 offset:29696
    s_add_u32 s47, s44, 4096
    buffer_load_dwordx4 a[20:23], v14, s[32:35], s47 offen offset:1024
    s_waitcnt lgkmcnt(6)
    v_mfma_f32_32x32x16_bf16 v[160:175], a[24:27], v[40:43], v[160:175]
    ds_read_b64_tr_b16 v[56:57], v18 offset:28672
    ds_read_b64_tr_b16 v[58:59], v18 offset:29696
    v_cvt_pk_bf16_f32 v208, v208, v209
    s_waitcnt lgkmcnt(6)
    v_mfma_f32_32x32x16_bf16 v[176:191], a[24:27], v[44:47], v[176:191]
    ds_read_b64_tr_b16 v[60:61], v19 offset:28672
    ds_read_b64_tr_b16 v[62:63], v19 offset:29696
    v_cvt_pk_bf16_f32 v209, v210, v211
    s_waitcnt vmcnt(38)
    s_waitcnt lgkmcnt(6)
    v_mfma_f32_32x32x16_bf16 v[128:143], a[28:31], v[48:51], v[128:143]
    ds_read_b64_tr_b16 v[32:33], v16 offset:32768
    ds_read_b64_tr_b16 v[34:35], v16 offset:33792
    s_waitcnt lgkmcnt(6)
    v_mfma_f32_32x32x16_bf16 v[144:159], a[28:31], v[52:55], v[144:159]
    ds_read_b64_tr_b16 v[36:37], v17 offset:32768
    ds_read_b64_tr_b16 v[38:39], v17 offset:33792
    s_add_u32 s47, s44, 4096
    buffer_load_dwordx4 a[24:27], v14, s[32:35], s47 offen offset:2048
    s_waitcnt lgkmcnt(6)
    v_mfma_f32_32x32x16_bf16 v[160:175], a[28:31], v[56:59], v[160:175]
    ds_read_b64_tr_b16 v[40:41], v18 offset:32768
    ds_read_b64_tr_b16 v[42:43], v18 offset:33792
    v_cvt_pk_bf16_f32 v210, v212, v213
    s_waitcnt lgkmcnt(6)
    v_mfma_f32_32x32x16_bf16 v[176:191], a[28:31], v[60:63], v[176:191]
    ds_read_b64_tr_b16 v[44:45], v19 offset:32768
    ds_read_b64_tr_b16 v[46:47], v19 offset:33792
    v_cvt_pk_bf16_f32 v211, v214, v215
    s_waitcnt vmcnt(38)
    s_waitcnt lgkmcnt(6)
    v_mfma_f32_32x32x16_bf16 v[128:143], a[32:35], v[32:35], v[128:143]
    ds_read_b64_tr_b16 v[48:49], v16 offset:36864
    ds_read_b64_tr_b16 v[50:51], v16 offset:37888
    s_waitcnt lgkmcnt(6)
    v_mfma_f32_32x32x16_bf16 v[144:159], a[32:35], v[36:39], v[144:159]
    ds_read_b64_tr_b16 v[52:53], v17 offset:36864
    ds_read_b64_tr_b16 v[54:55], v17 offset:37888
    s_add_u32 s47, s44, 4096
    buffer_load_dwordx4 a[28:31], v14, s[32:35], s47 offen offset:3072
    s_waitcnt lgkmcnt(6)
    v_mfma_f32_32x32x16_bf16 v[160:175], a[32:35], v[40:43], v[160:175]
    ds_read_b64_tr_b16 v[56:57], v18 offset:36864
    ds_read_b64_tr_b16 v[58:59], v18 offset:37888
    v_cvt_pk_bf16_f32 v212, v216, v217
    s_waitcnt lgkmcnt(6)
    v_mfma_f32_32x32x16_bf16 v[176:191], a[32:35], v[44:47], v[176:191]
    ds_read_b64_tr_b16 v[60:61], v19 offset:36864
    ds_read_b64_tr_b16 v[62:63], v19 offset:37888
    v_cvt_pk_bf16_f32 v213, v218, v219
    s_waitcnt vmcnt(38)
    s_waitcnt lgkmcnt(6)
    v_mfma_f32_32x32x16_bf16 v[128:143], a[36:39], v[48:51], v[128:143]
    ds_read_b64_tr_b16 v[32:33], v16 offset:40960
    ds_read_b64_tr_b16 v[34:35], v16 offset:41984
    s_waitcnt lgkmcnt(6)
    v_mfma_f32_32x32x16_bf16 v[144:159], a[36:39], v[52:55], v[144:159]
    ds_read_b64_tr_b16 v[36:37], v17 offset:40960
    ds_read_b64_tr_b16 v[38:39], v17 offset:41984
    s_add_u32 s47, s44, 8192
    buffer_load_dwordx4 a[32:35], v14, s[32:35], s47 offen offset:0
    s_waitcnt lgkmcnt(6)
    v_mfma_f32_32x32x16_bf16 v[160:175], a[36:39], v[56:59], v[160:175]
    ds_read_b64_tr_b16 v[40:41], v18 offset:40960
    ds_read_b64_tr_b16 v[42:43], v18 offset:41984
    v_cvt_pk_bf16_f32 v214, v220, v221
    s_waitcnt lgkmcnt(6)
    v_mfma_f32_32x32x16_bf16 v[176:191], a[36:39], v[60:63], v[176:191]
    ds_read_b64_tr_b16 v[44:45], v19 offset:40960
    ds_read_b64_tr_b16 v[46:47], v19 offset:41984
    v_cvt_pk_bf16_f32 v215, v222, v223
    s_waitcnt vmcnt(36)
    s_waitcnt lgkmcnt(6)
    v_mfma_f32_32x32x16_bf16 v[128:143], a[40:43], v[32:35], v[128:143]
    ds_read_b64_tr_b16 v[48:49], v16 offset:45056
    ds_read_b64_tr_b16 v[50:51], v16 offset:46080
    s_waitcnt lgkmcnt(6)
    v_mfma_f32_32x32x16_bf16 v[144:159], a[40:43], v[36:39], v[144:159]
    ds_read_b64_tr_b16 v[52:53], v17 offset:45056
    ds_read_b64_tr_b16 v[54:55], v17 offset:46080
    s_add_u32 s47, s44, 8192
    buffer_load_dwordx4 a[36:39], v14, s[32:35], s47 offen offset:1024
    s_waitcnt lgkmcnt(6)
    v_mfma_f32_32x32x16_bf16 v[160:175], a[40:43], v[40:43], v[160:175]
    ds_read_b64_tr_b16 v[56:57], v18 offset:45056
    ds_read_b64_tr_b16 v[58:59], v18 offset:46080
    buffer_store_dwordx4 v[208:211], v2, s[32:35], s42 offen offset:1024 sc1
    s_waitcnt lgkmcnt(6)
    v_mfma_f32_32x32x16_bf16 v[176:191], a[40:43], v[44:47], v[176:191]
    ds_read_b64_tr_b16 v[60:61], v19 offset:45056
    ds_read_b64_tr_b16 v[62:63], v19 offset:46080
    buffer_store_dwordx4 v[212:215], v2, s[32:35], s43 offen offset:1024 sc1
    s_waitcnt vmcnt(38)
    s_waitcnt lgkmcnt(6)
    v_mfma_f32_32x32x16_bf16 v[128:143], a[44:47], v[48:51], v[128:143]
    ds_read_b64_tr_b16 v[32:33], v16 offset:49152
    ds_read_b64_tr_b16 v[34:35], v16 offset:50176
    s_waitcnt lgkmcnt(6)
    v_mfma_f32_32x32x16_bf16 v[144:159], a[44:47], v[52:55], v[144:159]
    ds_read_b64_tr_b16 v[36:37], v17 offset:49152
    ds_read_b64_tr_b16 v[38:39], v17 offset:50176
    s_add_u32 s47, s44, 8192
    buffer_load_dwordx4 a[40:43], v14, s[32:35], s47 offen offset:2048
    s_waitcnt lgkmcnt(6)
    v_mfma_f32_32x32x16_bf16 v[160:175], a[44:47], v[56:59], v[160:175]
    ds_read_b64_tr_b16 v[40:41], v18 offset:49152
    ds_read_b64_tr_b16 v[42:43], v18 offset:50176
    v_cvt_pk_bf16_f32 v224, v224, v225
    s_waitcnt lgkmcnt(6)
    v_mfma_f32_32x32x16_bf16 v[176:191], a[44:47], v[60:63], v[176:191]
    ds_read_b64_tr_b16 v[44:45], v19 offset:49152
    ds_read_b64_tr_b16 v[46:47], v19 offset:50176
    v_cvt_pk_bf16_f32 v225, v226, v227
    s_waitcnt vmcnt(38)
    s_waitcnt lgkmcnt(6)
    v_mfma_f32_32x32x16_bf16 v[128:143], a[48:51], v[32:35], v[128:143]
    ds_read_b64_tr_b16 v[48:49], v16 offset:53248
    ds_read_b64_tr_b16 v[50:51], v16 offset:54272
    s_waitcnt lgkmcnt(6)
    v_mfma_f32_32x32x16_bf16 v[144:159], a[48:51], v[36:39], v[144:159]
    ds_read_b64_tr_b16 v[52:53], v17 offset:53248
    ds_read_b64_tr_b16 v[54:55], v17 offset:54272
    s_add_u32 s47, s44, 8192
    buffer_load_dwordx4 a[44:47], v14, s[32:35], s47 offen offset:3072
    s_waitcnt lgkmcnt(6)
    v_mfma_f32_32x32x16_bf16 v[160:175], a[48:51], v[40:43], v[160:175]
    ds_read_b64_tr_b16 v[56:57], v18 offset:53248
    ds_read_b64_tr_b16 v[58:59], v18 offset:54272
    v_cvt_pk_bf16_f32 v226, v228, v229
    s_waitcnt lgkmcnt(6)
    v_mfma_f32_32x32x16_bf16 v[176:191], a[48:51], v[44:47], v[176:191]
    ds_read_b64_tr_b16 v[60:61], v19 offset:53248
    ds_read_b64_tr_b16 v[62:63], v19 offset:54272
    v_cvt_pk_bf16_f32 v227, v230, v231
    s_waitcnt vmcnt(38)
    s_waitcnt lgkmcnt(6)
    v_mfma_f32_32x32x16_bf16 v[128:143], a[52:55], v[48:51], v[128:143]
    ds_read_b64_tr_b16 v[32:33], v16 offset:57344
    ds_read_b64_tr_b16 v[34:35], v16 offset:58368
    s_waitcnt lgkmcnt(6)
    v_mfma_f32_32x32x16_bf16 v[144:159], a[52:55], v[52:55], v[144:159]
    ds_read_b64_tr_b16 v[36:37], v17 offset:57344
    ds_read_b64_tr_b16 v[38:39], v17 offset:58368
    s_add_u32 s47, s44, 12288
    buffer_load_dwordx4 a[48:51], v14, s[32:35], s47 offen offset:0
    s_waitcnt lgkmcnt(6)
    v_mfma_f32_32x32x16_bf16 v[160:175], a[52:55], v[56:59], v[160:175]
    ds_read_b64_tr_b16 v[40:41], v18 offset:57344
    ds_read_b64_tr_b16 v[42:43], v18 offset:58368
    v_cvt_pk_bf16_f32 v228, v232, v233
    s_waitcnt lgkmcnt(6)
    v_mfma_f32_32x32x16_bf16 v[176:191], a[52:55], v[60:63], v[176:191]
    ds_read_b64_tr_b16 v[44:45], v19 offset:57344
    ds_read_b64_tr_b16 v[46:47], v19 offset:58368
    v_cvt_pk_bf16_f32 v229, v234, v235
    s_waitcnt vmcnt(38)
    s_waitcnt lgkmcnt(6)
    v_mfma_f32_32x32x16_bf16 v[128:143], a[56:59], v[32:35], v[128:143]
    ds_read_b64_tr_b16 v[48:49], v16 offset:61440
    ds_read_b64_tr_b16 v[50:51], v16 offset:62464
    s_waitcnt lgkmcnt(6)
    v_mfma_f32_32x32x16_bf16 v[144:159], a[56:59], v[36:39], v[144:159]
    ds_read_b64_tr_b16 v[52:53], v17 offset:61440
    ds_read_b64_tr_b16 v[54:55], v17 offset:62464
    s_add_u32 s47, s44, 12288
    buffer_load_dwordx4 a[52:55], v14, s[32:35], s47 offen offset:1024
    s_waitcnt lgkmcnt(6)
    v_mfma_f32_32x32x16_bf16 v[160:175], a[56:59], v[40:43], v[160:175]
    ds_read_b64_tr_b16 v[56:57], v18 offset:61440
    ds_read_b64_tr_b16 v[58:59], v18 offset:62464
    v_cvt_pk_bf16_f32 v230, v236, v237
    s_waitcnt lgkmcnt(6)
    v_mfma_f32_32x32x16_bf16 v[176:191], a[56:59], v[44:47], v[176:191]
    ds_read_b64_tr_b16 v[60:61], v19 offset:61440
    ds_read_b64_tr_b16 v[62:63], v19 offset:62464
    v_cvt_pk_bf16_f32 v231, v238, v239
    s_waitcnt vmcnt(36)
    s_waitcnt lgkmcnt(6)
    v_mfma_f32_32x32x16_bf16 v[128:143], a[60:63], v[48:51], v[128:143]
    ds_read_b64_tr_b16 v[32:33], v20 offset:0
    ds_read_b64_tr_b16 v[34:35], v20 offset:1024
    s_waitcnt lgkmcnt(6)
    v_mfma_f32_32x32x16_bf16 v[144:159], a[60:63], v[52:55], v[144:159]
    ds_read_b64_tr_b16 v[36:37], v21 offset:0
    ds_read_b64_tr_b16 v[38:39], v21 offset:1024
    s_add_u32 s47, s44, 12288
    buffer_load_dwordx4 a[56:59], v14, s[32:35], s47 offen offset:2048
    s_waitcnt lgkmcnt(6)
    v_mfma_f32_32x32x16_bf16 v[160:175], a[60:63], v[56:59], v[160:175]
    ds_read_b64_tr_b16 v[40:41], v22 offset:0
    ds_read_b64_tr_b16 v[42:43], v22 offset:1024
    buffer_store_dwordx4 v[224:227], v2, s[32:35], s42 offen offset:2048 sc1
    s_waitcnt lgkmcnt(6)
    v_mfma_f32_32x32x16_bf16 v[176:191], a[60:63], v[60:63], v[176:191]
    ds_read_b64_tr_b16 v[44:45], v23 offset:0
    ds_read_b64_tr_b16 v[46:47], v23 offset:1024
    buffer_store_dwordx4 v[228:231], v2, s[32:35], s43 offen offset:2048 sc1
    s_waitcnt vmcnt(38)
    s_waitcnt lgkmcnt(6)
    v_mfma_f32_32x32x16_bf16 v[128:143], a[64:67], v[32:35], v[128:143]
    ds_read_b64_tr_b16 v[48:49], v20 offset:4096
    ds_read_b64_tr_b16 v[50:51], v20 offset:5120
    s_waitcnt lgkmcnt(6)
    v_mfma_f32_32x32x16_bf16 v[144:159], a[64:67], v[36:39], v[144:159]
    ds_read_b64_tr_b16 v[52:53], v21 offset:4096
    ds_read_b64_tr_b16 v[54:55], v21 offset:5120
    s_add_u32 s47, s44, 12288
    buffer_load_dwordx4 a[60:63], v14, s[32:35], s47 offen offset:3072
    s_waitcnt lgkmcnt(6)
    v_mfma_f32_32x32x16_bf16 v[160:175], a[64:67], v[40:43], v[160:175]
    ds_read_b64_tr_b16 v[56:57], v22 offset:4096
    ds_read_b64_tr_b16 v[58:59], v22 offset:5120
    v_cvt_pk_bf16_f32 v240, v240, v241
    s_waitcnt lgkmcnt(6)
    v_mfma_f32_32x32x16_bf16 v[176:191], a[64:67], v[44:47], v[176:191]
    ds_read_b64_tr_b16 v[60:61], v23 offset:4096
    ds_read_b64_tr_b16 v[62:63], v23 offset:5120
    v_cvt_pk_bf16_f32 v241, v242, v243
    s_waitcnt vmcnt(38)
    s_waitcnt lgkmcnt(6)
    v_mfma_f32_32x32x16_bf16 v[128:143], a[68:71], v[48:51], v[128:143]
    ds_read_b64_tr_b16 v[32:33], v20 offset:8192
    ds_read_b64_tr_b16 v[34:35], v20 offset:9216
    s_waitcnt lgkmcnt(6)
    v_mfma_f32_32x32x16_bf16 v[144:159], a[68:71], v[52:55], v[144:159]
    ds_read_b64_tr_b16 v[36:37], v21 offset:8192
    ds_read_b64_tr_b16 v[38:39], v21 offset:9216
    s_add_u32 s47, s44, 16384
    buffer_load_dwordx4 a[64:67], v14, s[32:35], s47 offen offset:0
    s_waitcnt lgkmcnt(6)
    v_mfma_f32_32x32x16_bf16 v[160:175], a[68:71], v[56:59], v[160:175]
    ds_read_b64_tr_b16 v[40:41], v22 offset:8192
    ds_read_b64_tr_b16 v[42:43], v22 offset:9216
    v_cvt_pk_bf16_f32 v242, v244, v245
    s_waitcnt lgkmcnt(6)
    v_mfma_f32_32x32x16_bf16 v[176:191], a[68:71], v[60:63], v[176:191]
    ds_read_b64_tr_b16 v[44:45], v23 offset:8192
    ds_read_b64_tr_b16 v[46:47], v23 offset:9216
    v_cvt_pk_bf16_f32 v243, v246, v247
    s_waitcnt vmcnt(38)
    s_waitcnt lgkmcnt(6)
    v_mfma_f32_32x32x16_bf16 v[128:143], a[72:75], v[32:35], v[128:143]
    ds_read_b64_tr_b16 v[48:49], v20 offset:12288
    ds_read_b64_tr_b16 v[50:51], v20 offset:13312
    s_waitcnt lgkmcnt(6)
    v_mfma_f32_32x32x16_bf16 v[144:159], a[72:75], v[36:39], v[144:159]
    ds_read_b64_tr_b16 v[52:53], v21 offset:12288
    ds_read_b64_tr_b16 v[54:55], v21 offset:13312
    s_add_u32 s47, s44, 16384
    buffer_load_dwordx4 a[68:71], v14, s[32:35], s47 offen offset:1024
    s_waitcnt lgkmcnt(6)
    v_mfma_f32_32x32x16_bf16 v[160:175], a[72:75], v[40:43], v[160:175]
    ds_read_b64_tr_b16 v[56:57], v22 offset:12288
    ds_read_b64_tr_b16 v[58:59], v22 offset:13312
    v_cvt_pk_bf16_f32 v244, v248, v249
    s_waitcnt lgkmcnt(6)
    v_mfma_f32_32x32x16_bf16 v[176:191], a[72:75], v[44:47], v[176:191]
    ds_read_b64_tr_b16 v[60:61], v23 offset:12288
    ds_read_b64_tr_b16 v[62:63], v23 offset:13312
    v_cvt_pk_bf16_f32 v245, v250, v251
    s_waitcnt vmcnt(38)
    s_waitcnt lgkmcnt(6)
    v_mfma_f32_32x32x16_bf16 v[128:143], a[76:79], v[48:51], v[128:143]
    ds_read_b64_tr_b16 v[32:33], v20 offset:16384
    ds_read_b64_tr_b16 v[34:35], v20 offset:17408
    s_waitcnt lgkmcnt(6)
    v_mfma_f32_32x32x16_bf16 v[144:159], a[76:79], v[52:55], v[144:159]
    ds_read_b64_tr_b16 v[36:37], v21 offset:16384
    ds_read_b64_tr_b16 v[38:39], v21 offset:17408
    s_add_u32 s47, s44, 16384
    buffer_load_dwordx4 a[72:75], v14, s[32:35], s47 offen offset:2048
    s_waitcnt lgkmcnt(6)
    v_mfma_f32_32x32x16_bf16 v[160:175], a[76:79], v[56:59], v[160:175]
    ds_read_b64_tr_b16 v[40:41], v22 offset:16384
    ds_read_b64_tr_b16 v[42:43], v22 offset:17408
    v_cvt_pk_bf16_f32 v246, v252, v253
    s_waitcnt lgkmcnt(6)
    v_mfma_f32_32x32x16_bf16 v[176:191], a[76:79], v[60:63], v[176:191]
    ds_read_b64_tr_b16 v[44:45], v23 offset:16384
    ds_read_b64_tr_b16 v[46:47], v23 offset:17408
    v_cvt_pk_bf16_f32 v247, v254, v255
    s_waitcnt vmcnt(36)
    s_waitcnt lgkmcnt(6)
    v_mfma_f32_32x32x16_bf16 v[128:143], a[80:83], v[32:35], v[128:143]
    ds_read_b64_tr_b16 v[48:49], v20 offset:20480
    ds_read_b64_tr_b16 v[50:51], v20 offset:21504
    s_waitcnt lgkmcnt(6)
    v_mfma_f32_32x32x16_bf16 v[144:159], a[80:83], v[36:39], v[144:159]
    ds_read_b64_tr_b16 v[52:53], v21 offset:20480
    ds_read_b64_tr_b16 v[54:55], v21 offset:21504
    s_add_u32 s47, s44, 16384
    buffer_load_dwordx4 a[76:79], v14, s[32:35], s47 offen offset:3072
    s_waitcnt lgkmcnt(6)
    v_mfma_f32_32x32x16_bf16 v[160:175], a[80:83], v[40:43], v[160:175]
    ds_read_b64_tr_b16 v[56:57], v22 offset:20480
    ds_read_b64_tr_b16 v[58:59], v22 offset:21504
    buffer_store_dwordx4 v[240:243], v2, s[32:35], s42 offen offset:3072 sc1
    s_waitcnt lgkmcnt(6)
    v_mfma_f32_32x32x16_bf16 v[176:191], a[80:83], v[44:47], v[176:191]
    ds_read_b64_tr_b16 v[60:61], v23 offset:20480
    ds_read_b64_tr_b16 v[62:63], v23 offset:21504
    buffer_store_dwordx4 v[244:247], v2, s[32:35], s43 offen offset:3072 sc1
    s_waitcnt vmcnt(38)
    s_waitcnt lgkmcnt(6)
    v_mfma_f32_32x32x16_bf16 v[128:143], a[84:87], v[48:51], v[128:143]
    ds_read_b64_tr_b16 v[32:33], v20 offset:24576
    ds_read_b64_tr_b16 v[34:35], v20 offset:25600
    s_waitcnt lgkmcnt(6)
    v_mfma_f32_32x32x16_bf16 v[144:159], a[84:87], v[52:55], v[144:159]
    ds_read_b64_tr_b16 v[36:37], v21 offset:24576
    ds_read_b64_tr_b16 v[38:39], v21 offset:25600
    s_add_u32 s47, s44, 20480
    buffer_load_dwordx4 a[80:83], v14, s[32:35], s47 offen offset:0
    s_waitcnt lgkmcnt(6)
    v_mfma_f32_32x32x16_bf16 v[160:175], a[84:87], v[56:59], v[160:175]
    ds_read_b64_tr_b16 v[40:41], v22 offset:24576
    ds_read_b64_tr_b16 v[42:43], v22 offset:25600
    s_waitcnt lgkmcnt(6)
    v_mfma_f32_32x32x16_bf16 v[176:191], a[84:87], v[60:63], v[176:191]
    ds_read_b64_tr_b16 v[44:45], v23 offset:24576
    ds_read_b64_tr_b16 v[46:47], v23 offset:25600
    s_waitcnt vmcnt(38)
    s_waitcnt lgkmcnt(6)
    v_mfma_f32_32x32x16_bf16 v[128:143], a[88:91], v[32:35], v[128:143]
    ds_read_b64_tr_b16 v[48:49], v20 offset:28672
    ds_read_b64_tr_b16 v[50:51], v20 offset:29696
    s_waitcnt lgkmcnt(6)
    v_mfma_f32_32x32x16_bf16 v[144:159], a[88:91], v[36:39], v[144:159]
    ds_read_b64_tr_b16 v[52:53], v21 offset:28672
    ds_read_b64_tr_b16 v[54:55], v21 offset:29696
    s_add_u32 s47, s44, 20480
    buffer_load_dwordx4 a[84:87], v14, s[32:35], s47 offen offset:1024
    s_waitcnt lgkmcnt(6)
    v_mfma_f32_32x32x16_bf16 v[160:175], a[88:91], v[40:43], v[160:175]
    ds_read_b64_tr_b16 v[56:57], v22 offset:28672
    ds_read_b64_tr_b16 v[58:59], v22 offset:29696
    s_waitcnt lgkmcnt(6)
    v_mfma_f32_32x32x16_bf16 v[176:191], a[88:91], v[44:47], v[176:191]
    ds_read_b64_tr_b16 v[60:61], v23 offset:28672
    ds_read_b64_tr_b16 v[62:63], v23 offset:29696
    s_waitcnt vmcnt(38)
    s_waitcnt lgkmcnt(6)
    v_mfma_f32_32x32x16_bf16 v[128:143], a[92:95], v[48:51], v[128:143]
    ds_read_b64_tr_b16 v[32:33], v20 offset:32768
    ds_read_b64_tr_b16 v[34:35], v20 offset:33792
    s_waitcnt lgkmcnt(6)
    v_mfma_f32_32x32x16_bf16 v[144:159], a[92:95], v[52:55], v[144:159]
    ds_read_b64_tr_b16 v[36:37], v21 offset:32768
    ds_read_b64_tr_b16 v[38:39], v21 offset:33792
    s_add_u32 s47, s44, 20480
    buffer_load_dwordx4 a[88:91], v14, s[32:35], s47 offen offset:2048
    s_waitcnt lgkmcnt(6)
    v_mfma_f32_32x32x16_bf16 v[160:175], a[92:95], v[56:59], v[160:175]
    ds_read_b64_tr_b16 v[40:41], v22 offset:32768
    ds_read_b64_tr_b16 v[42:43], v22 offset:33792
    s_waitcnt lgkmcnt(6)
    v_mfma_f32_32x32x16_bf16 v[176:191], a[92:95], v[60:63], v[176:191]
    ds_read_b64_tr_b16 v[44:45], v23 offset:32768
    ds_read_b64_tr_b16 v[46:47], v23 offset:33792
    s_waitcnt vmcnt(38)
    s_waitcnt lgkmcnt(6)
    v_mfma_f32_32x32x16_bf16 v[128:143], a[96:99], v[32:35], v[128:143]
    ds_read_b64_tr_b16 v[48:49], v20 offset:36864
    ds_read_b64_tr_b16 v[50:51], v20 offset:37888
    s_waitcnt lgkmcnt(6)
    v_mfma_f32_32x32x16_bf16 v[144:159], a[96:99], v[36:39], v[144:159]
    ds_read_b64_tr_b16 v[52:53], v21 offset:36864
    ds_read_b64_tr_b16 v[54:55], v21 offset:37888
    s_add_u32 s47, s44, 20480
    buffer_load_dwordx4 a[92:95], v14, s[32:35], s47 offen offset:3072
    s_waitcnt lgkmcnt(6)
    v_mfma_f32_32x32x16_bf16 v[160:175], a[96:99], v[40:43], v[160:175]
    ds_read_b64_tr_b16 v[56:57], v22 offset:36864
    ds_read_b64_tr_b16 v[58:59], v22 offset:37888
    s_waitcnt lgkmcnt(6)
    v_mfma_f32_32x32x16_bf16 v[176:191], a[96:99], v[44:47], v[176:191]
    ds_read_b64_tr_b16 v[60:61], v23 offset:36864
    ds_read_b64_tr_b16 v[62:63], v23 offset:37888
    s_waitcnt vmcnt(38)
    s_waitcnt lgkmcnt(6)
    v_mfma_f32_32x32x16_bf16 v[128:143], a[100:103], v[48:51], v[128:143]
    ds_read_b64_tr_b16 v[32:33], v20 offset:40960
    ds_read_b64_tr_b16 v[34:35], v20 offset:41984
    s_waitcnt lgkmcnt(6)
    v_mfma_f32_32x32x16_bf16 v[144:159], a[100:103], v[52:55], v[144:159]
    ds_read_b64_tr_b16 v[36:37], v21 offset:40960
    ds_read_b64_tr_b16 v[38:39], v21 offset:41984
    s_add_u32 s47, s44, 24576
    buffer_load_dwordx4 a[96:99], v14, s[32:35], s47 offen offset:0
    s_waitcnt lgkmcnt(6)
    v_mfma_f32_32x32x16_bf16 v[160:175], a[100:103], v[56:59], v[160:175]
    ds_read_b64_tr_b16 v[40:41], v22 offset:40960
    ds_read_b64_tr_b16 v[42:43], v22 offset:41984
    s_waitcnt lgkmcnt(6)
    v_mfma_f32_32x32x16_bf16 v[176:191], a[100:103], v[60:63], v[176:191]
    ds_read_b64_tr_b16 v[44:45], v23 offset:40960
    ds_read_b64_tr_b16 v[46:47], v23 offset:41984
    s_waitcnt vmcnt(38)
    s_waitcnt lgkmcnt(6)
    v_mfma_f32_32x32x16_bf16 v[128:143], a[104:107], v[32:35], v[128:143]
    ds_read_b64_tr_b16 v[48:49], v20 offset:45056
    ds_read_b64_tr_b16 v[50:51], v20 offset:46080
    s_waitcnt lgkmcnt(6)
    v_mfma_f32_32x32x16_bf16 v[144:159], a[104:107], v[36:39], v[144:159]
    ds_read_b64_tr_b16 v[52:53], v21 offset:45056
    ds_read_b64_tr_b16 v[54:55], v21 offset:46080
    s_add_u32 s47, s44, 24576
    buffer_load_dwordx4 a[100:103], v14, s[32:35], s47 offen offset:1024
    s_waitcnt lgkmcnt(6)
    v_mfma_f32_32x32x16_bf16 v[160:175], a[104:107], v[40:43], v[160:175]
    ds_read_b64_tr_b16 v[56:57], v22 offset:45056
    ds_read_b64_tr_b16 v[58:59], v22 offset:46080
    s_waitcnt lgkmcnt(6)
    v_mfma_f32_32x32x16_bf16 v[176:191], a[104:107], v[44:47], v[176:191]
    ds_read_b64_tr_b16 v[60:61], v23 offset:45056
    ds_read_b64_tr_b16 v[62:63], v23 offset:46080
    s_waitcnt vmcnt(38)
    s_waitcnt lgkmcnt(6)
    v_mfma_f32_32x32x16_bf16 v[128:143], a[108:111], v[48:51], v[128:143]
    ds_read_b64_tr_b16 v[32:33], v20 offset:49152
    ds_read_b64_tr_b16 v[34:35], v20 offset:50176
    s_waitcnt lgkmcnt(6)
    v_mfma_f32_32x32x16_bf16 v[144:159], a[108:111], v[52:55], v[144:159]
    ds_read_b64_tr_b16 v[36:37], v21 offset:49152
    ds_read_b64_tr_b16 v[38:39], v21 offset:50176
    s_add_u32 s47, s44, 24576
    buffer_load_dwordx4 a[104:107], v14, s[32:35], s47 offen offset:2048
    s_waitcnt lgkmcnt(6)
    v_mfma_f32_32x32x16_bf16 v[160:175], a[108:111], v[56:59], v[160:175]
    ds_read_b64_tr_b16 v[40:41], v22 offset:49152
    ds_read_b64_tr_b16 v[42:43], v22 offset:50176
    s_waitcnt lgkmcnt(6)
    v_mfma_f32_32x32x16_bf16 v[176:191], a[108:111], v[60:63], v[176:191]
    ds_read_b64_tr_b16 v[44:45], v23 offset:49152
    ds_read_b64_tr_b16 v[46:47], v23 offset:50176
    s_waitcnt vmcnt(38)
    s_waitcnt lgkmcnt(6)
    v_mfma_f32_32x32x16_bf16 v[128:143], a[112:115], v[32:35], v[128:143]
    ds_read_b64_tr_b16 v[48:49], v20 offset:53248
    ds_read_b64_tr_b16 v[50:51], v20 offset:54272
    s_waitcnt lgkmcnt(6)
    v_mfma_f32_32x32x16_bf16 v[144:159], a[112:115], v[36:39], v[144:159]
    ds_read_b64_tr_b16 v[52:53], v21 offset:53248
    ds_read_b64_tr_b16 v[54:55], v21 offset:54272
    s_add_u32 s47, s44, 24576
    buffer_load_dwordx4 a[108:111], v14, s[32:35], s47 offen offset:3072
    s_waitcnt lgkmcnt(6)
    v_mfma_f32_32x32x16_bf16 v[160:175], a[112:115], v[40:43], v[160:175]
    ds_read_b64_tr_b16 v[56:57], v22 offset:53248
    ds_read_b64_tr_b16 v[58:59], v22 offset:54272
    s_waitcnt lgkmcnt(6)
    v_mfma_f32_32x32x16_bf16 v[176:191], a[112:115], v[44:47], v[176:191]
    ds_read_b64_tr_b16 v[60:61], v23 offset:53248
    ds_read_b64_tr_b16 v[62:63], v23 offset:54272
    s_waitcnt vmcnt(38)
    s_waitcnt lgkmcnt(6)
    v_mfma_f32_32x32x16_bf16 v[128:143], a[116:119], v[48:51], v[128:143]
    ds_read_b64_tr_b16 v[32:33], v20 offset:57344
    ds_read_b64_tr_b16 v[34:35], v20 offset:58368
    s_waitcnt lgkmcnt(6)
    v_mfma_f32_32x32x16_bf16 v[144:159], a[116:119], v[52:55], v[144:159]
    ds_read_b64_tr_b16 v[36:37], v21 offset:57344
    ds_read_b64_tr_b16 v[38:39], v21 offset:58368
    s_add_u32 s47, s44, 28672
    buffer_load_dwordx4 a[112:115], v14, s[32:35], s47 offen offset:0
    s_waitcnt lgkmcnt(6)
    v_mfma_f32_32x32x16_bf16 v[160:175], a[116:119], v[56:59], v[160:175]
    ds_read_b64_tr_b16 v[40:41], v22 offset:57344
    ds_read_b64_tr_b16 v[42:43], v22 offset:58368
    s_waitcnt lgkmcnt(6)
    v_mfma_f32_32x32x16_bf16 v[176:191], a[116:119], v[60:63], v[176:191]
    ds_read_b64_tr_b16 v[44:45], v23 offset:57344
    ds_read_b64_tr_b16 v[46:47], v23 offset:58368
    s_waitcnt vmcnt(38)
    s_waitcnt lgkmcnt(6)
    v_mfma_f32_32x32x16_bf16 v[128:143], a[120:123], v[32:35], v[128:143]
    ds_read_b64_tr_b16 v[48:49], v20 offset:61440
    ds_read_b64_tr_b16 v[50:51], v20 offset:62464
    s_waitcnt lgkmcnt(6)
    v_mfma_f32_32x32x16_bf16 v[144:159], a[120:123], v[36:39], v[144:159]
    ds_read_b64_tr_b16 v[52:53], v21 offset:61440
    ds_read_b64_tr_b16 v[54:55], v21 offset:62464
    s_add_u32 s47, s44, 28672
    buffer_load_dwordx4 a[116:119], v14, s[32:35], s47 offen offset:1024
    s_waitcnt lgkmcnt(6)
    v_mfma_f32_32x32x16_bf16 v[160:175], a[120:123], v[40:43], v[160:175]
    ds_read_b64_tr_b16 v[56:57], v22 offset:61440
    ds_read_b64_tr_b16 v[58:59], v22 offset:62464
    s_waitcnt lgkmcnt(6)
    v_mfma_f32_32x32x16_bf16 v[176:191], a[120:123], v[44:47], v[176:191]
    ds_read_b64_tr_b16 v[60:61], v23 offset:61440
    ds_read_b64_tr_b16 v[62:63], v23 offset:62464
    s_waitcnt vmcnt(38)
    s_waitcnt lgkmcnt(6)
    v_mfma_f32_32x32x16_bf16 v[128:143], a[124:127], v[48:51], v[128:143]
    ds_read_b64_tr_b16 v[32:33], v16 offset:0
    ds_read_b64_tr_b16 v[34:35], v16 offset:1024
    s_waitcnt lgkmcnt(6)
    v_mfma_f32_32x32x16_bf16 v[144:159], a[124:127], v[52:55], v[144:159]
    ds_read_b64_tr_b16 v[36:37], v17 offset:0
    ds_read_b64_tr_b16 v[38:39], v17 offset:1024
    s_add_u32 s47, s44, 28672
    buffer_load_dwordx4 a[120:123], v14, s[32:35], s47 offen offset:2048
    s_waitcnt lgkmcnt(6)
    v_mfma_f32_32x32x16_bf16 v[160:175], a[124:127], v[56:59], v[160:175]
    ds_read_b64_tr_b16 v[40:41], v18 offset:0
    ds_read_b64_tr_b16 v[42:43], v18 offset:1024
    s_waitcnt lgkmcnt(6)
    v_mfma_f32_32x32x16_bf16 v[176:191], a[124:127], v[60:63], v[176:191]
    ds_read_b64_tr_b16 v[44:45], v19 offset:0
    ds_read_b64_tr_b16 v[46:47], v19 offset:1024
    s_add_u32 s47, s44, 28672
    buffer_load_dwordx4 a[124:127], v14, s[32:35], s47 offen offset:3072
    s_add_u32 s42, s41, 32768
    s_add_u32 s43, s41, 36864
    s_waitcnt vmcnt(39)
    s_waitcnt lgkmcnt(6)
    v_mfma_f32_32x32x16_bf16 v[192:207], a[0:3], v[32:35], 0
    ds_read_b64_tr_b16 v[48:49], v16 offset:4096
    ds_read_b64_tr_b16 v[50:51], v16 offset:5120
    s_waitcnt lgkmcnt(6)
    v_mfma_f32_32x32x16_bf16 v[208:223], a[0:3], v[36:39], 0
    ds_read_b64_tr_b16 v[52:53], v17 offset:4096
    ds_read_b64_tr_b16 v[54:55], v17 offset:5120
    s_waitcnt lgkmcnt(6)
    v_mfma_f32_32x32x16_bf16 v[224:239], a[0:3], v[40:43], 0
    ds_read_b64_tr_b16 v[56:57], v18 offset:4096
    ds_read_b64_tr_b16 v[58:59], v18 offset:5120
    s_waitcnt lgkmcnt(6)
    v_mfma_f32_32x32x16_bf16 v[240:255], a[0:3], v[44:47], 0
    ds_read_b64_tr_b16 v[60:61], v19 offset:4096
    ds_read_b64_tr_b16 v[62:63], v19 offset:5120
    s_waitcnt vmcnt(38)
    s_waitcnt lgkmcnt(6)
    v_mfma_f32_32x32x16_bf16 v[192:207], a[4:7], v[48:51], v[192:207]
    ds_read_b64_tr_b16 v[32:33], v16 offset:8192
    ds_read_b64_tr_b16 v[34:35], v16 offset:9216
    s_waitcnt lgkmcnt(6)
    v_mfma_f32_32x32x16_bf16 v[208:223], a[4:7], v[52:55], v[208:223]
    ds_read_b64_tr_b16 v[36:37], v17 offset:8192
    ds_read_b64_tr_b16 v[38:39], v17 offset:9216
    s_waitcnt lgkmcnt(6)
    v_mfma_f32_32x32x16_bf16 v[224:239], a[4:7], v[56:59], v[224:239]
    ds_read_b64_tr_b16 v[40:41], v18 offset:8192
    ds_read_b64_tr_b16 v[42:43], v18 offset:9216
    v_cvt_pk_bf16_f32 v128, v128, v129
    s_waitcnt lgkmcnt(6)
    v_mfma_f32_32x32x16_bf16 v[240:255], a[4:7], v[60:63], v[240:255]
    ds_read_b64_tr_b16 v[44:45], v19 offset:8192
    ds_read_b64_tr_b16 v[46:47], v19 offset:9216
    v_cvt_pk_bf16_f32 v129, v130, v131
    s_waitcnt vmcnt(37)
    s_waitcnt lgkmcnt(6)
    v_mfma_f32_32x32x16_bf16 v[192:207], a[8:11], v[32:35], v[192:207]
    ds_read_b64_tr_b16 v[48:49], v16 offset:12288
    ds_read_b64_tr_b16 v[50:51], v16 offset:13312
    s_waitcnt lgkmcnt(6)
    v_mfma_f32_32x32x16_bf16 v[208:223], a[8:11], v[36:39], v[208:223]
    ds_read_b64_tr_b16 v[52:53], v17 offset:12288
    ds_read_b64_tr_b16 v[54:55], v17 offset:13312
    s_waitcnt lgkmcnt(6)
    v_mfma_f32_32x32x16_bf16 v[224:239], a[8:11], v[40:43], v[224:239]
    ds_read_b64_tr_b16 v[56:57], v18 offset:12288
    ds_read_b64_tr_b16 v[58:59], v18 offset:13312
    v_cvt_pk_bf16_f32 v130, v132, v133
    s_waitcnt lgkmcnt(6)
    v_mfma_f32_32x32x16_bf16 v[240:255], a[8:11], v[44:47], v[240:255]
    ds_read_b64_tr_b16 v[60:61], v19 offset:12288
    ds_read_b64_tr_b16 v[62:63], v19 offset:13312
    v_cvt_pk_bf16_f32 v131, v134, v135
    s_waitcnt vmcnt(36)
    s_waitcnt lgkmcnt(6)
    v_mfma_f32_32x32x16_bf16 v[192:207], a[12:15], v[48:51], v[192:207]
    ds_read_b64_tr_b16 v[32:33], v16 offset:16384
    ds_read_b64_tr_b16 v[34:35], v16 offset:17408
    s_waitcnt lgkmcnt(6)
    v_mfma_f32_32x32x16_bf16 v[208:223], a[12:15], v[52:55], v[208:223]
    ds_read_b64_tr_b16 v[36:37], v17 offset:16384
    ds_read_b64_tr_b16 v[38:39], v17 offset:17408
    s_waitcnt lgkmcnt(6)
    v_mfma_f32_32x32x16_bf16 v[224:239], a[12:15], v[56:59], v[224:239]
    ds_read_b64_tr_b16 v[40:41], v18 offset:16384
    ds_read_b64_tr_b16 v[42:43], v18 offset:17408
    v_cvt_pk_bf16_f32 v132, v136, v137
    s_waitcnt lgkmcnt(6)
    v_mfma_f32_32x32x16_bf16 v[240:255], a[12:15], v[60:63], v[240:255]
    ds_read_b64_tr_b16 v[44:45], v19 offset:16384
    ds_read_b64_tr_b16 v[46:47], v19 offset:17408
    v_cvt_pk_bf16_f32 v133, v138, v139
    s_waitcnt vmcnt(35)
    s_waitcnt lgkmcnt(6)
    v_mfma_f32_32x32x16_bf16 v[192:207], a[16:19], v[32:35], v[192:207]
    ds_read_b64_tr_b16 v[48:49], v16 offset:20480
    ds_read_b64_tr_b16 v[50:51], v16 offset:21504
    s_waitcnt lgkmcnt(6)
    v_mfma_f32_32x32x16_bf16 v[208:223], a[16:19], v[36:39], v[208:223]
    ds_read_b64_tr_b16 v[52:53], v17 offset:20480
    ds_read_b64_tr_b16 v[54:55], v17 offset:21504
    s_waitcnt lgkmcnt(6)
    v_mfma_f32_32x32x16_bf16 v[224:239], a[16:19], v[40:43], v[224:239]
    ds_read_b64_tr_b16 v[56:57], v18 offset:20480
    ds_read_b64_tr_b16 v[58:59], v18 offset:21504
    v_cvt_pk_bf16_f32 v134, v140, v141
    s_waitcnt lgkmcnt(6)
    v_mfma_f32_32x32x16_bf16 v[240:255], a[16:19], v[44:47], v[240:255]
    ds_read_b64_tr_b16 v[60:61], v19 offset:20480
    ds_read_b64_tr_b16 v[62:63], v19 offset:21504
    v_cvt_pk_bf16_f32 v135, v142, v143
    s_waitcnt vmcnt(32)
    s_waitcnt lgkmcnt(6)
    v_mfma_f32_32x32x16_bf16 v[192:207], a[20:23], v[48:51], v[192:207]
    ds_read_b64_tr_b16 v[32:33], v16 offset:24576
    ds_read_b64_tr_b16 v[34:35], v16 offset:25600
    s_waitcnt lgkmcnt(6)
    v_mfma_f32_32x32x16_bf16 v[208:223], a[20:23], v[52:55], v[208:223]
    ds_read_b64_tr_b16 v[36:37], v17 offset:24576
    ds_read_b64_tr_b16 v[38:39], v17 offset:25600
    s_waitcnt lgkmcnt(6)
    v_mfma_f32_32x32x16_bf16 v[224:239], a[20:23], v[56:59], v[224:239]
    ds_read_b64_tr_b16 v[40:41], v18 offset:24576
    ds_read_b64_tr_b16 v[42:43], v18 offset:25600
    buffer_store_dwordx4 v[128:131], v2, s[32:35], s42 offen offset:0 sc1
    s_waitcnt lgkmcnt(6)
    v_mfma_f32_32x32x16_bf16 v[240:255], a[20:23], v[60:63], v[240:255]
    ds_read_b64_tr_b16 v[44:45], v19 offset:24576
    ds_read_b64_tr_b16 v[46:47], v19 offset:25600
    buffer_store_dwordx4 v[132:135], v2, s[32:35], s43 offen offset:0 sc1
    s_waitcnt vmcnt(33)
    s_waitcnt lgkmcnt(6)
    v_mfma_f32_32x32x16_bf16 v[192:207], a[24:27], v[32:35], v[192:207]
    ds_read_b64_tr_b16 v[48:49], v16 offset:28672
    ds_read_b64_tr_b16 v[50:51], v16 offset:29696
    s_waitcnt lgkmcnt(6)
    v_mfma_f32_32x32x16_bf16 v[208:223], a[24:27], v[36:39], v[208:223]
    ds_read_b64_tr_b16 v[52:53], v17 offset:28672
    ds_read_b64_tr_b16 v[54:55], v17 offset:29696
    s_waitcnt lgkmcnt(6)
    v_mfma_f32_32x32x16_bf16 v[224:239], a[24:27], v[40:43], v[224:239]
    ds_read_b64_tr_b16 v[56:57], v18 offset:28672
    ds_read_b64_tr_b16 v[58:59], v18 offset:29696
    v_cvt_pk_bf16_f32 v144, v144, v145
    s_waitcnt lgkmcnt(6)
    v_mfma_f32_32x32x16_bf16 v[240:255], a[24:27], v[44:47], v[240:255]
    ds_read_b64_tr_b16 v[60:61], v19 offset:28672
    ds_read_b64_tr_b16 v[62:63], v19 offset:29696
    v_cvt_pk_bf16_f32 v145, v146, v147
    s_waitcnt vmcnt(32)
    s_waitcnt lgkmcnt(6)
    v_mfma_f32_32x32x16_bf16 v[192:207], a[28:31], v[48:51], v[192:207]
    ds_read_b64_tr_b16 v[32:33], v16 offset:32768
    ds_read_b64_tr_b16 v[34:35], v16 offset:33792
    s_waitcnt lgkmcnt(6)
    v_mfma_f32_32x32x16_bf16 v[208:223], a[28:31], v[52:55], v[208:223]
    ds_read_b64_tr_b16 v[36:37], v17 offset:32768
    ds_read_b64_tr_b16 v[38:39], v17 offset:33792
    s_waitcnt lgkmcnt(6)
    v_mfma_f32_32x32x16_bf16 v[224:239], a[28:31], v[56:59], v[224:239]
    ds_read_b64_tr_b16 v[40:41], v18 offset:32768
    ds_read_b64_tr_b16 v[42:43], v18 offset:33792
    v_cvt_pk_bf16_f32 v146, v148, v149
    s_waitcnt lgkmcnt(6)
    v_mfma_f32_32x32x16_bf16 v[240:255], a[28:31], v[60:63], v[240:255]
    ds_read_b64_tr_b16 v[44:45], v19 offset:32768
    ds_read_b64_tr_b16 v[46:47], v19 offset:33792
    v_cvt_pk_bf16_f32 v147, v150, v151
    s_waitcnt vmcnt(31)
    s_waitcnt lgkmcnt(6)
    v_mfma_f32_32x32x16_bf16 v[192:207], a[32:35], v[32:35], v[192:207]
    ds_read_b64_tr_b16 v[48:49], v16 offset:36864
    ds_read_b64_tr_b16 v[50:51], v16 offset:37888
    s_waitcnt lgkmcnt(6)
    v_mfma_f32_32x32x16_bf16 v[208:223], a[32:35], v[36:39], v[208:223]
    ds_read_b64_tr_b16 v[52:53], v17 offset:36864
    ds_read_b64_tr_b16 v[54:55], v17 offset:37888
    s_waitcnt lgkmcnt(6)
    v_mfma_f32_32x32x16_bf16 v[224:239], a[32:35], v[40:43], v[224:239]
    ds_read_b64_tr_b16 v[56:57], v18 offset:36864
    ds_read_b64_tr_b16 v[58:59], v18 offset:37888
    v_cvt_pk_bf16_f32 v148, v152, v153
    s_waitcnt lgkmcnt(6)
    v_mfma_f32_32x32x16_bf16 v[240:255], a[32:35], v[44:47], v[240:255]
    ds_read_b64_tr_b16 v[60:61], v19 offset:36864
    ds_read_b64_tr_b16 v[62:63], v19 offset:37888
    v_cvt_pk_bf16_f32 v149, v154, v155
    s_waitcnt vmcnt(30)
    s_waitcnt lgkmcnt(6)
    v_mfma_f32_32x32x16_bf16 v[192:207], a[36:39], v[48:51], v[192:207]
    ds_read_b64_tr_b16 v[32:33], v16 offset:40960
    ds_read_b64_tr_b16 v[34:35], v16 offset:41984
    s_waitcnt lgkmcnt(6)
    v_mfma_f32_32x32x16_bf16 v[208:223], a[36:39], v[52:55], v[208:223]
    ds_read_b64_tr_b16 v[36:37], v17 offset:40960
    ds_read_b64_tr_b16 v[38:39], v17 offset:41984
    s_waitcnt lgkmcnt(6)
    v_mfma_f32_32x32x16_bf16 v[224:239], a[36:39], v[56:59], v[224:239]
    ds_read_b64_tr_b16 v[40:41], v18 offset:40960
    ds_read_b64_tr_b16 v[42:43], v18 offset:41984
    v_cvt_pk_bf16_f32 v150, v156, v157
    s_waitcnt lgkmcnt(6)
    v_mfma_f32_32x32x16_bf16 v[240:255], a[36:39], v[60:63], v[240:255]
    ds_read_b64_tr_b16 v[44:45], v19 offset:40960
    ds_read_b64_tr_b16 v[46:47], v19 offset:41984
    v_cvt_pk_bf16_f32 v151, v158, v159
    s_waitcnt vmcnt(27)
    s_waitcnt lgkmcnt(6)
    v_mfma_f32_32x32x16_bf16 v[192:207], a[40:43], v[32:35], v[192:207]
    ds_read_b64_tr_b16 v[48:49], v16 offset:45056
    ds_read_b64_tr_b16 v[50:51], v16 offset:46080
    s_waitcnt lgkmcnt(6)
    v_mfma_f32_32x32x16_bf16 v[208:223], a[40:43], v[36:39], v[208:223]
    ds_read_b64_tr_b16 v[52:53], v17 offset:45056
    ds_read_b64_tr_b16 v[54:55], v17 offset:46080
    s_waitcnt lgkmcnt(6)
    v_mfma_f32_32x32x16_bf16 v[224:239], a[40:43], v[40:43], v[224:239]
    ds_read_b64_tr_b16 v[56:57], v18 offset:45056
    ds_read_b64_tr_b16 v[58:59], v18 offset:46080
    buffer_store_dwordx4 v[144:147], v2, s[32:35], s42 offen offset:1024 sc1
    s_waitcnt lgkmcnt(6)
    v_mfma_f32_32x32x16_bf16 v[240:255], a[40:43], v[44:47], v[240:255]
    ds_read_b64_tr_b16 v[60:61], v19 offset:45056
    ds_read_b64_tr_b16 v[62:63], v19 offset:46080
    buffer_store_dwordx4 v[148:151], v2, s[32:35], s43 offen offset:1024 sc1
    s_waitcnt vmcnt(28)
    s_waitcnt lgkmcnt(6)
    v_mfma_f32_32x32x16_bf16 v[192:207], a[44:47], v[48:51], v[192:207]
    ds_read_b64_tr_b16 v[32:33], v16 offset:49152
    ds_read_b64_tr_b16 v[34:35], v16 offset:50176
    s_waitcnt lgkmcnt(6)
    v_mfma_f32_32x32x16_bf16 v[208:223], a[44:47], v[52:55], v[208:223]
    ds_read_b64_tr_b16 v[36:37], v17 offset:49152
    ds_read_b64_tr_b16 v[38:39], v17 offset:50176
    s_waitcnt lgkmcnt(6)
    v_mfma_f32_32x32x16_bf16 v[224:239], a[44:47], v[56:59], v[224:239]
    ds_read_b64_tr_b16 v[40:41], v18 offset:49152
    ds_read_b64_tr_b16 v[42:43], v18 offset:50176
    v_cvt_pk_bf16_f32 v160, v160, v161
    s_waitcnt lgkmcnt(6)
    v_mfma_f32_32x32x16_bf16 v[240:255], a[44:47], v[60:63], v[240:255]
    ds_read_b64_tr_b16 v[44:45], v19 offset:49152
    ds_read_b64_tr_b16 v[46:47], v19 offset:50176
    v_cvt_pk_bf16_f32 v161, v162, v163
    s_waitcnt vmcnt(27)
    s_waitcnt lgkmcnt(6)
    v_mfma_f32_32x32x16_bf16 v[192:207], a[48:51], v[32:35], v[192:207]
    ds_read_b64_tr_b16 v[48:49], v16 offset:53248
    ds_read_b64_tr_b16 v[50:51], v16 offset:54272
    s_waitcnt lgkmcnt(6)
    v_mfma_f32_32x32x16_bf16 v[208:223], a[48:51], v[36:39], v[208:223]
    ds_read_b64_tr_b16 v[52:53], v17 offset:53248
    ds_read_b64_tr_b16 v[54:55], v17 offset:54272
    s_waitcnt lgkmcnt(6)
    v_mfma_f32_32x32x16_bf16 v[224:239], a[48:51], v[40:43], v[224:239]
    ds_read_b64_tr_b16 v[56:57], v18 offset:53248
    ds_read_b64_tr_b16 v[58:59], v18 offset:54272
    v_cvt_pk_bf16_f32 v162, v164, v165
    s_waitcnt lgkmcnt(6)
    v_mfma_f32_32x32x16_bf16 v[240:255], a[48:51], v[44:47], v[240:255]
    ds_read_b64_tr_b16 v[60:61], v19 offset:53248
    ds_read_b64_tr_b16 v[62:63], v19 offset:54272
    v_cvt_pk_bf16_f32 v163, v166, v167
    s_waitcnt vmcnt(26)
    s_waitcnt lgkmcnt(6)
    v_mfma_f32_32x32x16_bf16 v[192:207], a[52:55], v[48:51], v[192:207]
    ds_read_b64_tr_b16 v[32:33], v16 offset:57344
    ds_read_b64_tr_b16 v[34:35], v16 offset:58368
    s_waitcnt lgkmcnt(6)
    v_mfma_f32_32x32x16_bf16 v[208:223], a[52:55], v[52:55], v[208:223]
    ds_read_b64_tr_b16 v[36:37], v17 offset:57344
    ds_read_b64_tr_b16 v[38:39], v17 offset:58368
    s_waitcnt lgkmcnt(6)
    v_mfma_f32_32x32x16_bf16 v[224:239], a[52:55], v[56:59], v[224:239]
    ds_read_b64_tr_b16 v[40:41], v18 offset:57344
    ds_read_b64_tr_b16 v[42:43], v18 offset:58368
    v_cvt_pk_bf16_f32 v164, v168, v169
    s_waitcnt lgkmcnt(6)
    v_mfma_f32_32x32x16_bf16 v[240:255], a[52:55], v[60:63], v[240:255]
    ds_read_b64_tr_b16 v[44:45], v19 offset:57344
    ds_read_b64_tr_b16 v[46:47], v19 offset:58368
    v_cvt_pk_bf16_f32 v165, v170, v171
    s_waitcnt vmcnt(25)
    s_waitcnt lgkmcnt(6)
    v_mfma_f32_32x32x16_bf16 v[192:207], a[56:59], v[32:35], v[192:207]
    ds_read_b64_tr_b16 v[48:49], v16 offset:61440
    ds_read_b64_tr_b16 v[50:51], v16 offset:62464
    s_waitcnt lgkmcnt(6)
    v_mfma_f32_32x32x16_bf16 v[208:223], a[56:59], v[36:39], v[208:223]
    ds_read_b64_tr_b16 v[52:53], v17 offset:61440
    ds_read_b64_tr_b16 v[54:55], v17 offset:62464
    s_waitcnt lgkmcnt(6)
    v_mfma_f32_32x32x16_bf16 v[224:239], a[56:59], v[40:43], v[224:239]
    ds_read_b64_tr_b16 v[56:57], v18 offset:61440
    ds_read_b64_tr_b16 v[58:59], v18 offset:62464
    v_cvt_pk_bf16_f32 v166, v172, v173
    s_waitcnt lgkmcnt(6)
    v_mfma_f32_32x32x16_bf16 v[240:255], a[56:59], v[44:47], v[240:255]
    ds_read_b64_tr_b16 v[60:61], v19 offset:61440
    ds_read_b64_tr_b16 v[62:63], v19 offset:62464
    v_cvt_pk_bf16_f32 v167, v174, v175
    s_waitcnt vmcnt(22)
    s_waitcnt lgkmcnt(6)
    v_mfma_f32_32x32x16_bf16 v[192:207], a[60:63], v[48:51], v[192:207]
    ds_read_b64_tr_b16 v[32:33], v20 offset:0
    ds_read_b64_tr_b16 v[34:35], v20 offset:1024
    s_waitcnt lgkmcnt(6)
    v_mfma_f32_32x32x16_bf16 v[208:223], a[60:63], v[52:55], v[208:223]
    ds_read_b64_tr_b16 v[36:37], v21 offset:0
    ds_read_b64_tr_b16 v[38:39], v21 offset:1024
    s_waitcnt lgkmcnt(6)
    v_mfma_f32_32x32x16_bf16 v[224:239], a[60:63], v[56:59], v[224:239]
    ds_read_b64_tr_b16 v[40:41], v22 offset:0
    ds_read_b64_tr_b16 v[42:43], v22 offset:1024
    buffer_store_dwordx4 v[160:163], v2, s[32:35], s42 offen offset:2048 sc1
    s_waitcnt lgkmcnt(6)
    v_mfma_f32_32x32x16_bf16 v[240:255], a[60:63], v[60:63], v[240:255]
    ds_read_b64_tr_b16 v[44:45], v23 offset:0
    ds_read_b64_tr_b16 v[46:47], v23 offset:1024
    buffer_store_dwordx4 v[164:167], v2, s[32:35], s43 offen offset:2048 sc1
    s_waitcnt vmcnt(23)
    s_waitcnt lgkmcnt(6)
    v_mfma_f32_32x32x16_bf16 v[192:207], a[64:67], v[32:35], v[192:207]
    ds_read_b64_tr_b16 v[48:49], v20 offset:4096
    ds_read_b64_tr_b16 v[50:51], v20 offset:5120
    s_waitcnt lgkmcnt(6)
    v_mfma_f32_32x32x16_bf16 v[208:223], a[64:67], v[36:39], v[208:223]
    ds_read_b64_tr_b16 v[52:53], v21 offset:4096
    ds_read_b64_tr_b16 v[54:55], v21 offset:5120
    s_waitcnt lgkmcnt(6)
    v_mfma_f32_32x32x16_bf16 v[224:239], a[64:67], v[40:43], v[224:239]
    ds_read_b64_tr_b16 v[56:57], v22 offset:4096
    ds_read_b64_tr_b16 v[58:59], v22 offset:5120
    v_cvt_pk_bf16_f32 v176, v176, v177
    s_waitcnt lgkmcnt(6)
    v_mfma_f32_32x32x16_bf16 v[240:255], a[64:67], v[44:47], v[240:255]
    ds_read_b64_tr_b16 v[60:61], v23 offset:4096
    ds_read_b64_tr_b16 v[62:63], v23 offset:5120
    v_cvt_pk_bf16_f32 v177, v178, v179
    s_waitcnt vmcnt(22)
    s_waitcnt lgkmcnt(6)
    v_mfma_f32_32x32x16_bf16 v[192:207], a[68:71], v[48:51], v[192:207]
    ds_read_b64_tr_b16 v[32:33], v20 offset:8192
    ds_read_b64_tr_b16 v[34:35], v20 offset:9216
    s_waitcnt lgkmcnt(6)
    v_mfma_f32_32x32x16_bf16 v[208:223], a[68:71], v[52:55], v[208:223]
    ds_read_b64_tr_b16 v[36:37], v21 offset:8192
    ds_read_b64_tr_b16 v[38:39], v21 offset:9216
    s_waitcnt lgkmcnt(6)
    v_mfma_f32_32x32x16_bf16 v[224:239], a[68:71], v[56:59], v[224:239]
    ds_read_b64_tr_b16 v[40:41], v22 offset:8192
    ds_read_b64_tr_b16 v[42:43], v22 offset:9216
    v_cvt_pk_bf16_f32 v178, v180, v181
    s_waitcnt lgkmcnt(6)
    v_mfma_f32_32x32x16_bf16 v[240:255], a[68:71], v[60:63], v[240:255]
    ds_read_b64_tr_b16 v[44:45], v23 offset:8192
    ds_read_b64_tr_b16 v[46:47], v23 offset:9216
    v_cvt_pk_bf16_f32 v179, v182, v183
    s_waitcnt vmcnt(21)
    s_waitcnt lgkmcnt(6)
    v_mfma_f32_32x32x16_bf16 v[192:207], a[72:75], v[32:35], v[192:207]
    ds_read_b64_tr_b16 v[48:49], v20 offset:12288
    ds_read_b64_tr_b16 v[50:51], v20 offset:13312
    s_waitcnt lgkmcnt(6)
    v_mfma_f32_32x32x16_bf16 v[208:223], a[72:75], v[36:39], v[208:223]
    ds_read_b64_tr_b16 v[52:53], v21 offset:12288
    ds_read_b64_tr_b16 v[54:55], v21 offset:13312
    s_waitcnt lgkmcnt(6)
    v_mfma_f32_32x32x16_bf16 v[224:239], a[72:75], v[40:43], v[224:239]
    ds_read_b64_tr_b16 v[56:57], v22 offset:12288
    ds_read_b64_tr_b16 v[58:59], v22 offset:13312
    v_cvt_pk_bf16_f32 v180, v184, v185
    s_waitcnt lgkmcnt(6)
    v_mfma_f32_32x32x16_bf16 v[240:255], a[72:75], v[44:47], v[240:255]
    ds_read_b64_tr_b16 v[60:61], v23 offset:12288
    ds_read_b64_tr_b16 v[62:63], v23 offset:13312
    v_cvt_pk_bf16_f32 v181, v186, v187
    s_waitcnt vmcnt(20)
    s_waitcnt lgkmcnt(6)
    v_mfma_f32_32x32x16_bf16 v[192:207], a[76:79], v[48:51], v[192:207]
    ds_read_b64_tr_b16 v[32:33], v20 offset:16384
    ds_read_b64_tr_b16 v[34:35], v20 offset:17408
    s_waitcnt lgkmcnt(6)
    v_mfma_f32_32x32x16_bf16 v[208:223], a[76:79], v[52:55], v[208:223]
    ds_read_b64_tr_b16 v[36:37], v21 offset:16384
    ds_read_b64_tr_b16 v[38:39], v21 offset:17408
    s_waitcnt lgkmcnt(6)
    v_mfma_f32_32x32x16_bf16 v[224:239], a[76:79], v[56:59], v[224:239]
    ds_read_b64_tr_b16 v[40:41], v22 offset:16384
    ds_read_b64_tr_b16 v[42:43], v22 offset:17408
    v_cvt_pk_bf16_f32 v182, v188, v189
    s_waitcnt lgkmcnt(6)
    v_mfma_f32_32x32x16_bf16 v[240:255], a[76:79], v[60:63], v[240:255]
    ds_read_b64_tr_b16 v[44:45], v23 offset:16384
    ds_read_b64_tr_b16 v[46:47], v23 offset:17408
    v_cvt_pk_bf16_f32 v183, v190, v191
    s_waitcnt vmcnt(17)
    s_waitcnt lgkmcnt(6)
    v_mfma_f32_32x32x16_bf16 v[192:207], a[80:83], v[32:35], v[192:207]
    ds_read_b64_tr_b16 v[48:49], v20 offset:20480
    ds_read_b64_tr_b16 v[50:51], v20 offset:21504
    s_waitcnt lgkmcnt(6)
    v_mfma_f32_32x32x16_bf16 v[208:223], a[80:83], v[36:39], v[208:223]
    ds_read_b64_tr_b16 v[52:53], v21 offset:20480
    ds_read_b64_tr_b16 v[54:55], v21 offset:21504
    s_waitcnt lgkmcnt(6)
    v_mfma_f32_32x32x16_bf16 v[224:239], a[80:83], v[40:43], v[224:239]
    ds_read_b64_tr_b16 v[56:57], v22 offset:20480
    ds_read_b64_tr_b16 v[58:59], v22 offset:21504
    buffer_store_dwordx4 v[176:179], v2, s[32:35], s42 offen offset:3072 sc1
    s_waitcnt lgkmcnt(6)
    v_mfma_f32_32x32x16_bf16 v[240:255], a[80:83], v[44:47], v[240:255]
    ds_read_b64_tr_b16 v[60:61], v23 offset:20480
    ds_read_b64_tr_b16 v[62:63], v23 offset:21504
    buffer_store_dwordx4 v[180:183], v2, s[32:35], s43 offen offset:3072 sc1
    s_waitcnt vmcnt(18)
    s_waitcnt lgkmcnt(6)
    v_mfma_f32_32x32x16_bf16 v[192:207], a[84:87], v[48:51], v[192:207]
    ds_read_b64_tr_b16 v[32:33], v20 offset:24576
    ds_read_b64_tr_b16 v[34:35], v20 offset:25600
    s_waitcnt lgkmcnt(6)
    v_mfma_f32_32x32x16_bf16 v[208:223], a[84:87], v[52:55], v[208:223]
    ds_read_b64_tr_b16 v[36:37], v21 offset:24576
    ds_read_b64_tr_b16 v[38:39], v21 offset:25600
    s_waitcnt lgkmcnt(6)
    v_mfma_f32_32x32x16_bf16 v[224:239], a[84:87], v[56:59], v[224:239]
    ds_read_b64_tr_b16 v[40:41], v22 offset:24576
    ds_read_b64_tr_b16 v[42:43], v22 offset:25600
    s_waitcnt lgkmcnt(6)
    v_mfma_f32_32x32x16_bf16 v[240:255], a[84:87], v[60:63], v[240:255]
    ds_read_b64_tr_b16 v[44:45], v23 offset:24576
    ds_read_b64_tr_b16 v[46:47], v23 offset:25600
    s_waitcnt vmcnt(17)
    s_waitcnt lgkmcnt(6)
    v_mfma_f32_32x32x16_bf16 v[192:207], a[88:91], v[32:35], v[192:207]
    ds_read_b64_tr_b16 v[48:49], v20 offset:28672
    ds_read_b64_tr_b16 v[50:51], v20 offset:29696
    s_waitcnt lgkmcnt(6)
    v_mfma_f32_32x32x16_bf16 v[208:223], a[88:91], v[36:39], v[208:223]
    ds_read_b64_tr_b16 v[52:53], v21 offset:28672
    ds_read_b64_tr_b16 v[54:55], v21 offset:29696
    s_waitcnt lgkmcnt(6)
    v_mfma_f32_32x32x16_bf16 v[224:239], a[88:91], v[40:43], v[224:239]
    ds_read_b64_tr_b16 v[56:57], v22 offset:28672
    ds_read_b64_tr_b16 v[58:59], v22 offset:29696
    s_waitcnt lgkmcnt(6)
    v_mfma_f32_32x32x16_bf16 v[240:255], a[88:91], v[44:47], v[240:255]
    ds_read_b64_tr_b16 v[60:61], v23 offset:28672
    ds_read_b64_tr_b16 v[62:63], v23 offset:29696
    s_waitcnt vmcnt(16)
    s_waitcnt lgkmcnt(6)
    v_mfma_f32_32x32x16_bf16 v[192:207], a[92:95], v[48:51], v[192:207]
    ds_read_b64_tr_b16 v[32:33], v20 offset:32768
    ds_read_b64_tr_b16 v[34:35], v20 offset:33792
    s_waitcnt lgkmcnt(6)
    v_mfma_f32_32x32x16_bf16 v[208:223], a[92:95], v[52:55], v[208:223]
    ds_read_b64_tr_b16 v[36:37], v21 offset:32768
    ds_read_b64_tr_b16 v[38:39], v21 offset:33792
    s_waitcnt lgkmcnt(6)
    v_mfma_f32_32x32x16_bf16 v[224:239], a[92:95], v[56:59], v[224:239]
    ds_read_b64_tr_b16 v[40:41], v22 offset:32768
    ds_read_b64_tr_b16 v[42:43], v22 offset:33792
    s_waitcnt lgkmcnt(6)
    v_mfma_f32_32x32x16_bf16 v[240:255], a[92:95], v[60:63], v[240:255]
    ds_read_b64_tr_b16 v[44:45], v23 offset:32768
    ds_read_b64_tr_b16 v[46:47], v23 offset:33792
    s_waitcnt vmcnt(15)
    s_waitcnt lgkmcnt(6)
    v_mfma_f32_32x32x16_bf16 v[192:207], a[96:99], v[32:35], v[192:207]
    ds_read_b64_tr_b16 v[48:49], v20 offset:36864
    ds_read_b64_tr_b16 v[50:51], v20 offset:37888
    v_lshlrev_b32 v3, 5, v1
    s_mov_b32 s18, 0
    s_lshl_b32 s17, s2, 3
    s_lshl_b32 s19, s16, 1
    s_add_u32 s17, s17, s19
    s_lshl_b32 s19, s17, 10
    buffer_load_dwordx4 v[24:27], v2, s[36:39], s19 offen
    buffer_load_dwordx4 v[64:67], v2, s[36:39], s19 offen offset:1024
    buffer_load_dwordx4 v[72:75], v3, s[32:35], s18 offen
    buffer_load_dwordx4 v[76:79], v3, s[32:35], s18 offen offset:16
    buffer_load_dwordx4 v[80:83], v3, s[32:35], s18 offen offset:2048
    buffer_load_dwordx4 v[84:87], v3, s[32:35], s18 offen offset:2064
    s_waitcnt lgkmcnt(6)
    v_mfma_f32_32x32x16_bf16 v[208:223], a[96:99], v[36:39], v[208:223]
    ds_read_b64_tr_b16 v[52:53], v21 offset:36864
    ds_read_b64_tr_b16 v[54:55], v21 offset:37888
    s_waitcnt lgkmcnt(6)
    v_mfma_f32_32x32x16_bf16 v[224:239], a[96:99], v[40:43], v[224:239]
    ds_read_b64_tr_b16 v[56:57], v22 offset:36864
    ds_read_b64_tr_b16 v[58:59], v22 offset:37888
    s_waitcnt lgkmcnt(6)
    v_mfma_f32_32x32x16_bf16 v[240:255], a[96:99], v[44:47], v[240:255]
    ds_read_b64_tr_b16 v[60:61], v23 offset:36864
    ds_read_b64_tr_b16 v[62:63], v23 offset:37888
    s_waitcnt vmcnt(20)
    s_waitcnt lgkmcnt(6)
    v_mfma_f32_32x32x16_bf16 v[192:207], a[100:103], v[48:51], v[192:207]
    ds_read_b64_tr_b16 v[32:33], v20 offset:40960
    ds_read_b64_tr_b16 v[34:35], v20 offset:41984
    s_waitcnt lgkmcnt(6)
    v_mfma_f32_32x32x16_bf16 v[208:223], a[100:103], v[52:55], v[208:223]
    ds_read_b64_tr_b16 v[36:37], v21 offset:40960
    ds_read_b64_tr_b16 v[38:39], v21 offset:41984
    s_waitcnt lgkmcnt(6)
    v_mfma_f32_32x32x16_bf16 v[224:239], a[100:103], v[56:59], v[224:239]
    ds_read_b64_tr_b16 v[40:41], v22 offset:40960
    ds_read_b64_tr_b16 v[42:43], v22 offset:41984
    s_waitcnt lgkmcnt(6)
    v_mfma_f32_32x32x16_bf16 v[240:255], a[100:103], v[60:63], v[240:255]
    ds_read_b64_tr_b16 v[44:45], v23 offset:40960
    ds_read_b64_tr_b16 v[46:47], v23 offset:41984
    s_waitcnt vmcnt(19)
    s_waitcnt lgkmcnt(6)
    v_mfma_f32_32x32x16_bf16 v[192:207], a[104:107], v[32:35], v[192:207]
    ds_read_b64_tr_b16 v[48:49], v20 offset:45056
    ds_read_b64_tr_b16 v[50:51], v20 offset:46080
    s_waitcnt lgkmcnt(6)
    v_mfma_f32_32x32x16_bf16 v[208:223], a[104:107], v[36:39], v[208:223]
    ds_read_b64_tr_b16 v[52:53], v21 offset:45056
    ds_read_b64_tr_b16 v[54:55], v21 offset:46080
    s_waitcnt lgkmcnt(6)
    v_mfma_f32_32x32x16_bf16 v[224:239], a[104:107], v[40:43], v[224:239]
    ds_read_b64_tr_b16 v[56:57], v22 offset:45056
    ds_read_b64_tr_b16 v[58:59], v22 offset:46080
    s_waitcnt lgkmcnt(6)
    v_mfma_f32_32x32x16_bf16 v[240:255], a[104:107], v[44:47], v[240:255]
    ds_read_b64_tr_b16 v[60:61], v23 offset:45056
    ds_read_b64_tr_b16 v[62:63], v23 offset:46080
    s_waitcnt vmcnt(18)
    s_waitcnt lgkmcnt(6)
    v_mfma_f32_32x32x16_bf16 v[192:207], a[108:111], v[48:51], v[192:207]
    ds_read_b64_tr_b16 v[32:33], v20 offset:49152
    ds_read_b64_tr_b16 v[34:35], v20 offset:50176
    s_waitcnt lgkmcnt(6)
    v_mfma_f32_32x32x16_bf16 v[208:223], a[108:111], v[52:55], v[208:223]
    ds_read_b64_tr_b16 v[36:37], v21 offset:49152
    ds_read_b64_tr_b16 v[38:39], v21 offset:50176
    s_waitcnt lgkmcnt(6)
    v_mfma_f32_32x32x16_bf16 v[224:239], a[108:111], v[56:59], v[224:239]
    ds_read_b64_tr_b16 v[40:41], v22 offset:49152
    ds_read_b64_tr_b16 v[42:43], v22 offset:50176
    s_waitcnt lgkmcnt(6)
    v_mfma_f32_32x32x16_bf16 v[240:255], a[108:111], v[60:63], v[240:255]
    ds_read_b64_tr_b16 v[44:45], v23 offset:49152
    ds_read_b64_tr_b16 v[46:47], v23 offset:50176
    s_waitcnt vmcnt(17)
    s_waitcnt lgkmcnt(6)
    v_mfma_f32_32x32x16_bf16 v[192:207], a[112:115], v[32:35], v[192:207]
    ds_read_b64_tr_b16 v[48:49], v20 offset:53248
    ds_read_b64_tr_b16 v[50:51], v20 offset:54272
    s_waitcnt lgkmcnt(6)
    v_mfma_f32_32x32x16_bf16 v[208:223], a[112:115], v[36:39], v[208:223]
    ds_read_b64_tr_b16 v[52:53], v21 offset:53248
    ds_read_b64_tr_b16 v[54:55], v21 offset:54272
    s_waitcnt lgkmcnt(6)
    v_mfma_f32_32x32x16_bf16 v[224:239], a[112:115], v[40:43], v[224:239]
    ds_read_b64_tr_b16 v[56:57], v22 offset:53248
    ds_read_b64_tr_b16 v[58:59], v22 offset:54272
    s_waitcnt lgkmcnt(6)
    v_mfma_f32_32x32x16_bf16 v[240:255], a[112:115], v[44:47], v[240:255]
    ds_read_b64_tr_b16 v[60:61], v23 offset:53248
    ds_read_b64_tr_b16 v[62:63], v23 offset:54272
    s_waitcnt vmcnt(16)
    s_waitcnt lgkmcnt(6)
    v_mfma_f32_32x32x16_bf16 v[192:207], a[116:119], v[48:51], v[192:207]
    ds_read_b64_tr_b16 v[32:33], v20 offset:57344
    ds_read_b64_tr_b16 v[34:35], v20 offset:58368
    s_waitcnt lgkmcnt(6)
    v_mfma_f32_32x32x16_bf16 v[208:223], a[116:119], v[52:55], v[208:223]
    ds_read_b64_tr_b16 v[36:37], v21 offset:57344
    ds_read_b64_tr_b16 v[38:39], v21 offset:58368
    s_waitcnt lgkmcnt(6)
    v_mfma_f32_32x32x16_bf16 v[224:239], a[116:119], v[56:59], v[224:239]
    ds_read_b64_tr_b16 v[40:41], v22 offset:57344
    ds_read_b64_tr_b16 v[42:43], v22 offset:58368
    s_waitcnt lgkmcnt(6)
    v_mfma_f32_32x32x16_bf16 v[240:255], a[116:119], v[60:63], v[240:255]
    ds_read_b64_tr_b16 v[44:45], v23 offset:57344
    ds_read_b64_tr_b16 v[46:47], v23 offset:58368
    s_waitcnt vmcnt(15)
    s_waitcnt lgkmcnt(6)
    v_mfma_f32_32x32x16_bf16 v[192:207], a[120:123], v[32:35], v[192:207]
    ds_read_b64_tr_b16 v[48:49], v20 offset:61440
    ds_read_b64_tr_b16 v[50:51], v20 offset:62464
    s_waitcnt lgkmcnt(6)
    v_mfma_f32_32x32x16_bf16 v[208:223], a[120:123], v[36:39], v[208:223]
    ds_read_b64_tr_b16 v[52:53], v21 offset:61440
    ds_read_b64_tr_b16 v[54:55], v21 offset:62464
    s_waitcnt lgkmcnt(6)
    v_mfma_f32_32x32x16_bf16 v[224:239], a[120:123], v[40:43], v[224:239]
    ds_read_b64_tr_b16 v[56:57], v22 offset:61440
    ds_read_b64_tr_b16 v[58:59], v22 offset:62464
    s_waitcnt lgkmcnt(6)
    v_mfma_f32_32x32x16_bf16 v[240:255], a[120:123], v[44:47], v[240:255]
    ds_read_b64_tr_b16 v[60:61], v23 offset:61440
    ds_read_b64_tr_b16 v[62:63], v23 offset:62464
    s_waitcnt vmcnt(14)
    s_waitcnt lgkmcnt(6)
    v_mfma_f32_32x32x16_bf16 v[192:207], a[124:127], v[48:51], v[192:207]
    s_waitcnt lgkmcnt(4)
    v_mfma_f32_32x32x16_bf16 v[208:223], a[124:127], v[52:55], v[208:223]
    s_waitcnt lgkmcnt(2)
    v_mfma_f32_32x32x16_bf16 v[224:239], a[124:127], v[56:59], v[224:239]
    s_waitcnt lgkmcnt(0)
    v_mfma_f32_32x32x16_bf16 v[240:255], a[124:127], v[60:63], v[240:255]
    s_nop 7
    s_nop 7
    s_add_u32 s42, s41, 49152
    s_add_u32 s43, s41, 53248
    v_cvt_pk_bf16_f32 v192, v192, v193
    v_cvt_pk_bf16_f32 v193, v194, v195
    v_cvt_pk_bf16_f32 v194, v196, v197
    v_cvt_pk_bf16_f32 v195, v198, v199
    v_cvt_pk_bf16_f32 v196, v200, v201
    v_cvt_pk_bf16_f32 v197, v202, v203
    v_cvt_pk_bf16_f32 v198, v204, v205
    v_cvt_pk_bf16_f32 v199, v206, v207
    buffer_store_dwordx4 v[192:195], v2, s[32:35], s42 offen offset:0 sc1
    buffer_store_dwordx4 v[196:199], v2, s[32:35], s43 offen offset:0 sc1
    v_cvt_pk_bf16_f32 v208, v208, v209
    v_cvt_pk_bf16_f32 v209, v210, v211
    v_cvt_pk_bf16_f32 v210, v212, v213
    v_cvt_pk_bf16_f32 v211, v214, v215
    v_cvt_pk_bf16_f32 v212, v216, v217
    v_cvt_pk_bf16_f32 v213, v218, v219
    v_cvt_pk_bf16_f32 v214, v220, v221
    v_cvt_pk_bf16_f32 v215, v222, v223
    buffer_store_dwordx4 v[208:211], v2, s[32:35], s42 offen offset:1024 sc1
    buffer_store_dwordx4 v[212:215], v2, s[32:35], s43 offen offset:1024 sc1
    v_cvt_pk_bf16_f32 v224, v224, v225
    v_cvt_pk_bf16_f32 v225, v226, v227
    v_cvt_pk_bf16_f32 v226, v228, v229
    v_cvt_pk_bf16_f32 v227, v230, v231
    v_cvt_pk_bf16_f32 v228, v232, v233
    v_cvt_pk_bf16_f32 v229, v234, v235
    v_cvt_pk_bf16_f32 v230, v236, v237
    v_cvt_pk_bf16_f32 v231, v238, v239
    buffer_store_dwordx4 v[224:227], v2, s[32:35], s42 offen offset:2048 sc1
    buffer_store_dwordx4 v[228:231], v2, s[32:35], s43 offen offset:2048 sc1
    v_cvt_pk_bf16_f32 v240, v240, v241
    v_cvt_pk_bf16_f32 v241, v242, v243
    v_cvt_pk_bf16_f32 v242, v244, v245
    v_cvt_pk_bf16_f32 v243, v246, v247
    v_cvt_pk_bf16_f32 v244, v248, v249
    v_cvt_pk_bf16_f32 v245, v250, v251
    v_cvt_pk_bf16_f32 v246, v252, v253
    v_cvt_pk_bf16_f32 v247, v254, v255
    buffer_store_dwordx4 v[240:243], v2, s[32:35], s42 offen offset:3072 sc1
    buffer_store_dwordx4 v[244:247], v2, s[32:35], s43 offen offset:3072 sc1
    s_mov_b32 s52, s48
    s_and_b32 s53, s49, 0xffff
    s_mov_b32 s54, 4194304
    s_mov_b32 s55, 0x20000
    s_lshr_b32 s50, s2, 3
    s_lshl_b32 s50, s50, 2
    s_add_u32 s50, s50, s16
    s_lshl_b32 s50, s50, 15
    s_and_b32 s51, s2, 7
    s_lshl_b32 s51, s51, 10
    s_add_u32 s50, s50, s51
    buffer_load_dwordx4 a[0:3], v2, s[52:55], s50 offen
    s_add_u32 s50, s50, 8192
    buffer_load_dwordx4 a[4:7], v2, s[52:55], s50 offen
    s_add_u32 s50, s50, 8192
    buffer_load_dwordx4 a[8:11], v2, s[52:55], s50 offen
    s_add_u32 s50, s50, 8192
    buffer_load_dwordx4 a[12:15], v2, s[52:55], s50 offen
    s_add_u32 s50, s50, 8192
    s_waitcnt vmcnt(12)
    s_branch kv_kernel_ln
kv_kernel_ln:
    v_lshrrev_b32 v4, 1, v1
    v_lshlrev_b32 v4, 10, v4
    v_and_b32 v5, 1, v1
    v_lshlrev_b32 v5, 9, v5
    v_add_u32 v4, v4, v5
    s_lshr_b32 s18, s17, 5
    s_lshl_b32 s18, s18, 15
    s_and_b32 s19, s17, 31
    s_lshl_b32 s19, s19, 4
    s_add_u32 s18, s18, s19
    s_add_u32 s46, s18, 1048576
    v_add_f32 v80, 1.0, v80
    v_add_f32 v81, 1.0, v81
    v_add_f32 v82, 1.0, v82
    v_add_f32 v83, 1.0, v83
    v_add_f32 v84, 1.0, v84
    v_add_f32 v85, 1.0, v85
    v_add_f32 v86, 1.0, v86
    v_add_f32 v87, 1.0, v87
    v_lshlrev_b32 v28, 16, v24
    v_and_b32 v29, 0xffff0000, v24
    v_lshlrev_b32 v30, 16, v25
    v_and_b32 v31, 0xffff0000, v25
    v_lshlrev_b32 v32, 16, v26
    v_and_b32 v33, 0xffff0000, v26
    v_lshlrev_b32 v34, 16, v27
    v_and_b32 v35, 0xffff0000, v27
    v_add_f32 v36, v28, v29
    v_add_f32 v36, v36, v30
    v_add_f32 v36, v36, v31
    v_add_f32 v36, v36, v32
    v_add_f32 v36, v36, v33
    v_add_f32 v36, v36, v34
    v_add_f32 v36, v36, v35
    s_nop 1
    v_add_f32_dpp v36, v36, v36 row_shr:1 row_mask:0xf bank_mask:0xf bound_ctrl:0
    s_nop 1
    v_add_f32_dpp v36, v36, v36 row_shr:2 row_mask:0xf bank_mask:0xf bound_ctrl:0
    s_nop 1
    v_add_f32_dpp v36, v36, v36 row_shr:4 row_mask:0xf bank_mask:0xf bound_ctrl:0
    s_nop 1
    v_add_f32_dpp v36, v36, v36 row_shr:8 row_mask:0xf bank_mask:0xf bound_ctrl:0
    s_nop 1
    v_add_f32_dpp v36, v36, v36 row_bcast:15 row_mask:0xa bank_mask:0xf
    s_nop 1
    v_add_f32_dpp v36, v36, v36 row_bcast:31 row_mask:0xc bank_mask:0xf
    s_nop 1
    v_readlane_b32 s18, v36, 63
    s_nop 3
    v_mov_b32 v36, 0xbb000000
    v_mul_f32 v36, s18, v36
    v_add_f32 v28, v28, v36
    v_add_f32 v29, v29, v36
    v_add_f32 v30, v30, v36
    v_add_f32 v31, v31, v36
    v_add_f32 v32, v32, v36
    v_add_f32 v33, v33, v36
    v_add_f32 v34, v34, v36
    v_add_f32 v35, v35, v36
    v_mul_f32 v36, v28, v28
    v_fmac_f32 v36, v29, v29
    v_fmac_f32 v36, v30, v30
    v_fmac_f32 v36, v31, v31
    v_fmac_f32 v36, v32, v32
    v_fmac_f32 v36, v33, v33
    v_fmac_f32 v36, v34, v34
    v_fmac_f32 v36, v35, v35
    s_nop 1
    v_add_f32_dpp v36, v36, v36 row_shr:1 row_mask:0xf bank_mask:0xf bound_ctrl:0
    s_nop 1
    v_add_f32_dpp v36, v36, v36 row_shr:2 row_mask:0xf bank_mask:0xf bound_ctrl:0
    s_nop 1
    v_add_f32_dpp v36, v36, v36 row_shr:4 row_mask:0xf bank_mask:0xf bound_ctrl:0
    s_nop 1
    v_add_f32_dpp v36, v36, v36 row_shr:8 row_mask:0xf bank_mask:0xf bound_ctrl:0
    s_nop 1
    v_add_f32_dpp v36, v36, v36 row_bcast:15 row_mask:0xa bank_mask:0xf
    s_nop 1
    v_add_f32_dpp v36, v36, v36 row_bcast:31 row_mask:0xc bank_mask:0xf
    s_nop 1
    v_readlane_b32 s18, v36, 63
    s_nop 3
    v_mov_b32 v36, 0x3b000000
    v_mul_f32 v36, s18, v36
    v_add_f32 v36, 0x3727c5ac, v36
    v_rsq_f32 v36, v36
    s_nop 0
    v_mul_f32 v28, v28, v36
    v_mul_f32 v29, v29, v36
    v_mul_f32 v30, v30, v36
    v_mul_f32 v31, v31, v36
    v_mul_f32 v32, v32, v36
    v_mul_f32 v33, v33, v36
    v_mul_f32 v34, v34, v36
    v_mul_f32 v35, v35, v36
    v_fma_f32 v28, v28, v80, v72
    v_fma_f32 v29, v29, v81, v73
    v_fma_f32 v30, v30, v82, v74
    v_fma_f32 v31, v31, v83, v75
    v_fma_f32 v32, v32, v84, v76
    v_fma_f32 v33, v33, v85, v77
    v_fma_f32 v34, v34, v86, v78
    v_fma_f32 v35, v35, v87, v79
    v_cvt_pk_bf16_f32 v88, v28, v29
    v_cvt_pk_bf16_f32 v89, v30, v31
    v_cvt_pk_bf16_f32 v90, v32, v33
    v_cvt_pk_bf16_f32 v91, v34, v35
    buffer_store_dwordx4 v[88:91], v4, s[32:35], s46 offen offset:0
    v_lshlrev_b32 v28, 16, v64
    v_and_b32 v29, 0xffff0000, v64
    v_lshlrev_b32 v30, 16, v65
    v_and_b32 v31, 0xffff0000, v65
    v_lshlrev_b32 v32, 16, v66
    v_and_b32 v33, 0xffff0000, v66
    v_lshlrev_b32 v34, 16, v67
    v_and_b32 v35, 0xffff0000, v67
    v_add_f32 v36, v28, v29
    v_add_f32 v36, v36, v30
    v_add_f32 v36, v36, v31
    v_add_f32 v36, v36, v32
    v_add_f32 v36, v36, v33
    v_add_f32 v36, v36, v34
    v_add_f32 v36, v36, v35
    s_nop 1
    v_add_f32_dpp v36, v36, v36 row_shr:1 row_mask:0xf bank_mask:0xf bound_ctrl:0
    s_nop 1
    v_add_f32_dpp v36, v36, v36 row_shr:2 row_mask:0xf bank_mask:0xf bound_ctrl:0
    s_nop 1
    v_add_f32_dpp v36, v36, v36 row_shr:4 row_mask:0xf bank_mask:0xf bound_ctrl:0
    s_nop 1
    v_add_f32_dpp v36, v36, v36 row_shr:8 row_mask:0xf bank_mask:0xf bound_ctrl:0
    s_nop 1
    v_add_f32_dpp v36, v36, v36 row_bcast:15 row_mask:0xa bank_mask:0xf
    s_nop 1
    v_add_f32_dpp v36, v36, v36 row_bcast:31 row_mask:0xc bank_mask:0xf
    s_nop 1
    v_readlane_b32 s18, v36, 63
    s_nop 3
    v_mov_b32 v36, 0xbb000000
    v_mul_f32 v36, s18, v36
    v_add_f32 v28, v28, v36
    v_add_f32 v29, v29, v36
    v_add_f32 v30, v30, v36
    v_add_f32 v31, v31, v36
    v_add_f32 v32, v32, v36
    v_add_f32 v33, v33, v36
    v_add_f32 v34, v34, v36
    v_add_f32 v35, v35, v36
    v_mul_f32 v36, v28, v28
    v_fmac_f32 v36, v29, v29
    v_fmac_f32 v36, v30, v30
    v_fmac_f32 v36, v31, v31
    v_fmac_f32 v36, v32, v32
    v_fmac_f32 v36, v33, v33
    v_fmac_f32 v36, v34, v34
    v_fmac_f32 v36, v35, v35
    s_nop 1
    v_add_f32_dpp v36, v36, v36 row_shr:1 row_mask:0xf bank_mask:0xf bound_ctrl:0
    s_nop 1
    v_add_f32_dpp v36, v36, v36 row_shr:2 row_mask:0xf bank_mask:0xf bound_ctrl:0
    s_nop 1
    v_add_f32_dpp v36, v36, v36 row_shr:4 row_mask:0xf bank_mask:0xf bound_ctrl:0
    s_nop 1
    v_add_f32_dpp v36, v36, v36 row_shr:8 row_mask:0xf bank_mask:0xf bound_ctrl:0
    s_nop 1
    v_add_f32_dpp v36, v36, v36 row_bcast:15 row_mask:0xa bank_mask:0xf
    s_nop 1
    v_add_f32_dpp v36, v36, v36 row_bcast:31 row_mask:0xc bank_mask:0xf
    s_nop 1
    v_readlane_b32 s18, v36, 63
    s_nop 3
    v_mov_b32 v36, 0x3b000000
    v_mul_f32 v36, s18, v36
    v_add_f32 v36, 0x3727c5ac, v36
    v_rsq_f32 v36, v36
    s_nop 0
    v_mul_f32 v28, v28, v36
    v_mul_f32 v29, v29, v36
    v_mul_f32 v30, v30, v36
    v_mul_f32 v31, v31, v36
    v_mul_f32 v32, v32, v36
    v_mul_f32 v33, v33, v36
    v_mul_f32 v34, v34, v36
    v_mul_f32 v35, v35, v36
    v_fma_f32 v28, v28, v80, v72
    v_fma_f32 v29, v29, v81, v73
    v_fma_f32 v30, v30, v82, v74
    v_fma_f32 v31, v31, v83, v75
    v_fma_f32 v32, v32, v84, v76
    v_fma_f32 v33, v33, v85, v77
    v_fma_f32 v34, v34, v86, v78
    v_fma_f32 v35, v35, v87, v79
    v_cvt_pk_bf16_f32 v92, v28, v29
    v_cvt_pk_bf16_f32 v93, v30, v31
    v_cvt_pk_bf16_f32 v94, v32, v33
    v_cvt_pk_bf16_f32 v95, v34, v35
    buffer_store_dwordx4 v[92:95], v4, s[32:35], s46 offen offset:16
    v_mov_b32 v122, s16
    v_lshlrev_b32 v122, 6, v122
    v_add_u32 v122, v122, v1
    s_getpc_b64 s[50:51]
pc_2:
    s_add_u32 s50, s50, attn_kernel-pc_2
    s_addc_u32 s51, s51, 0
    s_mov_b32 s52, attn_kernel_end-attn_kernel-4
    v_lshlrev_b32 v126, 6, v122
    v_min_u32 v126, s52, v126
    v_and_b32 v126, -4, v126
    v_mov_b32 v125, s51
    v_add_co_u32 v124, vcc, s50, v126
    v_addc_co_u32 v125, vcc, 0, v125, vcc
    global_load_dword v127, v[124:125], off
    v_lshlrev_b32 v126, 6, v122
    v_add_u32 v126, 16384, v126
    v_min_u32 v126, s52, v126
    v_and_b32 v126, -4, v126
    v_mov_b32 v125, s51
    v_add_co_u32 v124, vcc, s50, v126
    v_addc_co_u32 v125, vcc, 0, v125, vcc
    global_load_dword v127, v[124:125], off
kv_kernel_end:
    s_endpgm
.section .rodata,"a"
.p2align 6
.amdhsa_kernel kv_kernel
  .amdhsa_next_free_vgpr 512
  .amdhsa_next_free_sgpr 102
  .amdhsa_accum_offset 256
  .amdhsa_group_segment_fixed_size 0
  .amdhsa_kernarg_size 112
  .amdhsa_user_sgpr_count 2
  .amdhsa_user_sgpr_kernarg_segment_ptr 1
  .amdhsa_system_sgpr_workgroup_id_x 1
.end_amdhsa_kernel
.text
.globl attn_kernel
.p2align 8
.type attn_kernel,@function
attn_kernel:
    s_cmp_ge_u32 s2, 256
    s_cbranch_scc1 attn_kernel_end
    s_load_dwordx2 s[4:5], s[0:1], 16
    s_load_dwordx2 s[10:11], s[0:1], 104
    s_load_dwordx2 s[58:59], s[0:1], 40
    s_load_dwordx2 s[60:61], s[0:1], 56
    s_load_dwordx2 s[62:63], s[0:1], 64
    s_and_b32 s14, s2, 7
    s_lshl_b32 s14, s14, 2
    s_lshr_b32 s15, s2, 3
    s_and_b32 s15, s15, 3
    s_add_u32 s14, s14, s15
    s_lshr_b32 s15, s2, 5
    v_lshrrev_b32 v1, 6, v0
    s_nop 0
    v_readfirstlane_b32 s16, v1
    v_and_b32 v1, 63, v0
    v_lshlrev_b32 v2, 4, v1
    s_lshr_b32 s17, s16, 2
    s_and_b32 s18, s16, 3
    s_sub_u32 s19, 15, s15
    s_cmp_eq_u32 s17, 0
    s_cselect_b32 s19, s15, s19
    s_lshl_b32 s40, s19, 1
    s_add_u32 s40, s40, 2
    s_lshl_b32 s41, s15, 1
    s_sub_u32 s41, 32, s41
    s_lshl_b32 s42, s19, 2
    s_add_u32 s42, s42, s18
    s_waitcnt lgkmcnt(0)
    s_mov_b32 s24, s4
    s_and_b32 s25, s5, 0xffff
    s_mov_b32 s26, 4194304
    s_mov_b32 s27, 0x20000
    s_mov_b32 s32, s10
    s_and_b32 s33, s11, 0xffff
    s_mov_b32 s34, 268435456
    s_mov_b32 s35, 0x20000
    v_lshrrev_b32 v10, 4, v1
    v_and_b32 v11, 15, v1
    v_lshlrev_b32 v12, 2, v10
    v_xor_b32 v11, v11, v12
    v_lshlrev_b32 v11, 4, v11
    s_lshl_b32 s20, s16, 4
    v_add_u32 v12, s20, v10
    v_lshlrev_b32 v12, 13, v12
    s_lshl_b32 s20, s14, 8
    v_add_u32 v12, s20, v12
    v_add_u32 v24, v12, v11
    v_add_u32 v25, 31744, v24
    v_add_u32 v26, 63488, v24
    v_add_u32 v27, 95232, v24
    s_lshl_b32 s43, s42, 15
    s_add_u32 s43, s43, 1048576
    s_lshl_b32 s44, s14, 20
    s_add_u32 s44, s44, 16777216
    s_lshl_b32 s20, s18, 13
    s_add_u32 s45, s44, s20
    s_lshl_b32 s46, s18, 13
    s_lshl_b32 s20, s16, 12
    s_mov_b32 s21, 0
    s_add_u32 m0, s20, 0
    s_nop 0
    buffer_load_dwordx4 v24, s[24:27], s21 offen offset:0 lds
    buffer_load_dwordx4 v25, s[24:27], s21 offen offset:1024 lds
    buffer_load_dwordx4 v26, s[24:27], s21 offen offset:2048 lds
    buffer_load_dwordx4 v27, s[24:27], s21 offen offset:3072 lds
    s_add_u32 s47, s43, 0
    buffer_load_dwordx4 v[192:195], v2, s[32:35], s47 offen offset:0
    s_add_u32 s47, s43, 0
    buffer_load_dwordx4 v[196:199], v2, s[32:35], s47 offen offset:1024
    s_add_u32 s47, s43, 0
    buffer_load_dwordx4 v[200:203], v2, s[32:35], s47 offen offset:2048
    s_add_u32 s47, s43, 0
    buffer_load_dwordx4 v[204:207], v2, s[32:35], s47 offen offset:3072
    s_add_u32 s47, s43, 4096
    buffer_load_dwordx4 v[208:211], v2, s[32:35], s47 offen offset:0
    s_add_u32 s47, s43, 4096
    buffer_load_dwordx4 v[212:215], v2, s[32:35], s47 offen offset:1024
    s_add_u32 s47, s43, 4096
    buffer_load_dwordx4 v[216:219], v2, s[32:35], s47 offen offset:2048
    s_add_u32 s47, s43, 4096
    buffer_load_dwordx4 v[220:223], v2, s[32:35], s47 offen offset:3072
    s_lshl_b32 s20, s16, 12
    s_mov_b32 s21, 1048576
    s_add_u32 m0, s20, 32768
    s_nop 0
    buffer_load_dwordx4 v24, s[24:27], s21 offen offset:0 lds
    buffer_load_dwordx4 v25, s[24:27], s21 offen offset:1024 lds
    buffer_load_dwordx4 v26, s[24:27], s21 offen offset:2048 lds
    buffer_load_dwordx4 v27, s[24:27], s21 offen offset:3072 lds
    v_lshrrev_b32 v10, 4, v1
    v_bfe_u32 v11, v1, 2, 2
    v_and_b32 v12, 3, v1
    v_lshrrev_b32 v13, 1, v10
    v_lshlrev_b32 v13, 3, v13
    v_add_u32 v13, v13, v11
    v_lshlrev_b32 v13, 8, v13
    v_and_b32 v14, 1, v10
    v_lshlrev_b32 v14, 1, v14
    v_lshrrev_b32 v15, 1, v12
    v_add_u32 v14, v14, v15
    v_lshlrev_b32 v14, 4, v14
    v_and_b32 v15, 1, v12
    v_lshlrev_b32 v15, 3, v15
    v_add_u32 v14, v14, v15
    v_add_u32 v13, v13, v14
    v_xor_b32 v14, 0, v11
    v_lshlrev_b32 v14, 6, v14
    v_add_u32 v16, v13, v14
    v_add_u32 v20, 0x10000, v16
    v_xor_b32 v14, 1, v11
    v_lshlrev_b32 v14, 6, v14
    v_add_u32 v17, v13, v14
    v_add_u32 v21, 0x10000, v17
    v_xor_b32 v14, 2, v11
    v_lshlrev_b32 v14, 6, v14
    v_add_u32 v18, v13, v14
    v_add_u32 v22, 0x10000, v18
    v_xor_b32 v14, 3, v11
    v_lshlrev_b32 v14, 6, v14
    v_add_u32 v19, v13, v14
    v_add_u32 v23, 0x10000, v19
    s_waitcnt vmcnt(12)
    s_barrier
    ds_read_b64_tr_b16 v[96:97], v16 offset:0
    ds_read_b64_tr_b16 v[98:99], v16 offset:1024
    ds_read_b64_tr_b16 v[100:101], v17 offset:0
    ds_read_b64_tr_b16 v[102:103], v17 offset:1024
    ds_read_b64_tr_b16 v[104:105], v18 offset:0
    ds_read_b64_tr_b16 v[106:107], v18 offset:1024
    ds_read_b64_tr_b16 v[108:109], v19 offset:0
    ds_read_b64_tr_b16 v[110:111], v19 offset:1024
    s_waitcnt vmcnt(11)
    s_waitcnt lgkmcnt(6)
    v_mfma_f32_32x32x16_bf16 v[128:143], v[96:99], v[192:195], 0
    ds_read_b64_tr_b16 v[112:113], v16 offset:4096
    ds_read_b64_tr_b16 v[114:115], v16 offset:5120
    s_add_u32 s47, s43, 8192
    buffer_load_dwordx4 v[224:227], v2, s[32:35], s47 offen offset:0
    s_waitcnt lgkmcnt(6)
    v_mfma_f32_32x32x16_bf16 v[144:159], v[100:103], v[192:195], 0
    ds_read_b64_tr_b16 v[116:117], v17 offset:4096
    ds_read_b64_tr_b16 v[118:119], v17 offset:5120
    s_waitcnt lgkmcnt(6)
    v_mfma_f32_32x32x16_bf16 v[160:175], v[104:107], v[192:195], 0
    ds_read_b64_tr_b16 v[120:121], v18 offset:4096
    ds_read_b64_tr_b16 v[122:123], v18 offset:5120
    s_lshl_b32 s20, s16, 12
    s_mov_b32 s21, 2097152
    s_add_u32 m0, s20, 65536
    s_nop 0
    buffer_load_dwordx4 v24, s[24:27], s21 offen offset:0 lds
    buffer_load_dwordx4 v25, s[24:27], s21 offen offset:1024 lds
    buffer_load_dwordx4 v26, s[24:27], s21 offen offset:2048 lds
    buffer_load_dwordx4 v27, s[24:27], s21 offen offset:3072 lds
    s_waitcnt lgkmcnt(6)
    v_mfma_f32_32x32x16_bf16 v[176:191], v[108:111], v[192:195], 0
    ds_read_b64_tr_b16 v[124:125], v19 offset:4096
    ds_read_b64_tr_b16 v[126:127], v19 offset:5120
    s_waitcnt vmcnt(15)
    s_waitcnt lgkmcnt(6)
    v_mfma_f32_32x32x16_bf16 v[128:143], v[112:115], v[196:199], v[128:143]
    ds_read_b64_tr_b16 v[96:97], v16 offset:8192
    ds_read_b64_tr_b16 v[98:99], v16 offset:9216
    s_add_u32 s47, s43, 8192
    buffer_load_dwordx4 v[228:231], v2, s[32:35], s47 offen offset:1024
    s_add_u32 s47, s43, 16384
    buffer_load_dwordx4 v[192:195], v2, s[32:35], s47 offen offset:0
    s_waitcnt lgkmcnt(6)
    v_mfma_f32_32x32x16_bf16 v[144:159], v[116:119], v[196:199], v[144:159]
    ds_read_b64_tr_b16 v[100:101], v17 offset:8192
    ds_read_b64_tr_b16 v[102:103], v17 offset:9216
    s_waitcnt lgkmcnt(6)
    v_mfma_f32_32x32x16_bf16 v[160:175], v[120:123], v[196:199], v[160:175]
    ds_read_b64_tr_b16 v[104:105], v18 offset:8192
    ds_read_b64_tr_b16 v[106:107], v18 offset:9216
    s_waitcnt lgkmcnt(6)
    v_mfma_f32_32x32x16_bf16 v[176:191], v[124:127], v[196:199], v[176:191]
    ds_read_b64_tr_b16 v[108:109], v19 offset:8192
    ds_read_b64_tr_b16 v[110:111], v19 offset:9216
    s_waitcnt vmcnt(16)
    s_waitcnt lgkmcnt(6)
    v_mfma_f32_32x32x16_bf16 v[128:143], v[96:99], v[200:203], v[128:143]
    ds_read_b64_tr_b16 v[112:113], v16 offset:12288
    ds_read_b64_tr_b16 v[114:115], v16 offset:13312
    s_add_u32 s47, s43, 8192
    buffer_load_dwordx4 v[232:235], v2, s[32:35], s47 offen offset:2048
    s_add_u32 s47, s43, 16384
    buffer_load_dwordx4 v[196:199], v2, s[32:35], s47 offen offset:1024
    s_waitcnt lgkmcnt(6)
    v_mfma_f32_32x32x16_bf16 v[144:159], v[100:103], v[200:203], v[144:159]
    ds_read_b64_tr_b16 v[116:117], v17 offset:12288
    ds_read_b64_tr_b16 v[118:119], v17 offset:13312
    s_waitcnt lgkmcnt(6)
    v_mfma_f32_32x32x16_bf16 v[160:175], v[104:107], v[200:203], v[160:175]
    ds_read_b64_tr_b16 v[120:121], v18 offset:12288
    ds_read_b64_tr_b16 v[122:123], v18 offset:13312
    s_lshl_b32 s20, s16, 12
    s_mov_b32 s21, 3145728
    s_add_u32 m0, s20, 98304
    s_nop 0
    buffer_load_dwordx4 v24, s[24:27], s21 offen offset:0 lds
    buffer_load_dwordx4 v25, s[24:27], s21 offen offset:1024 lds
    buffer_load_dwordx4 v26, s[24:27], s21 offen offset:2048 lds
    buffer_load_dwordx4 v27, s[24:27], s21 offen offset:3072 lds
    s_waitcnt lgkmcnt(6)
    v_mfma_f32_32x32x16_bf16 v[176:191], v[108:111], v[200:203], v[176:191]
    ds_read_b64_tr_b16 v[124:125], v19 offset:12288
    ds_read_b64_tr_b16 v[126:127], v19 offset:13312
    s_waitcnt vmcnt(21)
    s_waitcnt lgkmcnt(6)
    v_mfma_f32_32x32x16_bf16 v[128:143], v[112:115], v[204:207], v[128:143]
    ds_read_b64_tr_b16 v[96:97], v16 offset:16384
    ds_read_b64_tr_b16 v[98:99], v16 offset:17408
    s_add_u32 s47, s43, 8192
    buffer_load_dwordx4 v[236:239], v2, s[32:35], s47 offen offset:3072
    s_add_u32 s47, s43, 16384
    buffer_load_dwordx4 v[200:203], v2, s[32:35], s47 offen offset:2048
    s_waitcnt lgkmcnt(6)
    v_mfma_f32_32x32x16_bf16 v[144:159], v[116:119], v[204:207], v[144:159]
    ds_read_b64_tr_b16 v[100:101], v17 offset:16384
    ds_read_b64_tr_b16 v[102:103], v17 offset:17408
    s_waitcnt lgkmcnt(6)
    v_mfma_f32_32x32x16_bf16 v[160:175], v[120:123], v[204:207], v[160:175]
    ds_read_b64_tr_b16 v[104:105], v18 offset:16384
    ds_read_b64_tr_b16 v[106:107], v18 offset:17408
    s_waitcnt lgkmcnt(6)
    v_mfma_f32_32x32x16_bf16 v[176:191], v[124:127], v[204:207], v[176:191]
    ds_read_b64_tr_b16 v[108:109], v19 offset:16384
    ds_read_b64_tr_b16 v[110:111], v19 offset:17408
    s_waitcnt vmcnt(22)
    s_waitcnt lgkmcnt(6)
    v_mfma_f32_32x32x16_bf16 v[128:143], v[96:99], v[208:211], v[128:143]
    ds_read_b64_tr_b16 v[112:113], v16 offset:20480
    ds_read_b64_tr_b16 v[114:115], v16 offset:21504
    s_add_u32 s47, s43, 12288
    buffer_load_dwordx4 v[240:243], v2, s[32:35], s47 offen offset:0
    s_add_u32 s47, s43, 16384
    buffer_load_dwordx4 v[204:207], v2, s[32:35], s47 offen offset:3072
    s_waitcnt lgkmcnt(6)
    v_mfma_f32_32x32x16_bf16 v[144:159], v[100:103], v[208:211], v[144:159]
    ds_read_b64_tr_b16 v[116:117], v17 offset:20480
    ds_read_b64_tr_b16 v[118:119], v17 offset:21504
    s_waitcnt lgkmcnt(6)
    v_mfma_f32_32x32x16_bf16 v[160:175], v[104:107], v[208:211], v[160:175]
    ds_read_b64_tr_b16 v[120:121], v18 offset:20480
    ds_read_b64_tr_b16 v[122:123], v18 offset:21504
    s_cmp_lg_u32 s17, 0
    s_cbranch_scc1 td_3
    s_add_u32 s47, s45, 0
    s_add_u32 m0, s46, 131072
    s_nop 0
    buffer_load_dwordx4 v2, s[32:35], s47 offen offset:0 lds
    buffer_load_dwordx4 v2, s[32:35], s47 offen offset:1024 lds
    buffer_load_dwordx4 v2, s[32:35], s47 offen offset:2048 lds
    buffer_load_dwordx4 v2, s[32:35], s47 offen offset:3072 lds
    s_add_u32 s47, s45, 4096
    s_add_u32 m0, s46, 135168
    s_nop 0
    buffer_load_dwordx4 v2, s[32:35], s47 offen offset:0 lds
    buffer_load_dwordx4 v2, s[32:35], s47 offen offset:1024 lds
    buffer_load_dwordx4 v2, s[32:35], s47 offen offset:2048 lds
    buffer_load_dwordx4 v2, s[32:35], s47 offen offset:3072 lds
td_3:
    s_waitcnt lgkmcnt(6)
    v_mfma_f32_32x32x16_bf16 v[176:191], v[108:111], v[208:211], v[176:191]
    ds_read_b64_tr_b16 v[124:125], v19 offset:20480
    ds_read_b64_tr_b16 v[126:127], v19 offset:21504
    s_waitcnt vmcnt(23)
    s_waitcnt lgkmcnt(6)
    v_mfma_f32_32x32x16_bf16 v[128:143], v[112:115], v[212:215], v[128:143]
    ds_read_b64_tr_b16 v[96:97], v16 offset:24576
    ds_read_b64_tr_b16 v[98:99], v16 offset:25600
    s_add_u32 s47, s43, 12288
    buffer_load_dwordx4 v[244:247], v2, s[32:35], s47 offen offset:1024
    s_add_u32 s47, s43, 20480
    buffer_load_dwordx4 v[208:211], v2, s[32:35], s47 offen offset:0
    s_waitcnt lgkmcnt(6)
    v_mfma_f32_32x32x16_bf16 v[144:159], v[116:119], v[212:215], v[144:159]
    ds_read_b64_tr_b16 v[100:101], v17 offset:24576
    ds_read_b64_tr_b16 v[102:103], v17 offset:25600
    s_waitcnt lgkmcnt(6)
    v_mfma_f32_32x32x16_bf16 v[160:175], v[120:123], v[212:215], v[160:175]
    ds_read_b64_tr_b16 v[104:105], v18 offset:24576
    ds_read_b64_tr_b16 v[106:107], v18 offset:25600
    s_waitcnt lgkmcnt(6)
    v_mfma_f32_32x32x16_bf16 v[176:191], v[124:127], v[212:215], v[176:191]
    ds_read_b64_tr_b16 v[108:109], v19 offset:24576
    ds_read_b64_tr_b16 v[110:111], v19 offset:25600
    s_waitcnt vmcnt(24)
    s_waitcnt lgkmcnt(6)
    v_mfma_f32_32x32x16_bf16 v[128:143], v[96:99], v[216:219], v[128:143]
    ds_read_b64_tr_b16 v[112:113], v16 offset:28672
    ds_read_b64_tr_b16 v[114:115], v16 offset:29696
    s_add_u32 s47, s43, 12288
    buffer_load_dwordx4 v[248:251], v2, s[32:35], s47 offen offset:2048
    s_add_u32 s47, s43, 20480
    buffer_load_dwordx4 v[212:215], v2, s[32:35], s47 offen offset:1024
    s_waitcnt lgkmcnt(6)
    v_mfma_f32_32x32x16_bf16 v[144:159], v[100:103], v[216:219], v[144:159]
    ds_read_b64_tr_b16 v[116:117], v17 offset:28672
    ds_read_b64_tr_b16 v[118:119], v17 offset:29696
    s_waitcnt lgkmcnt(6)
    v_mfma_f32_32x32x16_bf16 v[160:175], v[104:107], v[216:219], v[160:175]
    ds_read_b64_tr_b16 v[120:121], v18 offset:28672
    ds_read_b64_tr_b16 v[122:123], v18 offset:29696
    s_waitcnt lgkmcnt(6)
    v_mfma_f32_32x32x16_bf16 v[176:191], v[108:111], v[216:219], v[176:191]
    ds_read_b64_tr_b16 v[124:125], v19 offset:28672
    ds_read_b64_tr_b16 v[126:127], v19 offset:29696
    s_waitcnt vmcnt(21)
    s_barrier
    s_waitcnt lgkmcnt(6)
    v_mfma_f32_32x32x16_bf16 v[128:143], v[112:115], v[220:223], v[128:143]
    ds_read_b64_tr_b16 v[96:97], v16 offset:32768
    ds_read_b64_tr_b16 v[98:99], v16 offset:33792
    s_add_u32 s47, s43, 12288
    buffer_load_dwordx4 v[252:255], v2, s[32:35], s47 offen offset:3072
    s_add_u32 s47, s43, 20480
    buffer_load_dwordx4 v[216:219], v2, s[32:35], s47 offen offset:2048
    s_waitcnt lgkmcnt(6)
    v_mfma_f32_32x32x16_bf16 v[144:159], v[116:119], v[220:223], v[144:159]
    ds_read_b64_tr_b16 v[100:101], v17 offset:32768
    ds_read_b64_tr_b16 v[102:103], v17 offset:33792
    s_waitcnt lgkmcnt(6)
    v_mfma_f32_32x32x16_bf16 v[160:175], v[120:123], v[220:223], v[160:175]
    ds_read_b64_tr_b16 v[104:105], v18 offset:32768
    ds_read_b64_tr_b16 v[106:107], v18 offset:33792
    s_waitcnt lgkmcnt(6)
    v_mfma_f32_32x32x16_bf16 v[176:191], v[124:127], v[220:223], v[176:191]
    ds_read_b64_tr_b16 v[108:109], v19 offset:32768
    ds_read_b64_tr_b16 v[110:111], v19 offset:33792
    s_waitcnt vmcnt(22)
    s_waitcnt lgkmcnt(6)
    v_mfma_f32_32x32x16_bf16 v[128:143], v[96:99], v[224:227], v[128:143]
    ds_read_b64_tr_b16 v[112:113], v16 offset:36864
    ds_read_b64_tr_b16 v[114:115], v16 offset:37888
    s_add_u32 s47, s43, 20480
    buffer_load_dwordx4 v[220:223], v2, s[32:35], s47 offen offset:3072
    s_waitcnt lgkmcnt(6)
    v_mfma_f32_32x32x16_bf16 v[144:159], v[100:103], v[224:227], v[144:159]
    ds_read_b64_tr_b16 v[116:117], v17 offset:36864
    ds_read_b64_tr_b16 v[118:119], v17 offset:37888
    s_waitcnt lgkmcnt(6)
    v_mfma_f32_32x32x16_bf16 v[160:175], v[104:107], v[224:227], v[160:175]
    ds_read_b64_tr_b16 v[120:121], v18 offset:36864
    ds_read_b64_tr_b16 v[122:123], v18 offset:37888
    s_waitcnt lgkmcnt(6)
    v_mfma_f32_32x32x16_bf16 v[176:191], v[108:111], v[224:227], v[176:191]
    v_mov_b32 v32, 0
    v_mov_b32 v33, 0
    v_mov_b32 v34, 0
    v_mov_b32 v35, 0
    ds_read_b64_tr_b16 v[124:125], v19 offset:36864
    ds_read_b64_tr_b16 v[126:127], v19 offset:37888
    s_waitcnt vmcnt(18)
    s_waitcnt lgkmcnt(6)
    v_mfma_f32_32x32x16_bf16 v[128:143], v[112:115], v[228:231], v[128:143]
    ds_read_b64_tr_b16 v[96:97], v16 offset:40960
    ds_read_b64_tr_b16 v[98:99], v16 offset:41984
    s_add_u32 s47, s43, 24576
    buffer_load_dwordx4 v[224:227], v2, s[32:35], s47 offen offset:0
    s_waitcnt lgkmcnt(6)
    v_mfma_f32_32x32x16_bf16 v[144:159], v[116:119], v[228:231], v[144:159]
    ds_read_b64_tr_b16 v[100:101], v17 offset:40960
    ds_read_b64_tr_b16 v[102:103], v17 offset:41984
    s_waitcnt lgkmcnt(6)
    v_mfma_f32_32x32x16_bf16 v[160:175], v[120:123], v[228:231], v[160:175]
    ds_read_b64_tr_b16 v[104:105], v18 offset:40960
    ds_read_b64_tr_b16 v[106:107], v18 offset:41984
    s_waitcnt lgkmcnt(6)
    v_mfma_f32_32x32x16_bf16 v[176:191], v[124:127], v[228:231], v[176:191]
    v_mov_b32 v36, 0
    v_mov_b32 v37, 0
    v_mov_b32 v38, 0
    v_mov_b32 v39, 0
    ds_read_b64_tr_b16 v[108:109], v19 offset:40960
    ds_read_b64_tr_b16 v[110:111], v19 offset:41984
    s_waitcnt vmcnt(17)
    s_waitcnt lgkmcnt(6)
    v_mfma_f32_32x32x16_bf16 v[128:143], v[96:99], v[232:235], v[128:143]
    ds_read_b64_tr_b16 v[112:113], v16 offset:45056
    ds_read_b64_tr_b16 v[114:115], v16 offset:46080
    s_add_u32 s47, s43, 24576
    buffer_load_dwordx4 v[228:231], v2, s[32:35], s47 offen offset:1024
    s_waitcnt lgkmcnt(6)
    v_mfma_f32_32x32x16_bf16 v[144:159], v[100:103], v[232:235], v[144:159]
    ds_read_b64_tr_b16 v[116:117], v17 offset:45056
    ds_read_b64_tr_b16 v[118:119], v17 offset:46080
    s_waitcnt lgkmcnt(6)
    v_mfma_f32_32x32x16_bf16 v[160:175], v[104:107], v[232:235], v[160:175]
    ds_read_b64_tr_b16 v[120:121], v18 offset:45056
    ds_read_b64_tr_b16 v[122:123], v18 offset:46080
    s_waitcnt lgkmcnt(6)
    v_mfma_f32_32x32x16_bf16 v[176:191], v[108:111], v[232:235], v[176:191]
    v_mov_b32 v40, 0
    v_mov_b32 v41, 0
    v_mov_b32 v42, 0
    v_mov_b32 v43, 0
    ds_read_b64_tr_b16 v[124:125], v19 offset:45056
    ds_read_b64_tr_b16 v[126:127], v19 offset:46080
    s_waitcnt vmcnt(12)
    s_waitcnt lgkmcnt(6)
    v_mfma_f32_32x32x16_bf16 v[128:143], v[112:115], v[236:239], v[128:143]
    ds_read_b64_tr_b16 v[96:97], v16 offset:49152
    ds_read_b64_tr_b16 v[98:99], v16 offset:50176
    s_add_u32 s47, s43, 24576
    buffer_load_dwordx4 v[232:235], v2, s[32:35], s47 offen offset:2048
    s_waitcnt lgkmcnt(6)
    v_mfma_f32_32x32x16_bf16 v[144:159], v[116:119], v[236:239], v[144:159]
    ds_read_b64_tr_b16 v[100:101], v17 offset:49152
    ds_read_b64_tr_b16 v[102:103], v17 offset:50176
    s_waitcnt lgkmcnt(6)
    v_mfma_f32_32x32x16_bf16 v[160:175], v[120:123], v[236:239], v[160:175]
    ds_read_b64_tr_b16 v[104:105], v18 offset:49152
    ds_read_b64_tr_b16 v[106:107], v18 offset:50176
    s_waitcnt lgkmcnt(6)
    v_mfma_f32_32x32x16_bf16 v[176:191], v[124:127], v[236:239], v[176:191]
    v_mov_b32 v44, 0
    v_mov_b32 v45, 0
    v_mov_b32 v46, 0
    v_mov_b32 v47, 0
    ds_read_b64_tr_b16 v[108:109], v19 offset:49152
    ds_read_b64_tr_b16 v[110:111], v19 offset:50176
    s_waitcnt vmcnt(11)
    s_waitcnt lgkmcnt(6)
    v_mfma_f32_32x32x16_bf16 v[128:143], v[96:99], v[240:243], v[128:143]
    ds_read_b64_tr_b16 v[112:113], v16 offset:53248
    ds_read_b64_tr_b16 v[114:115], v16 offset:54272
    s_add_u32 s47, s43, 24576
    buffer_load_dwordx4 v[236:239], v2, s[32:35], s47 offen offset:3072
    s_waitcnt lgkmcnt(6)
    v_mfma_f32_32x32x16_bf16 v[144:159], v[100:103], v[240:243], v[144:159]
    ds_read_b64_tr_b16 v[116:117], v17 offset:53248
    ds_read_b64_tr_b16 v[118:119], v17 offset:54272
    s_waitcnt lgkmcnt(6)
    v_mfma_f32_32x32x16_bf16 v[160:175], v[104:107], v[240:243], v[160:175]
    ds_read_b64_tr_b16 v[120:121], v18 offset:53248
    ds_read_b64_tr_b16 v[122:123], v18 offset:54272
    s_waitcnt lgkmcnt(6)
    v_mfma_f32_32x32x16_bf16 v[176:191], v[108:111], v[240:243], v[176:191]
    v_mov_b32 v48, 0
    v_mov_b32 v49, 0
    v_mov_b32 v50, 0
    v_mov_b32 v51, 0
    ds_read_b64_tr_b16 v[124:125], v19 offset:53248
    ds_read_b64_tr_b16 v[126:127], v19 offset:54272
    s_waitcnt vmcnt(10)
    s_waitcnt lgkmcnt(6)
    v_mfma_f32_32x32x16_bf16 v[128:143], v[112:115], v[244:247], v[128:143]
    ds_read_b64_tr_b16 v[96:97], v16 offset:57344
    ds_read_b64_tr_b16 v[98:99], v16 offset:58368
    s_add_u32 s47, s43, 28672
    buffer_load_dwordx4 v[240:243], v2, s[32:35], s47 offen offset:0
    s_waitcnt lgkmcnt(6)
    v_mfma_f32_32x32x16_bf16 v[144:159], v[116:119], v[244:247], v[144:159]
    ds_read_b64_tr_b16 v[100:101], v17 offset:57344
    ds_read_b64_tr_b16 v[102:103], v17 offset:58368
    s_waitcnt lgkmcnt(6)
    v_mfma_f32_32x32x16_bf16 v[160:175], v[120:123], v[244:247], v[160:175]
    ds_read_b64_tr_b16 v[104:105], v18 offset:57344
    ds_read_b64_tr_b16 v[106:107], v18 offset:58368
    s_waitcnt lgkmcnt(6)
    v_mfma_f32_32x32x16_bf16 v[176:191], v[124:127], v[244:247], v[176:191]
    v_mov_b32 v52, 0
    v_mov_b32 v53, 0
    v_mov_b32 v54, 0
    v_mov_b32 v55, 0
    ds_read_b64_tr_b16 v[108:109], v19 offset:57344
    ds_read_b64_tr_b16 v[110:111], v19 offset:58368
    s_waitcnt vmcnt(9)
    s_waitcnt lgkmcnt(6)
    v_mfma_f32_32x32x16_bf16 v[128:143], v[96:99], v[248:251], v[128:143]
    ds_read_b64_tr_b16 v[112:113], v16 offset:61440
    ds_read_b64_tr_b16 v[114:115], v16 offset:62464
    s_add_u32 s47, s43, 28672
    buffer_load_dwordx4 v[244:247], v2, s[32:35], s47 offen offset:1024
    s_waitcnt lgkmcnt(6)
    v_mfma_f32_32x32x16_bf16 v[144:159], v[100:103], v[248:251], v[144:159]
    ds_read_b64_tr_b16 v[116:117], v17 offset:61440
    ds_read_b64_tr_b16 v[118:119], v17 offset:62464
    s_waitcnt lgkmcnt(6)
    v_mfma_f32_32x32x16_bf16 v[160:175], v[104:107], v[248:251], v[160:175]
    ds_read_b64_tr_b16 v[120:121], v18 offset:61440
    ds_read_b64_tr_b16 v[122:123], v18 offset:62464
    s_waitcnt lgkmcnt(6)
    v_mfma_f32_32x32x16_bf16 v[176:191], v[108:111], v[248:251], v[176:191]
    v_mov_b32 v56, 0
    v_mov_b32 v57, 0
    v_mov_b32 v58, 0
    v_mov_b32 v59, 0
    ds_read_b64_tr_b16 v[124:125], v19 offset:61440
    ds_read_b64_tr_b16 v[126:127], v19 offset:62464
    s_barrier
    s_cmp_lg_u32 s17, 0
    s_cbranch_scc1 td_4
    s_add_u32 s47, s45, 32768
    s_add_u32 m0, s46, 0
    s_nop 0
    buffer_load_dwordx4 v2, s[32:35], s47 offen offset:0 lds
    buffer_load_dwordx4 v2, s[32:35], s47 offen offset:1024 lds
    buffer_load_dwordx4 v2, s[32:35], s47 offen offset:2048 lds
    buffer_load_dwordx4 v2, s[32:35], s47 offen offset:3072 lds
    s_add_u32 s47, s45, 36864
    s_add_u32 m0, s46, 4096
    s_nop 0
    buffer_load_dwordx4 v2, s[32:35], s47 offen offset:0 lds
    buffer_load_dwordx4 v2, s[32:35], s47 offen offset:1024 lds
    buffer_load_dwordx4 v2, s[32:35], s47 offen offset:2048 lds
    buffer_load_dwordx4 v2, s[32:35], s47 offen offset:3072 lds
td_4:
    s_waitcnt vmcnt(8)
    s_waitcnt lgkmcnt(6)
    v_mfma_f32_32x32x16_bf16 v[128:143], v[112:115], v[252:255], v[128:143]
    ds_read_b64_tr_b16 v[96:97], v20 offset:0
    ds_read_b64_tr_b16 v[98:99], v20 offset:1024
    s_add_u32 s47, s43, 28672
    buffer_load_dwordx4 v[248:251], v2, s[32:35], s47 offen offset:2048
    s_waitcnt lgkmcnt(6)
    v_mfma_f32_32x32x16_bf16 v[144:159], v[116:119], v[252:255], v[144:159]
    ds_read_b64_tr_b16 v[100:101], v21 offset:0
    ds_read_b64_tr_b16 v[102:103], v21 offset:1024
    s_waitcnt lgkmcnt(6)
    v_mfma_f32_32x32x16_bf16 v[160:175], v[120:123], v[252:255], v[160:175]
    ds_read_b64_tr_b16 v[104:105], v22 offset:0
    ds_read_b64_tr_b16 v[106:107], v22 offset:1024
    s_waitcnt lgkmcnt(6)
    v_mfma_f32_32x32x16_bf16 v[176:191], v[124:127], v[252:255], v[176:191]
    v_mov_b32 v60, 0
    v_mov_b32 v61, 0
    v_mov_b32 v62, 0
    v_mov_b32 v63, 0
    ds_read_b64_tr_b16 v[108:109], v23 offset:0
    ds_read_b64_tr_b16 v[110:111], v23 offset:1024
    s_waitcnt lgkmcnt(6)
    v_mfma_f32_32x32x16_bf16 v[128:143], v[96:99], v[192:195], v[128:143]
    ds_read_b64_tr_b16 v[112:113], v20 offset:4096
    ds_read_b64_tr_b16 v[114:115], v20 offset:5120
    s_add_u32 s47, s43, 28672
    buffer_load_dwordx4 v[252:255], v2, s[32:35], s47 offen offset:3072
    s_waitcnt lgkmcnt(6)
    v_mfma_f32_32x32x16_bf16 v[144:159], v[100:103], v[192:195], v[144:159]
    ds_read_b64_tr_b16 v[116:117], v21 offset:4096
    ds_read_b64_tr_b16 v[118:119], v21 offset:5120
    s_waitcnt lgkmcnt(6)
    v_mfma_f32_32x32x16_bf16 v[160:175], v[104:107], v[192:195], v[160:175]
    ds_read_b64_tr_b16 v[120:121], v22 offset:4096
    ds_read_b64_tr_b16 v[122:123], v22 offset:5120
    s_waitcnt lgkmcnt(6)
    v_mfma_f32_32x32x16_bf16 v[176:191], v[108:111], v[192:195], v[176:191]
    v_mov_b32 v64, 0
    v_mov_b32 v65, 0
    v_mov_b32 v66, 0
    v_mov_b32 v67, 0
    ds_read_b64_tr_b16 v[124:125], v23 offset:4096
    ds_read_b64_tr_b16 v[126:127], v23 offset:5120
    s_waitcnt lgkmcnt(6)
    v_mfma_f32_32x32x16_bf16 v[128:143], v[112:115], v[196:199], v[128:143]
    ds_read_b64_tr_b16 v[96:97], v20 offset:8192
    ds_read_b64_tr_b16 v[98:99], v20 offset:9216
    s_waitcnt lgkmcnt(6)
    v_mfma_f32_32x32x16_bf16 v[144:159], v[116:119], v[196:199], v[144:159]
    ds_read_b64_tr_b16 v[100:101], v21 offset:8192
    ds_read_b64_tr_b16 v[102:103], v21 offset:9216
    s_waitcnt lgkmcnt(6)
    v_mfma_f32_32x32x16_bf16 v[160:175], v[120:123], v[196:199], v[160:175]
    ds_read_b64_tr_b16 v[104:105], v22 offset:8192
    ds_read_b64_tr_b16 v[106:107], v22 offset:9216
    s_waitcnt lgkmcnt(6)
    v_mfma_f32_32x32x16_bf16 v[176:191], v[124:127], v[196:199], v[176:191]
    v_mov_b32 v68, 0
    v_mov_b32 v69, 0
    v_mov_b32 v70, 0
    v_mov_b32 v71, 0
    ds_read_b64_tr_b16 v[108:109], v23 offset:8192
    ds_read_b64_tr_b16 v[110:111], v23 offset:9216
    s_waitcnt lgkmcnt(6)
    v_mfma_f32_32x32x16_bf16 v[128:143], v[96:99], v[200:203], v[128:143]
    ds_read_b64_tr_b16 v[112:113], v20 offset:12288
    ds_read_b64_tr_b16 v[114:115], v20 offset:13312
    s_waitcnt lgkmcnt(6)
    v_mfma_f32_32x32x16_bf16 v[144:159], v[100:103], v[200:203], v[144:159]
    ds_read_b64_tr_b16 v[116:117], v21 offset:12288
    ds_read_b64_tr_b16 v[118:119], v21 offset:13312
    s_waitcnt lgkmcnt(6)
    v_mfma_f32_32x32x16_bf16 v[160:175], v[104:107], v[200:203], v[160:175]
    ds_read_b64_tr_b16 v[120:121], v22 offset:12288
    ds_read_b64_tr_b16 v[122:123], v22 offset:13312
    s_waitcnt lgkmcnt(6)
    v_mfma_f32_32x32x16_bf16 v[176:191], v[108:111], v[200:203], v[176:191]
    v_mov_b32 v72, 0
    v_mov_b32 v73, 0
    v_mov_b32 v74, 0
    v_mov_b32 v75, 0
    ds_read_b64_tr_b16 v[124:125], v23 offset:12288
    ds_read_b64_tr_b16 v[126:127], v23 offset:13312
    s_waitcnt lgkmcnt(6)
    v_mfma_f32_32x32x16_bf16 v[128:143], v[112:115], v[204:207], v[128:143]
    ds_read_b64_tr_b16 v[96:97], v20 offset:16384
    ds_read_b64_tr_b16 v[98:99], v20 offset:17408
    s_waitcnt lgkmcnt(6)
    v_mfma_f32_32x32x16_bf16 v[144:159], v[116:119], v[204:207], v[144:159]
    ds_read_b64_tr_b16 v[100:101], v21 offset:16384
    ds_read_b64_tr_b16 v[102:103], v21 offset:17408
    s_waitcnt lgkmcnt(6)
    v_mfma_f32_32x32x16_bf16 v[160:175], v[120:123], v[204:207], v[160:175]
    ds_read_b64_tr_b16 v[104:105], v22 offset:16384
    ds_read_b64_tr_b16 v[106:107], v22 offset:17408
    s_waitcnt lgkmcnt(6)
    v_mfma_f32_32x32x16_bf16 v[176:191], v[124:127], v[204:207], v[176:191]
    v_mov_b32 v76, 0
    v_mov_b32 v77, 0
    v_mov_b32 v78, 0
    v_mov_b32 v79, 0
    ds_read_b64_tr_b16 v[108:109], v23 offset:16384
    ds_read_b64_tr_b16 v[110:111], v23 offset:17408
    s_waitcnt lgkmcnt(6)
    v_mfma_f32_32x32x16_bf16 v[128:143], v[96:99], v[208:211], v[128:143]
    ds_read_b64_tr_b16 v[112:113], v20 offset:20480
    ds_read_b64_tr_b16 v[114:115], v20 offset:21504
    s_waitcnt lgkmcnt(6)
    v_mfma_f32_32x32x16_bf16 v[144:159], v[100:103], v[208:211], v[144:159]
    ds_read_b64_tr_b16 v[116:117], v21 offset:20480
    ds_read_b64_tr_b16 v[118:119], v21 offset:21504
    s_waitcnt lgkmcnt(6)
    v_mfma_f32_32x32x16_bf16 v[160:175], v[104:107], v[208:211], v[160:175]
    ds_read_b64_tr_b16 v[120:121], v22 offset:20480
    ds_read_b64_tr_b16 v[122:123], v22 offset:21504
    s_waitcnt lgkmcnt(6)
    v_mfma_f32_32x32x16_bf16 v[176:191], v[108:111], v[208:211], v[176:191]
    v_mov_b32 v80, 0
    v_mov_b32 v81, 0
    v_mov_b32 v82, 0
    v_mov_b32 v83, 0
    ds_read_b64_tr_b16 v[124:125], v23 offset:20480
    ds_read_b64_tr_b16 v[126:127], v23 offset:21504
    s_waitcnt lgkmcnt(6)
    v_mfma_f32_32x32x16_bf16 v[128:143], v[112:115], v[212:215], v[128:143]
    ds_read_b64_tr_b16 v[96:97], v20 offset:24576
    ds_read_b64_tr_b16 v[98:99], v20 offset:25600
    s_waitcnt lgkmcnt(6)
    v_mfma_f32_32x32x16_bf16 v[144:159], v[116:119], v[212:215], v[144:159]
    ds_read_b64_tr_b16 v[100:101], v21 offset:24576
    ds_read_b64_tr_b16 v[102:103], v21 offset:25600
    s_waitcnt lgkmcnt(6)
    v_mfma_f32_32x32x16_bf16 v[160:175], v[120:123], v[212:215], v[160:175]
    ds_read_b64_tr_b16 v[104:105], v22 offset:24576
    ds_read_b64_tr_b16 v[106:107], v22 offset:25600
    s_waitcnt lgkmcnt(6)
    v_mfma_f32_32x32x16_bf16 v[176:191], v[124:127], v[212:215], v[176:191]
    v_mov_b32 v84, 0
    v_mov_b32 v85, 0
    v_mov_b32 v86, 0
    v_mov_b32 v87, 0
    ds_read_b64_tr_b16 v[108:109], v23 offset:24576
    ds_read_b64_tr_b16 v[110:111], v23 offset:25600
    s_waitcnt vmcnt(9)
    s_waitcnt lgkmcnt(6)
    v_mfma_f32_32x32x16_bf16 v[128:143], v[96:99], v[216:219], v[128:143]
    ds_read_b64_tr_b16 v[112:113], v20 offset:28672
    ds_read_b64_tr_b16 v[114:115], v20 offset:29696
    s_waitcnt lgkmcnt(6)
    v_mfma_f32_32x32x16_bf16 v[144:159], v[100:103], v[216:219], v[144:159]
    ds_read_b64_tr_b16 v[116:117], v21 offset:28672
    ds_read_b64_tr_b16 v[118:119], v21 offset:29696
    s_waitcnt lgkmcnt(6)
    v_mfma_f32_32x32x16_bf16 v[160:175], v[104:107], v[216:219], v[160:175]
    ds_read_b64_tr_b16 v[120:121], v22 offset:28672
    ds_read_b64_tr_b16 v[122:123], v22 offset:29696
    s_waitcnt lgkmcnt(6)
    v_mfma_f32_32x32x16_bf16 v[176:191], v[108:111], v[216:219], v[176:191]
    v_mov_b32 v88, 0
    v_mov_b32 v89, 0
    v_mov_b32 v90, 0
    v_mov_b32 v91, 0
    ds_read_b64_tr_b16 v[124:125], v23 offset:28672
    ds_read_b64_tr_b16 v[126:127], v23 offset:29696
    s_barrier
    s_cmp_lg_u32 s17, 0
    s_cbranch_scc1 td_5
    s_add_u32 s47, s45, 65536
    s_add_u32 m0, s46, 32768
    s_nop 0
    buffer_load_dwordx4 v2, s[32:35], s47 offen offset:0 lds
    buffer_load_dwordx4 v2, s[32:35], s47 offen offset:1024 lds
    buffer_load_dwordx4 v2, s[32:35], s47 offen offset:2048 lds
    buffer_load_dwordx4 v2, s[32:35], s47 offen offset:3072 lds
    s_add_u32 s47, s45, 69632
    s_add_u32 m0, s46, 36864
    s_nop 0
    buffer_load_dwordx4 v2, s[32:35], s47 offen offset:0 lds
    buffer_load_dwordx4 v2, s[32:35], s47 offen offset:1024 lds
    buffer_load_dwordx4 v2, s[32:35], s47 offen offset:2048 lds
    buffer_load_dwordx4 v2, s[32:35], s47 offen offset:3072 lds
td_5:
    s_waitcnt vmcnt(8)
    s_waitcnt lgkmcnt(6)
    v_mfma_f32_32x32x16_bf16 v[128:143], v[112:115], v[220:223], v[128:143]
    ds_read_b64_tr_b16 v[96:97], v20 offset:32768
    ds_read_b64_tr_b16 v[98:99], v20 offset:33792
    s_waitcnt lgkmcnt(6)
    v_mfma_f32_32x32x16_bf16 v[144:159], v[116:119], v[220:223], v[144:159]
    ds_read_b64_tr_b16 v[100:101], v21 offset:32768
    ds_read_b64_tr_b16 v[102:103], v21 offset:33792
    s_waitcnt lgkmcnt(6)
    v_mfma_f32_32x32x16_bf16 v[160:175], v[120:123], v[220:223], v[160:175]
    ds_read_b64_tr_b16 v[104:105], v22 offset:32768
    ds_read_b64_tr_b16 v[106:107], v22 offset:33792
    s_waitcnt lgkmcnt(6)
    v_mfma_f32_32x32x16_bf16 v[176:191], v[124:127], v[220:223], v[176:191]
    v_mov_b32 v92, 0
    v_mov_b32 v93, 0
    v_mov_b32 v94, 0
    v_mov_b32 v95, 0
    ds_read_b64_tr_b16 v[108:109], v23 offset:32768
    ds_read_b64_tr_b16 v[110:111], v23 offset:33792
    s_waitcnt vmcnt(7)
    s_waitcnt lgkmcnt(6)
    v_mfma_f32_32x32x16_bf16 v[128:143], v[96:99], v[224:227], v[128:143]
    ds_read_b64_tr_b16 v[112:113], v20 offset:36864
    ds_read_b64_tr_b16 v[114:115], v20 offset:37888
    s_waitcnt lgkmcnt(6)
    v_mfma_f32_32x32x16_bf16 v[144:159], v[100:103], v[224:227], v[144:159]
    ds_read_b64_tr_b16 v[116:117], v21 offset:36864
    ds_read_b64_tr_b16 v[118:119], v21 offset:37888
    s_waitcnt lgkmcnt(6)
    v_mfma_f32_32x32x16_bf16 v[160:175], v[104:107], v[224:227], v[160:175]
    ds_read_b64_tr_b16 v[120:121], v22 offset:36864
    ds_read_b64_tr_b16 v[122:123], v22 offset:37888
    s_waitcnt lgkmcnt(6)
    v_mfma_f32_32x32x16_bf16 v[176:191], v[108:111], v[224:227], v[176:191]
    ds_read_b64_tr_b16 v[124:125], v23 offset:36864
    ds_read_b64_tr_b16 v[126:127], v23 offset:37888
    s_waitcnt vmcnt(6)
    s_waitcnt lgkmcnt(6)
    v_mfma_f32_32x32x16_bf16 v[128:143], v[112:115], v[228:231], v[128:143]
    ds_read_b64_tr_b16 v[96:97], v20 offset:40960
    ds_read_b64_tr_b16 v[98:99], v20 offset:41984
    s_waitcnt lgkmcnt(6)
    v_mfma_f32_32x32x16_bf16 v[144:159], v[116:119], v[228:231], v[144:159]
    ds_read_b64_tr_b16 v[100:101], v21 offset:40960
    ds_read_b64_tr_b16 v[102:103], v21 offset:41984
    s_waitcnt lgkmcnt(6)
    v_mfma_f32_32x32x16_bf16 v[160:175], v[120:123], v[228:231], v[160:175]
    ds_read_b64_tr_b16 v[104:105], v22 offset:40960
    ds_read_b64_tr_b16 v[106:107], v22 offset:41984
    s_waitcnt lgkmcnt(6)
    v_mfma_f32_32x32x16_bf16 v[176:191], v[124:127], v[228:231], v[176:191]
    ds_read_b64_tr_b16 v[108:109], v23 offset:40960
    ds_read_b64_tr_b16 v[110:111], v23 offset:41984
    s_waitcnt vmcnt(5)
    s_waitcnt lgkmcnt(6)
    v_mfma_f32_32x32x16_bf16 v[128:143], v[96:99], v[232:235], v[128:143]
    ds_read_b64_tr_b16 v[112:113], v20 offset:45056
    ds_read_b64_tr_b16 v[114:115], v20 offset:46080
    s_waitcnt lgkmcnt(6)
    v_mfma_f32_32x32x16_bf16 v[144:159], v[100:103], v[232:235], v[144:159]
    ds_read_b64_tr_b16 v[116:117], v21 offset:45056
    ds_read_b64_tr_b16 v[118:119], v21 offset:46080
    s_waitcnt lgkmcnt(6)
    v_mfma_f32_32x32x16_bf16 v[160:175], v[104:107], v[232:235], v[160:175]
    ds_read_b64_tr_b16 v[120:121], v22 offset:45056
    ds_read_b64_tr_b16 v[122:123], v22 offset:46080
    s_waitcnt lgkmcnt(6)
    v_mfma_f32_32x32x16_bf16 v[176:191], v[108:111], v[232:235], v[176:191]
    ds_read_b64_tr_b16 v[124:125], v23 offset:45056
    ds_read_b64_tr_b16 v[126:127], v23 offset:46080
    s_waitcnt vmcnt(4)
    s_waitcnt lgkmcnt(6)
    v_mfma_f32_32x32x16_bf16 v[128:143], v[112:115], v[236:239], v[128:143]
    ds_read_b64_tr_b16 v[96:97], v20 offset:49152
    ds_read_b64_tr_b16 v[98:99], v20 offset:50176
    s_waitcnt lgkmcnt(6)
    v_mfma_f32_32x32x16_bf16 v[144:159], v[116:119], v[236:239], v[144:159]
    ds_read_b64_tr_b16 v[100:101], v21 offset:49152
    ds_read_b64_tr_b16 v[102:103], v21 offset:50176
    s_waitcnt lgkmcnt(6)
    v_mfma_f32_32x32x16_bf16 v[160:175], v[120:123], v[236:239], v[160:175]
    ds_read_b64_tr_b16 v[104:105], v22 offset:49152
    ds_read_b64_tr_b16 v[106:107], v22 offset:50176
    s_waitcnt lgkmcnt(6)
    v_mfma_f32_32x32x16_bf16 v[176:191], v[124:127], v[236:239], v[176:191]
    ds_read_b64_tr_b16 v[108:109], v23 offset:49152
    ds_read_b64_tr_b16 v[110:111], v23 offset:50176
    s_waitcnt vmcnt(3)
    s_waitcnt lgkmcnt(6)
    v_mfma_f32_32x32x16_bf16 v[128:143], v[96:99], v[240:243], v[128:143]
    ds_read_b64_tr_b16 v[112:113], v20 offset:53248
    ds_read_b64_tr_b16 v[114:115], v20 offset:54272
    s_waitcnt lgkmcnt(6)
    v_mfma_f32_32x32x16_bf16 v[144:159], v[100:103], v[240:243], v[144:159]
    ds_read_b64_tr_b16 v[116:117], v21 offset:53248
    ds_read_b64_tr_b16 v[118:119], v21 offset:54272
    s_waitcnt lgkmcnt(6)
    v_mfma_f32_32x32x16_bf16 v[160:175], v[104:107], v[240:243], v[160:175]
    ds_read_b64_tr_b16 v[120:121], v22 offset:53248
    ds_read_b64_tr_b16 v[122:123], v22 offset:54272
    s_waitcnt lgkmcnt(6)
    v_mfma_f32_32x32x16_bf16 v[176:191], v[108:111], v[240:243], v[176:191]
    ds_read_b64_tr_b16 v[124:125], v23 offset:53248
    ds_read_b64_tr_b16 v[126:127], v23 offset:54272
    s_waitcnt vmcnt(2)
    s_waitcnt lgkmcnt(6)
    v_mfma_f32_32x32x16_bf16 v[128:143], v[112:115], v[244:247], v[128:143]
    ds_read_b64_tr_b16 v[96:97], v20 offset:57344
    ds_read_b64_tr_b16 v[98:99], v20 offset:58368
    s_waitcnt lgkmcnt(6)
    v_mfma_f32_32x32x16_bf16 v[144:159], v[116:119], v[244:247], v[144:159]
    ds_read_b64_tr_b16 v[100:101], v21 offset:57344
    ds_read_b64_tr_b16 v[102:103], v21 offset:58368
    s_waitcnt lgkmcnt(6)
    v_mfma_f32_32x32x16_bf16 v[160:175], v[120:123], v[244:247], v[160:175]
    ds_read_b64_tr_b16 v[104:105], v22 offset:57344
    ds_read_b64_tr_b16 v[106:107], v22 offset:58368
    s_waitcnt lgkmcnt(6)
    v_mfma_f32_32x32x16_bf16 v[176:191], v[124:127], v[244:247], v[176:191]
    ds_read_b64_tr_b16 v[108:109], v23 offset:57344
    ds_read_b64_tr_b16 v[110:111], v23 offset:58368
    s_waitcnt vmcnt(1)
    s_waitcnt lgkmcnt(6)
    v_mfma_f32_32x32x16_bf16 v[128:143], v[96:99], v[248:251], v[128:143]
    ds_read_b64_tr_b16 v[112:113], v20 offset:61440
    ds_read_b64_tr_b16 v[114:115], v20 offset:62464
    s_waitcnt lgkmcnt(6)
    v_mfma_f32_32x32x16_bf16 v[144:159], v[100:103], v[248:251], v[144:159]
    ds_read_b64_tr_b16 v[116:117], v21 offset:61440
    ds_read_b64_tr_b16 v[118:119], v21 offset:62464
    s_waitcnt lgkmcnt(6)
    v_mfma_f32_32x32x16_bf16 v[160:175], v[104:107], v[248:251], v[160:175]
    ds_read_b64_tr_b16 v[120:121], v22 offset:61440
    ds_read_b64_tr_b16 v[122:123], v22 offset:62464
    s_waitcnt lgkmcnt(6)
    v_mfma_f32_32x32x16_bf16 v[176:191], v[108:111], v[248:251], v[176:191]
    ds_read_b64_tr_b16 v[124:125], v23 offset:61440
    ds_read_b64_tr_b16 v[126:127], v23 offset:62464
    s_waitcnt vmcnt(0)
    s_waitcnt lgkmcnt(6)
    v_mfma_f32_32x32x16_bf16 v[128:143], v[112:115], v[252:255], v[128:143]
    s_waitcnt lgkmcnt(4)
    v_mfma_f32_32x32x16_bf16 v[144:159], v[116:119], v[252:255], v[144:159]
    s_waitcnt lgkmcnt(2)
    v_mfma_f32_32x32x16_bf16 v[160:175], v[120:123], v[252:255], v[160:175]
    s_waitcnt lgkmcnt(0)
    v_mfma_f32_32x32x16_bf16 v[176:191], v[124:127], v[252:255], v[176:191]
    s_barrier
    s_cmp_lg_u32 s17, 0
    s_cbranch_scc1 td_6
    s_add_u32 s47, s45, 98304
    s_add_u32 m0, s46, 65536
    s_nop 0
    buffer_load_dwordx4 v2, s[32:35], s47 offen offset:0 lds
    buffer_load_dwordx4 v2, s[32:35], s47 offen offset:1024 lds
    buffer_load_dwordx4 v2, s[32:35], s47 offen offset:2048 lds
    buffer_load_dwordx4 v2, s[32:35], s47 offen offset:3072 lds
    s_add_u32 s47, s45, 102400
    s_add_u32 m0, s46, 69632
    s_nop 0
    buffer_load_dwordx4 v2, s[32:35], s47 offen offset:0 lds
    buffer_load_dwordx4 v2, s[32:35], s47 offen offset:1024 lds
    buffer_load_dwordx4 v2, s[32:35], s47 offen offset:2048 lds
    buffer_load_dwordx4 v2, s[32:35], s47 offen offset:3072 lds
td_6:
    v_add_u32 v4, 131072, v2
    v_mov_b32 v5, v2
    ds_read_b128 v[192:195], v4 offset:0
    ds_read_b128 v[196:199], v4 offset:1024
    ds_read_b128 v[200:203], v4 offset:2048
    ds_read_b128 v[204:207], v4 offset:3072
    ds_read_b128 v[208:211], v4 offset:4096
    ds_read_b128 v[212:215], v4 offset:5120
    ds_read_b128 v[216:219], v4 offset:6144
    ds_read_b128 v[220:223], v4 offset:7168
    s_mov_b32 s20, 0x3e0293ee
    s_mov_b32 s21, s20
    v_and_b32 v10, 31, v1
    v_lshrrev_b32 v11, 5, v1
    v_lshlrev_b32 v11, 2, v11
    v_sub_u32 v10, v10, v11
    s_lshl_b32 s22, s42, 5
    v_add_u32 v10, s22, v10
    v_cvt_f32_i32 v10, v10
    v_add_f32 v10, 0.5, v10
    v_mul_f32 v8, 0x71800000, v10
    v_mov_b32 v6, 0
    v_pk_mul_f32 v[128:129], v[128:129], s[20:21]
    v_pk_mul_f32 v[130:131], v[130:131], s[20:21]
    v_pk_mul_f32 v[132:133], v[132:133], s[20:21]
    v_pk_mul_f32 v[134:135], v[134:135], s[20:21]
    v_pk_mul_f32 v[136:137], v[136:137], s[20:21]
    v_pk_mul_f32 v[138:139], v[138:139], s[20:21]
    v_pk_mul_f32 v[140:141], v[140:141], s[20:21]
    v_pk_mul_f32 v[142:143], v[142:143], s[20:21]
    v_pk_mul_f32 v[144:145], v[144:145], s[20:21]
    v_pk_mul_f32 v[146:147], v[146:147], s[20:21]
    v_pk_mul_f32 v[148:149], v[148:149], s[20:21]
    v_pk_mul_f32 v[150:151], v[150:151], s[20:21]
    v_pk_mul_f32 v[152:153], v[152:153], s[20:21]
    v_pk_mul_f32 v[154:155], v[154:155], s[20:21]
    v_pk_mul_f32 v[156:157], v[156:157], s[20:21]
    v_pk_mul_f32 v[158:159], v[158:159], s[20:21]
    v_pk_mul_f32 v[160:161], v[160:161], s[20:21]
    v_pk_mul_f32 v[162:163], v[162:163], s[20:21]
    v_pk_mul_f32 v[164:165], v[164:165], s[20:21]
    v_pk_mul_f32 v[166:167], v[166:167], s[20:21]
    v_pk_mul_f32 v[168:169], v[168:169], s[20:21]
    v_pk_mul_f32 v[170:171], v[170:171], s[20:21]
    v_pk_mul_f32 v[172:173], v[172:173], s[20:21]
    v_pk_mul_f32 v[174:175], v[174:175], s[20:21]
    v_pk_mul_f32 v[176:177], v[176:177], s[20:21]
    v_pk_mul_f32 v[178:179], v[178:179], s[20:21]
    v_pk_mul_f32 v[180:181], v[180:181], s[20:21]
    v_pk_mul_f32 v[182:183], v[182:183], s[20:21]
    v_pk_mul_f32 v[184:185], v[184:185], s[20:21]
    v_pk_mul_f32 v[186:187], v[186:187], s[20:21]
    v_pk_mul_f32 v[188:189], v[188:189], s[20:21]
    v_pk_mul_f32 v[190:191], v[190:191], s[20:21]
    v_cvt_pk_bf16_f32 v96, v128, v129
    v_cvt_pk_bf16_f32 v97, v130, v131
    v_cvt_pk_bf16_f32 v98, v132, v133
    v_cvt_pk_bf16_f32 v99, v134, v135
    v_cvt_pk_bf16_f32 v100, v136, v137
    v_cvt_pk_bf16_f32 v101, v138, v139
    v_cvt_pk_bf16_f32 v102, v140, v141
    v_cvt_pk_bf16_f32 v103, v142, v143
    v_cvt_pk_bf16_f32 v104, v144, v145
    v_cvt_pk_bf16_f32 v105, v146, v147
    v_cvt_pk_bf16_f32 v106, v148, v149
    v_cvt_pk_bf16_f32 v107, v150, v151
    v_cvt_pk_bf16_f32 v108, v152, v153
    v_cvt_pk_bf16_f32 v109, v154, v155
    v_cvt_pk_bf16_f32 v110, v156, v157
    v_cvt_pk_bf16_f32 v111, v158, v159
    v_cvt_pk_bf16_f32 v112, v160, v161
    v_cvt_pk_bf16_f32 v113, v162, v163
    v_cvt_pk_bf16_f32 v114, v164, v165
    v_cvt_pk_bf16_f32 v115, v166, v167
    v_cvt_pk_bf16_f32 v116, v168, v169
    v_cvt_pk_bf16_f32 v117, v170, v171
    v_cvt_pk_bf16_f32 v118, v172, v173
    v_cvt_pk_bf16_f32 v119, v174, v175
    v_cvt_pk_bf16_f32 v120, v176, v177
    v_cvt_pk_bf16_f32 v121, v178, v179
    v_cvt_pk_bf16_f32 v122, v180, v181
    v_cvt_pk_bf16_f32 v123, v182, v183
    v_cvt_pk_bf16_f32 v124, v184, v185
    v_cvt_pk_bf16_f32 v125, v186, v187
    v_cvt_pk_bf16_f32 v126, v188, v189
    v_cvt_pk_bf16_f32 v127, v190, v191
    s_waitcnt lgkmcnt(0)
    v_mfma_f32_32x32x16_bf16 v[128:143], v[192:195], v[96:99], 0
    v_mfma_f32_32x32x16_bf16 v[128:143], v[196:199], v[100:103], v[128:143]
    ds_read_b128 v[192:195], v4 offset:16384
    v_mfma_f32_32x32x16_bf16 v[128:143], v[200:203], v[104:107], v[128:143]
    ds_read_b128 v[196:199], v4 offset:17408
    v_mfma_f32_32x32x16_bf16 v[128:143], v[204:207], v[108:111], v[128:143]
    ds_read_b128 v[200:203], v4 offset:18432
    v_mfma_f32_32x32x16_bf16 v[128:143], v[208:211], v[112:115], v[128:143]
    ds_read_b128 v[204:207], v4 offset:19456
    v_mfma_f32_32x32x16_bf16 v[128:143], v[212:215], v[116:119], v[128:143]
    ds_read_b128 v[208:211], v4 offset:20480
    v_mfma_f32_32x32x16_bf16 v[128:143], v[216:219], v[120:123], v[128:143]
    ds_read_b128 v[212:215], v4 offset:21504
    v_mfma_f32_32x32x16_bf16 v[128:143], v[220:223], v[124:127], v[128:143]
    ds_read_b128 v[216:219], v4 offset:22528
    ds_read_b128 v[220:223], v4 offset:23552
    s_nop 7
    s_nop 3
    v_mov_b32 v10, v128
    v_mov_b32 v11, v128
    s_nop 1
    v_permlane32_swap_b32 v10, v11
    s_nop 1
    v_sub_f32 v7, 0, v10
    s_cmp_eq_u32 s42, 0
    s_cbranch_scc1 s0_7
    v_add_f32 v128, v128, v7
    v_add_f32 v129, v129, v7
    v_add_f32 v130, v130, v7
    v_add_f32 v131, v131, v7
    v_add_f32 v132, v132, v7
    v_add_f32 v133, v133, v7
    v_add_f32 v134, v134, v7
    v_add_f32 v135, v135, v7
    v_add_f32 v136, v136, v7
    v_add_f32 v137, v137, v7
    v_add_f32 v138, v138, v7
    v_add_f32 v139, v139, v7
    v_add_f32 v140, v140, v7
    v_add_f32 v141, v141, v7
    v_add_f32 v142, v142, v7
    v_add_f32 v143, v143, v7
    s_branch s0_8
s0_7:
    v_mov_b32 v176, v8
    v_min_f32 v176, v176, v7
    v_add_f32 v177, 0xf1800000, v8
    v_min_f32 v177, v177, v7
    v_add_f32 v178, 0xf2000000, v8
    v_min_f32 v178, v178, v7
    v_add_f32 v179, 0xf2400000, v8
    v_min_f32 v179, v179, v7
    v_add_f32 v180, 0xf3000000, v8
    v_min_f32 v180, v180, v7
    v_add_f32 v181, 0xf3100000, v8
    v_min_f32 v181, v181, v7
    v_add_f32 v182, 0xf3200000, v8
    v_min_f32 v182, v182, v7
    v_add_f32 v183, 0xf3300000, v8
    v_min_f32 v183, v183, v7
    v_add_f32 v184, 0xf3800000, v8
    v_min_f32 v184, v184, v7
    v_add_f32 v185, 0xf3880000, v8
    v_min_f32 v185, v185, v7
    v_add_f32 v186, 0xf3900000, v8
    v_min_f32 v186, v186, v7
    v_add_f32 v187, 0xf3980000, v8
    v_min_f32 v187, v187, v7
    v_add_f32 v188, 0xf3c00000, v8
    v_min_f32 v188, v188, v7
    v_add_f32 v189, 0xf3c80000, v8
    v_min_f32 v189, v189, v7
    v_add_f32 v190, 0xf3d00000, v8
    v_min_f32 v190, v190, v7
    v_add_f32 v191, 0xf3d80000, v8
    v_min_f32 v191, v191, v7
    v_add_f32 v128, v128, v176
    v_add_f32 v129, v129, v177
    v_add_f32 v130, v130, v178
    v_add_f32 v131, v131, v179
    v_add_f32 v132, v132, v180
    v_add_f32 v133, v133, v181
    v_add_f32 v134, v134, v182
    v_add_f32 v135, v135, v183
    v_add_f32 v136, v136, v184
    v_add_f32 v137, v137, v185
    v_add_f32 v138, v138, v186
    v_add_f32 v139, v139, v187
    v_add_f32 v140, v140, v188
    v_add_f32 v141, v141, v189
    v_add_f32 v142, v142, v190
    v_add_f32 v143, v143, v191
s0_8:
    v_mov_b32 v160, v7
    v_mov_b32 v161, v7
    v_mov_b32 v162, v7
    v_mov_b32 v163, v7
    v_mov_b32 v164, v7
    v_mov_b32 v165, v7
    v_mov_b32 v166, v7
    v_mov_b32 v167, v7
    v_mov_b32 v168, v7
    v_mov_b32 v169, v7
    v_mov_b32 v170, v7
    v_mov_b32 v171, v7
    v_mov_b32 v172, v7
    v_mov_b32 v173, v7
    v_mov_b32 v174, v7
    v_mov_b32 v175, v7
    v_add_f32 v8, 0xf4000000, v8
    v_exp_f32 v128, v128
    v_exp_f32 v129, v129
    v_exp_f32 v130, v130
    v_exp_f32 v131, v131
    v_exp_f32 v132, v132
    v_exp_f32 v133, v133
    s_nop 0
    v_add_f32 v6, v6, v128
    v_add_f32 v6, v6, v129
    v_add_f32 v6, v6, v130
    v_add_f32 v6, v6, v131
    v_add_f32 v6, v6, v132
    v_cvt_pk_bf16_f32 v128, v128, v129
    v_cvt_pk_bf16_f32 v129, v130, v131
    s_mov_b32 s48, 0
    s_mov_b32 s49, 98304
    s_add_u32 s50, s45, 131072
    s_mov_b32 s51, 0
    s_cmp_lg_u32 s17, 0
    s_cbranch_scc1 attn_kernel_hi
    s_add_i32 s54, s40, -3
    s_cmp_ge_i32 s48, s54
    s_cbranch_scc1 bn_9_done
    .p2align 3
bn_9:
    s_waitcnt lgkmcnt(6)
    v_mfma_f32_32x32x16_bf16 v[144:159], v[192:195], v[96:99], v[160:175]
    ds_read_b128 v[224:227], v4 offset:8192
    v_add_f32 v6, v6, v133
    v_cvt_pk_bf16_f32 v130, v132, v133
    v_exp_f32 v134, v134
    v_mfma_f32_32x32x16_bf16 v[144:159], v[196:199], v[100:103], v[144:159]
    ds_read_b128 v[228:231], v4 offset:9216
    v_add_f32 v6, v6, v134
    v_exp_f32 v135, v135
    s_waitcnt lgkmcnt(6)
    v_mfma_f32_32x32x16_bf16 v[144:159], v[200:203], v[104:107], v[144:159]
    ds_read_b128 v[232:235], v4 offset:10240
    v_add_f32 v6, v6, v135
    v_cvt_pk_bf16_f32 v131, v134, v135
    v_exp_f32 v136, v136
    v_mfma_f32_32x32x16_bf16 v[144:159], v[204:207], v[108:111], v[144:159]
    ds_read_b128 v[236:239], v4 offset:11264
    v_add_f32 v6, v6, v136
    v_exp_f32 v137, v137
    s_waitcnt lgkmcnt(6)
    v_mfma_f32_32x32x16_bf16 v[144:159], v[208:211], v[112:115], v[144:159]
    ds_read_b128 v[240:243], v4 offset:12288
    v_add_f32 v6, v6, v137
    v_cvt_pk_bf16_f32 v132, v136, v137
    v_exp_f32 v138, v138
    v_mfma_f32_32x32x16_bf16 v[144:159], v[212:215], v[116:119], v[144:159]
    ds_read_b128 v[244:247], v4 offset:13312
    v_add_f32 v6, v6, v138
    v_exp_f32 v139, v139
    s_waitcnt lgkmcnt(6)
    v_mfma_f32_32x32x16_bf16 v[144:159], v[216:219], v[120:123], v[144:159]
    ds_read_b128 v[248:251], v4 offset:14336
    v_add_f32 v6, v6, v139
    v_cvt_pk_bf16_f32 v133, v138, v139
    v_exp_f32 v140, v140
    v_mfma_f32_32x32x16_bf16 v[144:159], v[220:223], v[124:127], v[144:159]
    ds_read_b128 v[252:255], v4 offset:15360
    v_add_f32 v6, v6, v140
    v_exp_f32 v141, v141
    s_waitcnt lgkmcnt(6)
    v_mfma_f32_32x32x16_bf16 v[32:47], v[224:227], v[128:131], v[32:47]
    s_add_u32 s52, s48, 3
    s_cmp_lt_u32 s52, s41
    s_cbranch_scc1 x_11
    s_waitcnt vmcnt(0)
x_11:
    s_waitcnt vmcnt(16)
    s_barrier
    ds_read_b128 v[192:195], v5 offset:0
    v_add_f32 v6, v6, v141
    v_cvt_pk_bf16_f32 v134, v140, v141
    v_exp_f32 v142, v142
    v_mfma_f32_32x32x16_bf16 v[48:63], v[228:231], v[128:131], v[48:63]
    ds_read_b128 v[196:199], v5 offset:1024
    v_add_f32 v6, v6, v142
    v_exp_f32 v143, v143
    s_waitcnt lgkmcnt(6)
    v_mfma_f32_32x32x16_bf16 v[64:79], v[232:235], v[128:131], v[64:79]
    ds_read_b128 v[200:203], v5 offset:2048
    v_add_f32 v6, v6, v143
    v_cvt_pk_bf16_f32 v135, v142, v143
    v_exp_f32 v144, v144
    s_add_u32 s52, s48, 4
    s_cmp_lt_u32 s52, s41
    s_cbranch_scc0 dn_12
    s_add_u32 s47, s50, 0
    s_add_u32 s53, s49, 0
    s_add_u32 m0, s46, s53
    s_nop 0
    buffer_load_dwordx4 v2, s[32:35], s47 offen offset:0 lds
    buffer_load_dwordx4 v2, s[32:35], s47 offen offset:1024 lds
    buffer_load_dwordx4 v2, s[32:35], s47 offen offset:2048 lds
    buffer_load_dwordx4 v2, s[32:35], s47 offen offset:3072 lds
dn_12:
    v_mfma_f32_32x32x16_bf16 v[80:95], v[236:239], v[128:131], v[80:95]
    ds_read_b128 v[204:207], v5 offset:3072
    v_add_f32 v6, v6, v144
    v_exp_f32 v145, v145
    s_waitcnt lgkmcnt(6)
    v_mfma_f32_32x32x16_bf16 v[32:47], v[240:243], v[132:135], v[32:47]
    ds_read_b128 v[208:211], v5 offset:4096
    v_add_f32 v6, v6, v145
    v_cvt_pk_bf16_f32 v144, v144, v145
    v_exp_f32 v146, v146
    v_mfma_f32_32x32x16_bf16 v[48:63], v[244:247], v[132:135], v[48:63]
    ds_read_b128 v[212:215], v5 offset:5120
    v_add_f32 v6, v6, v146
    v_exp_f32 v147, v147
    s_waitcnt lgkmcnt(6)
    v_mfma_f32_32x32x16_bf16 v[64:79], v[248:251], v[132:135], v[64:79]
    ds_read_b128 v[216:219], v5 offset:6144
    v_add_f32 v6, v6, v147
    v_cvt_pk_bf16_f32 v145, v146, v147
    v_exp_f32 v148, v148
    s_add_u32 s52, s48, 4
    s_cmp_lt_u32 s52, s41
    s_cbranch_scc0 dn_13
    s_add_u32 s47, s50, 4096
    s_add_u32 s53, s49, 4096
    s_add_u32 m0, s46, s53
    s_nop 0
    buffer_load_dwordx4 v2, s[32:35], s47 offen offset:0 lds
    buffer_load_dwordx4 v2, s[32:35], s47 offen offset:1024 lds
    buffer_load_dwordx4 v2, s[32:35], s47 offen offset:2048 lds
    buffer_load_dwordx4 v2, s[32:35], s47 offen offset:3072 lds
dn_13:
    v_mfma_f32_32x32x16_bf16 v[80:95], v[252:255], v[132:135], v[80:95]
    ds_read_b128 v[220:223], v5 offset:7168
    v_add_f32 v6, v6, v148
    v_exp_f32 v149, v149
    s_waitcnt lgkmcnt(6)
    v_mfma_f32_32x32x16_bf16 v[128:143], v[192:195], v[96:99], v[160:175]
    ds_read_b128 v[224:227], v4 offset:24576
    v_add_f32 v6, v6, v149
    v_cvt_pk_bf16_f32 v146, v148, v149
    v_exp_f32 v150, v150
    v_mfma_f32_32x32x16_bf16 v[128:143], v[196:199], v[100:103], v[128:143]
    ds_read_b128 v[228:231], v4 offset:25600
    v_add_f32 v6, v6, v150
    v_exp_f32 v151, v151
    s_waitcnt lgkmcnt(6)
    v_mfma_f32_32x32x16_bf16 v[128:143], v[200:203], v[104:107], v[128:143]
    ds_read_b128 v[232:235], v4 offset:26624
    v_add_f32 v6, v6, v151
    v_cvt_pk_bf16_f32 v147, v150, v151
    v_exp_f32 v152, v152
    v_mfma_f32_32x32x16_bf16 v[128:143], v[204:207], v[108:111], v[128:143]
    ds_read_b128 v[236:239], v4 offset:27648
    v_add_f32 v6, v6, v152
    v_exp_f32 v153, v153
    s_waitcnt lgkmcnt(6)
    v_mfma_f32_32x32x16_bf16 v[128:143], v[208:211], v[112:115], v[128:143]
    ds_read_b128 v[240:243], v4 offset:28672
    v_add_f32 v6, v6, v153
    v_cvt_pk_bf16_f32 v148, v152, v153
    v_exp_f32 v154, v154
    v_mfma_f32_32x32x16_bf16 v[128:143], v[212:215], v[116:119], v[128:143]
    ds_read_b128 v[244:247], v4 offset:29696
    v_add_f32 v6, v6, v154
    v_exp_f32 v155, v155
    s_waitcnt lgkmcnt(6)
    v_mfma_f32_32x32x16_bf16 v[128:143], v[216:219], v[120:123], v[128:143]
    ds_read_b128 v[248:251], v4 offset:30720
    v_add_f32 v6, v6, v155
    v_cvt_pk_bf16_f32 v149, v154, v155
    v_exp_f32 v156, v156
    v_mfma_f32_32x32x16_bf16 v[128:143], v[220:223], v[124:127], v[128:143]
    ds_read_b128 v[252:255], v4 offset:31744
    v_add_f32 v6, v6, v156
    v_exp_f32 v157, v157
    s_waitcnt lgkmcnt(6)
    v_mfma_f32_32x32x16_bf16 v[32:47], v[224:227], v[144:147], v[32:47]
    ds_read_b128 v[192:195], v5 offset:16384
    v_add_f32 v6, v6, v157
    v_cvt_pk_bf16_f32 v150, v156, v157
    v_exp_f32 v158, v158
    v_mfma_f32_32x32x16_bf16 v[48:63], v[228:231], v[144:147], v[48:63]
    ds_read_b128 v[196:199], v5 offset:17408
    v_add_f32 v6, v6, v158
    v_exp_f32 v159, v159
    v_mov_b32 v4, v5
    s_add_u32 s51, s51, 32768
    s_waitcnt lgkmcnt(6)
    v_mfma_f32_32x32x16_bf16 v[64:79], v[232:235], v[144:147], v[64:79]
    ds_read_b128 v[200:203], v5 offset:18432
    v_add_f32 v6, v6, v159
    v_cvt_pk_bf16_f32 v151, v158, v159
    v_exp_f32 v128, v128
    v_mfma_f32_32x32x16_bf16 v[80:95], v[236:239], v[144:147], v[80:95]
    ds_read_b128 v[204:207], v5 offset:19456
    v_add_f32 v6, v6, v128
    v_exp_f32 v129, v129
    s_cmp_eq_u32 s51, 163840
    s_cselect_b32 s51, 0, s51
    s_waitcnt lgkmcnt(6)
    v_mfma_f32_32x32x16_bf16 v[32:47], v[240:243], v[148:151], v[32:47]
    ds_read_b128 v[208:211], v5 offset:20480
    v_add_f32 v6, v6, v129
    v_cvt_pk_bf16_f32 v128, v128, v129
    v_exp_f32 v130, v130
    v_mfma_f32_32x32x16_bf16 v[48:63], v[244:247], v[148:151], v[48:63]
    ds_read_b128 v[212:215], v5 offset:21504
    v_add_f32 v6, v6, v130
    v_exp_f32 v131, v131
    s_add_u32 s50, s50, 32768
    s_add_u32 s49, s49, 32768
    s_add_u32 s48, s48, 1
    s_waitcnt lgkmcnt(6)
    v_mfma_f32_32x32x16_bf16 v[64:79], v[248:251], v[148:151], v[64:79]
    ds_read_b128 v[216:219], v5 offset:22528
    v_add_f32 v6, v6, v131
    v_cvt_pk_bf16_f32 v129, v130, v131
    v_exp_f32 v132, v132
    s_cmp_eq_u32 s49, 163840
    s_cselect_b32 s49, 0, s49
    v_mfma_f32_32x32x16_bf16 v[80:95], v[252:255], v[148:151], v[80:95]
    ds_read_b128 v[220:223], v5 offset:23552
    v_add_f32 v6, v6, v132
    v_exp_f32 v133, v133
    v_add_u32 v5, s51, v2
    s_cmp_lt_i32 s48, s54
    s_cbranch_scc1 bn_9
bn_9_done:
    s_lshl_b32 s52, s48, 6
    v_cvt_f32_u32 v10, s52
    v_mul_f32 v10, 0x71800000, v10
    v_sub_f32 v8, v8, v10
    v_mov_b32 v176, v8
    v_min_f32 v176, v176, v7
    v_add_f32 v177, 0xf1800000, v8
    v_min_f32 v177, v177, v7
    v_add_f32 v178, 0xf2000000, v8
    v_min_f32 v178, v178, v7
    v_add_f32 v179, 0xf2400000, v8
    v_min_f32 v179, v179, v7
    v_add_f32 v180, 0xf3000000, v8
    v_min_f32 v180, v180, v7
    v_add_f32 v181, 0xf3100000, v8
    v_min_f32 v181, v181, v7
    v_add_f32 v182, 0xf3200000, v8
    v_min_f32 v182, v182, v7
    v_add_f32 v183, 0xf3300000, v8
    v_min_f32 v183, v183, v7
    v_add_f32 v184, 0xf3800000, v8
    v_min_f32 v184, v184, v7
    v_add_f32 v185, 0xf3880000, v8
    v_min_f32 v185, v185, v7
    v_add_f32 v186, 0xf3900000, v8
    v_min_f32 v186, v186, v7
    v_add_f32 v187, 0xf3980000, v8
    v_min_f32 v187, v187, v7
    v_add_f32 v188, 0xf3c00000, v8
    v_min_f32 v188, v188, v7
    v_add_f32 v189, 0xf3c80000, v8
    v_min_f32 v189, v189, v7
    v_add_f32 v190, 0xf3d00000, v8
    v_min_f32 v190, v190, v7
    v_add_f32 v191, 0xf3d80000, v8
    v_min_f32 v191, v191, v7
    s_add_u32 s54, s40, -1
bm_10:
    s_waitcnt lgkmcnt(6)
    v_mfma_f32_32x32x16_bf16 v[144:159], v[192:195], v[96:99], v[176:191]
    ds_read_b128 v[224:227], v4 offset:8192
    v_add_f32 v6, v6, v133
    v_cvt_pk_bf16_f32 v130, v132, v133
    v_exp_f32 v134, v134
    v_mfma_f32_32x32x16_bf16 v[144:159], v[196:199], v[100:103], v[144:159]
    ds_read_b128 v[228:231], v4 offset:9216
    v_add_f32 v6, v6, v134
    v_exp_f32 v135, v135
    s_waitcnt lgkmcnt(6)
    v_mfma_f32_32x32x16_bf16 v[144:159], v[200:203], v[104:107], v[144:159]
    ds_read_b128 v[232:235], v4 offset:10240
    v_add_f32 v6, v6, v135
    v_cvt_pk_bf16_f32 v131, v134, v135
    v_exp_f32 v136, v136
    v_mfma_f32_32x32x16_bf16 v[144:159], v[204:207], v[108:111], v[144:159]
    ds_read_b128 v[236:239], v4 offset:11264
    v_add_f32 v6, v6, v136
    v_exp_f32 v137, v137
    s_waitcnt lgkmcnt(6)
    v_mfma_f32_32x32x16_bf16 v[144:159], v[208:211], v[112:115], v[144:159]
    ds_read_b128 v[240:243], v4 offset:12288
    v_add_f32 v6, v6, v137
    v_cvt_pk_bf16_f32 v132, v136, v137
    v_exp_f32 v138, v138
    v_mfma_f32_32x32x16_bf16 v[144:159], v[212:215], v[116:119], v[144:159]
    ds_read_b128 v[244:247], v4 offset:13312
    v_add_f32 v6, v6, v138
    v_exp_f32 v139, v139
    s_waitcnt lgkmcnt(6)
    v_mfma_f32_32x32x16_bf16 v[144:159], v[216:219], v[120:123], v[144:159]
    ds_read_b128 v[248:251], v4 offset:14336
    v_add_f32 v6, v6, v139
    v_cvt_pk_bf16_f32 v133, v138, v139
    v_exp_f32 v140, v140
    v_mfma_f32_32x32x16_bf16 v[144:159], v[220:223], v[124:127], v[144:159]
    ds_read_b128 v[252:255], v4 offset:15360
    v_add_f32 v6, v6, v140
    v_exp_f32 v141, v141
    s_waitcnt lgkmcnt(6)
    v_mfma_f32_32x32x16_bf16 v[32:47], v[224:227], v[128:131], v[32:47]
    s_add_u32 s52, s48, 3
    s_cmp_lt_u32 s52, s41
    s_cbranch_scc1 x_14
    s_waitcnt vmcnt(0)
x_14:
    s_waitcnt vmcnt(16)
    s_barrier
    ds_read_b128 v[192:195], v5 offset:0
    v_add_f32 v6, v6, v141
    v_cvt_pk_bf16_f32 v134, v140, v141
    v_exp_f32 v142, v142
    v_mfma_f32_32x32x16_bf16 v[48:63], v[228:231], v[128:131], v[48:63]
    ds_read_b128 v[196:199], v5 offset:1024
    v_add_f32 v6, v6, v142
    v_exp_f32 v143, v143
    v_add_f32 v8, 0xf4000000, v8
    v_mov_b32 v176, v8
    v_min_f32 v176, v176, v7
    v_add_f32 v177, 0xf1800000, v8
    v_min_f32 v177, v177, v7
    s_waitcnt lgkmcnt(6)
    v_mfma_f32_32x32x16_bf16 v[64:79], v[232:235], v[128:131], v[64:79]
    ds_read_b128 v[200:203], v5 offset:2048
    v_add_f32 v6, v6, v143
    v_cvt_pk_bf16_f32 v135, v142, v143
    v_exp_f32 v144, v144
    v_add_f32 v178, 0xf2000000, v8
    v_min_f32 v178, v178, v7
    v_add_f32 v179, 0xf2400000, v8
    v_min_f32 v179, v179, v7
    v_add_f32 v180, 0xf3000000, v8
    s_add_u32 s52, s48, 4
    s_cmp_lt_u32 s52, s41
    s_cbranch_scc0 dn_15
    s_add_u32 s47, s50, 0
    s_add_u32 s53, s49, 0
    s_add_u32 m0, s46, s53
    s_nop 0
    buffer_load_dwordx4 v2, s[32:35], s47 offen offset:0 lds
    buffer_load_dwordx4 v2, s[32:35], s47 offen offset:1024 lds
    buffer_load_dwordx4 v2, s[32:35], s47 offen offset:2048 lds
    buffer_load_dwordx4 v2, s[32:35], s47 offen offset:3072 lds
dn_15:
    v_mfma_f32_32x32x16_bf16 v[80:95], v[236:239], v[128:131], v[80:95]
    ds_read_b128 v[204:207], v5 offset:3072
    v_add_f32 v6, v6, v144
    v_exp_f32 v145, v145
    v_min_f32 v180, v180, v7
    v_add_f32 v181, 0xf3100000, v8
    v_min_f32 v181, v181, v7
    v_add_f32 v182, 0xf3200000, v8
    v_min_f32 v182, v182, v7
    s_waitcnt lgkmcnt(6)
    v_mfma_f32_32x32x16_bf16 v[32:47], v[240:243], v[132:135], v[32:47]
    ds_read_b128 v[208:211], v5 offset:4096
    v_add_f32 v6, v6, v145
    v_cvt_pk_bf16_f32 v144, v144, v145
    v_exp_f32 v146, v146
    v_add_f32 v183, 0xf3300000, v8
    v_min_f32 v183, v183, v7
    v_add_f32 v184, 0xf3800000, v8
    v_min_f32 v184, v184, v7
    v_add_f32 v185, 0xf3880000, v8
    v_mfma_f32_32x32x16_bf16 v[48:63], v[244:247], v[132:135], v[48:63]
    ds_read_b128 v[212:215], v5 offset:5120
    v_add_f32 v6, v6, v146
    v_exp_f32 v147, v147
    v_min_f32 v185, v185, v7
    v_add_f32 v186, 0xf3900000, v8
    v_min_f32 v186, v186, v7
    v_add_f32 v187, 0xf3980000, v8
    v_min_f32 v187, v187, v7
    s_waitcnt lgkmcnt(6)
    v_mfma_f32_32x32x16_bf16 v[64:79], v[248:251], v[132:135], v[64:79]
    ds_read_b128 v[216:219], v5 offset:6144
    v_add_f32 v6, v6, v147
    v_cvt_pk_bf16_f32 v145, v146, v147
    v_exp_f32 v148, v148
    v_add_f32 v188, 0xf3c00000, v8
    v_min_f32 v188, v188, v7
    v_add_f32 v189, 0xf3c80000, v8
    v_min_f32 v189, v189, v7
    v_add_f32 v190, 0xf3d00000, v8
    s_add_u32 s52, s48, 4
    s_cmp_lt_u32 s52, s41
    s_cbranch_scc0 dn_16
    s_add_u32 s47, s50, 4096
    s_add_u32 s53, s49, 4096
    s_add_u32 m0, s46, s53
    s_nop 0
    buffer_load_dwordx4 v2, s[32:35], s47 offen offset:0 lds
    buffer_load_dwordx4 v2, s[32:35], s47 offen offset:1024 lds
    buffer_load_dwordx4 v2, s[32:35], s47 offen offset:2048 lds
    buffer_load_dwordx4 v2, s[32:35], s47 offen offset:3072 lds
dn_16:
    v_mfma_f32_32x32x16_bf16 v[80:95], v[252:255], v[132:135], v[80:95]
    ds_read_b128 v[220:223], v5 offset:7168
    v_add_f32 v6, v6, v148
    v_exp_f32 v149, v149
    v_min_f32 v190, v190, v7
    v_add_f32 v191, 0xf3d80000, v8
    v_min_f32 v191, v191, v7
    s_waitcnt lgkmcnt(6)
    s_nop 1
    v_mfma_f32_32x32x16_bf16 v[128:143], v[192:195], v[96:99], v[176:191]
    ds_read_b128 v[224:227], v4 offset:24576
    v_add_f32 v6, v6, v149
    v_cvt_pk_bf16_f32 v146, v148, v149
    v_exp_f32 v150, v150
    v_mfma_f32_32x32x16_bf16 v[128:143], v[196:199], v[100:103], v[128:143]
    ds_read_b128 v[228:231], v4 offset:25600
    v_add_f32 v6, v6, v150
    v_exp_f32 v151, v151
    s_waitcnt lgkmcnt(6)
    v_mfma_f32_32x32x16_bf16 v[128:143], v[200:203], v[104:107], v[128:143]
    ds_read_b128 v[232:235], v4 offset:26624
    v_add_f32 v6, v6, v151
    v_cvt_pk_bf16_f32 v147, v150, v151
    v_exp_f32 v152, v152
    v_mfma_f32_32x32x16_bf16 v[128:143], v[204:207], v[108:111], v[128:143]
    ds_read_b128 v[236:239], v4 offset:27648
    v_add_f32 v6, v6, v152
    v_exp_f32 v153, v153
    s_waitcnt lgkmcnt(6)
    v_mfma_f32_32x32x16_bf16 v[128:143], v[208:211], v[112:115], v[128:143]
    ds_read_b128 v[240:243], v4 offset:28672
    v_add_f32 v6, v6, v153
    v_cvt_pk_bf16_f32 v148, v152, v153
    v_exp_f32 v154, v154
    v_mfma_f32_32x32x16_bf16 v[128:143], v[212:215], v[116:119], v[128:143]
    ds_read_b128 v[244:247], v4 offset:29696
    v_add_f32 v6, v6, v154
    v_exp_f32 v155, v155
    s_waitcnt lgkmcnt(6)
    v_mfma_f32_32x32x16_bf16 v[128:143], v[216:219], v[120:123], v[128:143]
    ds_read_b128 v[248:251], v4 offset:30720
    v_add_f32 v6, v6, v155
    v_cvt_pk_bf16_f32 v149, v154, v155
    v_exp_f32 v156, v156
    v_mfma_f32_32x32x16_bf16 v[128:143], v[220:223], v[124:127], v[128:143]
    ds_read_b128 v[252:255], v4 offset:31744
    v_add_f32 v6, v6, v156
    v_exp_f32 v157, v157
    s_waitcnt lgkmcnt(6)
    v_mfma_f32_32x32x16_bf16 v[32:47], v[224:227], v[144:147], v[32:47]
    ds_read_b128 v[192:195], v5 offset:16384
    v_add_f32 v6, v6, v157
    v_cvt_pk_bf16_f32 v150, v156, v157
    v_exp_f32 v158, v158
    v_add_f32 v8, 0xf4000000, v8
    v_mov_b32 v176, v8
    v_min_f32 v176, v176, v7
    v_add_f32 v177, 0xf1800000, v8
    v_min_f32 v177, v177, v7
    v_mfma_f32_32x32x16_bf16 v[48:63], v[228:231], v[144:147], v[48:63]
    ds_read_b128 v[196:199], v5 offset:17408
    v_add_f32 v6, v6, v158
    v_exp_f32 v159, v159
    v_add_f32 v178, 0xf2000000, v8
    v_min_f32 v178, v178, v7
    v_add_f32 v179, 0xf2400000, v8
    v_min_f32 v179, v179, v7
    v_add_f32 v180, 0xf3000000, v8
    v_mov_b32 v4, v5
    s_add_u32 s51, s51, 32768
    s_waitcnt lgkmcnt(6)
    v_mfma_f32_32x32x16_bf16 v[64:79], v[232:235], v[144:147], v[64:79]
    ds_read_b128 v[200:203], v5 offset:18432
    v_add_f32 v6, v6, v159
    v_cvt_pk_bf16_f32 v151, v158, v159
    v_exp_f32 v128, v128
    v_min_f32 v180, v180, v7
    v_add_f32 v181, 0xf3100000, v8
    v_min_f32 v181, v181, v7
    v_add_f32 v182, 0xf3200000, v8
    v_min_f32 v182, v182, v7
    v_mfma_f32_32x32x16_bf16 v[80:95], v[236:239], v[144:147], v[80:95]
    ds_read_b128 v[204:207], v5 offset:19456
    v_add_f32 v6, v6, v128
    v_exp_f32 v129, v129
    v_add_f32 v183, 0xf3300000, v8
    v_min_f32 v183, v183, v7
    v_add_f32 v184, 0xf3800000, v8
    v_min_f32 v184, v184, v7
    v_add_f32 v185, 0xf3880000, v8
    s_cmp_eq_u32 s51, 163840
    s_cselect_b32 s51, 0, s51
    s_waitcnt lgkmcnt(6)
    v_mfma_f32_32x32x16_bf16 v[32:47], v[240:243], v[148:151], v[32:47]
    ds_read_b128 v[208:211], v5 offset:20480
    v_add_f32 v6, v6, v129
    v_cvt_pk_bf16_f32 v128, v128, v129
    v_exp_f32 v130, v130
    v_min_f32 v185, v185, v7
    v_add_f32 v186, 0xf3900000, v8
    v_min_f32 v186, v186, v7
    v_add_f32 v187, 0xf3980000, v8
    v_min_f32 v187, v187, v7
    v_mfma_f32_32x32x16_bf16 v[48:63], v[244:247], v[148:151], v[48:63]
    ds_read_b128 v[212:215], v5 offset:21504
    v_add_f32 v6, v6, v130
    v_exp_f32 v131, v131
    v_add_f32 v188, 0xf3c00000, v8
    v_min_f32 v188, v188, v7
    v_add_f32 v189, 0xf3c80000, v8
    v_min_f32 v189, v189, v7
    v_add_f32 v190, 0xf3d00000, v8
    s_add_u32 s50, s50, 32768
    s_add_u32 s49, s49, 32768
    s_add_u32 s48, s48, 1
    s_waitcnt lgkmcnt(6)
    v_mfma_f32_32x32x16_bf16 v[64:79], v[248:251], v[148:151], v[64:79]
    ds_read_b128 v[216:219], v5 offset:22528
    v_add_f32 v6, v6, v131
    v_cvt_pk_bf16_f32 v129, v130, v131
    v_exp_f32 v132, v132
    v_min_f32 v190, v190, v7
    v_add_f32 v191, 0xf3d80000, v8
    v_min_f32 v191, v191, v7
    s_cmp_eq_u32 s49, 163840
    s_cselect_b32 s49, 0, s49
    v_mfma_f32_32x32x16_bf16 v[80:95], v[252:255], v[148:151], v[80:95]
    ds_read_b128 v[220:223], v5 offset:23552
    v_add_f32 v6, v6, v132
    v_exp_f32 v133, v133
    v_add_u32 v5, s51, v2
    s_cmp_lt_u32 s48, s54
    s_cbranch_scc1 bm_10
    s_waitcnt lgkmcnt(6)
    v_mfma_f32_32x32x16_bf16 v[144:159], v[192:195], v[96:99], v[176:191]
    ds_read_b128 v[224:227], v4 offset:8192
    v_add_f32 v6, v6, v133
    v_cvt_pk_bf16_f32 v130, v132, v133
    v_exp_f32 v134, v134
    v_mfma_f32_32x32x16_bf16 v[144:159], v[196:199], v[100:103], v[144:159]
    ds_read_b128 v[228:231], v4 offset:9216
    v_add_f32 v6, v6, v134
    v_exp_f32 v135, v135
    s_waitcnt lgkmcnt(6)
    v_mfma_f32_32x32x16_bf16 v[144:159], v[200:203], v[104:107], v[144:159]
    ds_read_b128 v[232:235], v4 offset:10240
    v_add_f32 v6, v6, v135
    v_cvt_pk_bf16_f32 v131, v134, v135
    v_exp_f32 v136, v136
    v_mfma_f32_32x32x16_bf16 v[144:159], v[204:207], v[108:111], v[144:159]
    ds_read_b128 v[236:239], v4 offset:11264
    v_add_f32 v6, v6, v136
    v_exp_f32 v137, v137
    s_waitcnt lgkmcnt(6)
    v_mfma_f32_32x32x16_bf16 v[144:159], v[208:211], v[112:115], v[144:159]
    ds_read_b128 v[240:243], v4 offset:12288
    v_add_f32 v6, v6, v137
    v_cvt_pk_bf16_f32 v132, v136, v137
    v_exp_f32 v138, v138
    v_mfma_f32_32x32x16_bf16 v[144:159], v[212:215], v[116:119], v[144:159]
    ds_read_b128 v[244:247], v4 offset:13312
    v_add_f32 v6, v6, v138
    v_exp_f32 v139, v139
    s_waitcnt lgkmcnt(6)
    v_mfma_f32_32x32x16_bf16 v[144:159], v[216:219], v[120:123], v[144:159]
    ds_read_b128 v[248:251], v4 offset:14336
    v_add_f32 v6, v6, v139
    v_cvt_pk_bf16_f32 v133, v138, v139
    v_exp_f32 v140, v140
    v_mfma_f32_32x32x16_bf16 v[144:159], v[220:223], v[124:127], v[144:159]
    ds_read_b128 v[252:255], v4 offset:15360
    v_add_f32 v6, v6, v140
    v_exp_f32 v141, v141
    s_waitcnt lgkmcnt(6)
    v_mfma_f32_32x32x16_bf16 v[32:47], v[224:227], v[128:131], v[32:47]
    s_add_u32 s52, s48, 3
    s_cmp_lt_u32 s52, s41
    s_cbranch_scc1 x_17
    s_waitcnt vmcnt(0)
x_17:
    s_waitcnt vmcnt(16)
    s_barrier
    v_add_f32 v6, v6, v141
    v_cvt_pk_bf16_f32 v134, v140, v141
    v_exp_f32 v142, v142
    v_mfma_f32_32x32x16_bf16 v[48:63], v[228:231], v[128:131], v[48:63]
    v_add_f32 v6, v6, v142
    v_exp_f32 v143, v143
    s_waitcnt lgkmcnt(4)
    v_mfma_f32_32x32x16_bf16 v[64:79], v[232:235], v[128:131], v[64:79]
    v_add_f32 v6, v6, v143
    v_cvt_pk_bf16_f32 v135, v142, v143
    v_exp_f32 v144, v144
    s_add_u32 s52, s48, 4
    s_cmp_lt_u32 s52, s41
    s_cbranch_scc0 dn_18
    s_add_u32 s47, s50, 0
    s_add_u32 s53, s49, 0
    s_add_u32 m0, s46, s53
    s_nop 0
    buffer_load_dwordx4 v2, s[32:35], s47 offen offset:0 lds
    buffer_load_dwordx4 v2, s[32:35], s47 offen offset:1024 lds
    buffer_load_dwordx4 v2, s[32:35], s47 offen offset:2048 lds
    buffer_load_dwordx4 v2, s[32:35], s47 offen offset:3072 lds
dn_18:
    v_mfma_f32_32x32x16_bf16 v[80:95], v[236:239], v[128:131], v[80:95]
    v_add_f32 v6, v6, v144
    v_exp_f32 v145, v145
    s_waitcnt lgkmcnt(2)
    v_mfma_f32_32x32x16_bf16 v[32:47], v[240:243], v[132:135], v[32:47]
    v_add_f32 v6, v6, v145
    v_cvt_pk_bf16_f32 v144, v144, v145
    v_exp_f32 v146, v146
    v_mfma_f32_32x32x16_bf16 v[48:63], v[244:247], v[132:135], v[48:63]
    v_add_f32 v6, v6, v146
    v_exp_f32 v147, v147
    s_waitcnt lgkmcnt(0)
    v_mfma_f32_32x32x16_bf16 v[64:79], v[248:251], v[132:135], v[64:79]
    v_add_f32 v6, v6, v147
    v_cvt_pk_bf16_f32 v145, v146, v147
    v_exp_f32 v148, v148
    s_add_u32 s52, s48, 4
    s_cmp_lt_u32 s52, s41
    s_cbranch_scc0 dn_19
    s_add_u32 s47, s50, 4096
    s_add_u32 s53, s49, 4096
    s_add_u32 m0, s46, s53
    s_nop 0
    buffer_load_dwordx4 v2, s[32:35], s47 offen offset:0 lds
    buffer_load_dwordx4 v2, s[32:35], s47 offen offset:1024 lds
    buffer_load_dwordx4 v2, s[32:35], s47 offen offset:2048 lds
    buffer_load_dwordx4 v2, s[32:35], s47 offen offset:3072 lds
dn_19:
    v_mfma_f32_32x32x16_bf16 v[80:95], v[252:255], v[132:135], v[80:95]
    v_add_f32 v6, v6, v148
    v_exp_f32 v149, v149
    s_nop 7
    ds_read_b128 v[224:227], v4 offset:24576
    v_add_f32 v6, v6, v149
    v_cvt_pk_bf16_f32 v146, v148, v149
    v_exp_f32 v150, v150
    s_nop 0
    ds_read_b128 v[228:231], v4 offset:25600
    v_add_f32 v6, v6, v150
    v_exp_f32 v151, v151
    s_nop 0
    ds_read_b128 v[232:235], v4 offset:26624
    v_add_f32 v6, v6, v151
    v_cvt_pk_bf16_f32 v147, v150, v151
    v_exp_f32 v152, v152
    s_nop 0
    ds_read_b128 v[236:239], v4 offset:27648
    v_add_f32 v6, v6, v152
    v_exp_f32 v153, v153
    s_nop 0
    ds_read_b128 v[240:243], v4 offset:28672
    v_add_f32 v6, v6, v153
    v_cvt_pk_bf16_f32 v148, v152, v153
    v_exp_f32 v154, v154
    s_nop 0
    ds_read_b128 v[244:247], v4 offset:29696
    v_add_f32 v6, v6, v154
    v_exp_f32 v155, v155
    s_nop 0
    ds_read_b128 v[248:251], v4 offset:30720
    v_add_f32 v6, v6, v155
    v_cvt_pk_bf16_f32 v149, v154, v155
    v_exp_f32 v156, v156
    s_nop 0
    ds_read_b128 v[252:255], v4 offset:31744
    v_add_f32 v6, v6, v156
    v_exp_f32 v157, v157
    s_nop 0
    s_waitcnt lgkmcnt(6)
    v_mfma_f32_32x32x16_bf16 v[32:47], v[224:227], v[144:147], v[32:47]
    v_add_f32 v6, v6, v157
    v_cvt_pk_bf16_f32 v150, v156, v157
    v_exp_f32 v158, v158
    v_mfma_f32_32x32x16_bf16 v[48:63], v[228:231], v[144:147], v[48:63]
    v_add_f32 v6, v6, v158
    v_exp_f32 v159, v159
    v_mov_b32 v4, v5
    s_add_u32 s51, s51, 32768
    s_waitcnt lgkmcnt(4)
    v_mfma_f32_32x32x16_bf16 v[64:79], v[232:235], v[144:147], v[64:79]
    v_add_f32 v6, v6, v159
    v_cvt_pk_bf16_f32 v151, v158, v159
    v_mfma_f32_32x32x16_bf16 v[80:95], v[236:239], v[144:147], v[80:95]
    s_cmp_eq_u32 s51, 163840
    s_cselect_b32 s51, 0, s51
    s_waitcnt lgkmcnt(2)
    v_mfma_f32_32x32x16_bf16 v[32:47], v[240:243], v[148:151], v[32:47]
    v_mfma_f32_32x32x16_bf16 v[48:63], v[244:247], v[148:151], v[48:63]
    s_add_u32 s50, s50, 32768
    s_add_u32 s49, s49, 32768
    s_add_u32 s48, s48, 1
    s_waitcnt lgkmcnt(0)
    v_mfma_f32_32x32x16_bf16 v[64:79], v[248:251], v[148:151], v[64:79]
    s_cmp_eq_u32 s49, 163840
    s_cselect_b32 s49, 0, s49
    v_mfma_f32_32x32x16_bf16 v[80:95], v[252:255], v[148:151], v[80:95]
    v_add_u32 v5, s51, v2
    s_branch attn_kernel_epi
attn_kernel_hi:
    s_add_i32 s54, s40, -3
    s_cmp_ge_i32 s48, s54
    s_cbranch_scc1 bn_20_done
    .p2align 3
bn_20:
    s_waitcnt lgkmcnt(6)
    v_mfma_f32_32x32x16_bf16 v[144:159], v[192:195], v[96:99], v[160:175]
    ds_read_b128 v[224:227], v4 offset:8192
    v_add_f32 v6, v6, v133
    v_cvt_pk_bf16_f32 v130, v132, v133
    v_exp_f32 v134, v134
    v_mfma_f32_32x32x16_bf16 v[144:159], v[196:199], v[100:103], v[144:159]
    ds_read_b128 v[228:231], v4 offset:9216
    v_add_f32 v6, v6, v134
    v_exp_f32 v135, v135
    s_waitcnt lgkmcnt(6)
    v_mfma_f32_32x32x16_bf16 v[144:159], v[200:203], v[104:107], v[144:159]
    ds_read_b128 v[232:235], v4 offset:10240
    v_add_f32 v6, v6, v135
    v_cvt_pk_bf16_f32 v131, v134, v135
    v_exp_f32 v136, v136
    v_mfma_f32_32x32x16_bf16 v[144:159], v[204:207], v[108:111], v[144:159]
    ds_read_b128 v[236:239], v4 offset:11264
    v_add_f32 v6, v6, v136
    v_exp_f32 v137, v137
    s_waitcnt lgkmcnt(6)
    v_mfma_f32_32x32x16_bf16 v[144:159], v[208:211], v[112:115], v[144:159]
    ds_read_b128 v[240:243], v4 offset:12288
    v_add_f32 v6, v6, v137
    v_cvt_pk_bf16_f32 v132, v136, v137
    v_exp_f32 v138, v138
    v_mfma_f32_32x32x16_bf16 v[144:159], v[212:215], v[116:119], v[144:159]
    ds_read_b128 v[244:247], v4 offset:13312
    v_add_f32 v6, v6, v138
    v_exp_f32 v139, v139
    s_waitcnt lgkmcnt(6)
    v_mfma_f32_32x32x16_bf16 v[144:159], v[216:219], v[120:123], v[144:159]
    ds_read_b128 v[248:251], v4 offset:14336
    v_add_f32 v6, v6, v139
    v_cvt_pk_bf16_f32 v133, v138, v139
    v_exp_f32 v140, v140
    v_mfma_f32_32x32x16_bf16 v[144:159], v[220:223], v[124:127], v[144:159]
    ds_read_b128 v[252:255], v4 offset:15360
    v_add_f32 v6, v6, v140
    v_exp_f32 v141, v141
    s_waitcnt lgkmcnt(6)
    v_mfma_f32_32x32x16_bf16 v[32:47], v[224:227], v[128:131], v[32:47]
    s_barrier
    ds_read_b128 v[192:195], v5 offset:0
    v_add_f32 v6, v6, v141
    v_cvt_pk_bf16_f32 v134, v140, v141
    v_exp_f32 v142, v142
    v_mfma_f32_32x32x16_bf16 v[48:63], v[228:231], v[128:131], v[48:63]
    ds_read_b128 v[196:199], v5 offset:1024
    v_add_f32 v6, v6, v142
    v_exp_f32 v143, v143
    s_waitcnt lgkmcnt(6)
    v_mfma_f32_32x32x16_bf16 v[64:79], v[232:235], v[128:131], v[64:79]
    ds_read_b128 v[200:203], v5 offset:2048
    v_add_f32 v6, v6, v143
    v_cvt_pk_bf16_f32 v135, v142, v143
    v_exp_f32 v144, v144
    v_mfma_f32_32x32x16_bf16 v[80:95], v[236:239], v[128:131], v[80:95]
    ds_read_b128 v[204:207], v5 offset:3072
    v_add_f32 v6, v6, v144
    v_exp_f32 v145, v145
    s_waitcnt lgkmcnt(6)
    v_mfma_f32_32x32x16_bf16 v[32:47], v[240:243], v[132:135], v[32:47]
    ds_read_b128 v[208:211], v5 offset:4096
    v_add_f32 v6, v6, v145
    v_cvt_pk_bf16_f32 v144, v144, v145
    v_exp_f32 v146, v146
    v_mfma_f32_32x32x16_bf16 v[48:63], v[244:247], v[132:135], v[48:63]
    ds_read_b128 v[212:215], v5 offset:5120
    v_add_f32 v6, v6, v146
    v_exp_f32 v147, v147
    s_waitcnt lgkmcnt(6)
    v_mfma_f32_32x32x16_bf16 v[64:79], v[248:251], v[132:135], v[64:79]
    ds_read_b128 v[216:219], v5 offset:6144
    v_add_f32 v6, v6, v147
    v_cvt_pk_bf16_f32 v145, v146, v147
    v_exp_f32 v148, v148
    v_mfma_f32_32x32x16_bf16 v[80:95], v[252:255], v[132:135], v[80:95]
    ds_read_b128 v[220:223], v5 offset:7168
    v_add_f32 v6, v6, v148
    v_exp_f32 v149, v149
    s_waitcnt lgkmcnt(6)
    v_mfma_f32_32x32x16_bf16 v[128:143], v[192:195], v[96:99], v[160:175]
    ds_read_b128 v[224:227], v4 offset:24576
    v_add_f32 v6, v6, v149
    v_cvt_pk_bf16_f32 v146, v148, v149
    v_exp_f32 v150, v150
    v_mfma_f32_32x32x16_bf16 v[128:143], v[196:199], v[100:103], v[128:143]
    ds_read_b128 v[228:231], v4 offset:25600
    v_add_f32 v6, v6, v150
    v_exp_f32 v151, v151
    s_waitcnt lgkmcnt(6)
    v_mfma_f32_32x32x16_bf16 v[128:143], v[200:203], v[104:107], v[128:143]
    ds_read_b128 v[232:235], v4 offset:26624
    v_add_f32 v6, v6, v151
    v_cvt_pk_bf16_f32 v147, v150, v151
    v_exp_f32 v152, v152
    v_mfma_f32_32x32x16_bf16 v[128:143], v[204:207], v[108:111], v[128:143]
    ds_read_b128 v[236:239], v4 offset:27648
    v_add_f32 v6, v6, v152
    v_exp_f32 v153, v153
    s_waitcnt lgkmcnt(6)
    v_mfma_f32_32x32x16_bf16 v[128:143], v[208:211], v[112:115], v[128:143]
    ds_read_b128 v[240:243], v4 offset:28672
    v_add_f32 v6, v6, v153
    v_cvt_pk_bf16_f32 v148, v152, v153
    v_exp_f32 v154, v154
    v_mfma_f32_32x32x16_bf16 v[128:143], v[212:215], v[116:119], v[128:143]
    ds_read_b128 v[244:247], v4 offset:29696
    v_add_f32 v6, v6, v154
    v_exp_f32 v155, v155
    s_waitcnt lgkmcnt(6)
    v_mfma_f32_32x32x16_bf16 v[128:143], v[216:219], v[120:123], v[128:143]
    ds_read_b128 v[248:251], v4 offset:30720
    v_add_f32 v6, v6, v155
    v_cvt_pk_bf16_f32 v149, v154, v155
    v_exp_f32 v156, v156
    v_mfma_f32_32x32x16_bf16 v[128:143], v[220:223], v[124:127], v[128:143]
    ds_read_b128 v[252:255], v4 offset:31744
    v_add_f32 v6, v6, v156
    v_exp_f32 v157, v157
    s_waitcnt lgkmcnt(6)
    v_mfma_f32_32x32x16_bf16 v[32:47], v[224:227], v[144:147], v[32:47]
    ds_read_b128 v[192:195], v5 offset:16384
    v_add_f32 v6, v6, v157
    v_cvt_pk_bf16_f32 v150, v156, v157
    v_exp_f32 v158, v158
    v_mfma_f32_32x32x16_bf16 v[48:63], v[228:231], v[144:147], v[48:63]
    ds_read_b128 v[196:199], v5 offset:17408
    v_add_f32 v6, v6, v158
    v_exp_f32 v159, v159
    v_mov_b32 v4, v5
    s_add_u32 s51, s51, 32768
    s_waitcnt lgkmcnt(6)
    v_mfma_f32_32x32x16_bf16 v[64:79], v[232:235], v[144:147], v[64:79]
    ds_read_b128 v[200:203], v5 offset:18432
    v_add_f32 v6, v6, v159
    v_cvt_pk_bf16_f32 v151, v158, v159
    v_exp_f32 v128, v128
    v_mfma_f32_32x32x16_bf16 v[80:95], v[236:239], v[144:147], v[80:95]
    ds_read_b128 v[204:207], v5 offset:19456
    v_add_f32 v6, v6, v128
    v_exp_f32 v129, v129
    s_cmp_eq_u32 s51, 163840
    s_cselect_b32 s51, 0, s51
    s_waitcnt lgkmcnt(6)
    v_mfma_f32_32x32x16_bf16 v[32:47], v[240:243], v[148:151], v[32:47]
    ds_read_b128 v[208:211], v5 offset:20480
    v_add_f32 v6, v6, v129
    v_cvt_pk_bf16_f32 v128, v128, v129
    v_exp_f32 v130, v130
    v_mfma_f32_32x32x16_bf16 v[48:63], v[244:247], v[148:151], v[48:63]
    ds_read_b128 v[212:215], v5 offset:21504
    v_add_f32 v6, v6, v130
    v_exp_f32 v131, v131
    s_add_u32 s48, s48, 1
    s_waitcnt lgkmcnt(6)
    v_mfma_f32_32x32x16_bf16 v[64:79], v[248:251], v[148:151], v[64:79]
    ds_read_b128 v[216:219], v5 offset:22528
    v_add_f32 v6, v6, v131
    v_cvt_pk_bf16_f32 v129, v130, v131
    v_exp_f32 v132, v132
    v_mfma_f32_32x32x16_bf16 v[80:95], v[252:255], v[148:151], v[80:95]
    ds_read_b128 v[220:223], v5 offset:23552
    v_add_f32 v6, v6, v132
    v_exp_f32 v133, v133
    v_add_u32 v5, s51, v2
    s_cmp_lt_i32 s48, s54
    s_cbranch_scc1 bn_20
bn_20_done:
    s_lshl_b32 s52, s48, 6
    v_cvt_f32_u32 v10, s52
    v_mul_f32 v10, 0x71800000, v10
    v_sub_f32 v8, v8, v10
    v_mov_b32 v176, v8
    v_min_f32 v176, v176, v7
    v_add_f32 v177, 0xf1800000, v8
    v_min_f32 v177, v177, v7
    v_add_f32 v178, 0xf2000000, v8
    v_min_f32 v178, v178, v7
    v_add_f32 v179, 0xf2400000, v8
    v_min_f32 v179, v179, v7
    v_add_f32 v180, 0xf3000000, v8
    v_min_f32 v180, v180, v7
    v_add_f32 v181, 0xf3100000, v8
    v_min_f32 v181, v181, v7
    v_add_f32 v182, 0xf3200000, v8
    v_min_f32 v182, v182, v7
    v_add_f32 v183, 0xf3300000, v8
    v_min_f32 v183, v183, v7
    v_add_f32 v184, 0xf3800000, v8
    v_min_f32 v184, v184, v7
    v_add_f32 v185, 0xf3880000, v8
    v_min_f32 v185, v185, v7
    v_add_f32 v186, 0xf3900000, v8
    v_min_f32 v186, v186, v7
    v_add_f32 v187, 0xf3980000, v8
    v_min_f32 v187, v187, v7
    v_add_f32 v188, 0xf3c00000, v8
    v_min_f32 v188, v188, v7
    v_add_f32 v189, 0xf3c80000, v8
    v_min_f32 v189, v189, v7
    v_add_f32 v190, 0xf3d00000, v8
    v_min_f32 v190, v190, v7
    v_add_f32 v191, 0xf3d80000, v8
    v_min_f32 v191, v191, v7
    s_add_u32 s54, s40, -1
bm_21:
    s_waitcnt lgkmcnt(6)
    v_mfma_f32_32x32x16_bf16 v[144:159], v[192:195], v[96:99], v[176:191]
    ds_read_b128 v[224:227], v4 offset:8192
    v_add_f32 v6, v6, v133
    v_cvt_pk_bf16_f32 v130, v132, v133
    v_exp_f32 v134, v134
    v_mfma_f32_32x32x16_bf16 v[144:159], v[196:199], v[100:103], v[144:159]
    ds_read_b128 v[228:231], v4 offset:9216
    v_add_f32 v6, v6, v134
    v_exp_f32 v135, v135
    s_waitcnt lgkmcnt(6)
    v_mfma_f32_32x32x16_bf16 v[144:159], v[200:203], v[104:107], v[144:159]
    ds_read_b128 v[232:235], v4 offset:10240
    v_add_f32 v6, v6, v135
    v_cvt_pk_bf16_f32 v131, v134, v135
    v_exp_f32 v136, v136
    v_mfma_f32_32x32x16_bf16 v[144:159], v[204:207], v[108:111], v[144:159]
    ds_read_b128 v[236:239], v4 offset:11264
    v_add_f32 v6, v6, v136
    v_exp_f32 v137, v137
    s_waitcnt lgkmcnt(6)
    v_mfma_f32_32x32x16_bf16 v[144:159], v[208:211], v[112:115], v[144:159]
    ds_read_b128 v[240:243], v4 offset:12288
    v_add_f32 v6, v6, v137
    v_cvt_pk_bf16_f32 v132, v136, v137
    v_exp_f32 v138, v138
    v_mfma_f32_32x32x16_bf16 v[144:159], v[212:215], v[116:119], v[144:159]
    ds_read_b128 v[244:247], v4 offset:13312
    v_add_f32 v6, v6, v138
    v_exp_f32 v139, v139
    s_waitcnt lgkmcnt(6)
    v_mfma_f32_32x32x16_bf16 v[144:159], v[216:219], v[120:123], v[144:159]
    ds_read_b128 v[248:251], v4 offset:14336
    v_add_f32 v6, v6, v139
    v_cvt_pk_bf16_f32 v133, v138, v139
    v_exp_f32 v140, v140
    v_mfma_f32_32x32x16_bf16 v[144:159], v[220:223], v[124:127], v[144:159]
    ds_read_b128 v[252:255], v4 offset:15360
    v_add_f32 v6, v6, v140
    v_exp_f32 v141, v141
    s_waitcnt lgkmcnt(6)
    v_mfma_f32_32x32x16_bf16 v[32:47], v[224:227], v[128:131], v[32:47]
    s_barrier
    ds_read_b128 v[192:195], v5 offset:0
    v_add_f32 v6, v6, v141
    v_cvt_pk_bf16_f32 v134, v140, v141
    v_exp_f32 v142, v142
    v_mfma_f32_32x32x16_bf16 v[48:63], v[228:231], v[128:131], v[48:63]
    ds_read_b128 v[196:199], v5 offset:1024
    v_add_f32 v6, v6, v142
    v_exp_f32 v143, v143
    v_add_f32 v8, 0xf4000000, v8
    v_mov_b32 v176, v8
    v_min_f32 v176, v176, v7
    v_add_f32 v177, 0xf1800000, v8
    v_min_f32 v177, v177, v7
    s_waitcnt lgkmcnt(6)
    v_mfma_f32_32x32x16_bf16 v[64:79], v[232:235], v[128:131], v[64:79]
    ds_read_b128 v[200:203], v5 offset:2048
    v_add_f32 v6, v6, v143
    v_cvt_pk_bf16_f32 v135, v142, v143
    v_exp_f32 v144, v144
    v_add_f32 v178, 0xf2000000, v8
    v_min_f32 v178, v178, v7
    v_add_f32 v179, 0xf2400000, v8
    v_min_f32 v179, v179, v7
    v_add_f32 v180, 0xf3000000, v8
    v_mfma_f32_32x32x16_bf16 v[80:95], v[236:239], v[128:131], v[80:95]
    ds_read_b128 v[204:207], v5 offset:3072
    v_add_f32 v6, v6, v144
    v_exp_f32 v145, v145
    v_min_f32 v180, v180, v7
    v_add_f32 v181, 0xf3100000, v8
    v_min_f32 v181, v181, v7
    v_add_f32 v182, 0xf3200000, v8
    v_min_f32 v182, v182, v7
    s_waitcnt lgkmcnt(6)
    v_mfma_f32_32x32x16_bf16 v[32:47], v[240:243], v[132:135], v[32:47]
    ds_read_b128 v[208:211], v5 offset:4096
    v_add_f32 v6, v6, v145
    v_cvt_pk_bf16_f32 v144, v144, v145
    v_exp_f32 v146, v146
    v_add_f32 v183, 0xf3300000, v8
    v_min_f32 v183, v183, v7
    v_add_f32 v184, 0xf3800000, v8
    v_min_f32 v184, v184, v7
    v_add_f32 v185, 0xf3880000, v8
    v_mfma_f32_32x32x16_bf16 v[48:63], v[244:247], v[132:135], v[48:63]
    ds_read_b128 v[212:215], v5 offset:5120
    v_add_f32 v6, v6, v146
    v_exp_f32 v147, v147
    v_min_f32 v185, v185, v7
    v_add_f32 v186, 0xf3900000, v8
    v_min_f32 v186, v186, v7
    v_add_f32 v187, 0xf3980000, v8
    v_min_f32 v187, v187, v7
    s_waitcnt lgkmcnt(6)
    v_mfma_f32_32x32x16_bf16 v[64:79], v[248:251], v[132:135], v[64:79]
    ds_read_b128 v[216:219], v5 offset:6144
    v_add_f32 v6, v6, v147
    v_cvt_pk_bf16_f32 v145, v146, v147
    v_exp_f32 v148, v148
    v_add_f32 v188, 0xf3c00000, v8
    v_min_f32 v188, v188, v7
    v_add_f32 v189, 0xf3c80000, v8
    v_min_f32 v189, v189, v7
    v_add_f32 v190, 0xf3d00000, v8
    v_mfma_f32_32x32x16_bf16 v[80:95], v[252:255], v[132:135], v[80:95]
    ds_read_b128 v[220:223], v5 offset:7168
    v_add_f32 v6, v6, v148
    v_exp_f32 v149, v149
    v_min_f32 v190, v190, v7
    v_add_f32 v191, 0xf3d80000, v8
    v_min_f32 v191, v191, v7
    s_waitcnt lgkmcnt(6)
    s_nop 1
    v_mfma_f32_32x32x16_bf16 v[128:143], v[192:195], v[96:99], v[176:191]
    ds_read_b128 v[224:227], v4 offset:24576
    v_add_f32 v6, v6, v149
    v_cvt_pk_bf16_f32 v146, v148, v149
    v_exp_f32 v150, v150
    v_mfma_f32_32x32x16_bf16 v[128:143], v[196:199], v[100:103], v[128:143]
    ds_read_b128 v[228:231], v4 offset:25600
    v_add_f32 v6, v6, v150
    v_exp_f32 v151, v151
    s_waitcnt lgkmcnt(6)
    v_mfma_f32_32x32x16_bf16 v[128:143], v[200:203], v[104:107], v[128:143]
    ds_read_b128 v[232:235], v4 offset:26624
    v_add_f32 v6, v6, v151
    v_cvt_pk_bf16_f32 v147, v150, v151
    v_exp_f32 v152, v152
    v_mfma_f32_32x32x16_bf16 v[128:143], v[204:207], v[108:111], v[128:143]
    ds_read_b128 v[236:239], v4 offset:27648
    v_add_f32 v6, v6, v152
    v_exp_f32 v153, v153
    s_waitcnt lgkmcnt(6)
    v_mfma_f32_32x32x16_bf16 v[128:143], v[208:211], v[112:115], v[128:143]
    ds_read_b128 v[240:243], v4 offset:28672
    v_add_f32 v6, v6, v153
    v_cvt_pk_bf16_f32 v148, v152, v153
    v_exp_f32 v154, v154
    v_mfma_f32_32x32x16_bf16 v[128:143], v[212:215], v[116:119], v[128:143]
    ds_read_b128 v[244:247], v4 offset:29696
    v_add_f32 v6, v6, v154
    v_exp_f32 v155, v155
    s_waitcnt lgkmcnt(6)
    v_mfma_f32_32x32x16_bf16 v[128:143], v[216:219], v[120:123], v[128:143]
    ds_read_b128 v[248:251], v4 offset:30720
    v_add_f32 v6, v6, v155
    v_cvt_pk_bf16_f32 v149, v154, v155
    v_exp_f32 v156, v156
    v_mfma_f32_32x32x16_bf16 v[128:143], v[220:223], v[124:127], v[128:143]
    ds_read_b128 v[252:255], v4 offset:31744
    v_add_f32 v6, v6, v156
    v_exp_f32 v157, v157
    s_waitcnt lgkmcnt(6)
    v_mfma_f32_32x32x16_bf16 v[32:47], v[224:227], v[144:147], v[32:47]
    ds_read_b128 v[192:195], v5 offset:16384
    v_add_f32 v6, v6, v157
    v_cvt_pk_bf16_f32 v150, v156, v157
    v_exp_f32 v158, v158
    v_add_f32 v8, 0xf4000000, v8
    v_mov_b32 v176, v8
    v_min_f32 v176, v176, v7
    v_add_f32 v177, 0xf1800000, v8
    v_min_f32 v177, v177, v7
    v_mfma_f32_32x32x16_bf16 v[48:63], v[228:231], v[144:147], v[48:63]
    ds_read_b128 v[196:199], v5 offset:17408
    v_add_f32 v6, v6, v158
    v_exp_f32 v159, v159
    v_add_f32 v178, 0xf2000000, v8
    v_min_f32 v178, v178, v7
    v_add_f32 v179, 0xf2400000, v8
    v_min_f32 v179, v179, v7
    v_add_f32 v180, 0xf3000000, v8
    v_mov_b32 v4, v5
    s_add_u32 s51, s51, 32768
    s_waitcnt lgkmcnt(6)
    v_mfma_f32_32x32x16_bf16 v[64:79], v[232:235], v[144:147], v[64:79]
    ds_read_b128 v[200:203], v5 offset:18432
    v_add_f32 v6, v6, v159
    v_cvt_pk_bf16_f32 v151, v158, v159
    v_exp_f32 v128, v128
    v_min_f32 v180, v180, v7
    v_add_f32 v181, 0xf3100000, v8
    v_min_f32 v181, v181, v7
    v_add_f32 v182, 0xf3200000, v8
    v_min_f32 v182, v182, v7
    v_mfma_f32_32x32x16_bf16 v[80:95], v[236:239], v[144:147], v[80:95]
    ds_read_b128 v[204:207], v5 offset:19456
    v_add_f32 v6, v6, v128
    v_exp_f32 v129, v129
    v_add_f32 v183, 0xf3300000, v8
    v_min_f32 v183, v183, v7
    v_add_f32 v184, 0xf3800000, v8
    v_min_f32 v184, v184, v7
    v_add_f32 v185, 0xf3880000, v8
    s_cmp_eq_u32 s51, 163840
    s_cselect_b32 s51, 0, s51
    s_waitcnt lgkmcnt(6)
    v_mfma_f32_32x32x16_bf16 v[32:47], v[240:243], v[148:151], v[32:47]
    ds_read_b128 v[208:211], v5 offset:20480
    v_add_f32 v6, v6, v129
    v_cvt_pk_bf16_f32 v128, v128, v129
    v_exp_f32 v130, v130
    v_min_f32 v185, v185, v7
    v_add_f32 v186, 0xf3900000, v8
    v_min_f32 v186, v186, v7
    v_add_f32 v187, 0xf3980000, v8
    v_min_f32 v187, v187, v7
    v_mfma_f32_32x32x16_bf16 v[48:63], v[244:247], v[148:151], v[48:63]
    ds_read_b128 v[212:215], v5 offset:21504
    v_add_f32 v6, v6, v130
    v_exp_f32 v131, v131
    v_add_f32 v188, 0xf3c00000, v8
    v_min_f32 v188, v188, v7
    v_add_f32 v189, 0xf3c80000, v8
    v_min_f32 v189, v189, v7
    v_add_f32 v190, 0xf3d00000, v8
    s_add_u32 s48, s48, 1
    s_waitcnt lgkmcnt(6)
    v_mfma_f32_32x32x16_bf16 v[64:79], v[248:251], v[148:151], v[64:79]
    ds_read_b128 v[216:219], v5 offset:22528
    v_add_f32 v6, v6, v131
    v_cvt_pk_bf16_f32 v129, v130, v131
    v_exp_f32 v132, v132
    v_min_f32 v190, v190, v7
    v_add_f32 v191, 0xf3d80000, v8
    v_min_f32 v191, v191, v7
    v_mfma_f32_32x32x16_bf16 v[80:95], v[252:255], v[148:151], v[80:95]
    ds_read_b128 v[220:223], v5 offset:23552
    v_add_f32 v6, v6, v132
    v_exp_f32 v133, v133
    v_add_u32 v5, s51, v2
    s_cmp_lt_u32 s48, s54
    s_cbranch_scc1 bm_21
    s_waitcnt lgkmcnt(6)
    v_mfma_f32_32x32x16_bf16 v[144:159], v[192:195], v[96:99], v[176:191]
    ds_read_b128 v[224:227], v4 offset:8192
    v_add_f32 v6, v6, v133
    v_cvt_pk_bf16_f32 v130, v132, v133
    v_exp_f32 v134, v134
    v_mfma_f32_32x32x16_bf16 v[144:159], v[196:199], v[100:103], v[144:159]
    ds_read_b128 v[228:231], v4 offset:9216
    v_add_f32 v6, v6, v134
    v_exp_f32 v135, v135
    s_waitcnt lgkmcnt(6)
    v_mfma_f32_32x32x16_bf16 v[144:159], v[200:203], v[104:107], v[144:159]
    ds_read_b128 v[232:235], v4 offset:10240
    v_add_f32 v6, v6, v135
    v_cvt_pk_bf16_f32 v131, v134, v135
    v_exp_f32 v136, v136
    v_mfma_f32_32x32x16_bf16 v[144:159], v[204:207], v[108:111], v[144:159]
    ds_read_b128 v[236:239], v4 offset:11264
    v_add_f32 v6, v6, v136
    v_exp_f32 v137, v137
    s_waitcnt lgkmcnt(6)
    v_mfma_f32_32x32x16_bf16 v[144:159], v[208:211], v[112:115], v[144:159]
    ds_read_b128 v[240:243], v4 offset:12288
    v_add_f32 v6, v6, v137
    v_cvt_pk_bf16_f32 v132, v136, v137
    v_exp_f32 v138, v138
    v_mfma_f32_32x32x16_bf16 v[144:159], v[212:215], v[116:119], v[144:159]
    ds_read_b128 v[244:247], v4 offset:13312
    v_add_f32 v6, v6, v138
    v_exp_f32 v139, v139
    s_waitcnt lgkmcnt(6)
    v_mfma_f32_32x32x16_bf16 v[144:159], v[216:219], v[120:123], v[144:159]
    ds_read_b128 v[248:251], v4 offset:14336
    v_add_f32 v6, v6, v139
    v_cvt_pk_bf16_f32 v133, v138, v139
    v_exp_f32 v140, v140
    v_mfma_f32_32x32x16_bf16 v[144:159], v[220:223], v[124:127], v[144:159]
    ds_read_b128 v[252:255], v4 offset:15360
    v_add_f32 v6, v6, v140
    v_exp_f32 v141, v141
    s_waitcnt lgkmcnt(6)
    v_mfma_f32_32x32x16_bf16 v[32:47], v[224:227], v[128:131], v[32:47]
    s_barrier
    v_add_f32 v6, v6, v141
    v_cvt_pk_bf16_f32 v134, v140, v141
    v_exp_f32 v142, v142
    v_mfma_f32_32x32x16_bf16 v[48:63], v[228:231], v[128:131], v[48:63]
    v_add_f32 v6, v6, v142
    v_exp_f32 v143, v143
    s_waitcnt lgkmcnt(4)
    v_mfma_f32_32x32x16_bf16 v[64:79], v[232:235], v[128:131], v[64:79]
    v_add_f32 v6, v6, v143
    v_cvt_pk_bf16_f32 v135, v142, v143
    v_exp_f32 v144, v144
    v_mfma_f32_32x32x16_bf16 v[80:95], v[236:239], v[128:131], v[80:95]
    v_add_f32 v6, v6, v144
    v_exp_f32 v145, v145
    s_waitcnt lgkmcnt(2)
    v_mfma_f32_32x32x16_bf16 v[32:47], v[240:243], v[132:135], v[32:47]
    v_add_f32 v6, v6, v145
    v_cvt_pk_bf16_f32 v144, v144, v145
    v_exp_f32 v146, v146
    v_mfma_f32_32x32x16_bf16 v[48:63], v[244:247], v[132:135], v[48:63]
    v_add_f32 v6, v6, v146
    v_exp_f32 v147, v147
    s_waitcnt lgkmcnt(0)
    v_mfma_f32_32x32x16_bf16 v[64:79], v[248:251], v[132:135], v[64:79]
    v_add_f32 v6, v6, v147
    v_cvt_pk_bf16_f32 v145, v146, v147
    v_exp_f32 v148, v148
    v_mfma_f32_32x32x16_bf16 v[80:95], v[252:255], v[132:135], v[80:95]
    v_add_f32 v6, v6, v148
    v_exp_f32 v149, v149
    s_nop 7
    ds_read_b128 v[224:227], v4 offset:24576
    v_add_f32 v6, v6, v149
    v_cvt_pk_bf16_f32 v146, v148, v149
    v_exp_f32 v150, v150
    s_nop 0
    ds_read_b128 v[228:231], v4 offset:25600
    v_add_f32 v6, v6, v150
    v_exp_f32 v151, v151
    s_nop 0
    ds_read_b128 v[232:235], v4 offset:26624
    v_add_f32 v6, v6, v151
    v_cvt_pk_bf16_f32 v147, v150, v151
    v_exp_f32 v152, v152
    s_nop 0
    ds_read_b128 v[236:239], v4 offset:27648
    v_add_f32 v6, v6, v152
    v_exp_f32 v153, v153
    s_nop 0
    ds_read_b128 v[240:243], v4 offset:28672
    v_add_f32 v6, v6, v153
    v_cvt_pk_bf16_f32 v148, v152, v153
    v_exp_f32 v154, v154
    s_nop 0
    ds_read_b128 v[244:247], v4 offset:29696
    v_add_f32 v6, v6, v154
    v_exp_f32 v155, v155
    s_nop 0
    ds_read_b128 v[248:251], v4 offset:30720
    v_add_f32 v6, v6, v155
    v_cvt_pk_bf16_f32 v149, v154, v155
    v_exp_f32 v156, v156
    s_nop 0
    ds_read_b128 v[252:255], v4 offset:31744
    v_add_f32 v6, v6, v156
    v_exp_f32 v157, v157
    s_nop 0
    s_waitcnt lgkmcnt(6)
    v_mfma_f32_32x32x16_bf16 v[32:47], v[224:227], v[144:147], v[32:47]
    v_add_f32 v6, v6, v157
    v_cvt_pk_bf16_f32 v150, v156, v157
    v_exp_f32 v158, v158
    v_mfma_f32_32x32x16_bf16 v[48:63], v[228:231], v[144:147], v[48:63]
    v_add_f32 v6, v6, v158
    v_exp_f32 v159, v159
    v_mov_b32 v4, v5
    s_add_u32 s51, s51, 32768
    s_waitcnt lgkmcnt(4)
    v_mfma_f32_32x32x16_bf16 v[64:79], v[232:235], v[144:147], v[64:79]
    v_add_f32 v6, v6, v159
    v_cvt_pk_bf16_f32 v151, v158, v159
    v_mfma_f32_32x32x16_bf16 v[80:95], v[236:239], v[144:147], v[80:95]
    s_cmp_eq_u32 s51, 163840
    s_cselect_b32 s51, 0, s51
    s_waitcnt lgkmcnt(2)
    v_mfma_f32_32x32x16_bf16 v[32:47], v[240:243], v[148:151], v[32:47]
    v_mfma_f32_32x32x16_bf16 v[48:63], v[244:247], v[148:151], v[48:63]
    s_add_u32 s48, s48, 1
    s_waitcnt lgkmcnt(0)
    v_mfma_f32_32x32x16_bf16 v[64:79], v[248:251], v[148:151], v[64:79]
    v_mfma_f32_32x32x16_bf16 v[80:95], v[252:255], v[148:151], v[80:95]
    v_add_u32 v5, s51, v2
attn_kernel_epi:
    v_mov_b32 v10, v6
    v_mov_b32 v11, v6
    s_nop 1
    v_permlane32_swap_b32 v10, v11
    s_nop 1
    v_add_f32 v6, v10, v11
    v_mov_b32 v12, 0x67800000
    v_cmp_nlt_f32 vcc, v6, v12
    s_cbranch_vccnz attn_kernel_fb
attn_kernel_fin:
    v_rcp_f32 v10, v6
    s_nop 7
    s_nop 3
    v_mul_f32 v32, v32, v10
    v_mul_f32 v33, v33, v10
    v_mul_f32 v34, v34, v10
    v_mul_f32 v35, v35, v10
    v_mul_f32 v36, v36, v10
    v_mul_f32 v37, v37, v10
    v_mul_f32 v38, v38, v10
    v_mul_f32 v39, v39, v10
    v_mul_f32 v40, v40, v10
    v_mul_f32 v41, v41, v10
    v_mul_f32 v42, v42, v10
    v_mul_f32 v43, v43, v10
    v_mul_f32 v44, v44, v10
    v_mul_f32 v45, v45, v10
    v_mul_f32 v46, v46, v10
    v_mul_f32 v47, v47, v10
    v_mul_f32 v48, v48, v10
    v_mul_f32 v49, v49, v10
    v_mul_f32 v50, v50, v10
    v_mul_f32 v51, v51, v10
    v_mul_f32 v52, v52, v10
    v_mul_f32 v53, v53, v10
    v_mul_f32 v54, v54, v10
    v_mul_f32 v55, v55, v10
    v_mul_f32 v56, v56, v10
    v_mul_f32 v57, v57, v10
    v_mul_f32 v58, v58, v10
    v_mul_f32 v59, v59, v10
    v_mul_f32 v60, v60, v10
    v_mul_f32 v61, v61, v10
    v_mul_f32 v62, v62, v10
    v_mul_f32 v63, v63, v10
    v_mul_f32 v64, v64, v10
    v_mul_f32 v65, v65, v10
    v_mul_f32 v66, v66, v10
    v_mul_f32 v67, v67, v10
    v_mul_f32 v68, v68, v10
    v_mul_f32 v69, v69, v10
    v_mul_f32 v70, v70, v10
    v_mul_f32 v71, v71, v10
    v_mul_f32 v72, v72, v10
    v_mul_f32 v73, v73, v10
    v_mul_f32 v74, v74, v10
    v_mul_f32 v75, v75, v10
    v_mul_f32 v76, v76, v10
    v_mul_f32 v77, v77, v10
    v_mul_f32 v78, v78, v10
    v_mul_f32 v79, v79, v10
    v_mul_f32 v80, v80, v10
    v_mul_f32 v81, v81, v10
    v_mul_f32 v82, v82, v10
    v_mul_f32 v83, v83, v10
    v_mul_f32 v84, v84, v10
    v_mul_f32 v85, v85, v10
    v_mul_f32 v86, v86, v10
    v_mul_f32 v87, v87, v10
    v_mul_f32 v88, v88, v10
    v_mul_f32 v89, v89, v10
    v_mul_f32 v90, v90, v10
    v_mul_f32 v91, v91, v10
    v_mul_f32 v92, v92, v10
    v_mul_f32 v93, v93, v10
    v_mul_f32 v94, v94, v10
    v_mul_f32 v95, v95, v10
    s_lshl_b32 s20, s42, 18
    s_lshl_b32 s21, s14, 13
    s_add_u32 s20, s20, s21
    s_add_u32 s20, s20, 50331648
    s_add_u32 s21, s20, 4096
    v_cvt_pk_bf16_f32 v32, v32, v33
    v_cvt_pk_bf16_f32 v33, v34, v35
    v_cvt_pk_bf16_f32 v34, v36, v37
    v_cvt_pk_bf16_f32 v35, v38, v39
    v_cvt_pk_bf16_f32 v36, v40, v41
    v_cvt_pk_bf16_f32 v37, v42, v43
    v_cvt_pk_bf16_f32 v38, v44, v45
    v_cvt_pk_bf16_f32 v39, v46, v47
    buffer_store_dwordx4 v[32:35], v2, s[32:35], s20 offen offset:0 sc1
    buffer_store_dwordx4 v[36:39], v2, s[32:35], s20 offen offset:1024 sc1
    v_cvt_pk_bf16_f32 v48, v48, v49
    v_cvt_pk_bf16_f32 v49, v50, v51
    v_cvt_pk_bf16_f32 v50, v52, v53
    v_cvt_pk_bf16_f32 v51, v54, v55
    v_cvt_pk_bf16_f32 v52, v56, v57
    v_cvt_pk_bf16_f32 v53, v58, v59
    v_cvt_pk_bf16_f32 v54, v60, v61
    v_cvt_pk_bf16_f32 v55, v62, v63
    buffer_store_dwordx4 v[48:51], v2, s[32:35], s20 offen offset:2048 sc1
    buffer_store_dwordx4 v[52:55], v2, s[32:35], s20 offen offset:3072 sc1
    v_cvt_pk_bf16_f32 v64, v64, v65
    v_cvt_pk_bf16_f32 v65, v66, v67
    v_cvt_pk_bf16_f32 v66, v68, v69
    v_cvt_pk_bf16_f32 v67, v70, v71
    v_cvt_pk_bf16_f32 v68, v72, v73
    v_cvt_pk_bf16_f32 v69, v74, v75
    v_cvt_pk_bf16_f32 v70, v76, v77
    v_cvt_pk_bf16_f32 v71, v78, v79
    buffer_store_dwordx4 v[64:67], v2, s[32:35], s21 offen offset:0 sc1
    buffer_store_dwordx4 v[68:71], v2, s[32:35], s21 offen offset:1024 sc1
    v_cvt_pk_bf16_f32 v80, v80, v81
    v_cvt_pk_bf16_f32 v81, v82, v83
    v_cvt_pk_bf16_f32 v82, v84, v85
    v_cvt_pk_bf16_f32 v83, v86, v87
    v_cvt_pk_bf16_f32 v84, v88, v89
    v_cvt_pk_bf16_f32 v85, v90, v91
    v_cvt_pk_bf16_f32 v86, v92, v93
    v_cvt_pk_bf16_f32 v87, v94, v95
    buffer_store_dwordx4 v[80:83], v2, s[32:35], s21 offen offset:2048 sc1
    buffer_store_dwordx4 v[84:87], v2, s[32:35], s21 offen offset:3072 sc1
    s_mov_b32 s64, 0
    s_cmp_lg_u32 s17, 0
    s_cbranch_scc1 attn_kernel_end2
    s_add_u32 s52, s48, 4
    s_cmp_gt_u32 s52, s41
    s_cbranch_scc1 pf_23
    s_cmp_eq_u32 s18, 2
    s_cselect_b32 s58, s60, s58
    s_cselect_b32 s59, s61, s59
    s_cmp_eq_u32 s18, 3
    s_cselect_b32 s58, s62, s58
    s_cselect_b32 s59, s63, s59
    s_mov_b32 s24, s58
    s_and_b32 s25, s59, 0xffff
    s_mov_b32 s26, 4194304
    s_mov_b32 s27, 0x20000
    s_and_b32 s20, s2, 7
    s_lshl_b32 s20, s20, 19
    s_lshr_b32 s21, s2, 3
    s_lshl_b32 s21, s21, 14
    s_add_u32 s20, s20, s21
    s_lshl_b32 s21, s18, 13
    s_add_u32 s20, s20, s21
    s_mul_i32 s21, s2, 7168
    s_cmp_ge_u32 s18, 2
    s_cselect_b32 s20, s21, s20
    s_cselect_b32 s26, 1835008, s26
    s_add_u32 s21, s20, 4096
    buffer_load_dwordx4 v[32:35], v2, s[24:27], s20 offen offset:0
    buffer_load_dwordx4 v[36:39], v2, s[24:27], s20 offen offset:1024
    buffer_load_dwordx4 v[40:43], v2, s[24:27], s20 offen offset:2048
    buffer_load_dwordx4 v[44:47], v2, s[24:27], s20 offen offset:3072
    buffer_load_dwordx4 v[48:51], v2, s[24:27], s21 offen offset:0
    buffer_load_dwordx4 v[52:55], v2, s[24:27], s21 offen offset:1024
    buffer_load_dwordx4 v[56:59], v2, s[24:27], s21 offen offset:2048
    buffer_load_dwordx4 v[60:63], v2, s[24:27], s21 offen offset:3072
    v_lshrrev_b32 v64, 4, v2
    s_lshl_b32 s20, s18, 6
    v_add_u32 v64, s20, v64
    s_getpc_b64 s[20:21]
pc_24:
    s_add_u32 s20, s20, tail_kernel-pc_24
    s_addc_u32 s21, s21, 0
    s_mov_b32 s22, tail_kernel_end-tail_kernel-4
    v_lshlrev_b32 v68, 6, v64
    v_min_u32 v68, s22, v68
    v_and_b32 v68, -4, v68
    v_mov_b32 v67, s21
    v_add_co_u32 v66, vcc, s20, v68
    v_addc_co_u32 v67, vcc, 0, v67, vcc
    global_load_dword v69, v[66:67], off
    v_lshlrev_b32 v68, 6, v64
    v_add_u32 v68, 16384, v68
    v_min_u32 v68, s22, v68
    v_and_b32 v68, -4, v68
    v_mov_b32 v67, s21
    v_add_co_u32 v66, vcc, s20, v68
    v_addc_co_u32 v67, vcc, 0, v67, vcc
    global_load_dword v69, v[66:67], off
    v_lshlrev_b32 v68, 6, v64
    v_add_u32 v68, 32768, v68
    v_min_u32 v68, s22, v68
    v_and_b32 v68, -4, v68
    v_mov_b32 v67, s21
    v_add_co_u32 v66, vcc, s20, v68
    v_addc_co_u32 v67, vcc, 0, v67, vcc
    global_load_dword v69, v[66:67], off
    s_mov_b32 s64, 1
pf_23:
    s_cmp_ge_u32 s48, s41
    s_cbranch_scc1 attn_kernel_out
ll_22:
    s_add_u32 s52, s48, 3
    s_cmp_lt_u32 s52, s41
    s_cbranch_scc1 x_25
    s_waitcnt vmcnt(0)
x_25:
    s_waitcnt vmcnt(16)
    s_barrier
    s_add_u32 s52, s48, 4
    s_cmp_lt_u32 s52, s41
    s_cselect_b32 s52, 1, 0
    s_andn2_b32 s52, s52, s17
    s_cmp_eq_u32 s52, 0
    s_cbranch_scc1 dn_28
    s_add_u32 s47, s50, 0
    s_add_u32 s53, s49, 0
    s_add_u32 m0, s46, s53
    s_nop 0
    buffer_load_dwordx4 v2, s[32:35], s47 offen offset:0 lds
    buffer_load_dwordx4 v2, s[32:35], s47 offen offset:1024 lds
    buffer_load_dwordx4 v2, s[32:35], s47 offen offset:2048 lds
    buffer_load_dwordx4 v2, s[32:35], s47 offen offset:3072 lds
    s_add_u32 s47, s50, 4096
    s_add_u32 s53, s49, 4096
    s_add_u32 m0, s46, s53
    s_nop 0
    buffer_load_dwordx4 v2, s[32:35], s47 offen offset:0 lds
    buffer_load_dwordx4 v2, s[32:35], s47 offen offset:1024 lds
    buffer_load_dwordx4 v2, s[32:35], s47 offen offset:2048 lds
    buffer_load_dwordx4 v2, s[32:35], s47 offen offset:3072 lds
dn_28:
    s_add_u32 s48, s48, 1
    s_add_u32 s50, s50, 32768
    s_add_u32 s49, s49, 32768
    s_cmp_eq_u32 s49, 163840
    s_cselect_b32 s49, 0, s49
    s_add_u32 s51, s51, 32768
    s_cmp_eq_u32 s51, 163840
    s_cselect_b32 s51, 0, s51
    s_cmp_lt_u32 s48, s41
    s_cbranch_scc1 ll_22
attn_kernel_out:
    s_cmp_lg_u32 s64, 0
    s_cbranch_scc1 attn_kernel_end2
    s_cmp_eq_u32 s18, 2
    s_cselect_b32 s58, s60, s58
    s_cselect_b32 s59, s61, s59
    s_cmp_eq_u32 s18, 3
    s_cselect_b32 s58, s62, s58
    s_cselect_b32 s59, s63, s59
    s_mov_b32 s24, s58
    s_and_b32 s25, s59, 0xffff
    s_mov_b32 s26, 4194304
    s_mov_b32 s27, 0x20000
    s_and_b32 s20, s2, 7
    s_lshl_b32 s20, s20, 19
    s_lshr_b32 s21, s2, 3
    s_lshl_b32 s21, s21, 14
    s_add_u32 s20, s20, s21
    s_lshl_b32 s21, s18, 13
    s_add_u32 s20, s20, s21
    s_mul_i32 s21, s2, 7168
    s_cmp_ge_u32 s18, 2
    s_cselect_b32 s20, s21, s20
    s_cselect_b32 s26, 1835008, s26
    s_add_u32 s21, s20, 4096
    buffer_load_dwordx4 v[32:35], v2, s[24:27], s20 offen offset:0
    buffer_load_dwordx4 v[36:39], v2, s[24:27], s20 offen offset:1024
    buffer_load_dwordx4 v[40:43], v2, s[24:27], s20 offen offset:2048
    buffer_load_dwordx4 v[44:47], v2, s[24:27], s20 offen offset:3072
    buffer_load_dwordx4 v[48:51], v2, s[24:27], s21 offen offset:0
    buffer_load_dwordx4 v[52:55], v2, s[24:27], s21 offen offset:1024
    buffer_load_dwordx4 v[56:59], v2, s[24:27], s21 offen offset:2048
    buffer_load_dwordx4 v[60:63], v2, s[24:27], s21 offen offset:3072
    v_lshrrev_b32 v64, 4, v2
    s_lshl_b32 s20, s18, 6
    v_add_u32 v64, s20, v64
    s_getpc_b64 s[20:21]
pc_29:
    s_add_u32 s20, s20, tail_kernel-pc_29
    s_addc_u32 s21, s21, 0
    s_mov_b32 s22, tail_kernel_end-tail_kernel-4
    v_lshlrev_b32 v68, 6, v64
    v_min_u32 v68, s22, v68
    v_and_b32 v68, -4, v68
    v_mov_b32 v67, s21
    v_add_co_u32 v66, vcc, s20, v68
    v_addc_co_u32 v67, vcc, 0, v67, vcc
    global_load_dword v69, v[66:67], off
    v_lshlrev_b32 v68, 6, v64
    v_add_u32 v68, 16384, v68
    v_min_u32 v68, s22, v68
    v_and_b32 v68, -4, v68
    v_mov_b32 v67, s21
    v_add_co_u32 v66, vcc, s20, v68
    v_addc_co_u32 v67, vcc, 0, v67, vcc
    global_load_dword v69, v[66:67], off
    v_lshlrev_b32 v68, 6, v64
    v_add_u32 v68, 32768, v68
    v_min_u32 v68, s22, v68
    v_and_b32 v68, -4, v68
    v_mov_b32 v67, s21
    v_add_co_u32 v66, vcc, s20, v68
    v_addc_co_u32 v67, vcc, 0, v67, vcc
    global_load_dword v69, v[66:67], off
attn_kernel_end2:
    s_endpgm
attn_kernel_fb:
    v_mov_b32 v32, 0
    v_mov_b32 v33, 0
    v_mov_b32 v34, 0
    v_mov_b32 v35, 0
    v_mov_b32 v36, 0
    v_mov_b32 v37, 0
    v_mov_b32 v38, 0
    v_mov_b32 v39, 0
    v_mov_b32 v40, 0
    v_mov_b32 v41, 0
    v_mov_b32 v42, 0
    v_mov_b32 v43, 0
    v_mov_b32 v44, 0
    v_mov_b32 v45, 0
    v_mov_b32 v46, 0
    v_mov_b32 v47, 0
    v_mov_b32 v48, 0
    v_mov_b32 v49, 0
    v_mov_b32 v50, 0
    v_mov_b32 v51, 0
    v_mov_b32 v52, 0
    v_mov_b32 v53, 0
    v_mov_b32 v54, 0
    v_mov_b32 v55, 0
    v_mov_b32 v56, 0
    v_mov_b32 v57, 0
    v_mov_b32 v58, 0
    v_mov_b32 v59, 0
    v_mov_b32 v60, 0
    v_mov_b32 v61, 0
    v_mov_b32 v62, 0
    v_mov_b32 v63, 0
    v_mov_b32 v64, 0
    v_mov_b32 v65, 0
    v_mov_b32 v66, 0
    v_mov_b32 v67, 0
    v_mov_b32 v68, 0
    v_mov_b32 v69, 0
    v_mov_b32 v70, 0
    v_mov_b32 v71, 0
    v_mov_b32 v72, 0
    v_mov_b32 v73, 0
    v_mov_b32 v74, 0
    v_mov_b32 v75, 0
    v_mov_b32 v76, 0
    v_mov_b32 v77, 0
    v_mov_b32 v78, 0
    v_mov_b32 v79, 0
    v_mov_b32 v80, 0
    v_mov_b32 v81, 0
    v_mov_b32 v82, 0
    v_mov_b32 v83, 0
    v_mov_b32 v84, 0
    v_mov_b32 v85, 0
    v_mov_b32 v86, 0
    v_mov_b32 v87, 0
    v_mov_b32 v88, 0
    v_mov_b32 v89, 0
    v_mov_b32 v90, 0
    v_mov_b32 v91, 0
    v_mov_b32 v92, 0
    v_mov_b32 v93, 0
    v_mov_b32 v94, 0
    v_mov_b32 v95, 0
    v_mov_b32 v6, 0
    v_mov_b32 v7, 0xff61b1e6
    v_and_b32 v10, 31, v1
    v_lshrrev_b32 v11, 5, v1
    v_lshlrev_b32 v11, 2, v11
    v_sub_u32 v10, v10, v11
    s_lshl_b32 s20, s42, 5
    v_add_u32 v10, s20, v10
    v_cvt_f32_i32 v10, v10
    v_add_f32 v10, 0.5, v10
    v_mul_f32 v8, 0x71800000, v10
    v_mov_b32 v12, 0
    s_mov_b32 s55, 0
    s_mov_b32 s56, s44
fl_30:
    s_add_u32 s57, s56, 0
    buffer_load_dwordx4 v[192:195], v2, s[32:35], s57 offen offset:0
    buffer_load_dwordx4 v[196:199], v2, s[32:35], s57 offen offset:1024
    buffer_load_dwordx4 v[200:203], v2, s[32:35], s57 offen offset:2048
    buffer_load_dwordx4 v[204:207], v2, s[32:35], s57 offen offset:3072
    s_add_u32 s57, s56, 4096
    buffer_load_dwordx4 v[208:211], v2, s[32:35], s57 offen offset:0
    buffer_load_dwordx4 v[212:215], v2, s[32:35], s57 offen offset:1024
    buffer_load_dwordx4 v[216:219], v2, s[32:35], s57 offen offset:2048
    buffer_load_dwordx4 v[220:223], v2, s[32:35], s57 offen offset:3072
    s_add_u32 s57, s56, 8192
    buffer_load_dwordx4 v[224:227], v2, s[32:35], s57 offen offset:0
    buffer_load_dwordx4 v[228:231], v2, s[32:35], s57 offen offset:1024
    buffer_load_dwordx4 v[232:235], v2, s[32:35], s57 offen offset:2048
    buffer_load_dwordx4 v[236:239], v2, s[32:35], s57 offen offset:3072
    s_add_u32 s57, s56, 12288
    buffer_load_dwordx4 v[240:243], v2, s[32:35], s57 offen offset:0
    buffer_load_dwordx4 v[244:247], v2, s[32:35], s57 offen offset:1024
    buffer_load_dwordx4 v[248:251], v2, s[32:35], s57 offen offset:2048
    buffer_load_dwordx4 v[252:255], v2, s[32:35], s57 offen offset:3072
    v_mov_b32 v176, v8
    v_min_f32 v176, v176, v12
    v_add_f32 v177, 0xf1800000, v8
    v_min_f32 v177, v177, v12
    v_add_f32 v178, 0xf2000000, v8
    v_min_f32 v178, v178, v12
    v_add_f32 v179, 0xf2400000, v8
    v_min_f32 v179, v179, v12
    v_add_f32 v180, 0xf3000000, v8
    v_min_f32 v180, v180, v12
    v_add_f32 v181, 0xf3100000, v8
    v_min_f32 v181, v181, v12
    v_add_f32 v182, 0xf3200000, v8
    v_min_f32 v182, v182, v12
    v_add_f32 v183, 0xf3300000, v8
    v_min_f32 v183, v183, v12
    v_add_f32 v184, 0xf3800000, v8
    v_min_f32 v184, v184, v12
    v_add_f32 v185, 0xf3880000, v8
    v_min_f32 v185, v185, v12
    v_add_f32 v186, 0xf3900000, v8
    v_min_f32 v186, v186, v12
    v_add_f32 v187, 0xf3980000, v8
    v_min_f32 v187, v187, v12
    v_add_f32 v188, 0xf3c00000, v8
    v_min_f32 v188, v188, v12
    v_add_f32 v189, 0xf3c80000, v8
    v_min_f32 v189, v189, v12
    v_add_f32 v190, 0xf3d00000, v8
    v_min_f32 v190, v190, v12
    v_add_f32 v191, 0xf3d80000, v8
    v_min_f32 v191, v191, v12
    v_add_f32 v8, 0xf4000000, v8
    s_waitcnt vmcnt(0)
    v_mfma_f32_32x32x16_bf16 v[128:143], v[192:195], v[96:99], v[176:191]
    v_mfma_f32_32x32x16_bf16 v[128:143], v[196:199], v[100:103], v[128:143]
    v_mfma_f32_32x32x16_bf16 v[128:143], v[200:203], v[104:107], v[128:143]
    v_mfma_f32_32x32x16_bf16 v[128:143], v[204:207], v[108:111], v[128:143]
    v_mfma_f32_32x32x16_bf16 v[128:143], v[208:211], v[112:115], v[128:143]
    v_mfma_f32_32x32x16_bf16 v[128:143], v[212:215], v[116:119], v[128:143]
    v_mfma_f32_32x32x16_bf16 v[128:143], v[216:219], v[120:123], v[128:143]
    v_mfma_f32_32x32x16_bf16 v[128:143], v[220:223], v[124:127], v[128:143]
    s_nop 7
    s_nop 7
    v_max_f32 v10, v128, v129
    v_max_f32 v10, v10, v130
    v_max_f32 v10, v10, v131
    v_max_f32 v10, v10, v132
    v_max_f32 v10, v10, v133
    v_max_f32 v10, v10, v134
    v_max_f32 v10, v10, v135
    v_max_f32 v10, v10, v136
    v_max_f32 v10, v10, v137
    v_max_f32 v10, v10, v138
    v_max_f32 v10, v10, v139
    v_max_f32 v10, v10, v140
    v_max_f32 v10, v10, v141
    v_max_f32 v10, v10, v142
    v_max_f32 v10, v10, v143
    v_mov_b32 v11, v10
    s_nop 1
    v_permlane32_swap_b32 v10, v11
    s_nop 1
    v_max_f32 v10, v10, v11
    v_max_f32 v10, v10, v7
    v_sub_f32 v11, v7, v10
    v_exp_f32 v11, v11
    v_mov_b32 v7, v10
    v_sub_f32 v128, v128, v10
    v_sub_f32 v129, v129, v10
    v_sub_f32 v130, v130, v10
    v_sub_f32 v131, v131, v10
    v_sub_f32 v132, v132, v10
    v_sub_f32 v133, v133, v10
    v_sub_f32 v134, v134, v10
    v_sub_f32 v135, v135, v10
    v_sub_f32 v136, v136, v10
    v_sub_f32 v137, v137, v10
    v_sub_f32 v138, v138, v10
    v_sub_f32 v139, v139, v10
    v_sub_f32 v140, v140, v10
    v_sub_f32 v141, v141, v10
    v_sub_f32 v142, v142, v10
    v_sub_f32 v143, v143, v10
    v_exp_f32 v128, v128
    v_exp_f32 v129, v129
    v_exp_f32 v130, v130
    v_exp_f32 v131, v131
    v_exp_f32 v132, v132
    v_exp_f32 v133, v133
    v_exp_f32 v134, v134
    v_exp_f32 v135, v135
    v_exp_f32 v136, v136
    v_exp_f32 v137, v137
    v_exp_f32 v138, v138
    v_exp_f32 v139, v139
    v_exp_f32 v140, v140
    v_exp_f32 v141, v141
    v_exp_f32 v142, v142
    v_exp_f32 v143, v143
    s_nop 0
    v_mul_f32 v6, v6, v11
    v_add_f32 v6, v6, v128
    v_add_f32 v6, v6, v129
    v_add_f32 v6, v6, v130
    v_add_f32 v6, v6, v131
    v_add_f32 v6, v6, v132
    v_add_f32 v6, v6, v133
    v_add_f32 v6, v6, v134
    v_add_f32 v6, v6, v135
    v_add_f32 v6, v6, v136
    v_add_f32 v6, v6, v137
    v_add_f32 v6, v6, v138
    v_add_f32 v6, v6, v139
    v_add_f32 v6, v6, v140
    v_add_f32 v6, v6, v141
    v_add_f32 v6, v6, v142
    v_add_f32 v6, v6, v143
    v_cvt_pk_bf16_f32 v128, v128, v129
    v_cvt_pk_bf16_f32 v129, v130, v131
    v_cvt_pk_bf16_f32 v130, v132, v133
    v_cvt_pk_bf16_f32 v131, v134, v135
    v_cvt_pk_bf16_f32 v132, v136, v137
    v_cvt_pk_bf16_f32 v133, v138, v139
    v_cvt_pk_bf16_f32 v134, v140, v141
    v_cvt_pk_bf16_f32 v135, v142, v143
    v_mul_f32 v32, v32, v11
    v_mul_f32 v33, v33, v11
    v_mul_f32 v34, v34, v11
    v_mul_f32 v35, v35, v11
    v_mul_f32 v36, v36, v11
    v_mul_f32 v37, v37, v11
    v_mul_f32 v38, v38, v11
    v_mul_f32 v39, v39, v11
    v_mul_f32 v40, v40, v11
    v_mul_f32 v41, v41, v11
    v_mul_f32 v42, v42, v11
    v_mul_f32 v43, v43, v11
    v_mul_f32 v44, v44, v11
    v_mul_f32 v45, v45, v11
    v_mul_f32 v46, v46, v11
    v_mul_f32 v47, v47, v11
    v_mul_f32 v48, v48, v11
    v_mul_f32 v49, v49, v11
    v_mul_f32 v50, v50, v11
    v_mul_f32 v51, v51, v11
    v_mul_f32 v52, v52, v11
    v_mul_f32 v53, v53, v11
    v_mul_f32 v54, v54, v11
    v_mul_f32 v55, v55, v11
    v_mul_f32 v56, v56, v11
    v_mul_f32 v57, v57, v11
    v_mul_f32 v58, v58, v11
    v_mul_f32 v59, v59, v11
    v_mul_f32 v60, v60, v11
    v_mul_f32 v61, v61, v11
    v_mul_f32 v62, v62, v11
    v_mul_f32 v63, v63, v11
    v_mul_f32 v64, v64, v11
    v_mul_f32 v65, v65, v11
    v_mul_f32 v66, v66, v11
    v_mul_f32 v67, v67, v11
    v_mul_f32 v68, v68, v11
    v_mul_f32 v69, v69, v11
    v_mul_f32 v70, v70, v11
    v_mul_f32 v71, v71, v11
    v_mul_f32 v72, v72, v11
    v_mul_f32 v73, v73, v11
    v_mul_f32 v74, v74, v11
    v_mul_f32 v75, v75, v11
    v_mul_f32 v76, v76, v11
    v_mul_f32 v77, v77, v11
    v_mul_f32 v78, v78, v11
    v_mul_f32 v79, v79, v11
    v_mul_f32 v80, v80, v11
    v_mul_f32 v81, v81, v11
    v_mul_f32 v82, v82, v11
    v_mul_f32 v83, v83, v11
    v_mul_f32 v84, v84, v11
    v_mul_f32 v85, v85, v11
    v_mul_f32 v86, v86, v11
    v_mul_f32 v87, v87, v11
    v_mul_f32 v88, v88, v11
    v_mul_f32 v89, v89, v11
    v_mul_f32 v90, v90, v11
    v_mul_f32 v91, v91, v11
    v_mul_f32 v92, v92, v11
    v_mul_f32 v93, v93, v11
    v_mul_f32 v94, v94, v11
    v_mul_f32 v95, v95, v11
    s_nop 1
    v_mfma_f32_32x32x16_bf16 v[32:47], v[224:227], v[128:131], v[32:47]
    v_mfma_f32_32x32x16_bf16 v[48:63], v[228:231], v[128:131], v[48:63]
    v_mfma_f32_32x32x16_bf16 v[64:79], v[232:235], v[128:131], v[64:79]
    v_mfma_f32_32x32x16_bf16 v[80:95], v[236:239], v[128:131], v[80:95]
    v_mfma_f32_32x32x16_bf16 v[32:47], v[240:243], v[132:135], v[32:47]
    v_mfma_f32_32x32x16_bf16 v[48:63], v[244:247], v[132:135], v[48:63]
    v_mfma_f32_32x32x16_bf16 v[64:79], v[248:251], v[132:135], v[64:79]
    v_mfma_f32_32x32x16_bf16 v[80:95], v[252:255], v[132:135], v[80:95]
    s_nop 7
    s_nop 7
    s_add_u32 s56, s56, 16384
    s_add_u32 s55, s55, 1
    s_cmp_le_u32 s55, s42
    s_cbranch_scc1 fl_30
    v_mov_b32 v10, v6
    v_mov_b32 v11, v6
    s_nop 1
    v_permlane32_swap_b32 v10, v11
    s_nop 1
    v_add_f32 v6, v10, v11
    s_branch attn_kernel_fin
attn_kernel_end:
    s_endpgm
.section .rodata,"a"
.p2align 6
.amdhsa_kernel attn_kernel
  .amdhsa_next_free_vgpr 256
  .amdhsa_next_free_sgpr 102
  .amdhsa_accum_offset 256
  .amdhsa_group_segment_fixed_size 0
  .amdhsa_kernarg_size 112
  .amdhsa_user_sgpr_count 2
  .amdhsa_user_sgpr_kernarg_segment_ptr 1
  .amdhsa_system_sgpr_workgroup_id_x 1
.end_amdhsa_kernel
.text
.globl tail_kernel
.p2align 8
.type tail_kernel,@function
tail_kernel:
    s_cmp_ge_u32 s2, 256
    s_cbranch_scc1 tail_kernel_end
    s_load_dwordx2 s[4:5], s[0:1], 40
    s_load_dwordx2 s[10:11], s[0:1], 104
    s_load_dwordx2 s[6:7], s[0:1], 56
    s_load_dwordx2 s[8:9], s[0:1], 64
    s_load_dwordx2 s[12:13], s[0:1], 88
    s_load_dwordx2 s[56:57], s[0:1], 0
    v_lshrrev_b32 v1, 6, v0
    s_nop 0
    v_readfirstlane_b32 s16, v1
    v_and_b32 v1, 63, v0
    v_lshlrev_b32 v2, 4, v1
    s_waitcnt lgkmcnt(0)
    s_mov_b32 s24, s4
    s_and_b32 s25, s5, 0xffff
    s_mov_b32 s26, 4194304
    s_mov_b32 s27, 0x20000
    s_mov_b32 s32, s10
    s_and_b32 s33, s11, 0xffff
    s_mov_b32 s34, 268435456
    s_mov_b32 s35, 0x20000
    s_and_b32 s15, s2, 3
    s_bfe_u32 s14, s2, 0x10002
    s_lshl_b32 s14, s14, 3
    s_bfe_u32 s17, s2, 0x30003
    s_add_u32 s14, s14, s17
    s_lshr_b32 s17, s2, 6
    s_lshl_b32 s20, s15, 20
    s_lshl_b32 s18, s17, 8
    s_add_u32 s20, s20, s18
    s_lshl_b32 s22, s14, 2
    s_add_u32 s22, s22, s16
    s_lshl_b32 s21, s22, 18
    s_lshl_b32 s18, s15, 16
    s_add_u32 s21, s21, s18
    s_add_u32 s21, s21, 50331648
    v_lshrrev_b32 v6, 4, v1
    v_and_b32 v5, 15, v1
    v_lshlrev_b32 v7, 2, v6
    v_xor_b32 v5, v5, v7
    v_lshlrev_b32 v5, 4, v5
    s_mul_i32 s18, s16, 32
    v_add_u32 v7, s18, v6
    s_mov_b32 s18, 1024
    v_mul_lo_u32 v7, v7, s18
    v_add_u32 v10, v7, v5
    v_add_u32 v11, 3072, v10
    v_add_u32 v12, 6144, v10
    v_add_u32 v13, 9216, v10
    s_mul_i32 s18, s16, 8192
    s_add_u32 s19, s20, 0
    s_add_u32 m0, s18, 0
    s_nop 0
    buffer_load_dwordx4 v10, s[24:27], s19 offen offset:0 lds
    buffer_load_dwordx4 v11, s[24:27], s19 offen offset:1024 lds
    buffer_load_dwordx4 v12, s[24:27], s19 offen offset:2048 lds
    buffer_load_dwordx4 v13, s[24:27], s19 offen offset:3072 lds
    s_mul_i32 s18, s16, 8192
    s_add_u32 s19, s20, 16384
    s_add_u32 m0, s18, 4096
    s_nop 0
    buffer_load_dwordx4 v10, s[24:27], s19 offen offset:0 lds
    buffer_load_dwordx4 v11, s[24:27], s19 offen offset:1024 lds
    buffer_load_dwordx4 v12, s[24:27], s19 offen offset:2048 lds
    buffer_load_dwordx4 v13, s[24:27], s19 offen offset:3072 lds
    s_add_u32 s47, s21, 0
    buffer_load_dwordx4 a[0:3], v2, s[32:35], s47 offen offset:0
    s_add_u32 s47, s21, 0
    buffer_load_dwordx4 a[4:7], v2, s[32:35], s47 offen offset:1024
    s_add_u32 s47, s21, 0
    buffer_load_dwordx4 a[8:11], v2, s[32:35], s47 offen offset:2048
    s_add_u32 s47, s21, 0
    buffer_load_dwordx4 a[12:15], v2, s[32:35], s47 offen offset:3072
    s_add_u32 s47, s21, 4096
    buffer_load_dwordx4 a[16:19], v2, s[32:35], s47 offen offset:0
    s_add_u32 s47, s21, 4096
    buffer_load_dwordx4 a[20:23], v2, s[32:35], s47 offen offset:1024
    s_add_u32 s47, s21, 4096
    buffer_load_dwordx4 a[24:27], v2, s[32:35], s47 offen offset:2048
    s_add_u32 s47, s21, 4096
    buffer_load_dwordx4 a[28:31], v2, s[32:35], s47 offen offset:3072
    s_mul_i32 s18, s16, 8192
    s_add_u32 s19, s20, 131072
    s_add_u32 m0, s18, 32768
    s_nop 0
    buffer_load_dwordx4 v10, s[24:27], s19 offen offset:0 lds
    buffer_load_dwordx4 v11, s[24:27], s19 offen offset:1024 lds
    buffer_load_dwordx4 v12, s[24:27], s19 offen offset:2048 lds
    buffer_load_dwordx4 v13, s[24:27], s19 offen offset:3072 lds
    s_mul_i32 s18, s16, 8192
    s_add_u32 s19, s20, 147456
    s_add_u32 m0, s18, 36864
    s_nop 0
    buffer_load_dwordx4 v10, s[24:27], s19 offen offset:0 lds
    buffer_load_dwordx4 v11, s[24:27], s19 offen offset:1024 lds
    buffer_load_dwordx4 v12, s[24:27], s19 offen offset:2048 lds
    buffer_load_dwordx4 v13, s[24:27], s19 offen offset:3072 lds
    v_lshrrev_b32 v4, 4, v1
    v_bfe_u32 v5, v1, 2, 2
    v_and_b32 v6, 3, v1
    v_lshrrev_b32 v7, 1, v4
    v_lshlrev_b32 v7, 2, v7
    v_add_u32 v7, v7, v5
    v_mul_u32_u24 v7, 256, v7
    v_and_b32 v8, 1, v4
    v_lshlrev_b32 v8, 1, v8
    v_lshrrev_b32 v9, 1, v6
    v_add_u32 v8, v8, v9
    v_lshlrev_b32 v8, 4, v8
    v_and_b32 v9, 1, v6
    v_lshlrev_b32 v9, 3, v9
    v_add_u32 v8, v8, v9
    v_add_u32 v7, v7, v8
    v_xor_b32 v8, 0, v5
    v_lshlrev_b32 v8, 6, v8
    v_add_u32 v16, v7, v8
    v_add_u32 v20, 65536, v16
    v_xor_b32 v8, 1, v5
    v_lshlrev_b32 v8, 6, v8
    v_add_u32 v17, v7, v8
    v_add_u32 v21, 65536, v17
    v_xor_b32 v8, 2, v5
    v_lshlrev_b32 v8, 6, v8
    v_add_u32 v18, v7, v8
    v_add_u32 v22, 65536, v18
    v_xor_b32 v8, 3, v5
    v_lshlrev_b32 v8, 6, v8
    v_add_u32 v19, v7, v8
    v_add_u32 v23, 65536, v19
    s_waitcnt vmcnt(16)
    s_barrier
    ds_read_b64_tr_b16 v[32:33], v16 offset:0
    ds_read_b64_tr_b16 v[34:35], v16 offset:2048
    ds_read_b64_tr_b16 v[36:37], v17 offset:0
    ds_read_b64_tr_b16 v[38:39], v17 offset:2048
    ds_read_b64_tr_b16 v[40:41], v18 offset:0
    ds_read_b64_tr_b16 v[42:43], v18 offset:2048
    ds_read_b64_tr_b16 v[44:45], v19 offset:0
    ds_read_b64_tr_b16 v[46:47], v19 offset:2048
    ds_read_b64_tr_b16 v[48:49], v16 offset:4096
    ds_read_b64_tr_b16 v[50:51], v16 offset:6144
    ds_read_b64_tr_b16 v[52:53], v17 offset:4096
    ds_read_b64_tr_b16 v[54:55], v17 offset:6144
    ds_read_b64_tr_b16 v[56:57], v18 offset:4096
    ds_read_b64_tr_b16 v[58:59], v18 offset:6144
    ds_read_b64_tr_b16 v[60:61], v19 offset:4096
    ds_read_b64_tr_b16 v[62:63], v19 offset:6144
    s_waitcnt vmcnt(15)
    s_waitcnt lgkmcnt(14)
    v_mfma_f32_32x32x16_bf16 v[128:143], v[32:35], a[0:3], 0
    ds_read_b64_tr_b16 v[64:65], v16 offset:8192
    ds_read_b64_tr_b16 v[66:67], v16 offset:10240
    s_add_u32 s47, s21, 8192
    buffer_load_dwordx4 a[32:35], v2, s[32:35], s47 offen offset:0
    s_add_u32 s47, s21, 8192
    buffer_load_dwordx4 a[36:39], v2, s[32:35], s47 offen offset:1024
    s_waitcnt lgkmcnt(14)
    v_mfma_f32_32x32x16_bf16 v[144:159], v[36:39], a[0:3], 0
    ds_read_b64_tr_b16 v[68:69], v17 offset:8192
    ds_read_b64_tr_b16 v[70:71], v17 offset:10240
    s_waitcnt lgkmcnt(14)
    v_mfma_f32_32x32x16_bf16 v[160:175], v[40:43], a[0:3], 0
    ds_read_b64_tr_b16 v[72:73], v18 offset:8192
    ds_read_b64_tr_b16 v[74:75], v18 offset:10240
    s_add_u32 s47, s21, 8192
    buffer_load_dwordx4 a[40:43], v2, s[32:35], s47 offen offset:2048
    s_add_u32 s47, s21, 8192
    buffer_load_dwordx4 a[44:47], v2, s[32:35], s47 offen offset:3072
    s_waitcnt lgkmcnt(14)
    v_mfma_f32_32x32x16_bf16 v[176:191], v[44:47], a[0:3], 0
    ds_read_b64_tr_b16 v[76:77], v19 offset:8192
    ds_read_b64_tr_b16 v[78:79], v19 offset:10240
    s_mul_i32 s18, s16, 8192
    s_add_u32 s19, s20, 262144
    s_add_u32 m0, s18, 65536
    s_nop 0
    buffer_load_dwordx4 v10, s[24:27], s19 offen offset:0 lds
    buffer_load_dwordx4 v11, s[24:27], s19 offen offset:1024 lds
    s_waitcnt vmcnt(20)
    s_waitcnt lgkmcnt(14)
    v_mfma_f32_32x32x16_bf16 v[128:143], v[48:51], a[4:7], v[128:143]
    ds_read_b64_tr_b16 v[32:33], v16 offset:12288
    ds_read_b64_tr_b16 v[34:35], v16 offset:14336
    s_add_u32 s47, s21, 12288
    buffer_load_dwordx4 a[48:51], v2, s[32:35], s47 offen offset:0
    s_add_u32 s47, s21, 12288
    buffer_load_dwordx4 a[52:55], v2, s[32:35], s47 offen offset:1024
    s_waitcnt lgkmcnt(14)
    v_mfma_f32_32x32x16_bf16 v[144:159], v[52:55], a[4:7], v[144:159]
    ds_read_b64_tr_b16 v[36:37], v17 offset:12288
    ds_read_b64_tr_b16 v[38:39], v17 offset:14336
    s_waitcnt lgkmcnt(14)
    v_mfma_f32_32x32x16_bf16 v[160:175], v[56:59], a[4:7], v[160:175]
    ds_read_b64_tr_b16 v[40:41], v18 offset:12288
    ds_read_b64_tr_b16 v[42:43], v18 offset:14336
    s_add_u32 s47, s21, 12288
    buffer_load_dwordx4 a[56:59], v2, s[32:35], s47 offen offset:2048
    s_add_u32 s47, s21, 12288
    buffer_load_dwordx4 a[60:63], v2, s[32:35], s47 offen offset:3072
    s_waitcnt lgkmcnt(14)
    v_mfma_f32_32x32x16_bf16 v[176:191], v[60:63], a[4:7], v[176:191]
    ds_read_b64_tr_b16 v[44:45], v19 offset:12288
    ds_read_b64_tr_b16 v[46:47], v19 offset:14336
    buffer_load_dwordx4 v12, s[24:27], s19 offen offset:2048 lds
    buffer_load_dwordx4 v13, s[24:27], s19 offen offset:3072 lds
    s_waitcnt vmcnt(25)
    s_waitcnt lgkmcnt(14)
    v_mfma_f32_32x32x16_bf16 v[128:143], v[64:67], a[8:11], v[128:143]
    ds_read_b64_tr_b16 v[48:49], v16 offset:16384
    ds_read_b64_tr_b16 v[50:51], v16 offset:18432
    s_add_u32 s47, s21, 16384
    buffer_load_dwordx4 a[64:67], v2, s[32:35], s47 offen offset:0
    s_add_u32 s47, s21, 16384
    buffer_load_dwordx4 a[68:71], v2, s[32:35], s47 offen offset:1024
    s_waitcnt lgkmcnt(14)
    v_mfma_f32_32x32x16_bf16 v[144:159], v[68:71], a[8:11], v[144:159]
    ds_read_b64_tr_b16 v[52:53], v17 offset:16384
    ds_read_b64_tr_b16 v[54:55], v17 offset:18432
    s_waitcnt lgkmcnt(14)
    v_mfma_f32_32x32x16_bf16 v[160:175], v[72:75], a[8:11], v[160:175]
    ds_read_b64_tr_b16 v[56:57], v18 offset:16384
    ds_read_b64_tr_b16 v[58:59], v18 offset:18432
    s_add_u32 s47, s21, 16384
    buffer_load_dwordx4 a[72:75], v2, s[32:35], s47 offen offset:2048
    s_add_u32 s47, s21, 16384
    buffer_load_dwordx4 a[76:79], v2, s[32:35], s47 offen offset:3072
    s_waitcnt lgkmcnt(14)
    v_mfma_f32_32x32x16_bf16 v[176:191], v[76:79], a[8:11], v[176:191]
    ds_read_b64_tr_b16 v[60:61], v19 offset:16384
    ds_read_b64_tr_b16 v[62:63], v19 offset:18432
    s_mul_i32 s18, s16, 8192
    s_add_u32 s19, s20, 278528
    s_add_u32 m0, s18, 69632
    s_nop 0
    buffer_load_dwordx4 v10, s[24:27], s19 offen offset:0 lds
    buffer_load_dwordx4 v11, s[24:27], s19 offen offset:1024 lds
    s_waitcnt vmcnt(30)
    s_waitcnt lgkmcnt(14)
    v_mfma_f32_32x32x16_bf16 v[128:143], v[32:35], a[12:15], v[128:143]
    ds_read_b64_tr_b16 v[64:65], v16 offset:20480
    ds_read_b64_tr_b16 v[66:67], v16 offset:22528
    s_add_u32 s47, s21, 20480
    buffer_load_dwordx4 a[80:83], v2, s[32:35], s47 offen offset:0
    s_add_u32 s47, s21, 20480
    buffer_load_dwordx4 a[84:87], v2, s[32:35], s47 offen offset:1024
    s_waitcnt lgkmcnt(14)
    v_mfma_f32_32x32x16_bf16 v[144:159], v[36:39], a[12:15], v[144:159]
    ds_read_b64_tr_b16 v[68:69], v17 offset:20480
    ds_read_b64_tr_b16 v[70:71], v17 offset:22528
    s_waitcnt lgkmcnt(14)
    v_mfma_f32_32x32x16_bf16 v[160:175], v[40:43], a[12:15], v[160:175]
    ds_read_b64_tr_b16 v[72:73], v18 offset:20480
    ds_read_b64_tr_b16 v[74:75], v18 offset:22528
    s_add_u32 s47, s21, 20480
    buffer_load_dwordx4 a[88:91], v2, s[32:35], s47 offen offset:2048
    s_add_u32 s47, s21, 20480
    buffer_load_dwordx4 a[92:95], v2, s[32:35], s47 offen offset:3072
    s_waitcnt lgkmcnt(14)
    v_mfma_f32_32x32x16_bf16 v[176:191], v[44:47], a[12:15], v[176:191]
    ds_read_b64_tr_b16 v[76:77], v19 offset:20480
    ds_read_b64_tr_b16 v[78:79], v19 offset:22528
    buffer_load_dwordx4 v12, s[24:27], s19 offen offset:2048 lds
    buffer_load_dwordx4 v13, s[24:27], s19 offen offset:3072 lds
    s_waitcnt vmcnt(35)
    s_waitcnt lgkmcnt(14)
    v_mfma_f32_32x32x16_bf16 v[128:143], v[48:51], a[16:19], v[128:143]
    ds_read_b64_tr_b16 v[32:33], v16 offset:24576
    ds_read_b64_tr_b16 v[34:35], v16 offset:26624
    s_add_u32 s47, s21, 24576
    buffer_load_dwordx4 a[96:99], v2, s[32:35], s47 offen offset:0
    s_add_u32 s47, s21, 24576
    buffer_load_dwordx4 a[100:103], v2, s[32:35], s47 offen offset:1024
    s_waitcnt lgkmcnt(14)
    v_mfma_f32_32x32x16_bf16 v[144:159], v[52:55], a[16:19], v[144:159]
    ds_read_b64_tr_b16 v[36:37], v17 offset:24576
    ds_read_b64_tr_b16 v[38:39], v17 offset:26624
    s_waitcnt lgkmcnt(14)
    v_mfma_f32_32x32x16_bf16 v[160:175], v[56:59], a[16:19], v[160:175]
    ds_read_b64_tr_b16 v[40:41], v18 offset:24576
    ds_read_b64_tr_b16 v[42:43], v18 offset:26624
    s_add_u32 s47, s21, 24576
    buffer_load_dwordx4 a[104:107], v2, s[32:35], s47 offen offset:2048
    s_add_u32 s47, s21, 24576
    buffer_load_dwordx4 a[108:111], v2, s[32:35], s47 offen offset:3072
    s_waitcnt lgkmcnt(14)
    v_mfma_f32_32x32x16_bf16 v[176:191], v[60:63], a[16:19], v[176:191]
    ds_read_b64_tr_b16 v[44:45], v19 offset:24576
    ds_read_b64_tr_b16 v[46:47], v19 offset:26624
    s_mul_i32 s18, s16, 8192
    s_add_u32 s19, s20, 393216
    s_add_u32 m0, s18, 98304
    s_nop 0
    buffer_load_dwordx4 v10, s[24:27], s19 offen offset:0 lds
    buffer_load_dwordx4 v11, s[24:27], s19 offen offset:1024 lds
    s_waitcnt vmcnt(40)
    s_waitcnt lgkmcnt(14)
    v_mfma_f32_32x32x16_bf16 v[128:143], v[64:67], a[20:23], v[128:143]
    ds_read_b64_tr_b16 v[48:49], v16 offset:28672
    ds_read_b64_tr_b16 v[50:51], v16 offset:30720
    s_add_u32 s47, s21, 28672
    buffer_load_dwordx4 a[112:115], v2, s[32:35], s47 offen offset:0
    s_add_u32 s47, s21, 28672
    buffer_load_dwordx4 a[116:119], v2, s[32:35], s47 offen offset:1024
    s_waitcnt lgkmcnt(14)
    v_mfma_f32_32x32x16_bf16 v[144:159], v[68:71], a[20:23], v[144:159]
    ds_read_b64_tr_b16 v[52:53], v17 offset:28672
    ds_read_b64_tr_b16 v[54:55], v17 offset:30720
    s_waitcnt lgkmcnt(14)
    v_mfma_f32_32x32x16_bf16 v[160:175], v[72:75], a[20:23], v[160:175]
    ds_read_b64_tr_b16 v[56:57], v18 offset:28672
    ds_read_b64_tr_b16 v[58:59], v18 offset:30720
    s_add_u32 s47, s21, 28672
    buffer_load_dwordx4 a[120:123], v2, s[32:35], s47 offen offset:2048
    s_add_u32 s47, s21, 28672
    buffer_load_dwordx4 a[124:127], v2, s[32:35], s47 offen offset:3072
    s_waitcnt lgkmcnt(14)
    v_mfma_f32_32x32x16_bf16 v[176:191], v[76:79], a[20:23], v[176:191]
    ds_read_b64_tr_b16 v[60:61], v19 offset:28672
    ds_read_b64_tr_b16 v[62:63], v19 offset:30720
    buffer_load_dwordx4 v12, s[24:27], s19 offen offset:2048 lds
    buffer_load_dwordx4 v13, s[24:27], s19 offen offset:3072 lds
    s_waitcnt vmcnt(36)
    s_barrier
    s_waitcnt lgkmcnt(14)
    v_mfma_f32_32x32x16_bf16 v[128:143], v[32:35], a[24:27], v[128:143]
    ds_read_b64_tr_b16 v[64:65], v16 offset:32768
    ds_read_b64_tr_b16 v[66:67], v16 offset:34816
    s_add_u32 s47, s21, 32768
    buffer_load_dwordx4 a[0:3], v2, s[32:35], s47 offen offset:0
    s_waitcnt lgkmcnt(14)
    v_mfma_f32_32x32x16_bf16 v[144:159], v[36:39], a[24:27], v[144:159]
    ds_read_b64_tr_b16 v[68:69], v17 offset:32768
    ds_read_b64_tr_b16 v[70:71], v17 offset:34816
    s_waitcnt lgkmcnt(14)
    v_mfma_f32_32x32x16_bf16 v[160:175], v[40:43], a[24:27], v[160:175]
    ds_read_b64_tr_b16 v[72:73], v18 offset:32768
    ds_read_b64_tr_b16 v[74:75], v18 offset:34816
    s_add_u32 s47, s21, 32768
    buffer_load_dwordx4 a[4:7], v2, s[32:35], s47 offen offset:1024
    s_waitcnt lgkmcnt(14)
    v_mfma_f32_32x32x16_bf16 v[176:191], v[44:47], a[24:27], v[176:191]
    ds_read_b64_tr_b16 v[76:77], v19 offset:32768
    ds_read_b64_tr_b16 v[78:79], v19 offset:34816
    s_mul_i32 s18, s16, 8192
    s_add_u32 s19, s20, 409600
    s_add_u32 m0, s18, 102400
    s_nop 0
    buffer_load_dwordx4 v10, s[24:27], s19 offen offset:0 lds
    buffer_load_dwordx4 v11, s[24:27], s19 offen offset:1024 lds
    s_waitcnt lgkmcnt(14)
    v_mfma_f32_32x32x16_bf16 v[128:143], v[48:51], a[28:31], v[128:143]
    ds_read_b64_tr_b16 v[32:33], v16 offset:36864
    ds_read_b64_tr_b16 v[34:35], v16 offset:38912
    s_add_u32 s47, s21, 32768
    buffer_load_dwordx4 a[8:11], v2, s[32:35], s47 offen offset:2048
    s_waitcnt lgkmcnt(14)
    v_mfma_f32_32x32x16_bf16 v[144:159], v[52:55], a[28:31], v[144:159]
    ds_read_b64_tr_b16 v[36:37], v17 offset:36864
    ds_read_b64_tr_b16 v[38:39], v17 offset:38912
    s_waitcnt lgkmcnt(14)
    v_mfma_f32_32x32x16_bf16 v[160:175], v[56:59], a[28:31], v[160:175]
    ds_read_b64_tr_b16 v[40:41], v18 offset:36864
    ds_read_b64_tr_b16 v[42:43], v18 offset:38912
    s_add_u32 s47, s21, 32768
    buffer_load_dwordx4 a[12:15], v2, s[32:35], s47 offen offset:3072
    s_waitcnt lgkmcnt(14)
    v_mfma_f32_32x32x16_bf16 v[176:191], v[60:63], a[28:31], v[176:191]
    ds_read_b64_tr_b16 v[44:45], v19 offset:36864
    ds_read_b64_tr_b16 v[46:47], v19 offset:38912
    buffer_load_dwordx4 v12, s[24:27], s19 offen offset:2048 lds
    buffer_load_dwordx4 v13, s[24:27], s19 offen offset:3072 lds
    s_waitcnt vmcnt(43)
    s_waitcnt lgkmcnt(14)
    v_mfma_f32_32x32x16_bf16 v[128:143], v[64:67], a[32:35], v[128:143]
    ds_read_b64_tr_b16 v[48:49], v16 offset:40960
    ds_read_b64_tr_b16 v[50:51], v16 offset:43008
    s_add_u32 s47, s21, 36864
    buffer_load_dwordx4 a[16:19], v2, s[32:35], s47 offen offset:0
    s_waitcnt lgkmcnt(14)
    v_mfma_f32_32x32x16_bf16 v[144:159], v[68:71], a[32:35], v[144:159]
    ds_read_b64_tr_b16 v[52:53], v17 offset:40960
    ds_read_b64_tr_b16 v[54:55], v17 offset:43008
    s_waitcnt lgkmcnt(14)
    v_mfma_f32_32x32x16_bf16 v[160:175], v[72:75], a[32:35], v[160:175]
    ds_read_b64_tr_b16 v[56:57], v18 offset:40960
    ds_read_b64_tr_b16 v[58:59], v18 offset:43008
    s_add_u32 s47, s21, 36864
    buffer_load_dwordx4 a[20:23], v2, s[32:35], s47 offen offset:1024
    s_waitcnt lgkmcnt(14)
    v_mfma_f32_32x32x16_bf16 v[176:191], v[76:79], a[32:35], v[176:191]
    ds_read_b64_tr_b16 v[60:61], v19 offset:40960
    ds_read_b64_tr_b16 v[62:63], v19 offset:43008
    s_waitcnt vmcnt(44)
    s_waitcnt lgkmcnt(14)
    v_mfma_f32_32x32x16_bf16 v[128:143], v[32:35], a[36:39], v[128:143]
    ds_read_b64_tr_b16 v[64:65], v16 offset:45056
    ds_read_b64_tr_b16 v[66:67], v16 offset:47104
    s_add_u32 s47, s21, 36864
    buffer_load_dwordx4 a[24:27], v2, s[32:35], s47 offen offset:2048
    s_waitcnt lgkmcnt(14)
    v_mfma_f32_32x32x16_bf16 v[144:159], v[36:39], a[36:39], v[144:159]
    ds_read_b64_tr_b16 v[68:69], v17 offset:45056
    ds_read_b64_tr_b16 v[70:71], v17 offset:47104
    s_waitcnt lgkmcnt(14)
    v_mfma_f32_32x32x16_bf16 v[160:175], v[40:43], a[36:39], v[160:175]
    ds_read_b64_tr_b16 v[72:73], v18 offset:45056
    ds_read_b64_tr_b16 v[74:75], v18 offset:47104
    s_add_u32 s47, s21, 36864
    buffer_load_dwordx4 a[28:31], v2, s[32:35], s47 offen offset:3072
    s_waitcnt lgkmcnt(14)
    v_mfma_f32_32x32x16_bf16 v[176:191], v[44:47], a[36:39], v[176:191]
    ds_read_b64_tr_b16 v[76:77], v19 offset:45056
    ds_read_b64_tr_b16 v[78:79], v19 offset:47104
    s_waitcnt vmcnt(45)
    s_waitcnt lgkmcnt(14)
    v_mfma_f32_32x32x16_bf16 v[128:143], v[48:51], a[40:43], v[128:143]
    ds_read_b64_tr_b16 v[32:33], v16 offset:49152
    ds_read_b64_tr_b16 v[34:35], v16 offset:51200
    s_add_u32 s47, s21, 40960
    buffer_load_dwordx4 a[32:35], v2, s[32:35], s47 offen offset:0
    s_waitcnt lgkmcnt(14)
    v_mfma_f32_32x32x16_bf16 v[144:159], v[52:55], a[40:43], v[144:159]
    ds_read_b64_tr_b16 v[36:37], v17 offset:49152
    ds_read_b64_tr_b16 v[38:39], v17 offset:51200
    s_waitcnt lgkmcnt(14)
    v_mfma_f32_32x32x16_bf16 v[160:175], v[56:59], a[40:43], v[160:175]
    ds_read_b64_tr_b16 v[40:41], v18 offset:49152
    ds_read_b64_tr_b16 v[42:43], v18 offset:51200
    s_add_u32 s47, s21, 40960
    buffer_load_dwordx4 a[36:39], v2, s[32:35], s47 offen offset:1024
    s_waitcnt lgkmcnt(14)
    v_mfma_f32_32x32x16_bf16 v[176:191], v[60:63], a[40:43], v[176:191]
    ds_read_b64_tr_b16 v[44:45], v19 offset:49152
    ds_read_b64_tr_b16 v[46:47], v19 offset:51200
    s_waitcnt vmcnt(46)
    s_waitcnt lgkmcnt(14)
    v_mfma_f32_32x32x16_bf16 v[128:143], v[64:67], a[44:47], v[128:143]
    ds_read_b64_tr_b16 v[48:49], v16 offset:53248
    ds_read_b64_tr_b16 v[50:51], v16 offset:55296
    s_add_u32 s47, s21, 40960
    buffer_load_dwordx4 a[40:43], v2, s[32:35], s47 offen offset:2048
    s_waitcnt lgkmcnt(14)
    v_mfma_f32_32x32x16_bf16 v[144:159], v[68:71], a[44:47], v[144:159]
    ds_read_b64_tr_b16 v[52:53], v17 offset:53248
    ds_read_b64_tr_b16 v[54:55], v17 offset:55296
    s_waitcnt lgkmcnt(14)
    v_mfma_f32_32x32x16_bf16 v[160:175], v[72:75], a[44:47], v[160:175]
    ds_read_b64_tr_b16 v[56:57], v18 offset:53248
    ds_read_b64_tr_b16 v[58:59], v18 offset:55296
    s_waitcnt lgkmcnt(14)
    v_mfma_f32_32x32x16_bf16 v[176:191], v[76:79], a[44:47], v[176:191]
    ds_read_b64_tr_b16 v[60:61], v19 offset:53248
    ds_read_b64_tr_b16 v[62:63], v19 offset:55296
    s_waitcnt vmcnt(44)
    s_waitcnt lgkmcnt(14)
    v_mfma_f32_32x32x16_bf16 v[128:143], v[32:35], a[48:51], v[128:143]
    ds_read_b64_tr_b16 v[64:65], v16 offset:57344
    ds_read_b64_tr_b16 v[66:67], v16 offset:59392
    s_add_u32 s47, s21, 40960
    buffer_load_dwordx4 a[44:47], v2, s[32:35], s47 offen offset:3072
    s_waitcnt lgkmcnt(14)
    v_mfma_f32_32x32x16_bf16 v[144:159], v[36:39], a[48:51], v[144:159]
    ds_read_b64_tr_b16 v[68:69], v17 offset:57344
    ds_read_b64_tr_b16 v[70:71], v17 offset:59392
    s_waitcnt lgkmcnt(14)
    v_mfma_f32_32x32x16_bf16 v[160:175], v[40:43], a[48:51], v[160:175]
    ds_read_b64_tr_b16 v[72:73], v18 offset:57344
    ds_read_b64_tr_b16 v[74:75], v18 offset:59392
    s_waitcnt lgkmcnt(14)
    v_mfma_f32_32x32x16_bf16 v[176:191], v[44:47], a[48:51], v[176:191]
    ds_read_b64_tr_b16 v[76:77], v19 offset:57344
    ds_read_b64_tr_b16 v[78:79], v19 offset:59392
    s_waitcnt vmcnt(44)
    s_waitcnt lgkmcnt(14)
    v_mfma_f32_32x32x16_bf16 v[128:143], v[48:51], a[52:55], v[128:143]
    ds_read_b64_tr_b16 v[32:33], v16 offset:61440
    ds_read_b64_tr_b16 v[34:35], v16 offset:63488
    s_add_u32 s47, s21, 45056
    buffer_load_dwordx4 a[48:51], v2, s[32:35], s47 offen offset:0
    s_waitcnt lgkmcnt(14)
    v_mfma_f32_32x32x16_bf16 v[144:159], v[52:55], a[52:55], v[144:159]
    ds_read_b64_tr_b16 v[36:37], v17 offset:61440
    ds_read_b64_tr_b16 v[38:39], v17 offset:63488
    s_waitcnt lgkmcnt(14)
    v_mfma_f32_32x32x16_bf16 v[160:175], v[56:59], a[52:55], v[160:175]
    ds_read_b64_tr_b16 v[40:41], v18 offset:61440
    ds_read_b64_tr_b16 v[42:43], v18 offset:63488
    s_waitcnt lgkmcnt(14)
    v_mfma_f32_32x32x16_bf16 v[176:191], v[60:63], a[52:55], v[176:191]
    ds_read_b64_tr_b16 v[44:45], v19 offset:61440
    ds_read_b64_tr_b16 v[46:47], v19 offset:63488
    s_waitcnt vmcnt(29)
    s_barrier
    s_waitcnt lgkmcnt(14)
    v_mfma_f32_32x32x16_bf16 v[128:143], v[64:67], a[56:59], v[128:143]
    ds_read_b64_tr_b16 v[48:49], v20 offset:0
    ds_read_b64_tr_b16 v[50:51], v20 offset:2048
    s_add_u32 s47, s21, 45056
    buffer_load_dwordx4 a[52:55], v2, s[32:35], s47 offen offset:1024
    s_waitcnt lgkmcnt(14)
    v_mfma_f32_32x32x16_bf16 v[144:159], v[68:71], a[56:59], v[144:159]
    ds_read_b64_tr_b16 v[52:53], v21 offset:0
    ds_read_b64_tr_b16 v[54:55], v21 offset:2048
    s_waitcnt lgkmcnt(14)
    v_mfma_f32_32x32x16_bf16 v[160:175], v[72:75], a[56:59], v[160:175]
    ds_read_b64_tr_b16 v[56:57], v22 offset:0
    ds_read_b64_tr_b16 v[58:59], v22 offset:2048
    s_waitcnt lgkmcnt(14)
    v_mfma_f32_32x32x16_bf16 v[176:191], v[76:79], a[56:59], v[176:191]
    ds_read_b64_tr_b16 v[60:61], v23 offset:0
    ds_read_b64_tr_b16 v[62:63], v23 offset:2048
    s_mul_i32 s18, s16, 8192
    s_add_u32 s19, s20, 524288
    s_add_u32 m0, s18, 0
    s_nop 0
    buffer_load_dwordx4 v10, s[24:27], s19 offen offset:0 lds
    buffer_load_dwordx4 v11, s[24:27], s19 offen offset:1024 lds
    s_waitcnt lgkmcnt(14)
    v_mfma_f32_32x32x16_bf16 v[128:143], v[32:35], a[60:63], v[128:143]
    ds_read_b64_tr_b16 v[64:65], v20 offset:4096
    ds_read_b64_tr_b16 v[66:67], v20 offset:6144
    s_add_u32 s47, s21, 45056
    buffer_load_dwordx4 a[56:59], v2, s[32:35], s47 offen offset:2048
    s_waitcnt lgkmcnt(14)
    v_mfma_f32_32x32x16_bf16 v[144:159], v[36:39], a[60:63], v[144:159]
    ds_read_b64_tr_b16 v[68:69], v21 offset:4096
    ds_read_b64_tr_b16 v[70:71], v21 offset:6144
    s_waitcnt lgkmcnt(14)
    v_mfma_f32_32x32x16_bf16 v[160:175], v[40:43], a[60:63], v[160:175]
    ds_read_b64_tr_b16 v[72:73], v22 offset:4096
    ds_read_b64_tr_b16 v[74:75], v22 offset:6144
    s_waitcnt lgkmcnt(14)
    v_mfma_f32_32x32x16_bf16 v[176:191], v[44:47], a[60:63], v[176:191]
    ds_read_b64_tr_b16 v[76:77], v23 offset:4096
    ds_read_b64_tr_b16 v[78:79], v23 offset:6144
    buffer_load_dwordx4 v12, s[24:27], s19 offen offset:2048 lds
    buffer_load_dwordx4 v13, s[24:27], s19 offen offset:3072 lds
    s_waitcnt lgkmcnt(14)
    v_mfma_f32_32x32x16_bf16 v[128:143], v[48:51], a[64:67], v[128:143]
    ds_read_b64_tr_b16 v[32:33], v20 offset:8192
    ds_read_b64_tr_b16 v[34:35], v20 offset:10240
    s_add_u32 s47, s21, 45056
    buffer_load_dwordx4 a[60:63], v2, s[32:35], s47 offen offset:3072
    s_waitcnt lgkmcnt(14)
    v_mfma_f32_32x32x16_bf16 v[144:159], v[52:55], a[64:67], v[144:159]
    ds_read_b64_tr_b16 v[36:37], v21 offset:8192
    ds_read_b64_tr_b16 v[38:39], v21 offset:10240
    s_waitcnt lgkmcnt(14)
    v_mfma_f32_32x32x16_bf16 v[160:175], v[56:59], a[64:67], v[160:175]
    ds_read_b64_tr_b16 v[40:41], v22 offset:8192
    ds_read_b64_tr_b16 v[42:43], v22 offset:10240
    s_waitcnt lgkmcnt(14)
    v_mfma_f32_32x32x16_bf16 v[176:191], v[60:63], a[64:67], v[176:191]
    ds_read_b64_tr_b16 v[44:45], v23 offset:8192
    ds_read_b64_tr_b16 v[46:47], v23 offset:10240
    s_mul_i32 s18, s16, 8192
    s_add_u32 s19, s20, 540672
    s_add_u32 m0, s18, 4096
    s_nop 0
    buffer_load_dwordx4 v10, s[24:27], s19 offen offset:0 lds
    buffer_load_dwordx4 v11, s[24:27], s19 offen offset:1024 lds
    s_waitcnt lgkmcnt(14)
    v_mfma_f32_32x32x16_bf16 v[128:143], v[64:67], a[68:71], v[128:143]
    ds_read_b64_tr_b16 v[48:49], v20 offset:12288
    ds_read_b64_tr_b16 v[50:51], v20 offset:14336
    s_add_u32 s47, s21, 49152
    buffer_load_dwordx4 a[64:67], v2, s[32:35], s47 offen offset:0
    s_waitcnt lgkmcnt(14)
    v_mfma_f32_32x32x16_bf16 v[144:159], v[68:71], a[68:71], v[144:159]
    ds_read_b64_tr_b16 v[52:53], v21 offset:12288
    ds_read_b64_tr_b16 v[54:55], v21 offset:14336
    s_waitcnt lgkmcnt(14)
    v_mfma_f32_32x32x16_bf16 v[160:175], v[72:75], a[68:71], v[160:175]
    ds_read_b64_tr_b16 v[56:57], v22 offset:12288
    ds_read_b64_tr_b16 v[58:59], v22 offset:14336
    s_waitcnt lgkmcnt(14)
    v_mfma_f32_32x32x16_bf16 v[176:191], v[76:79], a[68:71], v[176:191]
    ds_read_b64_tr_b16 v[60:61], v23 offset:12288
    ds_read_b64_tr_b16 v[62:63], v23 offset:14336
    buffer_load_dwordx4 v12, s[24:27], s19 offen offset:2048 lds
    buffer_load_dwordx4 v13, s[24:27], s19 offen offset:3072 lds
    s_waitcnt lgkmcnt(14)
    v_mfma_f32_32x32x16_bf16 v[128:143], v[32:35], a[72:75], v[128:143]
    ds_read_b64_tr_b16 v[64:65], v20 offset:16384
    ds_read_b64_tr_b16 v[66:67], v20 offset:18432
    s_add_u32 s47, s21, 49152
    buffer_load_dwordx4 a[68:71], v2, s[32:35], s47 offen offset:1024
    s_waitcnt lgkmcnt(14)
    v_mfma_f32_32x32x16_bf16 v[144:159], v[36:39], a[72:75], v[144:159]
    ds_read_b64_tr_b16 v[68:69], v21 offset:16384
    ds_read_b64_tr_b16 v[70:71], v21 offset:18432
    s_waitcnt lgkmcnt(14)
    v_mfma_f32_32x32x16_bf16 v[160:175], v[40:43], a[72:75], v[160:175]
    ds_read_b64_tr_b16 v[72:73], v22 offset:16384
    ds_read_b64_tr_b16 v[74:75], v22 offset:18432
    s_waitcnt lgkmcnt(14)
    v_mfma_f32_32x32x16_bf16 v[176:191], v[44:47], a[72:75], v[176:191]
    ds_read_b64_tr_b16 v[76:77], v23 offset:16384
    ds_read_b64_tr_b16 v[78:79], v23 offset:18432
    s_waitcnt lgkmcnt(14)
    v_mfma_f32_32x32x16_bf16 v[128:143], v[48:51], a[76:79], v[128:143]
    ds_read_b64_tr_b16 v[32:33], v20 offset:20480
    ds_read_b64_tr_b16 v[34:35], v20 offset:22528
    s_add_u32 s47, s21, 49152
    buffer_load_dwordx4 a[72:75], v2, s[32:35], s47 offen offset:2048
    s_waitcnt lgkmcnt(14)
    v_mfma_f32_32x32x16_bf16 v[144:159], v[52:55], a[76:79], v[144:159]
    ds_read_b64_tr_b16 v[36:37], v21 offset:20480
    ds_read_b64_tr_b16 v[38:39], v21 offset:22528
    s_waitcnt lgkmcnt(14)
    v_mfma_f32_32x32x16_bf16 v[160:175], v[56:59], a[76:79], v[160:175]
    ds_read_b64_tr_b16 v[40:41], v22 offset:20480
    ds_read_b64_tr_b16 v[42:43], v22 offset:22528
    s_waitcnt lgkmcnt(14)
    v_mfma_f32_32x32x16_bf16 v[176:191], v[60:63], a[76:79], v[176:191]
    ds_read_b64_tr_b16 v[44:45], v23 offset:20480
    ds_read_b64_tr_b16 v[46:47], v23 offset:22528
    s_waitcnt lgkmcnt(14)
    v_mfma_f32_32x32x16_bf16 v[128:143], v[64:67], a[80:83], v[128:143]
    ds_read_b64_tr_b16 v[48:49], v20 offset:24576
    ds_read_b64_tr_b16 v[50:51], v20 offset:26624
    s_add_u32 s47, s21, 49152
    buffer_load_dwordx4 a[76:79], v2, s[32:35], s47 offen offset:3072
    s_waitcnt lgkmcnt(14)
    v_mfma_f32_32x32x16_bf16 v[144:159], v[68:71], a[80:83], v[144:159]
    ds_read_b64_tr_b16 v[52:53], v21 offset:24576
    ds_read_b64_tr_b16 v[54:55], v21 offset:26624
    s_waitcnt lgkmcnt(14)
    v_mfma_f32_32x32x16_bf16 v[160:175], v[72:75], a[80:83], v[160:175]
    ds_read_b64_tr_b16 v[56:57], v22 offset:24576
    ds_read_b64_tr_b16 v[58:59], v22 offset:26624
    s_waitcnt lgkmcnt(14)
    v_mfma_f32_32x32x16_bf16 v[176:191], v[76:79], a[80:83], v[176:191]
    ds_read_b64_tr_b16 v[60:61], v23 offset:24576
    ds_read_b64_tr_b16 v[62:63], v23 offset:26624
    s_waitcnt lgkmcnt(14)
    v_mfma_f32_32x32x16_bf16 v[128:143], v[32:35], a[84:87], v[128:143]
    ds_read_b64_tr_b16 v[64:65], v20 offset:28672
    ds_read_b64_tr_b16 v[66:67], v20 offset:30720
    s_add_u32 s47, s21, 53248
    buffer_load_dwordx4 a[80:83], v2, s[32:35], s47 offen offset:0
    s_waitcnt lgkmcnt(14)
    v_mfma_f32_32x32x16_bf16 v[144:159], v[36:39], a[84:87], v[144:159]
    ds_read_b64_tr_b16 v[68:69], v21 offset:28672
    ds_read_b64_tr_b16 v[70:71], v21 offset:30720
    s_waitcnt lgkmcnt(14)
    v_mfma_f32_32x32x16_bf16 v[160:175], v[40:43], a[84:87], v[160:175]
    ds_read_b64_tr_b16 v[72:73], v22 offset:28672
    ds_read_b64_tr_b16 v[74:75], v22 offset:30720
    s_waitcnt lgkmcnt(14)
    v_mfma_f32_32x32x16_bf16 v[176:191], v[44:47], a[84:87], v[176:191]
    ds_read_b64_tr_b16 v[76:77], v23 offset:28672
    ds_read_b64_tr_b16 v[78:79], v23 offset:30720
    s_waitcnt vmcnt(25)
    s_barrier
    s_waitcnt lgkmcnt(14)
    v_mfma_f32_32x32x16_bf16 v[128:143], v[48:51], a[88:91], v[128:143]
    ds_read_b64_tr_b16 v[32:33], v20 offset:32768
    ds_read_b64_tr_b16 v[34:35], v20 offset:34816
    s_add_u32 s47, s21, 53248
    buffer_load_dwordx4 a[84:87], v2, s[32:35], s47 offen offset:1024
    s_waitcnt lgkmcnt(14)
    v_mfma_f32_32x32x16_bf16 v[144:159], v[52:55], a[88:91], v[144:159]
    ds_read_b64_tr_b16 v[36:37], v21 offset:32768
    ds_read_b64_tr_b16 v[38:39], v21 offset:34816
    s_waitcnt lgkmcnt(14)
    v_mfma_f32_32x32x16_bf16 v[160:175], v[56:59], a[88:91], v[160:175]
    ds_read_b64_tr_b16 v[40:41], v22 offset:32768
    ds_read_b64_tr_b16 v[42:43], v22 offset:34816
    s_waitcnt lgkmcnt(14)
    v_mfma_f32_32x32x16_bf16 v[176:191], v[60:63], a[88:91], v[176:191]
    ds_read_b64_tr_b16 v[44:45], v23 offset:32768
    ds_read_b64_tr_b16 v[46:47], v23 offset:34816
    s_mul_i32 s18, s16, 8192
    s_add_u32 s19, s20, 655360
    s_add_u32 m0, s18, 32768
    s_nop 0
    buffer_load_dwordx4 v10, s[24:27], s19 offen offset:0 lds
    buffer_load_dwordx4 v11, s[24:27], s19 offen offset:1024 lds
    s_waitcnt lgkmcnt(14)
    v_mfma_f32_32x32x16_bf16 v[128:143], v[64:67], a[92:95], v[128:143]
    ds_read_b64_tr_b16 v[48:49], v20 offset:36864
    ds_read_b64_tr_b16 v[50:51], v20 offset:38912
    s_add_u32 s47, s21, 53248
    buffer_load_dwordx4 a[88:91], v2, s[32:35], s47 offen offset:2048
    s_waitcnt lgkmcnt(14)
    v_mfma_f32_32x32x16_bf16 v[144:159], v[68:71], a[92:95], v[144:159]
    ds_read_b64_tr_b16 v[52:53], v21 offset:36864
    ds_read_b64_tr_b16 v[54:55], v21 offset:38912
    s_waitcnt lgkmcnt(14)
    v_mfma_f32_32x32x16_bf16 v[160:175], v[72:75], a[92:95], v[160:175]
    ds_read_b64_tr_b16 v[56:57], v22 offset:36864
    ds_read_b64_tr_b16 v[58:59], v22 offset:38912
    s_waitcnt lgkmcnt(14)
    v_mfma_f32_32x32x16_bf16 v[176:191], v[76:79], a[92:95], v[176:191]
    ds_read_b64_tr_b16 v[60:61], v23 offset:36864
    ds_read_b64_tr_b16 v[62:63], v23 offset:38912
    buffer_load_dwordx4 v12, s[24:27], s19 offen offset:2048 lds
    buffer_load_dwordx4 v13, s[24:27], s19 offen offset:3072 lds
    s_waitcnt lgkmcnt(14)
    v_mfma_f32_32x32x16_bf16 v[128:143], v[32:35], a[96:99], v[128:143]
    ds_read_b64_tr_b16 v[64:65], v20 offset:40960
    ds_read_b64_tr_b16 v[66:67], v20 offset:43008
    s_add_u32 s47, s21, 53248
    buffer_load_dwordx4 a[92:95], v2, s[32:35], s47 offen offset:3072
    s_waitcnt lgkmcnt(14)
    v_mfma_f32_32x32x16_bf16 v[144:159], v[36:39], a[96:99], v[144:159]
    ds_read_b64_tr_b16 v[68:69], v21 offset:40960
    ds_read_b64_tr_b16 v[70:71], v21 offset:43008
    s_waitcnt lgkmcnt(14)
    v_mfma_f32_32x32x16_bf16 v[160:175], v[40:43], a[96:99], v[160:175]
    ds_read_b64_tr_b16 v[72:73], v22 offset:40960
    ds_read_b64_tr_b16 v[74:75], v22 offset:43008
    s_waitcnt lgkmcnt(14)
    v_mfma_f32_32x32x16_bf16 v[176:191], v[44:47], a[96:99], v[176:191]
    ds_read_b64_tr_b16 v[76:77], v23 offset:40960
    ds_read_b64_tr_b16 v[78:79], v23 offset:43008
    s_mul_i32 s18, s16, 8192
    s_add_u32 s19, s20, 671744
    s_add_u32 m0, s18, 36864
    s_nop 0
    buffer_load_dwordx4 v10, s[24:27], s19 offen offset:0 lds
    buffer_load_dwordx4 v11, s[24:27], s19 offen offset:1024 lds
    s_waitcnt lgkmcnt(14)
    v_mfma_f32_32x32x16_bf16 v[128:143], v[48:51], a[100:103], v[128:143]
    ds_read_b64_tr_b16 v[32:33], v20 offset:45056
    ds_read_b64_tr_b16 v[34:35], v20 offset:47104
    s_add_u32 s47, s21, 57344
    buffer_load_dwordx4 a[96:99], v2, s[32:35], s47 offen offset:0
    s_waitcnt lgkmcnt(14)
    v_mfma_f32_32x32x16_bf16 v[144:159], v[52:55], a[100:103], v[144:159]
    ds_read_b64_tr_b16 v[36:37], v21 offset:45056
    ds_read_b64_tr_b16 v[38:39], v21 offset:47104
    s_waitcnt lgkmcnt(14)
    v_mfma_f32_32x32x16_bf16 v[160:175], v[56:59], a[100:103], v[160:175]
    ds_read_b64_tr_b16 v[40:41], v22 offset:45056
    ds_read_b64_tr_b16 v[42:43], v22 offset:47104
    s_waitcnt lgkmcnt(14)
    v_mfma_f32_32x32x16_bf16 v[176:191], v[60:63], a[100:103], v[176:191]
    ds_read_b64_tr_b16 v[44:45], v23 offset:45056
    ds_read_b64_tr_b16 v[46:47], v23 offset:47104
    buffer_load_dwordx4 v12, s[24:27], s19 offen offset:2048 lds
    buffer_load_dwordx4 v13, s[24:27], s19 offen offset:3072 lds
    s_waitcnt lgkmcnt(14)
    v_mfma_f32_32x32x16_bf16 v[128:143], v[64:67], a[104:107], v[128:143]
    ds_read_b64_tr_b16 v[48:49], v20 offset:49152
    ds_read_b64_tr_b16 v[50:51], v20 offset:51200
    s_add_u32 s47, s21, 57344
    buffer_load_dwordx4 a[100:103], v2, s[32:35], s47 offen offset:1024
    s_waitcnt lgkmcnt(14)
    v_mfma_f32_32x32x16_bf16 v[144:159], v[68:71], a[104:107], v[144:159]
    ds_read_b64_tr_b16 v[52:53], v21 offset:49152
    ds_read_b64_tr_b16 v[54:55], v21 offset:51200
    s_waitcnt lgkmcnt(14)
    v_mfma_f32_32x32x16_bf16 v[160:175], v[72:75], a[104:107], v[160:175]
    ds_read_b64_tr_b16 v[56:57], v22 offset:49152
    ds_read_b64_tr_b16 v[58:59], v22 offset:51200
    s_waitcnt lgkmcnt(14)
    v_mfma_f32_32x32x16_bf16 v[176:191], v[76:79], a[104:107], v[176:191]
    ds_read_b64_tr_b16 v[60:61], v23 offset:49152
    ds_read_b64_tr_b16 v[62:63], v23 offset:51200
    s_waitcnt lgkmcnt(14)
    v_mfma_f32_32x32x16_bf16 v[128:143], v[32:35], a[108:111], v[128:143]
    ds_read_b64_tr_b16 v[64:65], v20 offset:53248
    ds_read_b64_tr_b16 v[66:67], v20 offset:55296
    s_add_u32 s47, s21, 57344
    buffer_load_dwordx4 a[104:107], v2, s[32:35], s47 offen offset:2048
    s_waitcnt lgkmcnt(14)
    v_mfma_f32_32x32x16_bf16 v[144:159], v[36:39], a[108:111], v[144:159]
    ds_read_b64_tr_b16 v[68:69], v21 offset:53248
    ds_read_b64_tr_b16 v[70:71], v21 offset:55296
    s_waitcnt lgkmcnt(14)
    v_mfma_f32_32x32x16_bf16 v[160:175], v[40:43], a[108:111], v[160:175]
    ds_read_b64_tr_b16 v[72:73], v22 offset:53248
    ds_read_b64_tr_b16 v[74:75], v22 offset:55296
    s_waitcnt lgkmcnt(14)
    v_mfma_f32_32x32x16_bf16 v[176:191], v[44:47], a[108:111], v[176:191]
    ds_read_b64_tr_b16 v[76:77], v23 offset:53248
    ds_read_b64_tr_b16 v[78:79], v23 offset:55296
    s_waitcnt lgkmcnt(14)
    v_mfma_f32_32x32x16_bf16 v[128:143], v[48:51], a[112:115], v[128:143]
    ds_read_b64_tr_b16 v[32:33], v20 offset:57344
    ds_read_b64_tr_b16 v[34:35], v20 offset:59392
    s_add_u32 s47, s21, 57344
    buffer_load_dwordx4 a[108:111], v2, s[32:35], s47 offen offset:3072
    s_waitcnt lgkmcnt(14)
    v_mfma_f32_32x32x16_bf16 v[144:159], v[52:55], a[112:115], v[144:159]
    ds_read_b64_tr_b16 v[36:37], v21 offset:57344
    ds_read_b64_tr_b16 v[38:39], v21 offset:59392
    s_waitcnt lgkmcnt(14)
    v_mfma_f32_32x32x16_bf16 v[160:175], v[56:59], a[112:115], v[160:175]
    ds_read_b64_tr_b16 v[40:41], v22 offset:57344
    ds_read_b64_tr_b16 v[42:43], v22 offset:59392
    s_waitcnt lgkmcnt(14)
    v_mfma_f32_32x32x16_bf16 v[176:191], v[60:63], a[112:115], v[176:191]
    ds_read_b64_tr_b16 v[44:45], v23 offset:57344
    ds_read_b64_tr_b16 v[46:47], v23 offset:59392
    s_waitcnt lgkmcnt(14)
    v_mfma_f32_32x32x16_bf16 v[128:143], v[64:67], a[116:119], v[128:143]
    ds_read_b64_tr_b16 v[48:49], v20 offset:61440
    ds_read_b64_tr_b16 v[50:51], v20 offset:63488
    s_add_u32 s47, s21, 61440
    buffer_load_dwordx4 a[112:115], v2, s[32:35], s47 offen offset:0
    s_waitcnt lgkmcnt(14)
    v_mfma_f32_32x32x16_bf16 v[144:159], v[68:71], a[116:119], v[144:159]
    ds_read_b64_tr_b16 v[52:53], v21 offset:61440
    ds_read_b64_tr_b16 v[54:55], v21 offset:63488
    s_waitcnt lgkmcnt(14)
    v_mfma_f32_32x32x16_bf16 v[160:175], v[72:75], a[116:119], v[160:175]
    ds_read_b64_tr_b16 v[56:57], v22 offset:61440
    ds_read_b64_tr_b16 v[58:59], v22 offset:63488
    s_waitcnt lgkmcnt(14)
    v_mfma_f32_32x32x16_bf16 v[176:191], v[76:79], a[116:119], v[176:191]
    ds_read_b64_tr_b16 v[60:61], v23 offset:61440
    ds_read_b64_tr_b16 v[62:63], v23 offset:63488
    s_waitcnt vmcnt(20)
    s_barrier
    s_waitcnt lgkmcnt(14)
    v_mfma_f32_32x32x16_bf16 v[128:143], v[32:35], a[120:123], v[128:143]
    ds_read_b64_tr_b16 v[64:65], v16 offset:0
    ds_read_b64_tr_b16 v[66:67], v16 offset:2048
    s_add_u32 s47, s21, 61440
    buffer_load_dwordx4 a[116:119], v2, s[32:35], s47 offen offset:1024
    s_waitcnt lgkmcnt(14)
    v_mfma_f32_32x32x16_bf16 v[144:159], v[36:39], a[120:123], v[144:159]
    ds_read_b64_tr_b16 v[68:69], v17 offset:0
    ds_read_b64_tr_b16 v[70:71], v17 offset:2048
    s_waitcnt lgkmcnt(14)
    v_mfma_f32_32x32x16_bf16 v[160:175], v[40:43], a[120:123], v[160:175]
    ds_read_b64_tr_b16 v[72:73], v18 offset:0
    ds_read_b64_tr_b16 v[74:75], v18 offset:2048
    s_waitcnt lgkmcnt(14)
    v_mfma_f32_32x32x16_bf16 v[176:191], v[44:47], a[120:123], v[176:191]
    ds_read_b64_tr_b16 v[76:77], v19 offset:0
    ds_read_b64_tr_b16 v[78:79], v19 offset:2048
    s_mul_i32 s18, s16, 8192
    s_add_u32 s19, s20, 786432
    s_add_u32 m0, s18, 65536
    s_nop 0
    buffer_load_dwordx4 v10, s[24:27], s19 offen offset:0 lds
    buffer_load_dwordx4 v11, s[24:27], s19 offen offset:1024 lds
    s_waitcnt lgkmcnt(14)
    v_mfma_f32_32x32x16_bf16 v[128:143], v[48:51], a[124:127], v[128:143]
    ds_read_b64_tr_b16 v[32:33], v16 offset:4096
    ds_read_b64_tr_b16 v[34:35], v16 offset:6144
    s_add_u32 s47, s21, 61440
    buffer_load_dwordx4 a[120:123], v2, s[32:35], s47 offen offset:2048
    s_waitcnt lgkmcnt(14)
    v_mfma_f32_32x32x16_bf16 v[144:159], v[52:55], a[124:127], v[144:159]
    ds_read_b64_tr_b16 v[36:37], v17 offset:4096
    ds_read_b64_tr_b16 v[38:39], v17 offset:6144
    s_waitcnt lgkmcnt(14)
    v_mfma_f32_32x32x16_bf16 v[160:175], v[56:59], a[124:127], v[160:175]
    ds_read_b64_tr_b16 v[40:41], v18 offset:4096
    ds_read_b64_tr_b16 v[42:43], v18 offset:6144
    s_waitcnt lgkmcnt(14)
    v_mfma_f32_32x32x16_bf16 v[176:191], v[60:63], a[124:127], v[176:191]
    ds_read_b64_tr_b16 v[44:45], v19 offset:4096
    ds_read_b64_tr_b16 v[46:47], v19 offset:6144
    buffer_load_dwordx4 v12, s[24:27], s19 offen offset:2048 lds
    buffer_load_dwordx4 v13, s[24:27], s19 offen offset:3072 lds
    s_waitcnt lgkmcnt(14)
    v_mfma_f32_32x32x16_bf16 v[128:143], v[64:67], a[0:3], v[128:143]
    ds_read_b64_tr_b16 v[48:49], v16 offset:8192
    ds_read_b64_tr_b16 v[50:51], v16 offset:10240
    s_add_u32 s47, s21, 61440
    buffer_load_dwordx4 a[124:127], v2, s[32:35], s47 offen offset:3072
    s_waitcnt lgkmcnt(14)
    v_mfma_f32_32x32x16_bf16 v[144:159], v[68:71], a[0:3], v[144:159]
    ds_read_b64_tr_b16 v[52:53], v17 offset:8192
    ds_read_b64_tr_b16 v[54:55], v17 offset:10240
    s_waitcnt lgkmcnt(14)
    v_mfma_f32_32x32x16_bf16 v[160:175], v[72:75], a[0:3], v[160:175]
    ds_read_b64_tr_b16 v[56:57], v18 offset:8192
    ds_read_b64_tr_b16 v[58:59], v18 offset:10240
    s_waitcnt lgkmcnt(14)
    v_mfma_f32_32x32x16_bf16 v[176:191], v[76:79], a[0:3], v[176:191]
    ds_read_b64_tr_b16 v[60:61], v19 offset:8192
    ds_read_b64_tr_b16 v[62:63], v19 offset:10240
    s_mul_i32 s18, s16, 8192
    s_add_u32 s19, s20, 802816
    s_add_u32 m0, s18, 69632
    s_nop 0
    buffer_load_dwordx4 v10, s[24:27], s19 offen offset:0 lds
    buffer_load_dwordx4 v11, s[24:27], s19 offen offset:1024 lds
    s_waitcnt lgkmcnt(14)
    v_mfma_f32_32x32x16_bf16 v[128:143], v[32:35], a[4:7], v[128:143]
    ds_read_b64_tr_b16 v[64:65], v16 offset:12288
    ds_read_b64_tr_b16 v[66:67], v16 offset:14336
    s_waitcnt lgkmcnt(14)
    v_mfma_f32_32x32x16_bf16 v[144:159], v[36:39], a[4:7], v[144:159]
    ds_read_b64_tr_b16 v[68:69], v17 offset:12288
    ds_read_b64_tr_b16 v[70:71], v17 offset:14336
    s_waitcnt lgkmcnt(14)
    v_mfma_f32_32x32x16_bf16 v[160:175], v[40:43], a[4:7], v[160:175]
    ds_read_b64_tr_b16 v[72:73], v18 offset:12288
    ds_read_b64_tr_b16 v[74:75], v18 offset:14336
    s_waitcnt lgkmcnt(14)
    v_mfma_f32_32x32x16_bf16 v[176:191], v[44:47], a[4:7], v[176:191]
    ds_read_b64_tr_b16 v[76:77], v19 offset:12288
    ds_read_b64_tr_b16 v[78:79], v19 offset:14336
    buffer_load_dwordx4 v12, s[24:27], s19 offen offset:2048 lds
    buffer_load_dwordx4 v13, s[24:27], s19 offen offset:3072 lds
    s_waitcnt lgkmcnt(14)
    v_mfma_f32_32x32x16_bf16 v[128:143], v[48:51], a[8:11], v[128:143]
    ds_read_b64_tr_b16 v[32:33], v16 offset:16384
    ds_read_b64_tr_b16 v[34:35], v16 offset:18432
    s_waitcnt lgkmcnt(14)
    v_mfma_f32_32x32x16_bf16 v[144:159], v[52:55], a[8:11], v[144:159]
    ds_read_b64_tr_b16 v[36:37], v17 offset:16384
    ds_read_b64_tr_b16 v[38:39], v17 offset:18432
    s_waitcnt lgkmcnt(14)
    v_mfma_f32_32x32x16_bf16 v[160:175], v[56:59], a[8:11], v[160:175]
    ds_read_b64_tr_b16 v[40:41], v18 offset:16384
    ds_read_b64_tr_b16 v[42:43], v18 offset:18432
    s_waitcnt lgkmcnt(14)
    v_mfma_f32_32x32x16_bf16 v[176:191], v[60:63], a[8:11], v[176:191]
    ds_read_b64_tr_b16 v[44:45], v19 offset:16384
    ds_read_b64_tr_b16 v[46:47], v19 offset:18432
    s_waitcnt lgkmcnt(14)
    v_mfma_f32_32x32x16_bf16 v[128:143], v[64:67], a[12:15], v[128:143]
    ds_read_b64_tr_b16 v[48:49], v16 offset:20480
    ds_read_b64_tr_b16 v[50:51], v16 offset:22528
    s_waitcnt lgkmcnt(14)
    v_mfma_f32_32x32x16_bf16 v[144:159], v[68:71], a[12:15], v[144:159]
    ds_read_b64_tr_b16 v[52:53], v17 offset:20480
    ds_read_b64_tr_b16 v[54:55], v17 offset:22528
    s_waitcnt lgkmcnt(14)
    v_mfma_f32_32x32x16_bf16 v[160:175], v[72:75], a[12:15], v[160:175]
    ds_read_b64_tr_b16 v[56:57], v18 offset:20480
    ds_read_b64_tr_b16 v[58:59], v18 offset:22528
    s_waitcnt lgkmcnt(14)
    v_mfma_f32_32x32x16_bf16 v[176:191], v[76:79], a[12:15], v[176:191]
    ds_read_b64_tr_b16 v[60:61], v19 offset:20480
    ds_read_b64_tr_b16 v[62:63], v19 offset:22528
    s_waitcnt lgkmcnt(14)
    v_mfma_f32_32x32x16_bf16 v[128:143], v[32:35], a[16:19], v[128:143]
    ds_read_b64_tr_b16 v[64:65], v16 offset:24576
    ds_read_b64_tr_b16 v[66:67], v16 offset:26624
    s_waitcnt lgkmcnt(14)
    v_mfma_f32_32x32x16_bf16 v[144:159], v[36:39], a[16:19], v[144:159]
    ds_read_b64_tr_b16 v[68:69], v17 offset:24576
    ds_read_b64_tr_b16 v[70:71], v17 offset:26624
    s_waitcnt lgkmcnt(14)
    v_mfma_f32_32x32x16_bf16 v[160:175], v[40:43], a[16:19], v[160:175]
    ds_read_b64_tr_b16 v[72:73], v18 offset:24576
    ds_read_b64_tr_b16 v[74:75], v18 offset:26624
    s_waitcnt lgkmcnt(14)
    v_mfma_f32_32x32x16_bf16 v[176:191], v[44:47], a[16:19], v[176:191]
    ds_read_b64_tr_b16 v[76:77], v19 offset:24576
    ds_read_b64_tr_b16 v[78:79], v19 offset:26624
    s_waitcnt lgkmcnt(14)
    v_mfma_f32_32x32x16_bf16 v[128:143], v[48:51], a[20:23], v[128:143]
    ds_read_b64_tr_b16 v[32:33], v16 offset:28672
    ds_read_b64_tr_b16 v[34:35], v16 offset:30720
    s_waitcnt lgkmcnt(14)
    v_mfma_f32_32x32x16_bf16 v[144:159], v[52:55], a[20:23], v[144:159]
    ds_read_b64_tr_b16 v[36:37], v17 offset:28672
    ds_read_b64_tr_b16 v[38:39], v17 offset:30720
    s_waitcnt lgkmcnt(14)
    v_mfma_f32_32x32x16_bf16 v[160:175], v[56:59], a[20:23], v[160:175]
    ds_read_b64_tr_b16 v[40:41], v18 offset:28672
    ds_read_b64_tr_b16 v[42:43], v18 offset:30720
    s_waitcnt lgkmcnt(14)
    v_mfma_f32_32x32x16_bf16 v[176:191], v[60:63], a[20:23], v[176:191]
    ds_read_b64_tr_b16 v[44:45], v19 offset:28672
    ds_read_b64_tr_b16 v[46:47], v19 offset:30720
    s_waitcnt vmcnt(15)
    s_barrier
    s_waitcnt lgkmcnt(14)
    v_mfma_f32_32x32x16_bf16 v[128:143], v[64:67], a[24:27], v[128:143]
    ds_read_b64_tr_b16 v[48:49], v16 offset:32768
    ds_read_b64_tr_b16 v[50:51], v16 offset:34816
    s_waitcnt lgkmcnt(14)
    v_mfma_f32_32x32x16_bf16 v[144:159], v[68:71], a[24:27], v[144:159]
    ds_read_b64_tr_b16 v[52:53], v17 offset:32768
    ds_read_b64_tr_b16 v[54:55], v17 offset:34816
    s_waitcnt lgkmcnt(14)
    v_mfma_f32_32x32x16_bf16 v[160:175], v[72:75], a[24:27], v[160:175]
    ds_read_b64_tr_b16 v[56:57], v18 offset:32768
    ds_read_b64_tr_b16 v[58:59], v18 offset:34816
    s_waitcnt lgkmcnt(14)
    v_mfma_f32_32x32x16_bf16 v[176:191], v[76:79], a[24:27], v[176:191]
    ds_read_b64_tr_b16 v[60:61], v19 offset:32768
    ds_read_b64_tr_b16 v[62:63], v19 offset:34816
    s_mul_i32 s18, s16, 8192
    s_add_u32 s19, s20, 917504
    s_add_u32 m0, s18, 98304
    s_nop 0
    buffer_load_dwordx4 v10, s[24:27], s19 offen offset:0 lds
    buffer_load_dwordx4 v11, s[24:27], s19 offen offset:1024 lds
    s_waitcnt lgkmcnt(14)
    v_mfma_f32_32x32x16_bf16 v[128:143], v[32:35], a[28:31], v[128:143]
    ds_read_b64_tr_b16 v[64:65], v16 offset:36864
    ds_read_b64_tr_b16 v[66:67], v16 offset:38912
    s_waitcnt lgkmcnt(14)
    v_mfma_f32_32x32x16_bf16 v[144:159], v[36:39], a[28:31], v[144:159]
    ds_read_b64_tr_b16 v[68:69], v17 offset:36864
    ds_read_b64_tr_b16 v[70:71], v17 offset:38912
    s_waitcnt lgkmcnt(14)
    v_mfma_f32_32x32x16_bf16 v[160:175], v[40:43], a[28:31], v[160:175]
    ds_read_b64_tr_b16 v[72:73], v18 offset:36864
    ds_read_b64_tr_b16 v[74:75], v18 offset:38912
    s_waitcnt lgkmcnt(14)
    v_mfma_f32_32x32x16_bf16 v[176:191], v[44:47], a[28:31], v[176:191]
    ds_read_b64_tr_b16 v[76:77], v19 offset:36864
    ds_read_b64_tr_b16 v[78:79], v19 offset:38912
    buffer_load_dwordx4 v12, s[24:27], s19 offen offset:2048 lds
    buffer_load_dwordx4 v13, s[24:27], s19 offen offset:3072 lds
    s_waitcnt lgkmcnt(14)
    v_mfma_f32_32x32x16_bf16 v[128:143], v[48:51], a[32:35], v[128:143]
    ds_read_b64_tr_b16 v[32:33], v16 offset:40960
    ds_read_b64_tr_b16 v[34:35], v16 offset:43008
    s_waitcnt lgkmcnt(14)
    v_mfma_f32_32x32x16_bf16 v[144:159], v[52:55], a[32:35], v[144:159]
    ds_read_b64_tr_b16 v[36:37], v17 offset:40960
    ds_read_b64_tr_b16 v[38:39], v17 offset:43008
    s_waitcnt lgkmcnt(14)
    v_mfma_f32_32x32x16_bf16 v[160:175], v[56:59], a[32:35], v[160:175]
    ds_read_b64_tr_b16 v[40:41], v18 offset:40960
    ds_read_b64_tr_b16 v[42:43], v18 offset:43008
    s_waitcnt lgkmcnt(14)
    v_mfma_f32_32x32x16_bf16 v[176:191], v[60:63], a[32:35], v[176:191]
    ds_read_b64_tr_b16 v[44:45], v19 offset:40960
    ds_read_b64_tr_b16 v[46:47], v19 offset:43008
    s_mul_i32 s18, s16, 8192
    s_add_u32 s19, s20, 933888
    s_add_u32 m0, s18, 102400
    s_nop 0
    buffer_load_dwordx4 v10, s[24:27], s19 offen offset:0 lds
    buffer_load_dwordx4 v11, s[24:27], s19 offen offset:1024 lds
    s_waitcnt lgkmcnt(14)
    v_mfma_f32_32x32x16_bf16 v[128:143], v[64:67], a[36:39], v[128:143]
    ds_read_b64_tr_b16 v[48:49], v16 offset:45056
    ds_read_b64_tr_b16 v[50:51], v16 offset:47104
    s_waitcnt lgkmcnt(14)
    v_mfma_f32_32x32x16_bf16 v[144:159], v[68:71], a[36:39], v[144:159]
    ds_read_b64_tr_b16 v[52:53], v17 offset:45056
    ds_read_b64_tr_b16 v[54:55], v17 offset:47104
    s_waitcnt lgkmcnt(14)
    v_mfma_f32_32x32x16_bf16 v[160:175], v[72:75], a[36:39], v[160:175]
    ds_read_b64_tr_b16 v[56:57], v18 offset:45056
    ds_read_b64_tr_b16 v[58:59], v18 offset:47104
    s_waitcnt lgkmcnt(14)
    v_mfma_f32_32x32x16_bf16 v[176:191], v[76:79], a[36:39], v[176:191]
    ds_read_b64_tr_b16 v[60:61], v19 offset:45056
    ds_read_b64_tr_b16 v[62:63], v19 offset:47104
    buffer_load_dwordx4 v12, s[24:27], s19 offen offset:2048 lds
    buffer_load_dwordx4 v13, s[24:27], s19 offen offset:3072 lds
    s_waitcnt lgkmcnt(14)
    v_mfma_f32_32x32x16_bf16 v[128:143], v[32:35], a[40:43], v[128:143]
    ds_read_b64_tr_b16 v[64:65], v16 offset:49152
    ds_read_b64_tr_b16 v[66:67], v16 offset:51200
    s_waitcnt lgkmcnt(14)
    v_mfma_f32_32x32x16_bf16 v[144:159], v[36:39], a[40:43], v[144:159]
    ds_read_b64_tr_b16 v[68:69], v17 offset:49152
    ds_read_b64_tr_b16 v[70:71], v17 offset:51200
    s_waitcnt lgkmcnt(14)
    v_mfma_f32_32x32x16_bf16 v[160:175], v[40:43], a[40:43], v[160:175]
    ds_read_b64_tr_b16 v[72:73], v18 offset:49152
    ds_read_b64_tr_b16 v[74:75], v18 offset:51200
    s_waitcnt lgkmcnt(14)
    v_mfma_f32_32x32x16_bf16 v[176:191], v[44:47], a[40:43], v[176:191]
    ds_read_b64_tr_b16 v[76:77], v19 offset:49152
    ds_read_b64_tr_b16 v[78:79], v19 offset:51200
    s_waitcnt lgkmcnt(14)
    v_mfma_f32_32x32x16_bf16 v[128:143], v[48:51], a[44:47], v[128:143]
    ds_read_b64_tr_b16 v[32:33], v16 offset:53248
    ds_read_b64_tr_b16 v[34:35], v16 offset:55296
    s_waitcnt lgkmcnt(14)
    v_mfma_f32_32x32x16_bf16 v[144:159], v[52:55], a[44:47], v[144:159]
    ds_read_b64_tr_b16 v[36:37], v17 offset:53248
    ds_read_b64_tr_b16 v[38:39], v17 offset:55296
    s_waitcnt lgkmcnt(14)
    v_mfma_f32_32x32x16_bf16 v[160:175], v[56:59], a[44:47], v[160:175]
    ds_read_b64_tr_b16 v[40:41], v18 offset:53248
    ds_read_b64_tr_b16 v[42:43], v18 offset:55296
    s_waitcnt lgkmcnt(14)
    v_mfma_f32_32x32x16_bf16 v[176:191], v[60:63], a[44:47], v[176:191]
    ds_read_b64_tr_b16 v[44:45], v19 offset:53248
    ds_read_b64_tr_b16 v[46:47], v19 offset:55296
    s_waitcnt lgkmcnt(14)
    v_mfma_f32_32x32x16_bf16 v[128:143], v[64:67], a[48:51], v[128:143]
    ds_read_b64_tr_b16 v[48:49], v16 offset:57344
    ds_read_b64_tr_b16 v[50:51], v16 offset:59392
    s_waitcnt lgkmcnt(14)
    v_mfma_f32_32x32x16_bf16 v[144:159], v[68:71], a[48:51], v[144:159]
    ds_read_b64_tr_b16 v[52:53], v17 offset:57344
    ds_read_b64_tr_b16 v[54:55], v17 offset:59392
    s_waitcnt lgkmcnt(14)
    v_mfma_f32_32x32x16_bf16 v[160:175], v[72:75], a[48:51], v[160:175]
    ds_read_b64_tr_b16 v[56:57], v18 offset:57344
    ds_read_b64_tr_b16 v[58:59], v18 offset:59392
    s_waitcnt lgkmcnt(14)
    v_mfma_f32_32x32x16_bf16 v[176:191], v[76:79], a[48:51], v[176:191]
    ds_read_b64_tr_b16 v[60:61], v19 offset:57344
    ds_read_b64_tr_b16 v[62:63], v19 offset:59392
    s_waitcnt lgkmcnt(14)
    v_mfma_f32_32x32x16_bf16 v[128:143], v[32:35], a[52:55], v[128:143]
    ds_read_b64_tr_b16 v[64:65], v16 offset:61440
    ds_read_b64_tr_b16 v[66:67], v16 offset:63488
    s_waitcnt lgkmcnt(14)
    v_mfma_f32_32x32x16_bf16 v[144:159], v[36:39], a[52:55], v[144:159]
    ds_read_b64_tr_b16 v[68:69], v17 offset:61440
    ds_read_b64_tr_b16 v[70:71], v17 offset:63488
    s_waitcnt lgkmcnt(14)
    v_mfma_f32_32x32x16_bf16 v[160:175], v[40:43], a[52:55], v[160:175]
    ds_read_b64_tr_b16 v[72:73], v18 offset:61440
    ds_read_b64_tr_b16 v[74:75], v18 offset:63488
    s_waitcnt lgkmcnt(14)
    v_mfma_f32_32x32x16_bf16 v[176:191], v[44:47], a[52:55], v[176:191]
    ds_read_b64_tr_b16 v[76:77], v19 offset:61440
    ds_read_b64_tr_b16 v[78:79], v19 offset:63488
    s_waitcnt vmcnt(8)
    s_barrier
    s_waitcnt lgkmcnt(14)
    v_mfma_f32_32x32x16_bf16 v[128:143], v[48:51], a[56:59], v[128:143]
    ds_read_b64_tr_b16 v[32:33], v20 offset:0
    ds_read_b64_tr_b16 v[34:35], v20 offset:2048
    s_waitcnt lgkmcnt(14)
    v_mfma_f32_32x32x16_bf16 v[144:159], v[52:55], a[56:59], v[144:159]
    ds_read_b64_tr_b16 v[36:37], v21 offset:0
    ds_read_b64_tr_b16 v[38:39], v21 offset:2048
    s_waitcnt lgkmcnt(14)
    v_mfma_f32_32x32x16_bf16 v[160:175], v[56:59], a[56:59], v[160:175]
    ds_read_b64_tr_b16 v[40:41], v22 offset:0
    ds_read_b64_tr_b16 v[42:43], v22 offset:2048
    s_waitcnt lgkmcnt(14)
    v_mfma_f32_32x32x16_bf16 v[176:191], v[60:63], a[56:59], v[176:191]
    ds_read_b64_tr_b16 v[44:45], v23 offset:0
    ds_read_b64_tr_b16 v[46:47], v23 offset:2048
    s_waitcnt lgkmcnt(14)
    v_mfma_f32_32x32x16_bf16 v[128:143], v[64:67], a[60:63], v[128:143]
    ds_read_b64_tr_b16 v[48:49], v20 offset:4096
    ds_read_b64_tr_b16 v[50:51], v20 offset:6144
    s_waitcnt lgkmcnt(14)
    v_mfma_f32_32x32x16_bf16 v[144:159], v[68:71], a[60:63], v[144:159]
    ds_read_b64_tr_b16 v[52:53], v21 offset:4096
    ds_read_b64_tr_b16 v[54:55], v21 offset:6144
    s_waitcnt lgkmcnt(14)
    v_mfma_f32_32x32x16_bf16 v[160:175], v[72:75], a[60:63], v[160:175]
    ds_read_b64_tr_b16 v[56:57], v22 offset:4096
    ds_read_b64_tr_b16 v[58:59], v22 offset:6144
    s_waitcnt lgkmcnt(14)
    v_mfma_f32_32x32x16_bf16 v[176:191], v[76:79], a[60:63], v[176:191]
    ds_read_b64_tr_b16 v[60:61], v23 offset:4096
    ds_read_b64_tr_b16 v[62:63], v23 offset:6144
    s_waitcnt lgkmcnt(14)
    v_mfma_f32_32x32x16_bf16 v[128:143], v[32:35], a[64:67], v[128:143]
    ds_read_b64_tr_b16 v[64:65], v20 offset:8192
    ds_read_b64_tr_b16 v[66:67], v20 offset:10240
    s_waitcnt lgkmcnt(14)
    v_mfma_f32_32x32x16_bf16 v[144:159], v[36:39], a[64:67], v[144:159]
    ds_read_b64_tr_b16 v[68:69], v21 offset:8192
    ds_read_b64_tr_b16 v[70:71], v21 offset:10240
    s_waitcnt lgkmcnt(14)
    v_mfma_f32_32x32x16_bf16 v[160:175], v[40:43], a[64:67], v[160:175]
    ds_read_b64_tr_b16 v[72:73], v22 offset:8192
    ds_read_b64_tr_b16 v[74:75], v22 offset:10240
    s_waitcnt lgkmcnt(14)
    v_mfma_f32_32x32x16_bf16 v[176:191], v[44:47], a[64:67], v[176:191]
    ds_read_b64_tr_b16 v[76:77], v23 offset:8192
    ds_read_b64_tr_b16 v[78:79], v23 offset:10240
    s_waitcnt lgkmcnt(14)
    v_mfma_f32_32x32x16_bf16 v[128:143], v[48:51], a[68:71], v[128:143]
    ds_read_b64_tr_b16 v[32:33], v20 offset:12288
    ds_read_b64_tr_b16 v[34:35], v20 offset:14336
    s_waitcnt lgkmcnt(14)
    v_mfma_f32_32x32x16_bf16 v[144:159], v[52:55], a[68:71], v[144:159]
    ds_read_b64_tr_b16 v[36:37], v21 offset:12288
    ds_read_b64_tr_b16 v[38:39], v21 offset:14336
    s_waitcnt lgkmcnt(14)
    v_mfma_f32_32x32x16_bf16 v[160:175], v[56:59], a[68:71], v[160:175]
    ds_read_b64_tr_b16 v[40:41], v22 offset:12288
    ds_read_b64_tr_b16 v[42:43], v22 offset:14336
    s_waitcnt lgkmcnt(14)
    v_mfma_f32_32x32x16_bf16 v[176:191], v[60:63], a[68:71], v[176:191]
    ds_read_b64_tr_b16 v[44:45], v23 offset:12288
    ds_read_b64_tr_b16 v[46:47], v23 offset:14336
    s_waitcnt lgkmcnt(14)
    v_mfma_f32_32x32x16_bf16 v[128:143], v[64:67], a[72:75], v[128:143]
    ds_read_b64_tr_b16 v[48:49], v20 offset:16384
    ds_read_b64_tr_b16 v[50:51], v20 offset:18432
    s_waitcnt lgkmcnt(14)
    v_mfma_f32_32x32x16_bf16 v[144:159], v[68:71], a[72:75], v[144:159]
    ds_read_b64_tr_b16 v[52:53], v21 offset:16384
    ds_read_b64_tr_b16 v[54:55], v21 offset:18432
    s_waitcnt lgkmcnt(14)
    v_mfma_f32_32x32x16_bf16 v[160:175], v[72:75], a[72:75], v[160:175]
    ds_read_b64_tr_b16 v[56:57], v22 offset:16384
    ds_read_b64_tr_b16 v[58:59], v22 offset:18432
    s_waitcnt lgkmcnt(14)
    v_mfma_f32_32x32x16_bf16 v[176:191], v[76:79], a[72:75], v[176:191]
    ds_read_b64_tr_b16 v[60:61], v23 offset:16384
    ds_read_b64_tr_b16 v[62:63], v23 offset:18432
    s_waitcnt lgkmcnt(14)
    v_mfma_f32_32x32x16_bf16 v[128:143], v[32:35], a[76:79], v[128:143]
    ds_read_b64_tr_b16 v[64:65], v20 offset:20480
    ds_read_b64_tr_b16 v[66:67], v20 offset:22528
    s_waitcnt lgkmcnt(14)
    v_mfma_f32_32x32x16_bf16 v[144:159], v[36:39], a[76:79], v[144:159]
    ds_read_b64_tr_b16 v[68:69], v21 offset:20480
    ds_read_b64_tr_b16 v[70:71], v21 offset:22528
    s_waitcnt lgkmcnt(14)
    v_mfma_f32_32x32x16_bf16 v[160:175], v[40:43], a[76:79], v[160:175]
    ds_read_b64_tr_b16 v[72:73], v22 offset:20480
    ds_read_b64_tr_b16 v[74:75], v22 offset:22528
    s_waitcnt lgkmcnt(14)
    v_mfma_f32_32x32x16_bf16 v[176:191], v[44:47], a[76:79], v[176:191]
    ds_read_b64_tr_b16 v[76:77], v23 offset:20480
    ds_read_b64_tr_b16 v[78:79], v23 offset:22528
    s_waitcnt lgkmcnt(14)
    v_mfma_f32_32x32x16_bf16 v[128:143], v[48:51], a[80:83], v[128:143]
    ds_read_b64_tr_b16 v[32:33], v20 offset:24576
    ds_read_b64_tr_b16 v[34:35], v20 offset:26624
    s_waitcnt lgkmcnt(14)
    v_mfma_f32_32x32x16_bf16 v[144:159], v[52:55], a[80:83], v[144:159]
    ds_read_b64_tr_b16 v[36:37], v21 offset:24576
    ds_read_b64_tr_b16 v[38:39], v21 offset:26624
    s_waitcnt lgkmcnt(14)
    v_mfma_f32_32x32x16_bf16 v[160:175], v[56:59], a[80:83], v[160:175]
    ds_read_b64_tr_b16 v[40:41], v22 offset:24576
    ds_read_b64_tr_b16 v[42:43], v22 offset:26624
    s_waitcnt lgkmcnt(14)
    v_mfma_f32_32x32x16_bf16 v[176:191], v[60:63], a[80:83], v[176:191]
    ds_read_b64_tr_b16 v[44:45], v23 offset:24576
    ds_read_b64_tr_b16 v[46:47], v23 offset:26624
    s_waitcnt lgkmcnt(14)
    v_mfma_f32_32x32x16_bf16 v[128:143], v[64:67], a[84:87], v[128:143]
    ds_read_b64_tr_b16 v[48:49], v20 offset:28672
    ds_read_b64_tr_b16 v[50:51], v20 offset:30720
    s_waitcnt lgkmcnt(14)
    v_mfma_f32_32x32x16_bf16 v[144:159], v[68:71], a[84:87], v[144:159]
    ds_read_b64_tr_b16 v[52:53], v21 offset:28672
    ds_read_b64_tr_b16 v[54:55], v21 offset:30720
    s_waitcnt lgkmcnt(14)
    v_mfma_f32_32x32x16_bf16 v[160:175], v[72:75], a[84:87], v[160:175]
    ds_read_b64_tr_b16 v[56:57], v22 offset:28672
    ds_read_b64_tr_b16 v[58:59], v22 offset:30720
    s_waitcnt lgkmcnt(14)
    v_mfma_f32_32x32x16_bf16 v[176:191], v[76:79], a[84:87], v[176:191]
    ds_read_b64_tr_b16 v[60:61], v23 offset:28672
    ds_read_b64_tr_b16 v[62:63], v23 offset:30720
    s_waitcnt vmcnt(0)
    s_barrier
    s_waitcnt lgkmcnt(14)
    v_mfma_f32_32x32x16_bf16 v[128:143], v[32:35], a[88:91], v[128:143]
    ds_read_b64_tr_b16 v[64:65], v20 offset:32768
    ds_read_b64_tr_b16 v[66:67], v20 offset:34816
    s_waitcnt lgkmcnt(14)
    v_mfma_f32_32x32x16_bf16 v[144:159], v[36:39], a[88:91], v[144:159]
    ds_read_b64_tr_b16 v[68:69], v21 offset:32768
    ds_read_b64_tr_b16 v[70:71], v21 offset:34816
    s_waitcnt lgkmcnt(14)
    v_mfma_f32_32x32x16_bf16 v[160:175], v[40:43], a[88:91], v[160:175]
    ds_read_b64_tr_b16 v[72:73], v22 offset:32768
    ds_read_b64_tr_b16 v[74:75], v22 offset:34816
    s_waitcnt lgkmcnt(14)
    v_mfma_f32_32x32x16_bf16 v[176:191], v[44:47], a[88:91], v[176:191]
    ds_read_b64_tr_b16 v[76:77], v23 offset:32768
    ds_read_b64_tr_b16 v[78:79], v23 offset:34816
    s_waitcnt lgkmcnt(14)
    v_mfma_f32_32x32x16_bf16 v[128:143], v[48:51], a[92:95], v[128:143]
    ds_read_b64_tr_b16 v[32:33], v20 offset:36864
    ds_read_b64_tr_b16 v[34:35], v20 offset:38912
    s_waitcnt lgkmcnt(14)
    v_mfma_f32_32x32x16_bf16 v[144:159], v[52:55], a[92:95], v[144:159]
    ds_read_b64_tr_b16 v[36:37], v21 offset:36864
    ds_read_b64_tr_b16 v[38:39], v21 offset:38912
    s_waitcnt lgkmcnt(14)
    v_mfma_f32_32x32x16_bf16 v[160:175], v[56:59], a[92:95], v[160:175]
    ds_read_b64_tr_b16 v[40:41], v22 offset:36864
    ds_read_b64_tr_b16 v[42:43], v22 offset:38912
    s_waitcnt lgkmcnt(14)
    v_mfma_f32_32x32x16_bf16 v[176:191], v[60:63], a[92:95], v[176:191]
    ds_read_b64_tr_b16 v[44:45], v23 offset:36864
    ds_read_b64_tr_b16 v[46:47], v23 offset:38912
    s_waitcnt lgkmcnt(14)
    v_mfma_f32_32x32x16_bf16 v[128:143], v[64:67], a[96:99], v[128:143]
    ds_read_b64_tr_b16 v[48:49], v20 offset:40960
    ds_read_b64_tr_b16 v[50:51], v20 offset:43008
    s_waitcnt lgkmcnt(14)
    v_mfma_f32_32x32x16_bf16 v[144:159], v[68:71], a[96:99], v[144:159]
    ds_read_b64_tr_b16 v[52:53], v21 offset:40960
    ds_read_b64_tr_b16 v[54:55], v21 offset:43008
    s_waitcnt lgkmcnt(14)
    v_mfma_f32_32x32x16_bf16 v[160:175], v[72:75], a[96:99], v[160:175]
    ds_read_b64_tr_b16 v[56:57], v22 offset:40960
    ds_read_b64_tr_b16 v[58:59], v22 offset:43008
    s_waitcnt lgkmcnt(14)
    v_mfma_f32_32x32x16_bf16 v[176:191], v[76:79], a[96:99], v[176:191]
    ds_read_b64_tr_b16 v[60:61], v23 offset:40960
    ds_read_b64_tr_b16 v[62:63], v23 offset:43008
    s_waitcnt lgkmcnt(14)
    v_mfma_f32_32x32x16_bf16 v[128:143], v[32:35], a[100:103], v[128:143]
    ds_read_b64_tr_b16 v[64:65], v20 offset:45056
    ds_read_b64_tr_b16 v[66:67], v20 offset:47104
    s_waitcnt lgkmcnt(14)
    v_mfma_f32_32x32x16_bf16 v[144:159], v[36:39], a[100:103], v[144:159]
    ds_read_b64_tr_b16 v[68:69], v21 offset:45056
    ds_read_b64_tr_b16 v[70:71], v21 offset:47104
    s_waitcnt lgkmcnt(14)
    v_mfma_f32_32x32x16_bf16 v[160:175], v[40:43], a[100:103], v[160:175]
    ds_read_b64_tr_b16 v[72:73], v22 offset:45056
    ds_read_b64_tr_b16 v[74:75], v22 offset:47104
    s_waitcnt lgkmcnt(14)
    v_mfma_f32_32x32x16_bf16 v[176:191], v[44:47], a[100:103], v[176:191]
    ds_read_b64_tr_b16 v[76:77], v23 offset:45056
    ds_read_b64_tr_b16 v[78:79], v23 offset:47104
    s_waitcnt lgkmcnt(14)
    v_mfma_f32_32x32x16_bf16 v[128:143], v[48:51], a[104:107], v[128:143]
    ds_read_b64_tr_b16 v[32:33], v20 offset:49152
    ds_read_b64_tr_b16 v[34:35], v20 offset:51200
    s_waitcnt lgkmcnt(14)
    v_mfma_f32_32x32x16_bf16 v[144:159], v[52:55], a[104:107], v[144:159]
    ds_read_b64_tr_b16 v[36:37], v21 offset:49152
    ds_read_b64_tr_b16 v[38:39], v21 offset:51200
    s_waitcnt lgkmcnt(14)
    v_mfma_f32_32x32x16_bf16 v[160:175], v[56:59], a[104:107], v[160:175]
    ds_read_b64_tr_b16 v[40:41], v22 offset:49152
    ds_read_b64_tr_b16 v[42:43], v22 offset:51200
    s_waitcnt lgkmcnt(14)
    v_mfma_f32_32x32x16_bf16 v[176:191], v[60:63], a[104:107], v[176:191]
    ds_read_b64_tr_b16 v[44:45], v23 offset:49152
    ds_read_b64_tr_b16 v[46:47], v23 offset:51200
    s_waitcnt lgkmcnt(14)
    v_mfma_f32_32x32x16_bf16 v[128:143], v[64:67], a[108:111], v[128:143]
    ds_read_b64_tr_b16 v[48:49], v20 offset:53248
    ds_read_b64_tr_b16 v[50:51], v20 offset:55296
    s_waitcnt lgkmcnt(14)
    v_mfma_f32_32x32x16_bf16 v[144:159], v[68:71], a[108:111], v[144:159]
    ds_read_b64_tr_b16 v[52:53], v21 offset:53248
    ds_read_b64_tr_b16 v[54:55], v21 offset:55296
    s_waitcnt lgkmcnt(14)
    v_mfma_f32_32x32x16_bf16 v[160:175], v[72:75], a[108:111], v[160:175]
    ds_read_b64_tr_b16 v[56:57], v22 offset:53248
    ds_read_b64_tr_b16 v[58:59], v22 offset:55296
    s_waitcnt lgkmcnt(14)
    v_mfma_f32_32x32x16_bf16 v[176:191], v[76:79], a[108:111], v[176:191]
    ds_read_b64_tr_b16 v[60:61], v23 offset:53248
    ds_read_b64_tr_b16 v[62:63], v23 offset:55296
    s_waitcnt lgkmcnt(14)
    v_mfma_f32_32x32x16_bf16 v[128:143], v[32:35], a[112:115], v[128:143]
    ds_read_b64_tr_b16 v[64:65], v20 offset:57344
    ds_read_b64_tr_b16 v[66:67], v20 offset:59392
    s_waitcnt lgkmcnt(14)
    v_mfma_f32_32x32x16_bf16 v[144:159], v[36:39], a[112:115], v[144:159]
    ds_read_b64_tr_b16 v[68:69], v21 offset:57344
    ds_read_b64_tr_b16 v[70:71], v21 offset:59392
    s_waitcnt lgkmcnt(14)
    v_mfma_f32_32x32x16_bf16 v[160:175], v[40:43], a[112:115], v[160:175]
    ds_read_b64_tr_b16 v[72:73], v22 offset:57344
    ds_read_b64_tr_b16 v[74:75], v22 offset:59392
    s_waitcnt lgkmcnt(14)
    v_mfma_f32_32x32x16_bf16 v[176:191], v[44:47], a[112:115], v[176:191]
    ds_read_b64_tr_b16 v[76:77], v23 offset:57344
    ds_read_b64_tr_b16 v[78:79], v23 offset:59392
    s_waitcnt lgkmcnt(14)
    v_mfma_f32_32x32x16_bf16 v[128:143], v[48:51], a[116:119], v[128:143]
    ds_read_b64_tr_b16 v[32:33], v20 offset:61440
    ds_read_b64_tr_b16 v[34:35], v20 offset:63488
    s_waitcnt lgkmcnt(14)
    v_mfma_f32_32x32x16_bf16 v[144:159], v[52:55], a[116:119], v[144:159]
    ds_read_b64_tr_b16 v[36:37], v21 offset:61440
    ds_read_b64_tr_b16 v[38:39], v21 offset:63488
    s_waitcnt lgkmcnt(14)
    v_mfma_f32_32x32x16_bf16 v[160:175], v[56:59], a[116:119], v[160:175]
    ds_read_b64_tr_b16 v[40:41], v22 offset:61440
    ds_read_b64_tr_b16 v[42:43], v22 offset:63488
    s_waitcnt lgkmcnt(14)
    v_mfma_f32_32x32x16_bf16 v[176:191], v[60:63], a[116:119], v[176:191]
    ds_read_b64_tr_b16 v[44:45], v23 offset:61440
    ds_read_b64_tr_b16 v[46:47], v23 offset:63488
    s_waitcnt lgkmcnt(14)
    v_mfma_f32_32x32x16_bf16 v[128:143], v[64:67], a[120:123], v[128:143]
    s_waitcnt lgkmcnt(12)
    v_mfma_f32_32x32x16_bf16 v[144:159], v[68:71], a[120:123], v[144:159]
    s_waitcnt lgkmcnt(10)
    v_mfma_f32_32x32x16_bf16 v[160:175], v[72:75], a[120:123], v[160:175]
    s_waitcnt lgkmcnt(8)
    v_mfma_f32_32x32x16_bf16 v[176:191], v[76:79], a[120:123], v[176:191]
    s_waitcnt lgkmcnt(6)
    v_mfma_f32_32x32x16_bf16 v[128:143], v[32:35], a[124:127], v[128:143]
    s_waitcnt lgkmcnt(4)
    v_mfma_f32_32x32x16_bf16 v[144:159], v[36:39], a[124:127], v[144:159]
    s_waitcnt lgkmcnt(2)
    v_mfma_f32_32x32x16_bf16 v[160:175], v[40:43], a[124:127], v[160:175]
    s_waitcnt lgkmcnt(0)
    v_mfma_f32_32x32x16_bf16 v[176:191], v[44:47], a[124:127], v[176:191]
    s_nop 7
    s_nop 7
    s_lshl_b32 s18, s22, 18
    s_lshl_b32 s19, s15, 15
    s_add_u32 s18, s18, s19
    s_lshl_b32 s19, s17, 13
    s_add_u32 s18, s18, s19
    s_add_u32 s18, s18, 67108864
    s_add_u32 s19, s18, 4096
    v_cvt_pk_bf16_f32 v128, v128, v129
    v_cvt_pk_bf16_f32 v129, v130, v131
    v_cvt_pk_bf16_f32 v130, v132, v133
    v_cvt_pk_bf16_f32 v131, v134, v135
    v_cvt_pk_bf16_f32 v132, v136, v137
    v_cvt_pk_bf16_f32 v133, v138, v139
    v_cvt_pk_bf16_f32 v134, v140, v141
    v_cvt_pk_bf16_f32 v135, v142, v143
    buffer_store_dwordx4 v[128:131], v2, s[32:35], s18 offen offset:0 sc1
    buffer_store_dwordx4 v[132:135], v2, s[32:35], s18 offen offset:1024 sc1
    v_cvt_pk_bf16_f32 v144, v144, v145
    v_cvt_pk_bf16_f32 v145, v146, v147
    v_cvt_pk_bf16_f32 v146, v148, v149
    v_cvt_pk_bf16_f32 v147, v150, v151
    v_cvt_pk_bf16_f32 v148, v152, v153
    v_cvt_pk_bf16_f32 v149, v154, v155
    v_cvt_pk_bf16_f32 v150, v156, v157
    v_cvt_pk_bf16_f32 v151, v158, v159
    buffer_store_dwordx4 v[144:147], v2, s[32:35], s18 offen offset:2048 sc1
    buffer_store_dwordx4 v[148:151], v2, s[32:35], s18 offen offset:3072 sc1
    v_cvt_pk_bf16_f32 v160, v160, v161
    v_cvt_pk_bf16_f32 v161, v162, v163
    v_cvt_pk_bf16_f32 v162, v164, v165
    v_cvt_pk_bf16_f32 v163, v166, v167
    v_cvt_pk_bf16_f32 v164, v168, v169
    v_cvt_pk_bf16_f32 v165, v170, v171
    v_cvt_pk_bf16_f32 v166, v172, v173
    v_cvt_pk_bf16_f32 v167, v174, v175
    buffer_store_dwordx4 v[160:163], v2, s[32:35], s19 offen offset:0 sc1
    buffer_store_dwordx4 v[164:167], v2, s[32:35], s19 offen offset:1024 sc1
    v_cvt_pk_bf16_f32 v176, v176, v177
    v_cvt_pk_bf16_f32 v177, v178, v179
    v_cvt_pk_bf16_f32 v178, v180, v181
    v_cvt_pk_bf16_f32 v179, v182, v183
    v_cvt_pk_bf16_f32 v180, v184, v185
    v_cvt_pk_bf16_f32 v181, v186, v187
    v_cvt_pk_bf16_f32 v182, v188, v189
    v_cvt_pk_bf16_f32 v183, v190, v191
    buffer_store_dwordx4 v[176:179], v2, s[32:35], s19 offen offset:2048 sc1
    buffer_store_dwordx4 v[180:183], v2, s[32:35], s19 offen offset:3072 sc1
    s_and_b32 s58, s2, 3
    s_lshr_b32 s59, s2, 6
    s_lshl_b32 s59, s59, 2
    s_add_u32 s58, s58, s59
    s_bfe_u32 s59, s2, 0x10002
    s_lshl_b32 s59, s59, 3
    s_bfe_u32 s60, s2, 0x30003
    s_add_u32 s59, s59, s60
    s_lshl_b32 s60, s59, 2
    s_lshr_b32 s61, s58, 2
    s_add_u32 s60, s60, s61
    s_and_b32 s61, s58, 3
    s_lshl_b32 s63, s59, 7
    s_add_u32 s63, s63, 3150848
    s_lshl_b32 s62, s58, 2
    s_add_u32 s62, s62, s63
    s_mov_b32 s36, s56
    s_and_b32 s37, s57, 0xffff
    s_mov_b32 s38, 2097152
    s_mov_b32 s39, 0x20000
    v_lshrrev_b32 v4, 4, v1
    v_bfe_u32 v5, v1, 3, 1
    v_and_b32 v6, 7, v1
    v_lshlrev_b32 v14, 10, v4
    v_lshlrev_b32 v7, 9, v5
    v_add_u32 v14, v14, v7
    v_lshlrev_b32 v7, 4, v6
    v_add_u32 v14, v14, v7
    v_lshlrev_b32 v8, 4, v4
    v_lshlrev_b32 v7, 2, v5
    v_add_u32 v8, v8, v7
    v_lshlrev_b32 v15, 1, v8
    v_lshlrev_b32 v7, 10, v6
    v_add_u32 v15, v15, v7
    v_lshlrev_b32 v9, 2, v8
    s_lshl_b32 s15, s16, 13
    s_lshl_b32 s18, s61, 7
    s_add_u32 s15, s15, s18
    s_lshl_b32 s19, s60, 15
    s_lshl_b32 s18, s61, 13
    s_add_u32 s19, s19, s18
    s_lshl_b32 s18, s16, 8
    s_add_u32 s19, s19, s18
    buffer_load_dwordx2 v[96:97], v15, s[36:39], s19 offen offset:0
    buffer_load_dwordx2 v[98:99], v15, s[36:39], s19 offen offset:16
    buffer_load_dwordx2 v[100:101], v15, s[36:39], s19 offen offset:128
    buffer_load_dwordx2 v[102:103], v15, s[36:39], s19 offen offset:144
    s_lshl_b32 s18, s16, 9
    s_add_u32 s19, s18, 4096
    buffer_load_dwordx4 v[104:107], v9, s[32:35], s19 offen offset:0
    buffer_load_dwordx4 v[108:111], v9, s[32:35], s19 offen offset:32
    buffer_load_dwordx4 v[112:115], v9, s[32:35], s19 offen offset:256
    buffer_load_dwordx4 v[116:119], v9, s[32:35], s19 offen offset:288
    s_add_u32 s19, s18, 6144
    buffer_load_dwordx4 v[120:123], v9, s[32:35], s19 offen offset:0
    buffer_load_dwordx4 v[124:127], v9, s[32:35], s19 offen offset:32
    buffer_load_dwordx4 v[128:131], v9, s[32:35], s19 offen offset:256
    buffer_load_dwordx4 v[132:135], v9, s[32:35], s19 offen offset:288
    s_add_u32 s19, s18, 8192
    buffer_load_dwordx4 v[136:139], v9, s[32:35], s19 offen offset:0
    buffer_load_dwordx4 v[140:143], v9, s[32:35], s19 offen offset:32
    buffer_load_dwordx4 v[144:147], v9, s[32:35], s19 offen offset:256
    buffer_load_dwordx4 v[148:151], v9, s[32:35], s19 offen offset:288
    v_lshlrev_b32 v12, 4, v6
    s_lshl_b32 s18, s16, 2
    v_add_u32 v13, s18, v12
    v_add_u32 v12, 131072, v12
    v_add_u32 v13, 131072, v13
    s_waitcnt vmcnt(16)
    s_barrier
    s_cmp_lg_u32 s16, 0
    s_cbranch_scc1 sy_32
    v_mov_b32 v3, 1
    v_mov_b32 v4, 0
    s_mov_b64 exec, 1
    buffer_store_dword v3, v4, s[32:35], s62 offen sc1
    s_mov_b64 exec, -1
sy_32:
    s_cmp_lg_u32 s16, 0
    s_cbranch_scc1 sy_34
    v_min_u32 v4, 15, v1
    v_lshlrev_b32 v4, 2, v4
    s_mov_b32 s46, 0
sy_33:
    buffer_load_dword v3, v4, s[32:35], s63 offen sc1
    s_waitcnt vmcnt(0)
    v_cmp_ne_u32 vcc, 1, v3
    s_cbranch_vccz sy_34
    s_sleep 1
    s_add_u32 s46, s46, 1
    s_cmp_lt_u32 s46, 30000
    s_cbranch_scc1 sy_33
sy_34:
    s_waitcnt vmcnt(0)
    s_barrier
    s_lshl_b32 s18, s60, 18
    s_add_u32 s18, s18, s15
    s_add_u32 s18, s18, 67108864
    s_add_u32 s19, s18, 4096
    buffer_load_dwordx4 v[32:35], v14, s[32:35], s18 offen sc1
    buffer_load_dwordx4 v[36:39], v14, s[32:35], s19 offen sc1
    s_add_u32 s18, s18, 32768
    s_add_u32 s19, s18, 4096
    buffer_load_dwordx4 v[40:43], v14, s[32:35], s18 offen sc1
    buffer_load_dwordx4 v[44:47], v14, s[32:35], s19 offen sc1
    s_add_u32 s18, s18, 32768
    s_add_u32 s19, s18, 4096
    buffer_load_dwordx4 v[48:51], v14, s[32:35], s18 offen sc1
    buffer_load_dwordx4 v[52:55], v14, s[32:35], s19 offen sc1
    s_add_u32 s18, s18, 32768
    s_add_u32 s19, s18, 4096
    buffer_load_dwordx4 v[56:59], v14, s[32:35], s18 offen sc1
    buffer_load_dwordx4 v[60:63], v14, s[32:35], s19 offen sc1
    s_waitcnt vmcnt(6)
    v_lshlrev_b32 v152, 16, v32
    v_and_b32 v153, 0xffff0000, v32
    v_lshlrev_b32 v154, 16, v33
    v_and_b32 v155, 0xffff0000, v33
    v_lshlrev_b32 v156, 16, v34
    v_and_b32 v157, 0xffff0000, v34
    v_lshlrev_b32 v158, 16, v35
    v_and_b32 v159, 0xffff0000, v35
    v_lshlrev_b32 v160, 16, v36
    v_and_b32 v161, 0xffff0000, v36
    v_lshlrev_b32 v162, 16, v37
    v_and_b32 v163, 0xffff0000, v37
    v_lshlrev_b32 v164, 16, v38
    v_and_b32 v165, 0xffff0000, v38
    v_lshlrev_b32 v166, 16, v39
    v_and_b32 v167, 0xffff0000, v39
    s_waitcnt vmcnt(4)
    v_lshlrev_b32 v168, 16, v40
    v_and_b32 v169, 0xffff0000, v40
    v_lshlrev_b32 v170, 16, v41
    v_and_b32 v171, 0xffff0000, v41
    v_lshlrev_b32 v172, 16, v42
    v_and_b32 v173, 0xffff0000, v42
    v_lshlrev_b32 v174, 16, v43
    v_and_b32 v175, 0xffff0000, v43
    v_add_f32 v152, v152, v168
    v_add_f32 v153, v153, v169
    v_add_f32 v154, v154, v170
    v_add_f32 v155, v155, v171
    v_add_f32 v156, v156, v172
    v_add_f32 v157, v157, v173
    v_add_f32 v158, v158, v174
    v_add_f32 v159, v159, v175
    v_lshlrev_b32 v168, 16, v44
    v_and_b32 v169, 0xffff0000, v44
    v_lshlrev_b32 v170, 16, v45
    v_and_b32 v171, 0xffff0000, v45
    v_lshlrev_b32 v172, 16, v46
    v_and_b32 v173, 0xffff0000, v46
    v_lshlrev_b32 v174, 16, v47
    v_and_b32 v175, 0xffff0000, v47
    v_add_f32 v160, v160, v168
    v_add_f32 v161, v161, v169
    v_add_f32 v162, v162, v170
    v_add_f32 v163, v163, v171
    v_add_f32 v164, v164, v172
    v_add_f32 v165, v165, v173
    v_add_f32 v166, v166, v174
    v_add_f32 v167, v167, v175
    s_waitcnt vmcnt(2)
    v_lshlrev_b32 v168, 16, v48
    v_and_b32 v169, 0xffff0000, v48
    v_lshlrev_b32 v170, 16, v49
    v_and_b32 v171, 0xffff0000, v49
    v_lshlrev_b32 v172, 16, v50
    v_and_b32 v173, 0xffff0000, v50
    v_lshlrev_b32 v174, 16, v51
    v_and_b32 v175, 0xffff0000, v51
    v_add_f32 v152, v152, v168
    v_add_f32 v153, v153, v169
    v_add_f32 v154, v154, v170
    v_add_f32 v155, v155, v171
    v_add_f32 v156, v156, v172
    v_add_f32 v157, v157, v173
    v_add_f32 v158, v158, v174
    v_add_f32 v159, v159, v175
    v_lshlrev_b32 v168, 16, v52
    v_and_b32 v169, 0xffff0000, v52
    v_lshlrev_b32 v170, 16, v53
    v_and_b32 v171, 0xffff0000, v53
    v_lshlrev_b32 v172, 16, v54
    v_and_b32 v173, 0xffff0000, v54
    v_lshlrev_b32 v174, 16, v55
    v_and_b32 v175, 0xffff0000, v55
    v_add_f32 v160, v160, v168
    v_add_f32 v161, v161, v169
    v_add_f32 v162, v162, v170
    v_add_f32 v163, v163, v171
    v_add_f32 v164, v164, v172
    v_add_f32 v165, v165, v173
    v_add_f32 v166, v166, v174
    v_add_f32 v167, v167, v175
    s_waitcnt vmcnt(0)
    v_lshlrev_b32 v168, 16, v56
    v_and_b32 v169, 0xffff0000, v56
    v_lshlrev_b32 v170, 16, v57
    v_and_b32 v171, 0xffff0000, v57
    v_lshlrev_b32 v172, 16, v58
    v_and_b32 v173, 0xffff0000, v58
    v_lshlrev_b32 v174, 16, v59
    v_and_b32 v175, 0xffff0000, v59
    v_add_f32 v152, v152, v168
    v_add_f32 v153, v153, v169
    v_add_f32 v154, v154, v170
    v_add_f32 v155, v155, v171
    v_add_f32 v156, v156, v172
    v_add_f32 v157, v157, v173
    v_add_f32 v158, v158, v174
    v_add_f32 v159, v159, v175
    v_lshlrev_b32 v168, 16, v60
    v_and_b32 v169, 0xffff0000, v60
    v_lshlrev_b32 v170, 16, v61
    v_and_b32 v171, 0xffff0000, v61
    v_lshlrev_b32 v172, 16, v62
    v_and_b32 v173, 0xffff0000, v62
    v_lshlrev_b32 v174, 16, v63
    v_and_b32 v175, 0xffff0000, v63
    v_add_f32 v160, v160, v168
    v_add_f32 v161, v161, v169
    v_add_f32 v162, v162, v170
    v_add_f32 v163, v163, v171
    v_add_f32 v164, v164, v172
    v_add_f32 v165, v165, v173
    v_add_f32 v166, v166, v174
    v_add_f32 v167, v167, v175
    v_cvt_pk_bf16_f32 v10, v152, v153
    v_lshlrev_b32 v152, 16, v10
    v_and_b32 v153, 0xffff0000, v10
    v_cvt_pk_bf16_f32 v10, v154, v155
    v_lshlrev_b32 v154, 16, v10
    v_and_b32 v155, 0xffff0000, v10
    v_cvt_pk_bf16_f32 v10, v156, v157
    v_lshlrev_b32 v156, 16, v10
    v_and_b32 v157, 0xffff0000, v10
    v_cvt_pk_bf16_f32 v10, v158, v159
    v_lshlrev_b32 v158, 16, v10
    v_and_b32 v159, 0xffff0000, v10
    v_cvt_pk_bf16_f32 v10, v160, v161
    v_lshlrev_b32 v160, 16, v10
    v_and_b32 v161, 0xffff0000, v10
    v_cvt_pk_bf16_f32 v10, v162, v163
    v_lshlrev_b32 v162, 16, v10
    v_and_b32 v163, 0xffff0000, v10
    v_cvt_pk_bf16_f32 v10, v164, v165
    v_lshlrev_b32 v164, 16, v10
    v_and_b32 v165, 0xffff0000, v10
    v_cvt_pk_bf16_f32 v10, v166, v167
    v_lshlrev_b32 v166, 16, v10
    v_and_b32 v167, 0xffff0000, v10
    v_lshlrev_b32 v176, 16, v96
    v_and_b32 v177, 0xffff0000, v96
    v_lshlrev_b32 v178, 16, v97
    v_and_b32 v179, 0xffff0000, v97
    v_lshlrev_b32 v180, 16, v98
    v_and_b32 v181, 0xffff0000, v98
    v_lshlrev_b32 v182, 16, v99
    v_and_b32 v183, 0xffff0000, v99
    v_lshlrev_b32 v184, 16, v100
    v_and_b32 v185, 0xffff0000, v100
    v_lshlrev_b32 v186, 16, v101
    v_and_b32 v187, 0xffff0000, v101
    v_lshlrev_b32 v188, 16, v102
    v_and_b32 v189, 0xffff0000, v102
    v_lshlrev_b32 v190, 16, v103
    v_and_b32 v191, 0xffff0000, v103
    v_mul_f32 v152, v152, v104
    v_mul_f32 v153, v153, v105
    v_mul_f32 v154, v154, v106
    v_mul_f32 v155, v155, v107
    v_mul_f32 v156, v156, v108
    v_mul_f32 v157, v157, v109
    v_mul_f32 v158, v158, v110
    v_mul_f32 v159, v159, v111
    v_mul_f32 v160, v160, v112
    v_mul_f32 v161, v161, v113
    v_mul_f32 v162, v162, v114
    v_mul_f32 v163, v163, v115
    v_mul_f32 v164, v164, v116
    v_mul_f32 v165, v165, v117
    v_mul_f32 v166, v166, v118
    v_mul_f32 v167, v167, v119
    v_cvt_pk_bf16_f32 v10, v152, v153
    v_lshlrev_b32 v152, 16, v10
    v_and_b32 v153, 0xffff0000, v10
    v_cvt_pk_bf16_f32 v10, v154, v155
    v_lshlrev_b32 v154, 16, v10
    v_and_b32 v155, 0xffff0000, v10
    v_cvt_pk_bf16_f32 v10, v156, v157
    v_lshlrev_b32 v156, 16, v10
    v_and_b32 v157, 0xffff0000, v10
    v_cvt_pk_bf16_f32 v10, v158, v159
    v_lshlrev_b32 v158, 16, v10
    v_and_b32 v159, 0xffff0000, v10
    v_cvt_pk_bf16_f32 v10, v160, v161
    v_lshlrev_b32 v160, 16, v10
    v_and_b32 v161, 0xffff0000, v10
    v_cvt_pk_bf16_f32 v10, v162, v163
    v_lshlrev_b32 v162, 16, v10
    v_and_b32 v163, 0xffff0000, v10
    v_cvt_pk_bf16_f32 v10, v164, v165
    v_lshlrev_b32 v164, 16, v10
    v_and_b32 v165, 0xffff0000, v10
    v_cvt_pk_bf16_f32 v10, v166, v167
    v_lshlrev_b32 v166, 16, v10
    v_and_b32 v167, 0xffff0000, v10
    v_add_f32 v176, v176, v152
    v_add_f32 v177, v177, v153
    v_add_f32 v178, v178, v154
    v_add_f32 v179, v179, v155
    v_add_f32 v180, v180, v156
    v_add_f32 v181, v181, v157
    v_add_f32 v182, v182, v158
    v_add_f32 v183, v183, v159
    v_add_f32 v184, v184, v160
    v_add_f32 v185, v185, v161
    v_add_f32 v186, v186, v162
    v_add_f32 v187, v187, v163
    v_add_f32 v188, v188, v164
    v_add_f32 v189, v189, v165
    v_add_f32 v190, v190, v166
    v_add_f32 v191, v191, v167
    v_cvt_pk_bf16_f32 v96, v176, v177
    v_cvt_pk_bf16_f32 v97, v178, v179
    v_cvt_pk_bf16_f32 v98, v180, v181
    v_cvt_pk_bf16_f32 v99, v182, v183
    v_cvt_pk_bf16_f32 v100, v184, v185
    v_cvt_pk_bf16_f32 v101, v186, v187
    v_cvt_pk_bf16_f32 v102, v188, v189
    v_cvt_pk_bf16_f32 v103, v190, v191
    s_lshl_b32 s19, s60, 15
    s_add_u32 s19, s19, s15
    s_add_u32 s18, s19, 83886080
    buffer_store_dwordx4 v[96:99], v14, s[32:35], s18 offen sc1
    s_add_u32 s18, s18, 4096
    buffer_store_dwordx4 v[100:103], v14, s[32:35], s18 offen sc1
    v_lshlrev_b32 v176, 16, v96
    v_and_b32 v177, 0xffff0000, v96
    v_lshlrev_b32 v178, 16, v97
    v_and_b32 v179, 0xffff0000, v97
    v_lshlrev_b32 v180, 16, v98
    v_and_b32 v181, 0xffff0000, v98
    v_lshlrev_b32 v182, 16, v99
    v_and_b32 v183, 0xffff0000, v99
    v_lshlrev_b32 v184, 16, v100
    v_and_b32 v185, 0xffff0000, v100
    v_lshlrev_b32 v186, 16, v101
    v_and_b32 v187, 0xffff0000, v101
    v_lshlrev_b32 v188, 16, v102
    v_and_b32 v189, 0xffff0000, v102
    v_lshlrev_b32 v190, 16, v103
    v_and_b32 v191, 0xffff0000, v103
    v_add_f32 v136, 1.0, v136
    v_add_f32 v137, 1.0, v137
    v_add_f32 v138, 1.0, v138
    v_add_f32 v139, 1.0, v139
    v_add_f32 v140, 1.0, v140
    v_add_f32 v141, 1.0, v141
    v_add_f32 v142, 1.0, v142
    v_add_f32 v143, 1.0, v143
    v_add_f32 v144, 1.0, v144
    v_add_f32 v145, 1.0, v145
    v_add_f32 v146, 1.0, v146
    v_add_f32 v147, 1.0, v147
    v_add_f32 v148, 1.0, v148
    v_add_f32 v149, 1.0, v149
    v_add_f32 v150, 1.0, v150
    v_add_f32 v151, 1.0, v151
    v_add_f32 v10, v176, v177
    v_add_f32 v10, v10, v178
    v_add_f32 v10, v10, v179
    v_add_f32 v10, v10, v180
    v_add_f32 v10, v10, v181
    v_add_f32 v10, v10, v182
    v_add_f32 v10, v10, v183
    v_add_f32 v10, v10, v184
    v_add_f32 v10, v10, v185
    v_add_f32 v10, v10, v186
    v_add_f32 v10, v10, v187
    v_add_f32 v10, v10, v188
    v_add_f32 v10, v10, v189
    v_add_f32 v10, v10, v190
    v_add_f32 v10, v10, v191
    s_nop 1
    v_add_f32_dpp v10, v10, v10 row_ror:8 row_mask:0xf bank_mask:0xf
    v_mov_b32 v11, v10
    s_nop 1
    v_permlane16_swap_b32 v10, v11
    s_nop 1
    v_add_f32 v10, v10, v11
    v_mov_b32 v11, v10
    s_nop 1
    v_permlane32_swap_b32 v10, v11
    s_nop 1
    v_add_f32 v10, v10, v11
    ds_write_b32 v13, v10 offset:0
    s_waitcnt lgkmcnt(0)
    s_barrier
    ds_read_b128 v[56:59], v12 offset:0
    s_waitcnt lgkmcnt(0)
    v_add_f32 v56, v56, v57
    v_add_f32 v58, v58, v59
    v_add_f32 v10, v56, v58
    v_mul_f32 v10, 0xbb000000, v10
    v_add_f32 v176, v176, v10
    v_add_f32 v177, v177, v10
    v_add_f32 v178, v178, v10
    v_add_f32 v179, v179, v10
    v_add_f32 v180, v180, v10
    v_add_f32 v181, v181, v10
    v_add_f32 v182, v182, v10
    v_add_f32 v183, v183, v10
    v_add_f32 v184, v184, v10
    v_add_f32 v185, v185, v10
    v_add_f32 v186, v186, v10
    v_add_f32 v187, v187, v10
    v_add_f32 v188, v188, v10
    v_add_f32 v189, v189, v10
    v_add_f32 v190, v190, v10
    v_add_f32 v191, v191, v10
    v_mul_f32 v10, v176, v176
    v_fmac_f32 v10, v177, v177
    v_fmac_f32 v10, v178, v178
    v_fmac_f32 v10, v179, v179
    v_fmac_f32 v10, v180, v180
    v_fmac_f32 v10, v181, v181
    v_fmac_f32 v10, v182, v182
    v_fmac_f32 v10, v183, v183
    v_fmac_f32 v10, v184, v184
    v_fmac_f32 v10, v185, v185
    v_fmac_f32 v10, v186, v186
    v_fmac_f32 v10, v187, v187
    v_fmac_f32 v10, v188, v188
    v_fmac_f32 v10, v189, v189
    v_fmac_f32 v10, v190, v190
    v_fmac_f32 v10, v191, v191
    s_nop 1
    v_add_f32_dpp v10, v10, v10 row_ror:8 row_mask:0xf bank_mask:0xf
    v_mov_b32 v11, v10
    s_nop 1
    v_permlane16_swap_b32 v10, v11
    s_nop 1
    v_add_f32 v10, v10, v11
    v_mov_b32 v11, v10
    s_nop 1
    v_permlane32_swap_b32 v10, v11
    s_nop 1
    v_add_f32 v10, v10, v11
    ds_write_b32 v13, v10 offset:128
    s_waitcnt lgkmcnt(0)
    s_barrier
    ds_read_b128 v[56:59], v12 offset:128
    s_waitcnt lgkmcnt(0)
    v_add_f32 v56, v56, v57
    v_add_f32 v58, v58, v59
    v_add_f32 v10, v56, v58
    v_mul_f32 v10, 0x3b000000, v10
    v_add_f32 v10, 0x3727c5ac, v10
    v_rsq_f32 v10, v10
    s_nop 0
    v_mul_f32 v176, v176, v10
    v_mul_f32 v177, v177, v10
    v_mul_f32 v178, v178, v10
    v_mul_f32 v179, v179, v10
    v_mul_f32 v180, v180, v10
    v_mul_f32 v181, v181, v10
    v_mul_f32 v182, v182, v10
    v_mul_f32 v183, v183, v10
    v_mul_f32 v184, v184, v10
    v_mul_f32 v185, v185, v10
    v_mul_f32 v186, v186, v10
    v_mul_f32 v187, v187, v10
    v_mul_f32 v188, v188, v10
    v_mul_f32 v189, v189, v10
    v_mul_f32 v190, v190, v10
    v_mul_f32 v191, v191, v10
    v_fma_f32 v176, v176, v136, v120
    v_fma_f32 v177, v177, v137, v121
    v_fma_f32 v178, v178, v138, v122
    v_fma_f32 v179, v179, v139, v123
    v_fma_f32 v180, v180, v140, v124
    v_fma_f32 v181, v181, v141, v125
    v_fma_f32 v182, v182, v142, v126
    v_fma_f32 v183, v183, v143, v127
    v_fma_f32 v184, v184, v144, v128
    v_fma_f32 v185, v185, v145, v129
    v_fma_f32 v186, v186, v146, v130
    v_fma_f32 v187, v187, v147, v131
    v_fma_f32 v188, v188, v148, v132
    v_fma_f32 v189, v189, v149, v133
    v_fma_f32 v190, v190, v150, v134
    v_fma_f32 v191, v191, v151, v135
    v_cvt_pk_bf16_f32 v96, v176, v177
    v_cvt_pk_bf16_f32 v97, v178, v179
    v_cvt_pk_bf16_f32 v98, v180, v181
    v_cvt_pk_bf16_f32 v99, v182, v183
    v_cvt_pk_bf16_f32 v100, v184, v185
    v_cvt_pk_bf16_f32 v101, v186, v187
    v_cvt_pk_bf16_f32 v102, v188, v189
    v_cvt_pk_bf16_f32 v103, v190, v191
    s_add_u32 s18, s19, 85983232
    buffer_store_dwordx4 v[96:99], v14, s[32:35], s18 offen sc1
    s_add_u32 s18, s18, 4096
    buffer_store_dwordx4 v[100:103], v14, s[32:35], s18 offen sc1
    s_lshr_b32 s62, s60, 2
    s_lshl_b32 s62, s62, 7
    s_and_b32 s63, s60, 3
    s_lshl_b32 s63, s63, 4
    s_add_u32 s62, s62, s63
    s_lshl_b32 s63, s61, 2
    s_add_u32 s62, s62, s63
    s_add_u32 s62, s62, 3146752
    s_and_b32 s63, s2, 3
    s_lshl_b32 s63, s63, 2
    s_bfe_u32 s66, s2, 0x20003
    s_add_u32 s63, s63, s66
    s_bfe_u32 s66, s2, 0x10002
    s_mul_i32 s66, s66, 7
    s_lshr_b32 s65, s2, 5
    s_add_u32 s66, s66, s65
    s_lshl_b32 s63, s63, 7
    s_add_u32 s63, s63, 3146752
    s_cmp_ge_u32 s2, 224
    s_cbranch_scc1 n3_35
    s_waitcnt vmcnt(0)
    s_barrier
    s_cmp_lg_u32 s16, 0
    s_cbranch_scc1 sy_38
    v_mov_b32 v3, 1
    v_mov_b32 v4, 0
    s_mov_b64 exec, 1
    buffer_store_dword v3, v4, s[32:35], s62 offen sc1
    s_mov_b64 exec, -1
    s_branch sy_37
sy_38:
    s_cmp_ge_u32 s2, 224
    s_cbranch_scc1 w1_41
    s_mov_b32 s24, s6
    s_and_b32 s25, s7, 0xffff
    s_mov_b32 s26, 1835008
    s_mov_b32 s27, 0x20000
    v_lshrrev_b32 v6, 4, v1
    v_and_b32 v5, 15, v1
    v_lshlrev_b32 v7, 2, v6
    v_xor_b32 v5, v5, v7
    v_lshlrev_b32 v5, 4, v5
    s_mov_b32 s18, 3584
    v_mul_lo_u32 v7, v6, s18
    v_add_u32 v10, v7, v5
    s_sub_u32 s18, s16, 1
    s_mul_i32 s19, s18, 14336
    s_and_b32 s66, s2, 3
    s_lshl_b32 s66, s66, 2
    s_bfe_u32 s20, s2, 0x20003
    s_add_u32 s66, s66, s20
    s_bfe_u32 s20, s2, 0x10002
    s_mul_i32 s20, s20, 7
    s_lshr_b32 s65, s2, 5
    s_add_u32 s20, s20, s65
    s_lshl_b32 s20, s20, 8
    s_add_u32 s19, s19, s20
    s_lshl_b32 m0, s18, 10
    s_nop 0
    buffer_load_dwordx4 v10, s[24:27], s19 offen lds
    s_add_u32 s19, s19, 43008
    s_add_u32 m0, m0, 3072
    s_nop 0
    buffer_load_dwordx4 v10, s[24:27], s19 offen lds
    s_add_u32 s19, s19, 43008
    s_add_u32 m0, m0, 3072
    s_nop 0
    buffer_load_dwordx4 v10, s[24:27], s19 offen lds
    s_add_u32 s19, s19, 43008
    s_add_u32 m0, m0, 3072
    s_nop 0
    buffer_load_dwordx4 v10, s[24:27], s19 offen lds
    s_add_u32 s19, s19, 43008
    s_add_u32 m0, m0, 3072
    s_nop 0
    buffer_load_dwordx4 v10, s[24:27], s19 offen lds
    s_add_u32 s19, s19, 43008
    s_add_u32 m0, m0, 3072
    s_nop 0
    buffer_load_dwordx4 v10, s[24:27], s19 offen lds
    s_add_u32 s19, s19, 43008
    s_add_u32 m0, m0, 3072
    s_nop 0
    buffer_load_dwordx4 v10, s[24:27], s19 offen lds
    s_add_u32 s19, s19, 43008
    s_add_u32 m0, m0, 3072
    s_nop 0
    buffer_load_dwordx4 v10, s[24:27], s19 offen lds
    s_add_u32 s19, s19, 43008
    s_add_u32 m0, m0, 3072
    s_nop 0
    buffer_load_dwordx4 v10, s[24:27], s19 offen lds
    s_add_u32 s19, s19, 43008
    s_add_u32 m0, m0, 3072
    s_nop 0
    buffer_load_dwordx4 v10, s[24:27], s19 offen lds
    s_add_u32 s19, s19, 43008
    s_add_u32 m0, m0, 3072
    s_nop 0
    buffer_load_dwordx4 v10, s[24:27], s19 offen lds
    s_add_u32 s19, s19, 43008
    s_add_u32 m0, m0, 3072
    s_nop 0
    buffer_load_dwordx4 v10, s[24:27], s19 offen lds
    s_add_u32 s19, s19, 43008
    s_add_u32 m0, m0, 3072
    s_nop 0
    buffer_load_dwordx4 v10, s[24:27], s19 offen lds
    s_add_u32 s19, s19, 43008
    s_add_u32 m0, m0, 3072
    s_nop 0
    buffer_load_dwordx4 v10, s[24:27], s19 offen lds
    s_add_u32 s19, s19, 43008
    s_add_u32 m0, m0, 3072
    s_nop 0
    buffer_load_dwordx4 v10, s[24:27], s19 offen lds
    s_add_u32 s19, s19, 43008
    s_add_u32 m0, m0, 3072
    s_nop 0
    buffer_load_dwordx4 v10, s[24:27], s19 offen lds
    s_add_u32 s19, s19, 43008
    s_add_u32 m0, m0, 3072
    s_nop 0
    buffer_load_dwordx4 v10, s[24:27], s19 offen lds
    s_add_u32 s19, s19, 43008
    s_add_u32 m0, m0, 3072
    s_nop 0
    buffer_load_dwordx4 v10, s[24:27], s19 offen lds
    s_add_u32 s19, s19, 43008
    s_add_u32 m0, m0, 3072
    s_nop 0
    buffer_load_dwordx4 v10, s[24:27], s19 offen lds
    s_add_u32 s19, s19, 43008
    s_add_u32 m0, m0, 3072
    s_nop 0
    buffer_load_dwordx4 v10, s[24:27], s19 offen lds
    s_add_u32 s19, s19, 43008
    s_add_u32 m0, m0, 3072
    s_nop 0
    buffer_load_dwordx4 v10, s[24:27], s19 offen lds
    s_add_u32 s19, s19, 43008
    s_add_u32 m0, m0, 3072
    s_nop 0
    buffer_load_dwordx4 v10, s[24:27], s19 offen lds
    s_add_u32 s19, s19, 43008
    s_add_u32 m0, m0, 3072
    s_nop 0
    buffer_load_dwordx4 v10, s[24:27], s19 offen lds
    s_add_u32 s19, s19, 43008
    s_add_u32 m0, m0, 3072
    s_nop 0
    buffer_load_dwordx4 v10, s[24:27], s19 offen lds
    s_add_u32 s19, s19, 43008
    s_add_u32 m0, m0, 3072
    s_nop 0
    buffer_load_dwordx4 v10, s[24:27], s19 offen lds
    s_add_u32 s19, s19, 43008
    s_add_u32 m0, m0, 3072
    s_nop 0
    buffer_load_dwordx4 v10, s[24:27], s19 offen lds
    s_add_u32 s19, s19, 43008
    s_add_u32 m0, m0, 3072
    s_nop 0
    buffer_load_dwordx4 v10, s[24:27], s19 offen lds
    s_add_u32 s19, s19, 43008
    s_add_u32 m0, m0, 3072
    s_nop 0
    buffer_load_dwordx4 v10, s[24:27], s19 offen lds
    s_add_u32 s19, s19, 43008
    s_add_u32 m0, m0, 3072
    s_nop 0
    buffer_load_dwordx4 v10, s[24:27], s19 offen lds
    s_add_u32 s19, s19, 43008
    s_add_u32 m0, m0, 3072
    s_nop 0
    buffer_load_dwordx4 v10, s[24:27], s19 offen lds
    s_add_u32 s19, s19, 43008
    s_add_u32 m0, m0, 3072
    s_nop 0
    buffer_load_dwordx4 v10, s[24:27], s19 offen lds
    s_add_u32 s19, s19, 43008
    s_add_u32 m0, m0, 3072
    s_nop 0
    buffer_load_dwordx4 v10, s[24:27], s19 offen lds
    s_add_u32 s19, s19, 43008
    s_add_u32 m0, m0, 3072
    s_nop 0
    buffer_load_dwordx4 v10, s[24:27], s19 offen lds
    s_add_u32 s19, s19, 43008
    s_add_u32 m0, m0, 3072
    s_nop 0
    buffer_load_dwordx4 v10, s[24:27], s19 offen lds
    s_add_u32 s19, s19, 43008
    s_add_u32 m0, m0, 3072
    s_nop 0
    buffer_load_dwordx4 v10, s[24:27], s19 offen lds
    s_add_u32 s19, s19, 43008
    s_add_u32 m0, m0, 3072
    s_nop 0
    buffer_load_dwordx4 v10, s[24:27], s19 offen lds
    s_add_u32 s19, s19, 43008
    s_add_u32 m0, m0, 3072
    s_nop 0
    buffer_load_dwordx4 v10, s[24:27], s19 offen lds
    s_add_u32 s19, s19, 43008
    s_add_u32 m0, m0, 3072
    s_nop 0
    buffer_load_dwordx4 v10, s[24:27], s19 offen lds
    s_add_u32 s19, s19, 43008
    s_add_u32 m0, m0, 3072
    s_nop 0
    buffer_load_dwordx4 v10, s[24:27], s19 offen lds
    s_add_u32 s19, s19, 43008
    s_add_u32 m0, m0, 3072
    s_nop 0
    buffer_load_dwordx4 v10, s[24:27], s19 offen lds
    s_add_u32 s19, s19, 43008
    s_add_u32 m0, m0, 3072
    s_nop 0
    buffer_load_dwordx4 v10, s[24:27], s19 offen lds
    s_add_u32 s19, s19, 43008
    s_add_u32 m0, m0, 3072
    s_nop 0
    buffer_load_dwordx4 v10, s[24:27], s19 offen lds
    s_add_u32 s19, s19, 43008
    s_add_u32 m0, m0, 3072
    s_nop 0
    buffer_load_dwordx4 v10, s[24:27], s19 offen lds
w1_41:
    s_branch sy_40
sy_37:
    s_cmp_lg_u32 s16, 0
    s_cbranch_scc1 sy_40
    v_min_u32 v4, 15, v1
    v_lshlrev_b32 v4, 2, v4
    s_mov_b32 s46, 0
sy_39:
    buffer_load_dword v3, v4, s[32:35], s63 offen sc1
    s_waitcnt vmcnt(0)
    v_cmp_ne_u32 vcc, 1, v3
    s_cbranch_vccz sy_40
    s_sleep 1
    s_add_u32 s46, s46, 1
    s_cmp_lt_u32 s46, 30000
    s_cbranch_scc1 sy_39
sy_40:
    s_waitcnt vmcnt(0)
    s_barrier
    s_and_b32 s14, s2, 3
    s_lshl_b32 s14, s14, 2
    s_bfe_u32 s17, s2, 0x20003
    s_add_u32 s14, s14, s17
    s_bfe_u32 s17, s2, 0x10002
    s_mul_i32 s17, s17, 7
    s_lshr_b32 s65, s2, 5
    s_add_u32 s17, s17, s65
    s_lshl_b32 s20, s17, 8
    s_lshl_b32 s22, s14, 2
    s_add_u32 s22, s22, s16
    s_lshl_b32 s21, s22, 15
    s_add_u32 s21, s21, 85983232
    v_lshrrev_b32 v6, 4, v1
    v_and_b32 v5, 15, v1
    v_lshlrev_b32 v7, 2, v6
    v_xor_b32 v5, v5, v7
    v_lshlrev_b32 v5, 4, v5
    s_mul_i32 s18, s16, 32
    v_add_u32 v7, s18, v6
    s_mov_b32 s18, 3584
    v_mul_lo_u32 v7, v7, s18
    v_add_u32 v10, v7, v5
    v_add_u32 v11, 13312, v10
    v_add_u32 v12, 26624, v10
    v_add_u32 v13, 39936, v10
    s_add_u32 s47, s21, 0
    buffer_load_dwordx4 a[0:3], v2, s[32:35], s47 offen offset:0 sc1
    s_add_u32 s47, s21, 0
    buffer_load_dwordx4 a[4:7], v2, s[32:35], s47 offen offset:1024 sc1
    s_add_u32 s47, s21, 0
    buffer_load_dwordx4 a[8:11], v2, s[32:35], s47 offen offset:2048 sc1
    s_add_u32 s47, s21, 0
    buffer_load_dwordx4 a[12:15], v2, s[32:35], s47 offen offset:3072 sc1
    s_add_u32 s47, s21, 4096
    buffer_load_dwordx4 a[16:19], v2, s[32:35], s47 offen offset:0 sc1
    s_add_u32 s47, s21, 4096
    buffer_load_dwordx4 a[20:23], v2, s[32:35], s47 offen offset:1024 sc1
    s_add_u32 s47, s21, 4096
    buffer_load_dwordx4 a[24:27], v2, s[32:35], s47 offen offset:2048 sc1
    s_add_u32 s47, s21, 4096
    buffer_load_dwordx4 a[28:31], v2, s[32:35], s47 offen offset:3072 sc1
    v_lshrrev_b32 v4, 4, v1
    v_bfe_u32 v5, v1, 2, 2
    v_and_b32 v6, 3, v1
    v_lshrrev_b32 v7, 1, v4
    v_lshlrev_b32 v7, 2, v7
    v_add_u32 v7, v7, v5
    v_mul_u32_u24 v7, 256, v7
    v_and_b32 v8, 1, v4
    v_lshlrev_b32 v8, 1, v8
    v_lshrrev_b32 v9, 1, v6
    v_add_u32 v8, v8, v9
    v_lshlrev_b32 v8, 4, v8
    v_and_b32 v9, 1, v6
    v_lshlrev_b32 v9, 3, v9
    v_add_u32 v8, v8, v9
    v_add_u32 v7, v7, v8
    v_xor_b32 v8, 0, v5
    v_lshlrev_b32 v8, 6, v8
    v_add_u32 v16, v7, v8
    v_add_u32 v20, 65536, v16
    v_xor_b32 v8, 1, v5
    v_lshlrev_b32 v8, 6, v8
    v_add_u32 v17, v7, v8
    v_add_u32 v21, 65536, v17
    v_xor_b32 v8, 2, v5
    v_lshlrev_b32 v8, 6, v8
    v_add_u32 v18, v7, v8
    v_add_u32 v22, 65536, v18
    v_xor_b32 v8, 3, v5
    v_lshlrev_b32 v8, 6, v8
    v_add_u32 v19, v7, v8
    v_add_u32 v23, 65536, v19
    s_mul_i32 s40, s22, 114688
    s_lshl_b32 s41, s17, 13
    s_add_u32 s40, s40, s41
    s_add_u32 s40, s40, 88080384
    s_add_u32 s41, s40, 4096
    ds_read_b64_tr_b16 v[32:33], v16 offset:0
    ds_read_b64_tr_b16 v[34:35], v16 offset:2048
    ds_read_b64_tr_b16 v[36:37], v17 offset:0
    ds_read_b64_tr_b16 v[38:39], v17 offset:2048
    ds_read_b64_tr_b16 v[40:41], v16 offset:4096
    ds_read_b64_tr_b16 v[42:43], v16 offset:6144
    ds_read_b64_tr_b16 v[44:45], v17 offset:4096
    ds_read_b64_tr_b16 v[46:47], v17 offset:6144
    ds_read_b64_tr_b16 v[48:49], v16 offset:8192
    ds_read_b64_tr_b16 v[50:51], v16 offset:10240
    ds_read_b64_tr_b16 v[52:53], v17 offset:8192
    ds_read_b64_tr_b16 v[54:55], v17 offset:10240
    s_waitcnt vmcnt(7)
    s_waitcnt lgkmcnt(10)
    v_mfma_f32_32x32x16_bf16 v[128:143], v[32:35], a[0:3], 0
    ds_read_b64_tr_b16 v[56:57], v16 offset:12288
    ds_read_b64_tr_b16 v[58:59], v16 offset:14336
    s_add_u32 s47, s21, 8192
    buffer_load_dwordx4 a[32:35], v2, s[32:35], s47 offen offset:0 sc1
    s_waitcnt lgkmcnt(10)
    v_mfma_f32_32x32x16_bf16 v[144:159], v[36:39], a[0:3], 0
    ds_read_b64_tr_b16 v[60:61], v17 offset:12288
    ds_read_b64_tr_b16 v[62:63], v17 offset:14336
    s_add_u32 s47, s21, 8192
    buffer_load_dwordx4 a[36:39], v2, s[32:35], s47 offen offset:1024 sc1
    s_waitcnt vmcnt(8)
    s_waitcnt lgkmcnt(10)
    v_mfma_f32_32x32x16_bf16 v[128:143], v[40:43], a[4:7], v[128:143]
    ds_read_b64_tr_b16 v[32:33], v16 offset:16384
    ds_read_b64_tr_b16 v[34:35], v16 offset:18432
    s_add_u32 s47, s21, 8192
    buffer_load_dwordx4 a[40:43], v2, s[32:35], s47 offen offset:2048 sc1
    s_waitcnt lgkmcnt(10)
    v_mfma_f32_32x32x16_bf16 v[144:159], v[44:47], a[4:7], v[144:159]
    ds_read_b64_tr_b16 v[36:37], v17 offset:16384
    ds_read_b64_tr_b16 v[38:39], v17 offset:18432
    s_add_u32 s47, s21, 8192
    buffer_load_dwordx4 a[44:47], v2, s[32:35], s47 offen offset:3072 sc1
    s_waitcnt vmcnt(9)
    s_waitcnt lgkmcnt(10)
    v_mfma_f32_32x32x16_bf16 v[128:143], v[48:51], a[8:11], v[128:143]
    ds_read_b64_tr_b16 v[40:41], v16 offset:20480
    ds_read_b64_tr_b16 v[42:43], v16 offset:22528
    s_add_u32 s47, s21, 12288
    buffer_load_dwordx4 a[48:51], v2, s[32:35], s47 offen offset:0 sc1
    s_waitcnt lgkmcnt(10)
    v_mfma_f32_32x32x16_bf16 v[144:159], v[52:55], a[8:11], v[144:159]
    ds_read_b64_tr_b16 v[44:45], v17 offset:20480
    ds_read_b64_tr_b16 v[46:47], v17 offset:22528
    s_add_u32 s47, s21, 12288
    buffer_load_dwordx4 a[52:55], v2, s[32:35], s47 offen offset:1024 sc1
    s_waitcnt vmcnt(10)
    s_waitcnt lgkmcnt(10)
    v_mfma_f32_32x32x16_bf16 v[128:143], v[56:59], a[12:15], v[128:143]
    ds_read_b64_tr_b16 v[48:49], v16 offset:24576
    ds_read_b64_tr_b16 v[50:51], v16 offset:26624
    s_add_u32 s47, s21, 12288
    buffer_load_dwordx4 a[56:59], v2, s[32:35], s47 offen offset:2048 sc1
    s_waitcnt lgkmcnt(10)
    v_mfma_f32_32x32x16_bf16 v[144:159], v[60:63], a[12:15], v[144:159]
    ds_read_b64_tr_b16 v[52:53], v17 offset:24576
    ds_read_b64_tr_b16 v[54:55], v17 offset:26624
    s_add_u32 s47, s21, 12288
    buffer_load_dwordx4 a[60:63], v2, s[32:35], s47 offen offset:3072 sc1
    s_waitcnt vmcnt(11)
    s_waitcnt lgkmcnt(10)
    v_mfma_f32_32x32x16_bf16 v[128:143], v[32:35], a[16:19], v[128:143]
    ds_read_b64_tr_b16 v[56:57], v16 offset:28672
    ds_read_b64_tr_b16 v[58:59], v16 offset:30720
    s_add_u32 s47, s21, 16384
    buffer_load_dwordx4 a[64:67], v2, s[32:35], s47 offen offset:0 sc1
    s_waitcnt lgkmcnt(10)
    v_mfma_f32_32x32x16_bf16 v[144:159], v[36:39], a[16:19], v[144:159]
    ds_read_b64_tr_b16 v[60:61], v17 offset:28672
    ds_read_b64_tr_b16 v[62:63], v17 offset:30720
    s_add_u32 s47, s21, 16384
    buffer_load_dwordx4 a[68:71], v2, s[32:35], s47 offen offset:1024 sc1
    s_waitcnt vmcnt(12)
    s_waitcnt lgkmcnt(10)
    v_mfma_f32_32x32x16_bf16 v[128:143], v[40:43], a[20:23], v[128:143]
    ds_read_b64_tr_b16 v[32:33], v16 offset:32768
    ds_read_b64_tr_b16 v[34:35], v16 offset:34816
    s_add_u32 s47, s21, 16384
    buffer_load_dwordx4 a[72:75], v2, s[32:35], s47 offen offset:2048 sc1
    s_waitcnt lgkmcnt(10)
    v_mfma_f32_32x32x16_bf16 v[144:159], v[44:47], a[20:23], v[144:159]
    ds_read_b64_tr_b16 v[36:37], v17 offset:32768
    ds_read_b64_tr_b16 v[38:39], v17 offset:34816
    s_add_u32 s47, s21, 16384
    buffer_load_dwordx4 a[76:79], v2, s[32:35], s47 offen offset:3072 sc1
    s_waitcnt vmcnt(13)
    s_waitcnt lgkmcnt(10)
    v_mfma_f32_32x32x16_bf16 v[128:143], v[48:51], a[24:27], v[128:143]
    ds_read_b64_tr_b16 v[40:41], v16 offset:36864
    ds_read_b64_tr_b16 v[42:43], v16 offset:38912
    s_add_u32 s47, s21, 20480
    buffer_load_dwordx4 a[80:83], v2, s[32:35], s47 offen offset:0 sc1
    s_waitcnt lgkmcnt(10)
    v_mfma_f32_32x32x16_bf16 v[144:159], v[52:55], a[24:27], v[144:159]
    ds_read_b64_tr_b16 v[44:45], v17 offset:36864
    ds_read_b64_tr_b16 v[46:47], v17 offset:38912
    s_add_u32 s47, s21, 20480
    buffer_load_dwordx4 a[84:87], v2, s[32:35], s47 offen offset:1024 sc1
    s_waitcnt vmcnt(14)
    s_waitcnt lgkmcnt(10)
    v_mfma_f32_32x32x16_bf16 v[128:143], v[56:59], a[28:31], v[128:143]
    ds_read_b64_tr_b16 v[48:49], v16 offset:40960
    ds_read_b64_tr_b16 v[50:51], v16 offset:43008
    s_add_u32 s47, s21, 20480
    buffer_load_dwordx4 a[88:91], v2, s[32:35], s47 offen offset:2048 sc1
    s_waitcnt lgkmcnt(10)
    v_mfma_f32_32x32x16_bf16 v[144:159], v[60:63], a[28:31], v[144:159]
    ds_read_b64_tr_b16 v[52:53], v17 offset:40960
    ds_read_b64_tr_b16 v[54:55], v17 offset:43008
    s_add_u32 s47, s21, 20480
    buffer_load_dwordx4 a[92:95], v2, s[32:35], s47 offen offset:3072 sc1
    s_waitcnt vmcnt(15)
    s_waitcnt lgkmcnt(10)
    v_mfma_f32_32x32x16_bf16 v[128:143], v[32:35], a[32:35], v[128:143]
    ds_read_b64_tr_b16 v[56:57], v16 offset:45056
    ds_read_b64_tr_b16 v[58:59], v16 offset:47104
    s_add_u32 s47, s21, 24576
    buffer_load_dwordx4 a[96:99], v2, s[32:35], s47 offen offset:0 sc1
    s_waitcnt lgkmcnt(10)
    v_mfma_f32_32x32x16_bf16 v[144:159], v[36:39], a[32:35], v[144:159]
    ds_read_b64_tr_b16 v[60:61], v17 offset:45056
    ds_read_b64_tr_b16 v[62:63], v17 offset:47104
    s_add_u32 s47, s21, 24576
    buffer_load_dwordx4 a[100:103], v2, s[32:35], s47 offen offset:1024 sc1
    s_waitcnt vmcnt(16)
    s_waitcnt lgkmcnt(10)
    v_mfma_f32_32x32x16_bf16 v[128:143], v[40:43], a[36:39], v[128:143]
    ds_read_b64_tr_b16 v[32:33], v16 offset:49152
    ds_read_b64_tr_b16 v[34:35], v16 offset:51200
    s_add_u32 s47, s21, 24576
    buffer_load_dwordx4 a[104:107], v2, s[32:35], s47 offen offset:2048 sc1
    s_waitcnt lgkmcnt(10)
    v_mfma_f32_32x32x16_bf16 v[144:159], v[44:47], a[36:39], v[144:159]
    ds_read_b64_tr_b16 v[36:37], v17 offset:49152
    ds_read_b64_tr_b16 v[38:39], v17 offset:51200
    s_add_u32 s47, s21, 24576
    buffer_load_dwordx4 a[108:111], v2, s[32:35], s47 offen offset:3072 sc1
    s_waitcnt vmcnt(17)
    s_waitcnt lgkmcnt(10)
    v_mfma_f32_32x32x16_bf16 v[128:143], v[48:51], a[40:43], v[128:143]
    ds_read_b64_tr_b16 v[40:41], v16 offset:53248
    ds_read_b64_tr_b16 v[42:43], v16 offset:55296
    s_add_u32 s47, s21, 28672
    buffer_load_dwordx4 a[112:115], v2, s[32:35], s47 offen offset:0 sc1
    s_waitcnt lgkmcnt(10)
    v_mfma_f32_32x32x16_bf16 v[144:159], v[52:55], a[40:43], v[144:159]
    ds_read_b64_tr_b16 v[44:45], v17 offset:53248
    ds_read_b64_tr_b16 v[46:47], v17 offset:55296
    s_add_u32 s47, s21, 28672
    buffer_load_dwordx4 a[116:119], v2, s[32:35], s47 offen offset:1024 sc1
    s_waitcnt vmcnt(18)
    s_waitcnt lgkmcnt(10)
    v_mfma_f32_32x32x16_bf16 v[128:143], v[56:59], a[44:47], v[128:143]
    ds_read_b64_tr_b16 v[48:49], v16 offset:57344
    ds_read_b64_tr_b16 v[50:51], v16 offset:59392
    s_add_u32 s47, s21, 28672
    buffer_load_dwordx4 a[120:123], v2, s[32:35], s47 offen offset:2048 sc1
    s_waitcnt lgkmcnt(10)
    v_mfma_f32_32x32x16_bf16 v[144:159], v[60:63], a[44:47], v[144:159]
    ds_read_b64_tr_b16 v[52:53], v17 offset:57344
    ds_read_b64_tr_b16 v[54:55], v17 offset:59392
    s_add_u32 s47, s21, 28672
    buffer_load_dwordx4 a[124:127], v2, s[32:35], s47 offen offset:3072 sc1
    s_waitcnt vmcnt(19)
    s_waitcnt lgkmcnt(10)
    v_mfma_f32_32x32x16_bf16 v[128:143], v[32:35], a[48:51], v[128:143]
    ds_read_b64_tr_b16 v[56:57], v16 offset:61440
    ds_read_b64_tr_b16 v[58:59], v16 offset:63488
    s_waitcnt lgkmcnt(10)
    v_mfma_f32_32x32x16_bf16 v[144:159], v[36:39], a[48:51], v[144:159]
    ds_read_b64_tr_b16 v[60:61], v17 offset:61440
    ds_read_b64_tr_b16 v[62:63], v17 offset:63488
    s_waitcnt vmcnt(18)
    s_waitcnt lgkmcnt(10)
    v_mfma_f32_32x32x16_bf16 v[128:143], v[40:43], a[52:55], v[128:143]
    ds_read_b64_tr_b16 v[32:33], v20 offset:0
    ds_read_b64_tr_b16 v[34:35], v20 offset:2048
    s_waitcnt lgkmcnt(10)
    v_mfma_f32_32x32x16_bf16 v[144:159], v[44:47], a[52:55], v[144:159]
    ds_read_b64_tr_b16 v[36:37], v21 offset:0
    ds_read_b64_tr_b16 v[38:39], v21 offset:2048
    s_waitcnt vmcnt(17)
    s_waitcnt lgkmcnt(10)
    v_mfma_f32_32x32x16_bf16 v[128:143], v[48:51], a[56:59], v[128:143]
    ds_read_b64_tr_b16 v[40:41], v20 offset:4096
    ds_read_b64_tr_b16 v[42:43], v20 offset:6144
    s_waitcnt lgkmcnt(10)
    v_mfma_f32_32x32x16_bf16 v[144:159], v[52:55], a[56:59], v[144:159]
    ds_read_b64_tr_b16 v[44:45], v21 offset:4096
    ds_read_b64_tr_b16 v[46:47], v21 offset:6144
    s_waitcnt vmcnt(16)
    s_waitcnt lgkmcnt(10)
    v_mfma_f32_32x32x16_bf16 v[128:143], v[56:59], a[60:63], v[128:143]
    ds_read_b64_tr_b16 v[48:49], v20 offset:8192
    ds_read_b64_tr_b16 v[50:51], v20 offset:10240
    s_waitcnt lgkmcnt(10)
    v_mfma_f32_32x32x16_bf16 v[144:159], v[60:63], a[60:63], v[144:159]
    ds_read_b64_tr_b16 v[52:53], v21 offset:8192
    ds_read_b64_tr_b16 v[54:55], v21 offset:10240
    s_waitcnt vmcnt(15)
    s_waitcnt lgkmcnt(10)
    v_mfma_f32_32x32x16_bf16 v[128:143], v[32:35], a[64:67], v[128:143]
    ds_read_b64_tr_b16 v[56:57], v20 offset:12288
    ds_read_b64_tr_b16 v[58:59], v20 offset:14336
    s_waitcnt lgkmcnt(10)
    v_mfma_f32_32x32x16_bf16 v[144:159], v[36:39], a[64:67], v[144:159]
    ds_read_b64_tr_b16 v[60:61], v21 offset:12288
    ds_read_b64_tr_b16 v[62:63], v21 offset:14336
    s_waitcnt vmcnt(14)
    s_waitcnt lgkmcnt(10)
    v_mfma_f32_32x32x16_bf16 v[128:143], v[40:43], a[68:71], v[128:143]
    ds_read_b64_tr_b16 v[32:33], v20 offset:16384
    ds_read_b64_tr_b16 v[34:35], v20 offset:18432
    s_waitcnt lgkmcnt(10)
    v_mfma_f32_32x32x16_bf16 v[144:159], v[44:47], a[68:71], v[144:159]
    ds_read_b64_tr_b16 v[36:37], v21 offset:16384
    ds_read_b64_tr_b16 v[38:39], v21 offset:18432
    s_waitcnt vmcnt(13)
    s_waitcnt lgkmcnt(10)
    v_mfma_f32_32x32x16_bf16 v[128:143], v[48:51], a[72:75], v[128:143]
    ds_read_b64_tr_b16 v[40:41], v20 offset:20480
    ds_read_b64_tr_b16 v[42:43], v20 offset:22528
    s_waitcnt lgkmcnt(10)
    v_mfma_f32_32x32x16_bf16 v[144:159], v[52:55], a[72:75], v[144:159]
    ds_read_b64_tr_b16 v[44:45], v21 offset:20480
    ds_read_b64_tr_b16 v[46:47], v21 offset:22528
    s_waitcnt vmcnt(12)
    s_waitcnt lgkmcnt(10)
    v_mfma_f32_32x32x16_bf16 v[128:143], v[56:59], a[76:79], v[128:143]
    ds_read_b64_tr_b16 v[48:49], v20 offset:24576
    ds_read_b64_tr_b16 v[50:51], v20 offset:26624
    s_waitcnt lgkmcnt(10)
    v_mfma_f32_32x32x16_bf16 v[144:159], v[60:63], a[76:79], v[144:159]
    ds_read_b64_tr_b16 v[52:53], v21 offset:24576
    ds_read_b64_tr_b16 v[54:55], v21 offset:26624
    s_waitcnt vmcnt(11)
    s_waitcnt lgkmcnt(10)
    v_mfma_f32_32x32x16_bf16 v[128:143], v[32:35], a[80:83], v[128:143]
    ds_read_b64_tr_b16 v[56:57], v20 offset:28672
    ds_read_b64_tr_b16 v[58:59], v20 offset:30720
    s_waitcnt lgkmcnt(10)
    v_mfma_f32_32x32x16_bf16 v[144:159], v[36:39], a[80:83], v[144:159]
    ds_read_b64_tr_b16 v[60:61], v21 offset:28672
    ds_read_b64_tr_b16 v[62:63], v21 offset:30720
    s_waitcnt vmcnt(10)
    s_waitcnt lgkmcnt(10)
    v_mfma_f32_32x32x16_bf16 v[128:143], v[40:43], a[84:87], v[128:143]
    ds_read_b64_tr_b16 v[32:33], v20 offset:32768
    ds_read_b64_tr_b16 v[34:35], v20 offset:34816
    s_waitcnt lgkmcnt(10)
    v_mfma_f32_32x32x16_bf16 v[144:159], v[44:47], a[84:87], v[144:159]
    ds_read_b64_tr_b16 v[36:37], v21 offset:32768
    ds_read_b64_tr_b16 v[38:39], v21 offset:34816
    s_waitcnt vmcnt(9)
    s_waitcnt lgkmcnt(10)
    v_mfma_f32_32x32x16_bf16 v[128:143], v[48:51], a[88:91], v[128:143]
    ds_read_b64_tr_b16 v[40:41], v20 offset:36864
    ds_read_b64_tr_b16 v[42:43], v20 offset:38912
    s_waitcnt lgkmcnt(10)
    v_mfma_f32_32x32x16_bf16 v[144:159], v[52:55], a[88:91], v[144:159]
    ds_read_b64_tr_b16 v[44:45], v21 offset:36864
    ds_read_b64_tr_b16 v[46:47], v21 offset:38912
    s_waitcnt vmcnt(8)
    s_waitcnt lgkmcnt(10)
    v_mfma_f32_32x32x16_bf16 v[128:143], v[56:59], a[92:95], v[128:143]
    ds_read_b64_tr_b16 v[48:49], v20 offset:40960
    ds_read_b64_tr_b16 v[50:51], v20 offset:43008
    s_waitcnt lgkmcnt(10)
    v_mfma_f32_32x32x16_bf16 v[144:159], v[60:63], a[92:95], v[144:159]
    ds_read_b64_tr_b16 v[52:53], v21 offset:40960
    ds_read_b64_tr_b16 v[54:55], v21 offset:43008
    s_waitcnt vmcnt(7)
    s_waitcnt lgkmcnt(10)
    v_mfma_f32_32x32x16_bf16 v[128:143], v[32:35], a[96:99], v[128:143]
    ds_read_b64_tr_b16 v[56:57], v20 offset:45056
    ds_read_b64_tr_b16 v[58:59], v20 offset:47104
    s_waitcnt lgkmcnt(10)
    v_mfma_f32_32x32x16_bf16 v[144:159], v[36:39], a[96:99], v[144:159]
    ds_read_b64_tr_b16 v[60:61], v21 offset:45056
    ds_read_b64_tr_b16 v[62:63], v21 offset:47104
    s_waitcnt vmcnt(6)
    s_waitcnt lgkmcnt(10)
    v_mfma_f32_32x32x16_bf16 v[128:143], v[40:43], a[100:103], v[128:143]
    ds_read_b64_tr_b16 v[32:33], v20 offset:49152
    ds_read_b64_tr_b16 v[34:35], v20 offset:51200
    s_waitcnt lgkmcnt(10)
    v_mfma_f32_32x32x16_bf16 v[144:159], v[44:47], a[100:103], v[144:159]
    ds_read_b64_tr_b16 v[36:37], v21 offset:49152
    ds_read_b64_tr_b16 v[38:39], v21 offset:51200
    s_waitcnt vmcnt(5)
    s_waitcnt lgkmcnt(10)
    v_mfma_f32_32x32x16_bf16 v[128:143], v[48:51], a[104:107], v[128:143]
    ds_read_b64_tr_b16 v[40:41], v20 offset:53248
    ds_read_b64_tr_b16 v[42:43], v20 offset:55296
    s_waitcnt lgkmcnt(10)
    v_mfma_f32_32x32x16_bf16 v[144:159], v[52:55], a[104:107], v[144:159]
    ds_read_b64_tr_b16 v[44:45], v21 offset:53248
    ds_read_b64_tr_b16 v[46:47], v21 offset:55296
    s_waitcnt vmcnt(4)
    s_waitcnt lgkmcnt(10)
    v_mfma_f32_32x32x16_bf16 v[128:143], v[56:59], a[108:111], v[128:143]
    ds_read_b64_tr_b16 v[48:49], v20 offset:57344
    ds_read_b64_tr_b16 v[50:51], v20 offset:59392
    s_waitcnt lgkmcnt(10)
    v_mfma_f32_32x32x16_bf16 v[144:159], v[60:63], a[108:111], v[144:159]
    ds_read_b64_tr_b16 v[52:53], v21 offset:57344
    ds_read_b64_tr_b16 v[54:55], v21 offset:59392
    s_waitcnt vmcnt(3)
    s_waitcnt lgkmcnt(10)
    v_mfma_f32_32x32x16_bf16 v[128:143], v[32:35], a[112:115], v[128:143]
    ds_read_b64_tr_b16 v[56:57], v20 offset:61440
    ds_read_b64_tr_b16 v[58:59], v20 offset:63488
    s_waitcnt lgkmcnt(10)
    v_mfma_f32_32x32x16_bf16 v[144:159], v[36:39], a[112:115], v[144:159]
    ds_read_b64_tr_b16 v[60:61], v21 offset:61440
    ds_read_b64_tr_b16 v[62:63], v21 offset:63488
    s_waitcnt vmcnt(2)
    s_waitcnt lgkmcnt(10)
    v_mfma_f32_32x32x16_bf16 v[128:143], v[40:43], a[116:119], v[128:143]
    ds_read_b64_tr_b16 v[32:33], v18 offset:0
    ds_read_b64_tr_b16 v[34:35], v18 offset:2048
    s_waitcnt lgkmcnt(10)
    v_mfma_f32_32x32x16_bf16 v[144:159], v[44:47], a[116:119], v[144:159]
    ds_read_b64_tr_b16 v[36:37], v18 offset:4096
    ds_read_b64_tr_b16 v[38:39], v18 offset:6144
    s_waitcnt vmcnt(1)
    s_waitcnt lgkmcnt(10)
    v_mfma_f32_32x32x16_bf16 v[128:143], v[48:51], a[120:123], v[128:143]
    ds_read_b64_tr_b16 v[40:41], v18 offset:8192
    ds_read_b64_tr_b16 v[42:43], v18 offset:10240
    s_waitcnt lgkmcnt(10)
    v_mfma_f32_32x32x16_bf16 v[144:159], v[52:55], a[120:123], v[144:159]
    ds_read_b64_tr_b16 v[44:45], v18 offset:12288
    ds_read_b64_tr_b16 v[46:47], v18 offset:14336
    s_waitcnt vmcnt(0)
    s_waitcnt lgkmcnt(10)
    v_mfma_f32_32x32x16_bf16 v[128:143], v[56:59], a[124:127], v[128:143]
    ds_read_b64_tr_b16 v[48:49], v18 offset:16384
    ds_read_b64_tr_b16 v[50:51], v18 offset:18432
    s_waitcnt lgkmcnt(10)
    v_mfma_f32_32x32x16_bf16 v[144:159], v[60:63], a[124:127], v[144:159]
    ds_read_b64_tr_b16 v[52:53], v18 offset:20480
    ds_read_b64_tr_b16 v[54:55], v18 offset:22528
    s_waitcnt lgkmcnt(10)
    v_mfma_f32_32x32x16_bf16 v[160:175], v[32:35], a[0:3], 0
    ds_read_b64_tr_b16 v[56:57], v18 offset:24576
    ds_read_b64_tr_b16 v[58:59], v18 offset:26624
    s_waitcnt lgkmcnt(10)
    v_mfma_f32_32x32x16_bf16 v[160:175], v[36:39], a[4:7], v[160:175]
    ds_read_b64_tr_b16 v[60:61], v18 offset:28672
    ds_read_b64_tr_b16 v[62:63], v18 offset:30720
    s_waitcnt lgkmcnt(10)
    v_mfma_f32_32x32x16_bf16 v[160:175], v[40:43], a[8:11], v[160:175]
    ds_read_b64_tr_b16 v[32:33], v18 offset:32768
    ds_read_b64_tr_b16 v[34:35], v18 offset:34816
    s_waitcnt lgkmcnt(10)
    v_mfma_f32_32x32x16_bf16 v[160:175], v[44:47], a[12:15], v[160:175]
    ds_read_b64_tr_b16 v[36:37], v18 offset:36864
    ds_read_b64_tr_b16 v[38:39], v18 offset:38912
    v_mul_f32 v64, 0xbfb8aa3b, v128
    v_mul_f32 v65, 0xbfb8aa3b, v129
    v_mul_f32 v66, 0xbfb8aa3b, v130
    v_mul_f32 v67, 0xbfb8aa3b, v131
    v_mul_f32 v68, 0xbfb8aa3b, v132
    s_waitcnt lgkmcnt(10)
    v_mfma_f32_32x32x16_bf16 v[160:175], v[48:51], a[16:19], v[160:175]
    ds_read_b64_tr_b16 v[40:41], v18 offset:40960
    ds_read_b64_tr_b16 v[42:43], v18 offset:43008
    v_mul_f32 v69, 0xbfb8aa3b, v133
    v_mul_f32 v70, 0xbfb8aa3b, v134
    v_mul_f32 v71, 0xbfb8aa3b, v135
    v_mul_f32 v72, 0xbfb8aa3b, v136
    v_mul_f32 v73, 0xbfb8aa3b, v137
    s_waitcnt lgkmcnt(10)
    v_mfma_f32_32x32x16_bf16 v[160:175], v[52:55], a[20:23], v[160:175]
    ds_read_b64_tr_b16 v[44:45], v18 offset:45056
    ds_read_b64_tr_b16 v[46:47], v18 offset:47104
    v_mul_f32 v74, 0xbfb8aa3b, v138
    v_mul_f32 v75, 0xbfb8aa3b, v139
    v_mul_f32 v76, 0xbfb8aa3b, v140
    v_mul_f32 v77, 0xbfb8aa3b, v141
    v_mul_f32 v78, 0xbfb8aa3b, v142
    s_waitcnt lgkmcnt(10)
    v_mfma_f32_32x32x16_bf16 v[160:175], v[56:59], a[24:27], v[160:175]
    ds_read_b64_tr_b16 v[48:49], v18 offset:49152
    ds_read_b64_tr_b16 v[50:51], v18 offset:51200
    v_mul_f32 v79, 0xbfb8aa3b, v143
    v_exp_f32 v64, v64
    v_exp_f32 v65, v65
    v_exp_f32 v66, v66
    v_exp_f32 v67, v67
    s_waitcnt lgkmcnt(10)
    v_mfma_f32_32x32x16_bf16 v[160:175], v[60:63], a[28:31], v[160:175]
    ds_read_b64_tr_b16 v[52:53], v18 offset:53248
    ds_read_b64_tr_b16 v[54:55], v18 offset:55296
    v_exp_f32 v68, v68
    v_exp_f32 v69, v69
    v_exp_f32 v70, v70
    v_exp_f32 v71, v71
    v_exp_f32 v72, v72
    s_waitcnt lgkmcnt(10)
    v_mfma_f32_32x32x16_bf16 v[160:175], v[32:35], a[32:35], v[160:175]
    ds_read_b64_tr_b16 v[56:57], v18 offset:57344
    ds_read_b64_tr_b16 v[58:59], v18 offset:59392
    v_exp_f32 v73, v73
    v_exp_f32 v74, v74
    v_exp_f32 v75, v75
    v_exp_f32 v76, v76
    v_exp_f32 v77, v77
    s_waitcnt lgkmcnt(10)
    v_mfma_f32_32x32x16_bf16 v[160:175], v[36:39], a[36:39], v[160:175]
    ds_read_b64_tr_b16 v[60:61], v18 offset:61440
    ds_read_b64_tr_b16 v[62:63], v18 offset:63488
    v_exp_f32 v78, v78
    v_exp_f32 v79, v79
    v_add_f32 v64, 1.0, v64
    v_add_f32 v65, 1.0, v65
    v_add_f32 v66, 1.0, v66
    s_waitcnt lgkmcnt(10)
    v_mfma_f32_32x32x16_bf16 v[160:175], v[40:43], a[40:43], v[160:175]
    ds_read_b64_tr_b16 v[32:33], v22 offset:0
    ds_read_b64_tr_b16 v[34:35], v22 offset:2048
    v_add_f32 v67, 1.0, v67
    v_add_f32 v68, 1.0, v68
    v_add_f32 v69, 1.0, v69
    v_add_f32 v70, 1.0, v70
    v_add_f32 v71, 1.0, v71
    s_waitcnt lgkmcnt(10)
    v_mfma_f32_32x32x16_bf16 v[160:175], v[44:47], a[44:47], v[160:175]
    ds_read_b64_tr_b16 v[36:37], v22 offset:4096
    ds_read_b64_tr_b16 v[38:39], v22 offset:6144
    v_add_f32 v72, 1.0, v72
    v_add_f32 v73, 1.0, v73
    v_add_f32 v74, 1.0, v74
    v_add_f32 v75, 1.0, v75
    v_add_f32 v76, 1.0, v76
    s_waitcnt lgkmcnt(10)
    v_mfma_f32_32x32x16_bf16 v[160:175], v[48:51], a[48:51], v[160:175]
    ds_read_b64_tr_b16 v[40:41], v22 offset:8192
    ds_read_b64_tr_b16 v[42:43], v22 offset:10240
    v_add_f32 v77, 1.0, v77
    v_add_f32 v78, 1.0, v78
    v_add_f32 v79, 1.0, v79
    v_rcp_f32 v64, v64
    v_rcp_f32 v65, v65
    s_waitcnt lgkmcnt(10)
    v_mfma_f32_32x32x16_bf16 v[160:175], v[52:55], a[52:55], v[160:175]
    ds_read_b64_tr_b16 v[44:45], v22 offset:12288
    ds_read_b64_tr_b16 v[46:47], v22 offset:14336
    v_rcp_f32 v66, v66
    v_rcp_f32 v67, v67
    v_rcp_f32 v68, v68
    v_rcp_f32 v69, v69
    v_rcp_f32 v70, v70
    s_waitcnt lgkmcnt(10)
    v_mfma_f32_32x32x16_bf16 v[160:175], v[56:59], a[56:59], v[160:175]
    ds_read_b64_tr_b16 v[48:49], v22 offset:16384
    ds_read_b64_tr_b16 v[50:51], v22 offset:18432
    v_rcp_f32 v71, v71
    v_rcp_f32 v72, v72
    v_rcp_f32 v73, v73
    v_rcp_f32 v74, v74
    v_rcp_f32 v75, v75
    s_waitcnt lgkmcnt(10)
    v_mfma_f32_32x32x16_bf16 v[160:175], v[60:63], a[60:63], v[160:175]
    ds_read_b64_tr_b16 v[52:53], v22 offset:20480
    ds_read_b64_tr_b16 v[54:55], v22 offset:22528
    v_rcp_f32 v76, v76
    v_rcp_f32 v77, v77
    v_rcp_f32 v78, v78
    v_rcp_f32 v79, v79
    v_mul_f32 v128, v128, v64
    s_waitcnt lgkmcnt(10)
    v_mfma_f32_32x32x16_bf16 v[160:175], v[32:35], a[64:67], v[160:175]
    ds_read_b64_tr_b16 v[56:57], v22 offset:24576
    ds_read_b64_tr_b16 v[58:59], v22 offset:26624
    v_mul_f32 v129, v129, v65
    v_mul_f32 v130, v130, v66
    v_mul_f32 v131, v131, v67
    v_mul_f32 v132, v132, v68
    v_mul_f32 v133, v133, v69
    s_waitcnt lgkmcnt(10)
    v_mfma_f32_32x32x16_bf16 v[160:175], v[36:39], a[68:71], v[160:175]
    ds_read_b64_tr_b16 v[60:61], v22 offset:28672
    ds_read_b64_tr_b16 v[62:63], v22 offset:30720
    v_mul_f32 v134, v134, v70
    v_mul_f32 v135, v135, v71
    v_mul_f32 v136, v136, v72
    v_mul_f32 v137, v137, v73
    v_mul_f32 v138, v138, v74
    s_waitcnt lgkmcnt(10)
    v_mfma_f32_32x32x16_bf16 v[160:175], v[40:43], a[72:75], v[160:175]
    ds_read_b64_tr_b16 v[32:33], v22 offset:32768
    ds_read_b64_tr_b16 v[34:35], v22 offset:34816
    v_mul_f32 v139, v139, v75
    v_mul_f32 v140, v140, v76
    v_mul_f32 v141, v141, v77
    v_mul_f32 v142, v142, v78
    v_mul_f32 v143, v143, v79
    s_waitcnt lgkmcnt(10)
    v_mfma_f32_32x32x16_bf16 v[160:175], v[44:47], a[76:79], v[160:175]
    ds_read_b64_tr_b16 v[36:37], v22 offset:36864
    ds_read_b64_tr_b16 v[38:39], v22 offset:38912
    v_cvt_pk_bf16_f32 v128, v128, v129
    v_cvt_pk_bf16_f32 v129, v130, v131
    v_cvt_pk_bf16_f32 v130, v132, v133
    v_cvt_pk_bf16_f32 v131, v134, v135
    v_cvt_pk_bf16_f32 v132, v136, v137
    s_waitcnt lgkmcnt(10)
    v_mfma_f32_32x32x16_bf16 v[160:175], v[48:51], a[80:83], v[160:175]
    ds_read_b64_tr_b16 v[40:41], v22 offset:40960
    ds_read_b64_tr_b16 v[42:43], v22 offset:43008
    v_cvt_pk_bf16_f32 v133, v138, v139
    v_cvt_pk_bf16_f32 v134, v140, v141
    v_cvt_pk_bf16_f32 v135, v142, v143
    buffer_store_dwordx4 v[128:131], v2, s[32:35], s40 offen offset:0 sc1
    s_waitcnt lgkmcnt(10)
    v_mfma_f32_32x32x16_bf16 v[160:175], v[52:55], a[84:87], v[160:175]
    ds_read_b64_tr_b16 v[44:45], v22 offset:45056
    ds_read_b64_tr_b16 v[46:47], v22 offset:47104
    buffer_store_dwordx4 v[132:135], v2, s[32:35], s40 offen offset:1024 sc1
    v_mul_f32 v80, 0xbfb8aa3b, v144
    v_mul_f32 v81, 0xbfb8aa3b, v145
    v_mul_f32 v82, 0xbfb8aa3b, v146
    s_waitcnt lgkmcnt(10)
    v_mfma_f32_32x32x16_bf16 v[160:175], v[56:59], a[88:91], v[160:175]
    ds_read_b64_tr_b16 v[48:49], v22 offset:49152
    ds_read_b64_tr_b16 v[50:51], v22 offset:51200
    v_mul_f32 v83, 0xbfb8aa3b, v147
    v_mul_f32 v84, 0xbfb8aa3b, v148
    v_mul_f32 v85, 0xbfb8aa3b, v149
    v_mul_f32 v86, 0xbfb8aa3b, v150
    v_mul_f32 v87, 0xbfb8aa3b, v151
    s_waitcnt lgkmcnt(10)
    v_mfma_f32_32x32x16_bf16 v[160:175], v[60:63], a[92:95], v[160:175]
    ds_read_b64_tr_b16 v[52:53], v22 offset:53248
    ds_read_b64_tr_b16 v[54:55], v22 offset:55296
    v_mul_f32 v88, 0xbfb8aa3b, v152
    v_mul_f32 v89, 0xbfb8aa3b, v153
    v_mul_f32 v90, 0xbfb8aa3b, v154
    v_mul_f32 v91, 0xbfb8aa3b, v155
    v_mul_f32 v92, 0xbfb8aa3b, v156
    s_waitcnt lgkmcnt(10)
    v_mfma_f32_32x32x16_bf16 v[160:175], v[32:35], a[96:99], v[160:175]
    ds_read_b64_tr_b16 v[56:57], v22 offset:57344
    ds_read_b64_tr_b16 v[58:59], v22 offset:59392
    v_mul_f32 v93, 0xbfb8aa3b, v157
    v_mul_f32 v94, 0xbfb8aa3b, v158
    v_mul_f32 v95, 0xbfb8aa3b, v159
    v_exp_f32 v80, v80
    v_exp_f32 v81, v81
    s_waitcnt lgkmcnt(10)
    v_mfma_f32_32x32x16_bf16 v[160:175], v[36:39], a[100:103], v[160:175]
    ds_read_b64_tr_b16 v[60:61], v22 offset:61440
    ds_read_b64_tr_b16 v[62:63], v22 offset:63488
    v_exp_f32 v82, v82
    v_exp_f32 v83, v83
    v_exp_f32 v84, v84
    v_exp_f32 v85, v85
    v_exp_f32 v86, v86
    s_waitcnt lgkmcnt(10)
    v_mfma_f32_32x32x16_bf16 v[160:175], v[40:43], a[104:107], v[160:175]
    ds_read_b64_tr_b16 v[32:33], v19 offset:0
    ds_read_b64_tr_b16 v[34:35], v19 offset:2048
    v_exp_f32 v87, v87
    v_exp_f32 v88, v88
    v_exp_f32 v89, v89
    v_exp_f32 v90, v90
    v_exp_f32 v91, v91
    s_waitcnt lgkmcnt(10)
    v_mfma_f32_32x32x16_bf16 v[160:175], v[44:47], a[108:111], v[160:175]
    ds_read_b64_tr_b16 v[36:37], v19 offset:4096
    ds_read_b64_tr_b16 v[38:39], v19 offset:6144
    v_exp_f32 v92, v92
    v_exp_f32 v93, v93
    v_exp_f32 v94, v94
    v_exp_f32 v95, v95
    v_add_f32 v80, 1.0, v80
    s_waitcnt lgkmcnt(10)
    v_mfma_f32_32x32x16_bf16 v[160:175], v[48:51], a[112:115], v[160:175]
    ds_read_b64_tr_b16 v[40:41], v19 offset:8192
    ds_read_b64_tr_b16 v[42:43], v19 offset:10240
    v_add_f32 v81, 1.0, v81
    v_add_f32 v82, 1.0, v82
    v_add_f32 v83, 1.0, v83
    v_add_f32 v84, 1.0, v84
    v_add_f32 v85, 1.0, v85
    s_waitcnt lgkmcnt(10)
    v_mfma_f32_32x32x16_bf16 v[160:175], v[52:55], a[116:119], v[160:175]
    ds_read_b64_tr_b16 v[44:45], v19 offset:12288
    ds_read_b64_tr_b16 v[46:47], v19 offset:14336
    v_add_f32 v86, 1.0, v86
    v_add_f32 v87, 1.0, v87
    v_add_f32 v88, 1.0, v88
    v_add_f32 v89, 1.0, v89
    v_add_f32 v90, 1.0, v90
    s_waitcnt lgkmcnt(10)
    v_mfma_f32_32x32x16_bf16 v[160:175], v[56:59], a[120:123], v[160:175]
    ds_read_b64_tr_b16 v[48:49], v19 offset:16384
    ds_read_b64_tr_b16 v[50:51], v19 offset:18432
    v_add_f32 v91, 1.0, v91
    v_add_f32 v92, 1.0, v92
    v_add_f32 v93, 1.0, v93
    v_add_f32 v94, 1.0, v94
    v_add_f32 v95, 1.0, v95
    s_waitcnt lgkmcnt(10)
    v_mfma_f32_32x32x16_bf16 v[160:175], v[60:63], a[124:127], v[160:175]
    ds_read_b64_tr_b16 v[52:53], v19 offset:20480
    ds_read_b64_tr_b16 v[54:55], v19 offset:22528
    v_rcp_f32 v80, v80
    v_rcp_f32 v81, v81
    v_rcp_f32 v82, v82
    v_rcp_f32 v83, v83
    v_rcp_f32 v84, v84
    s_waitcnt lgkmcnt(10)
    v_mfma_f32_32x32x16_bf16 v[176:191], v[32:35], a[0:3], 0
    ds_read_b64_tr_b16 v[56:57], v19 offset:24576
    ds_read_b64_tr_b16 v[58:59], v19 offset:26624
    s_waitcnt lgkmcnt(10)
    v_mfma_f32_32x32x16_bf16 v[176:191], v[36:39], a[4:7], v[176:191]
    ds_read_b64_tr_b16 v[60:61], v19 offset:28672
    ds_read_b64_tr_b16 v[62:63], v19 offset:30720
    s_waitcnt lgkmcnt(10)
    v_mfma_f32_32x32x16_bf16 v[176:191], v[40:43], a[8:11], v[176:191]
    ds_read_b64_tr_b16 v[32:33], v19 offset:32768
    ds_read_b64_tr_b16 v[34:35], v19 offset:34816
    s_waitcnt lgkmcnt(10)
    v_mfma_f32_32x32x16_bf16 v[176:191], v[44:47], a[12:15], v[176:191]
    ds_read_b64_tr_b16 v[36:37], v19 offset:36864
    ds_read_b64_tr_b16 v[38:39], v19 offset:38912
    v_rcp_f32 v85, v85
    v_rcp_f32 v86, v86
    v_rcp_f32 v87, v87
    v_rcp_f32 v88, v88
    v_rcp_f32 v89, v89
    s_waitcnt lgkmcnt(10)
    v_mfma_f32_32x32x16_bf16 v[176:191], v[48:51], a[16:19], v[176:191]
    ds_read_b64_tr_b16 v[40:41], v19 offset:40960
    ds_read_b64_tr_b16 v[42:43], v19 offset:43008
    v_rcp_f32 v90, v90
    v_rcp_f32 v91, v91
    v_rcp_f32 v92, v92
    v_rcp_f32 v93, v93
    v_rcp_f32 v94, v94
    s_waitcnt lgkmcnt(10)
    v_mfma_f32_32x32x16_bf16 v[176:191], v[52:55], a[20:23], v[176:191]
    ds_read_b64_tr_b16 v[44:45], v19 offset:45056
    ds_read_b64_tr_b16 v[46:47], v19 offset:47104
    v_rcp_f32 v95, v95
    v_mul_f32 v144, v144, v80
    v_mul_f32 v145, v145, v81
    v_mul_f32 v146, v146, v82
    v_mul_f32 v147, v147, v83
    s_waitcnt lgkmcnt(10)
    v_mfma_f32_32x32x16_bf16 v[176:191], v[56:59], a[24:27], v[176:191]
    ds_read_b64_tr_b16 v[48:49], v19 offset:49152
    ds_read_b64_tr_b16 v[50:51], v19 offset:51200
    v_mul_f32 v148, v148, v84
    v_mul_f32 v149, v149, v85
    v_mul_f32 v150, v150, v86
    v_mul_f32 v151, v151, v87
    v_mul_f32 v152, v152, v88
    s_waitcnt lgkmcnt(10)
    v_mfma_f32_32x32x16_bf16 v[176:191], v[60:63], a[28:31], v[176:191]
    ds_read_b64_tr_b16 v[52:53], v19 offset:53248
    ds_read_b64_tr_b16 v[54:55], v19 offset:55296
    v_mul_f32 v153, v153, v89
    v_mul_f32 v154, v154, v90
    v_mul_f32 v155, v155, v91
    v_mul_f32 v156, v156, v92
    v_mul_f32 v157, v157, v93
    s_waitcnt lgkmcnt(10)
    v_mfma_f32_32x32x16_bf16 v[176:191], v[32:35], a[32:35], v[176:191]
    ds_read_b64_tr_b16 v[56:57], v19 offset:57344
    ds_read_b64_tr_b16 v[58:59], v19 offset:59392
    v_mul_f32 v158, v158, v94
    v_mul_f32 v159, v159, v95
    v_cvt_pk_bf16_f32 v144, v144, v145
    v_cvt_pk_bf16_f32 v145, v146, v147
    v_cvt_pk_bf16_f32 v146, v148, v149
    s_waitcnt lgkmcnt(10)
    v_mfma_f32_32x32x16_bf16 v[176:191], v[36:39], a[36:39], v[176:191]
    ds_read_b64_tr_b16 v[60:61], v19 offset:61440
    ds_read_b64_tr_b16 v[62:63], v19 offset:63488
    v_cvt_pk_bf16_f32 v147, v150, v151
    v_cvt_pk_bf16_f32 v148, v152, v153
    v_cvt_pk_bf16_f32 v149, v154, v155
    v_cvt_pk_bf16_f32 v150, v156, v157
    v_cvt_pk_bf16_f32 v151, v158, v159
    s_waitcnt lgkmcnt(10)
    v_mfma_f32_32x32x16_bf16 v[176:191], v[40:43], a[40:43], v[176:191]
    ds_read_b64_tr_b16 v[32:33], v23 offset:0
    ds_read_b64_tr_b16 v[34:35], v23 offset:2048
    buffer_store_dwordx4 v[144:147], v2, s[32:35], s40 offen offset:2048 sc1
    buffer_store_dwordx4 v[148:151], v2, s[32:35], s40 offen offset:3072 sc1
    v_mul_f32 v64, 0xbfb8aa3b, v160
    s_waitcnt lgkmcnt(10)
    v_mfma_f32_32x32x16_bf16 v[176:191], v[44:47], a[44:47], v[176:191]
    ds_read_b64_tr_b16 v[36:37], v23 offset:4096
    ds_read_b64_tr_b16 v[38:39], v23 offset:6144
    v_mul_f32 v65, 0xbfb8aa3b, v161
    v_mul_f32 v66, 0xbfb8aa3b, v162
    v_mul_f32 v67, 0xbfb8aa3b, v163
    v_mul_f32 v68, 0xbfb8aa3b, v164
    v_mul_f32 v69, 0xbfb8aa3b, v165
    s_waitcnt lgkmcnt(10)
    v_mfma_f32_32x32x16_bf16 v[176:191], v[48:51], a[48:51], v[176:191]
    ds_read_b64_tr_b16 v[40:41], v23 offset:8192
    ds_read_b64_tr_b16 v[42:43], v23 offset:10240
    v_mul_f32 v70, 0xbfb8aa3b, v166
    v_mul_f32 v71, 0xbfb8aa3b, v167
    v_mul_f32 v72, 0xbfb8aa3b, v168
    v_mul_f32 v73, 0xbfb8aa3b, v169
    v_mul_f32 v74, 0xbfb8aa3b, v170
    s_waitcnt lgkmcnt(10)
    v_mfma_f32_32x32x16_bf16 v[176:191], v[52:55], a[52:55], v[176:191]
    ds_read_b64_tr_b16 v[44:45], v23 offset:12288
    ds_read_b64_tr_b16 v[46:47], v23 offset:14336
    v_mul_f32 v75, 0xbfb8aa3b, v171
    v_mul_f32 v76, 0xbfb8aa3b, v172
    v_mul_f32 v77, 0xbfb8aa3b, v173
    v_mul_f32 v78, 0xbfb8aa3b, v174
    v_mul_f32 v79, 0xbfb8aa3b, v175
    s_waitcnt lgkmcnt(10)
    v_mfma_f32_32x32x16_bf16 v[176:191], v[56:59], a[56:59], v[176:191]
    ds_read_b64_tr_b16 v[48:49], v23 offset:16384
    ds_read_b64_tr_b16 v[50:51], v23 offset:18432
    v_exp_f32 v64, v64
    v_exp_f32 v65, v65
    v_exp_f32 v66, v66
    v_exp_f32 v67, v67
    v_exp_f32 v68, v68
    s_waitcnt lgkmcnt(10)
    v_mfma_f32_32x32x16_bf16 v[176:191], v[60:63], a[60:63], v[176:191]
    ds_read_b64_tr_b16 v[52:53], v23 offset:20480
    ds_read_b64_tr_b16 v[54:55], v23 offset:22528
    v_exp_f32 v69, v69
    v_exp_f32 v70, v70
    v_exp_f32 v71, v71
    v_exp_f32 v72, v72
    v_exp_f32 v73, v73
    s_waitcnt lgkmcnt(10)
    v_mfma_f32_32x32x16_bf16 v[176:191], v[32:35], a[64:67], v[176:191]
    ds_read_b64_tr_b16 v[56:57], v23 offset:24576
    ds_read_b64_tr_b16 v[58:59], v23 offset:26624
    v_exp_f32 v74, v74
    v_exp_f32 v75, v75
    v_exp_f32 v76, v76
    v_exp_f32 v77, v77
    v_exp_f32 v78, v78
    s_waitcnt lgkmcnt(10)
    v_mfma_f32_32x32x16_bf16 v[176:191], v[36:39], a[68:71], v[176:191]
    ds_read_b64_tr_b16 v[60:61], v23 offset:28672
    ds_read_b64_tr_b16 v[62:63], v23 offset:30720
    v_exp_f32 v79, v79
    v_add_f32 v64, 1.0, v64
    v_add_f32 v65, 1.0, v65
    v_add_f32 v66, 1.0, v66
    v_add_f32 v67, 1.0, v67
    s_waitcnt lgkmcnt(10)
    v_mfma_f32_32x32x16_bf16 v[176:191], v[40:43], a[72:75], v[176:191]
    ds_read_b64_tr_b16 v[32:33], v23 offset:32768
    ds_read_b64_tr_b16 v[34:35], v23 offset:34816
    v_add_f32 v68, 1.0, v68
    v_add_f32 v69, 1.0, v69
    v_add_f32 v70, 1.0, v70
    v_add_f32 v71, 1.0, v71
    v_add_f32 v72, 1.0, v72
    s_waitcnt lgkmcnt(10)
    v_mfma_f32_32x32x16_bf16 v[176:191], v[44:47], a[76:79], v[176:191]
    ds_read_b64_tr_b16 v[36:37], v23 offset:36864
    ds_read_b64_tr_b16 v[38:39], v23 offset:38912
    v_add_f32 v73, 1.0, v73
    v_add_f32 v74, 1.0, v74
    v_add_f32 v75, 1.0, v75
    v_add_f32 v76, 1.0, v76
    v_add_f32 v77, 1.0, v77
    s_waitcnt lgkmcnt(10)
    v_mfma_f32_32x32x16_bf16 v[176:191], v[48:51], a[80:83], v[176:191]
    ds_read_b64_tr_b16 v[40:41], v23 offset:40960
    ds_read_b64_tr_b16 v[42:43], v23 offset:43008
    v_add_f32 v78, 1.0, v78
    v_add_f32 v79, 1.0, v79
    v_rcp_f32 v64, v64
    v_rcp_f32 v65, v65
    v_rcp_f32 v66, v66
    s_waitcnt lgkmcnt(10)
    v_mfma_f32_32x32x16_bf16 v[176:191], v[52:55], a[84:87], v[176:191]
    ds_read_b64_tr_b16 v[44:45], v23 offset:45056
    ds_read_b64_tr_b16 v[46:47], v23 offset:47104
    v_rcp_f32 v67, v67
    v_rcp_f32 v68, v68
    v_rcp_f32 v69, v69
    v_rcp_f32 v70, v70
    v_rcp_f32 v71, v71
    s_waitcnt lgkmcnt(10)
    v_mfma_f32_32x32x16_bf16 v[176:191], v[56:59], a[88:91], v[176:191]
    ds_read_b64_tr_b16 v[48:49], v23 offset:49152
    ds_read_b64_tr_b16 v[50:51], v23 offset:51200
    v_rcp_f32 v72, v72
    v_rcp_f32 v73, v73
    v_rcp_f32 v74, v74
    v_rcp_f32 v75, v75
    v_rcp_f32 v76, v76
    s_waitcnt lgkmcnt(10)
    v_mfma_f32_32x32x16_bf16 v[176:191], v[60:63], a[92:95], v[176:191]
    ds_read_b64_tr_b16 v[52:53], v23 offset:53248
    ds_read_b64_tr_b16 v[54:55], v23 offset:55296
    v_rcp_f32 v77, v77
    v_rcp_f32 v78, v78
    v_rcp_f32 v79, v79
    v_mul_f32 v160, v160, v64
    v_mul_f32 v161, v161, v65
    s_waitcnt lgkmcnt(10)
    v_mfma_f32_32x32x16_bf16 v[176:191], v[32:35], a[96:99], v[176:191]
    ds_read_b64_tr_b16 v[56:57], v23 offset:57344
    ds_read_b64_tr_b16 v[58:59], v23 offset:59392
    v_mul_f32 v162, v162, v66
    v_mul_f32 v163, v163, v67
    v_mul_f32 v164, v164, v68
    v_mul_f32 v165, v165, v69
    v_mul_f32 v166, v166, v70
    s_waitcnt lgkmcnt(10)
    v_mfma_f32_32x32x16_bf16 v[176:191], v[36:39], a[100:103], v[176:191]
    ds_read_b64_tr_b16 v[60:61], v23 offset:61440
    ds_read_b64_tr_b16 v[62:63], v23 offset:63488
    v_mul_f32 v167, v167, v71
    v_mul_f32 v168, v168, v72
    v_mul_f32 v169, v169, v73
    v_mul_f32 v170, v170, v74
    v_mul_f32 v171, v171, v75
    s_waitcnt lgkmcnt(10)
    v_mfma_f32_32x32x16_bf16 v[176:191], v[40:43], a[104:107], v[176:191]
    v_mul_f32 v172, v172, v76
    v_mul_f32 v173, v173, v77
    v_mul_f32 v174, v174, v78
    v_mul_f32 v175, v175, v79
    v_cvt_pk_bf16_f32 v160, v160, v161
    s_waitcnt lgkmcnt(8)
    v_mfma_f32_32x32x16_bf16 v[176:191], v[44:47], a[108:111], v[176:191]
    v_cvt_pk_bf16_f32 v161, v162, v163
    v_cvt_pk_bf16_f32 v162, v164, v165
    v_cvt_pk_bf16_f32 v163, v166, v167
    v_cvt_pk_bf16_f32 v164, v168, v169
    v_cvt_pk_bf16_f32 v165, v170, v171
    s_waitcnt lgkmcnt(6)
    v_mfma_f32_32x32x16_bf16 v[176:191], v[48:51], a[112:115], v[176:191]
    v_cvt_pk_bf16_f32 v166, v172, v173
    v_cvt_pk_bf16_f32 v167, v174, v175
    buffer_store_dwordx4 v[160:163], v2, s[32:35], s41 offen offset:0 sc1
    s_waitcnt lgkmcnt(4)
    v_mfma_f32_32x32x16_bf16 v[176:191], v[52:55], a[116:119], v[176:191]
    buffer_store_dwordx4 v[164:167], v2, s[32:35], s41 offen offset:1024 sc1
    s_waitcnt lgkmcnt(2)
    v_mfma_f32_32x32x16_bf16 v[176:191], v[56:59], a[120:123], v[176:191]
    s_waitcnt lgkmcnt(0)
    v_mfma_f32_32x32x16_bf16 v[176:191], v[60:63], a[124:127], v[176:191]
    s_nop 7
    s_nop 7
    v_mul_f32 v80, 0xbfb8aa3b, v176
    v_mul_f32 v81, 0xbfb8aa3b, v177
    v_mul_f32 v82, 0xbfb8aa3b, v178
    v_mul_f32 v83, 0xbfb8aa3b, v179
    v_mul_f32 v84, 0xbfb8aa3b, v180
    v_mul_f32 v85, 0xbfb8aa3b, v181
    v_mul_f32 v86, 0xbfb8aa3b, v182
    v_mul_f32 v87, 0xbfb8aa3b, v183
    v_mul_f32 v88, 0xbfb8aa3b, v184
    v_mul_f32 v89, 0xbfb8aa3b, v185
    v_mul_f32 v90, 0xbfb8aa3b, v186
    v_mul_f32 v91, 0xbfb8aa3b, v187
    v_mul_f32 v92, 0xbfb8aa3b, v188
    v_mul_f32 v93, 0xbfb8aa3b, v189
    v_mul_f32 v94, 0xbfb8aa3b, v190
    v_mul_f32 v95, 0xbfb8aa3b, v191
    v_exp_f32 v80, v80
    v_exp_f32 v81, v81
    v_exp_f32 v82, v82
    v_exp_f32 v83, v83
    v_exp_f32 v84, v84
    v_exp_f32 v85, v85
    v_exp_f32 v86, v86
    v_exp_f32 v87, v87
    v_exp_f32 v88, v88
    v_exp_f32 v89, v89
    v_exp_f32 v90, v90
    v_exp_f32 v91, v91
    v_exp_f32 v92, v92
    v_exp_f32 v93, v93
    v_exp_f32 v94, v94
    v_exp_f32 v95, v95
    v_add_f32 v80, 1.0, v80
    v_add_f32 v81, 1.0, v81
    v_add_f32 v82, 1.0, v82
    v_add_f32 v83, 1.0, v83
    v_add_f32 v84, 1.0, v84
    v_add_f32 v85, 1.0, v85
    v_add_f32 v86, 1.0, v86
    v_add_f32 v87, 1.0, v87
    v_add_f32 v88, 1.0, v88
    v_add_f32 v89, 1.0, v89
    v_add_f32 v90, 1.0, v90
    v_add_f32 v91, 1.0, v91
    v_add_f32 v92, 1.0, v92
    v_add_f32 v93, 1.0, v93
    v_add_f32 v94, 1.0, v94
    v_add_f32 v95, 1.0, v95
    v_rcp_f32 v80, v80
    v_rcp_f32 v81, v81
    v_rcp_f32 v82, v82
    v_rcp_f32 v83, v83
    v_rcp_f32 v84, v84
    v_rcp_f32 v85, v85
    v_rcp_f32 v86, v86
    v_rcp_f32 v87, v87
    v_rcp_f32 v88, v88
    v_rcp_f32 v89, v89
    v_rcp_f32 v90, v90
    v_rcp_f32 v91, v91
    v_rcp_f32 v92, v92
    v_rcp_f32 v93, v93
    v_rcp_f32 v94, v94
    v_rcp_f32 v95, v95
    v_mul_f32 v176, v176, v80
    v_mul_f32 v177, v177, v81
    v_mul_f32 v178, v178, v82
    v_mul_f32 v179, v179, v83
    v_mul_f32 v180, v180, v84
    v_mul_f32 v181, v181, v85
    v_mul_f32 v182, v182, v86
    v_mul_f32 v183, v183, v87
    v_mul_f32 v184, v184, v88
    v_mul_f32 v185, v185, v89
    v_mul_f32 v186, v186, v90
    v_mul_f32 v187, v187, v91
    v_mul_f32 v188, v188, v92
    v_mul_f32 v189, v189, v93
    v_mul_f32 v190, v190, v94
    v_mul_f32 v191, v191, v95
    v_cvt_pk_bf16_f32 v176, v176, v177
    v_cvt_pk_bf16_f32 v177, v178, v179
    v_cvt_pk_bf16_f32 v178, v180, v181
    v_cvt_pk_bf16_f32 v179, v182, v183
    v_cvt_pk_bf16_f32 v180, v184, v185
    v_cvt_pk_bf16_f32 v181, v186, v187
    v_cvt_pk_bf16_f32 v182, v188, v189
    v_cvt_pk_bf16_f32 v183, v190, v191
    buffer_store_dwordx4 v[176:179], v2, s[32:35], s41 offen offset:2048 sc1
    buffer_store_dwordx4 v[180:183], v2, s[32:35], s41 offen offset:3072 sc1
    s_and_b32 s63, s2, 3
    s_lshl_b32 s63, s63, 2
    s_bfe_u32 s66, s2, 0x20003
    s_add_u32 s63, s63, s66
    s_bfe_u32 s66, s2, 0x10002
    s_lshl_b32 s66, s66, 3
    s_lshr_b32 s65, s2, 5
    s_add_u32 s66, s66, s65
    s_lshl_b32 s63, s63, 7
    s_add_u32 s63, s63, 3148800
    s_and_b32 s62, s2, 3
    s_lshl_b32 s62, s62, 2
    s_bfe_u32 s66, s2, 0x20003
    s_add_u32 s62, s62, s66
    s_bfe_u32 s66, s2, 0x10002
    s_mul_i32 s66, s66, 7
    s_lshr_b32 s65, s2, 5
    s_add_u32 s66, s66, s65
    s_lshl_b32 s62, s62, 7
    s_lshl_b32 s66, s66, 2
    s_add_u32 s62, s62, s66
    s_add_u32 s62, s62, 3148800
    s_branch p3_36
n3_35:
    s_waitcnt vmcnt(0)
    s_barrier
    s_cmp_lg_u32 s16, 0
    s_cbranch_scc1 sy_43
    v_mov_b32 v3, 1
    v_mov_b32 v4, 0
    s_mov_b64 exec, 1
    buffer_store_dword v3, v4, s[32:35], s62 offen sc1
    s_mov_b64 exec, -1
sy_43:
    s_and_b32 s63, s2, 3
    s_lshl_b32 s63, s63, 2
    s_bfe_u32 s66, s2, 0x20003
    s_add_u32 s63, s63, s66
    s_bfe_u32 s66, s2, 0x10002
    s_lshl_b32 s66, s66, 3
    s_lshr_b32 s65, s2, 5
    s_add_u32 s66, s66, s65
    s_lshl_b32 s63, s63, 7
    s_add_u32 s63, s63, 3148800
    s_add_u32 s62, s63, 124
p3_36:
    s_waitcnt vmcnt(0)
    s_barrier
    s_cmp_lg_u32 s16, 0
    s_cbranch_scc1 sy_47
    v_mov_b32 v3, 1
    v_mov_b32 v4, 0
    s_mov_b64 exec, 1
    buffer_store_dword v3, v4, s[32:35], s62 offen sc1
    s_mov_b64 exec, -1
    s_branch sy_46
sy_47:
    s_mov_b32 s24, s8
    s_and_b32 s25, s9, 0xffff
    s_mov_b32 s26, 1835008
    s_mov_b32 s27, 0x20000
    v_lshrrev_b32 v6, 2, v1
    v_and_b32 v5, 3, v1
    v_lshlrev_b32 v5, 4, v5
    s_mov_b32 s18, 1024
    v_mul_lo_u32 v7, v6, s18
    v_add_u32 v10, v7, v5
    s_sub_u32 s18, s16, 1
    s_mul_i32 s19, s18, 16384
    s_and_b32 s66, s2, 3
    s_lshl_b32 s66, s66, 2
    s_bfe_u32 s20, s2, 0x20003
    s_add_u32 s66, s66, s20
    s_bfe_u32 s20, s2, 0x10002
    s_lshl_b32 s20, s20, 3
    s_lshr_b32 s65, s2, 5
    s_add_u32 s20, s20, s65
    s_lshl_b32 s20, s20, 6
    s_add_u32 s19, s19, s20
    s_lshl_b32 m0, s18, 10
    s_nop 0
    buffer_load_dwordx4 v10, s[24:27], s19 offen lds
    s_add_u32 s19, s19, 49152
    s_add_u32 m0, m0, 3072
    s_nop 0
    buffer_load_dwordx4 v10, s[24:27], s19 offen lds
    s_add_u32 s19, s19, 49152
    s_add_u32 m0, m0, 3072
    s_nop 0
    buffer_load_dwordx4 v10, s[24:27], s19 offen lds
    s_add_u32 s19, s19, 49152
    s_add_u32 m0, m0, 3072
    s_nop 0
    buffer_load_dwordx4 v10, s[24:27], s19 offen lds
    s_add_u32 s19, s19, 49152
    s_add_u32 m0, m0, 3072
    s_nop 0
    buffer_load_dwordx4 v10, s[24:27], s19 offen lds
    s_add_u32 s19, s19, 49152
    s_add_u32 m0, m0, 3072
    s_nop 0
    buffer_load_dwordx4 v10, s[24:27], s19 offen lds
    s_add_u32 s19, s19, 49152
    s_add_u32 m0, m0, 3072
    s_nop 0
    buffer_load_dwordx4 v10, s[24:27], s19 offen lds
    s_add_u32 s19, s19, 49152
    s_add_u32 m0, m0, 3072
    s_nop 0
    buffer_load_dwordx4 v10, s[24:27], s19 offen lds
    s_add_u32 s19, s19, 49152
    s_add_u32 m0, m0, 3072
    s_nop 0
    buffer_load_dwordx4 v10, s[24:27], s19 offen lds
    s_add_u32 s19, s19, 49152
    s_add_u32 m0, m0, 3072
    s_nop 0
    buffer_load_dwordx4 v10, s[24:27], s19 offen lds
    s_add_u32 s19, s19, 49152
    s_add_u32 m0, m0, 3072
    s_nop 0
    buffer_load_dwordx4 v10, s[24:27], s19 offen lds
    s_add_u32 s19, s19, 49152
    s_add_u32 m0, m0, 3072
    s_nop 0
    buffer_load_dwordx4 v10, s[24:27], s19 offen lds
    s_add_u32 s19, s19, 49152
    s_add_u32 m0, m0, 3072
    s_nop 0
    buffer_load_dwordx4 v10, s[24:27], s19 offen lds
    s_add_u32 s19, s19, 49152
    s_add_u32 m0, m0, 3072
    s_nop 0
    buffer_load_dwordx4 v10, s[24:27], s19 offen lds
    s_add_u32 s19, s19, 49152
    s_add_u32 m0, m0, 3072
    s_nop 0
    buffer_load_dwordx4 v10, s[24:27], s19 offen lds
    s_add_u32 s19, s19, 49152
    s_add_u32 m0, m0, 3072
    s_nop 0
    buffer_load_dwordx4 v10, s[24:27], s19 offen lds
    s_add_u32 s19, s19, 49152
    s_add_u32 m0, m0, 3072
    s_nop 0
    buffer_load_dwordx4 v10, s[24:27], s19 offen lds
    s_add_u32 s19, s19, 49152
    s_add_u32 m0, m0, 3072
    s_nop 0
    buffer_load_dwordx4 v10, s[24:27], s19 offen lds
    s_add_u32 s19, s19, 49152
    s_add_u32 m0, m0, 3072
    s_nop 0
    buffer_load_dwordx4 v10, s[24:27], s19 offen lds
    s_add_u32 s19, s19, 49152
    s_add_u32 m0, m0, 3072
    s_nop 0
    buffer_load_dwordx4 v10, s[24:27], s19 offen lds
    s_add_u32 s19, s19, 49152
    s_add_u32 m0, m0, 3072
    s_nop 0
    buffer_load_dwordx4 v10, s[24:27], s19 offen lds
    s_add_u32 s19, s19, 49152
    s_add_u32 m0, m0, 3072
    s_nop 0
    buffer_load_dwordx4 v10, s[24:27], s19 offen lds
    s_add_u32 s19, s19, 49152
    s_add_u32 m0, m0, 3072
    s_nop 0
    buffer_load_dwordx4 v10, s[24:27], s19 offen lds
    s_add_u32 s19, s19, 49152
    s_add_u32 m0, m0, 3072
    s_nop 0
    buffer_load_dwordx4 v10, s[24:27], s19 offen lds
    s_add_u32 s19, s19, 49152
    s_add_u32 m0, m0, 3072
    s_nop 0
    buffer_load_dwordx4 v10, s[24:27], s19 offen lds
    s_add_u32 s19, s19, 49152
    s_add_u32 m0, m0, 3072
    s_nop 0
    buffer_load_dwordx4 v10, s[24:27], s19 offen lds
    s_add_u32 s19, s19, 49152
    s_add_u32 m0, m0, 3072
    s_nop 0
    buffer_load_dwordx4 v10, s[24:27], s19 offen lds
    s_add_u32 s19, s19, 49152
    s_add_u32 m0, m0, 3072
    s_nop 0
    buffer_load_dwordx4 v10, s[24:27], s19 offen lds
    s_add_u32 s19, s19, 49152
    s_add_u32 m0, m0, 3072
    s_nop 0
    buffer_load_dwordx4 v10, s[24:27], s19 offen lds
    s_add_u32 s19, s19, 49152
    s_add_u32 m0, m0, 3072
    s_nop 0
    buffer_load_dwordx4 v10, s[24:27], s19 offen lds
    s_add_u32 s19, s19, 49152
    s_add_u32 m0, m0, 3072
    s_nop 0
    buffer_load_dwordx4 v10, s[24:27], s19 offen lds
    s_add_u32 s19, s19, 49152
    s_add_u32 m0, m0, 3072
    s_nop 0
    buffer_load_dwordx4 v10, s[24:27], s19 offen lds
    s_add_u32 s19, s19, 49152
    s_add_u32 m0, m0, 3072
    s_nop 0
    buffer_load_dwordx4 v10, s[24:27], s19 offen lds
    s_add_u32 s19, s19, 49152
    s_add_u32 m0, m0, 3072
    s_nop 0
    buffer_load_dwordx4 v10, s[24:27], s19 offen lds
    s_add_u32 s19, s19, 49152
    s_add_u32 m0, m0, 3072
    s_nop 0
    buffer_load_dwordx4 v10, s[24:27], s19 offen lds
    s_add_u32 s19, s19, 49152
    s_add_u32 m0, m0, 3072
    s_nop 0
    buffer_load_dwordx4 v10, s[24:27], s19 offen lds
    s_add_u32 s19, s19, 49152
    s_add_u32 m0, m0, 3072
    s_nop 0
    buffer_load_dwordx4 v10, s[24:27], s19 offen lds
    s_add_u32 s19, s19, 49152
    s_add_u32 m0, m0, 3072
    s_nop 0
    buffer_load_dwordx4 v10, s[24:27], s19 offen lds
    s_branch sy_49
sy_46:
    s_cmp_lg_u32 s16, 0
    s_cbranch_scc1 sy_49
    v_min_u32 v4, 13, v1
    v_lshlrev_b32 v4, 2, v4
    s_mov_b32 s46, 0
sy_48:
    buffer_load_dword v3, v4, s[32:35], s63 offen sc1
    s_waitcnt vmcnt(0)
    v_cmp_ne_u32 vcc, 1, v3
    s_cbranch_vccz sy_49
    s_sleep 1
    s_add_u32 s46, s46, 1
    s_cmp_lt_u32 s46, 30000
    s_cbranch_scc1 sy_48
sy_49:
    s_waitcnt vmcnt(0)
    s_barrier
    s_mov_b32 s36, s12
    s_and_b32 s37, s13, 0xffff
    s_mov_b32 s38, 2097152
    s_mov_b32 s39, 0x20000
    s_and_b32 s14, s2, 3
    s_lshl_b32 s14, s14, 2
    s_bfe_u32 s17, s2, 0x20003
    s_add_u32 s14, s14, s17
    s_bfe_u32 s17, s2, 0x10002
    s_lshl_b32 s17, s17, 3
    s_lshr_b32 s65, s2, 5
    s_add_u32 s17, s17, s65
    s_lshl_b32 s20, s17, 6
    s_lshl_b32 s22, s14, 2
    s_add_u32 s22, s22, s16
    s_mul_i32 s21, s22, 114688
    s_add_u32 s21, s21, 88080384
    v_lshrrev_b32 v6, 2, v1
    v_and_b32 v5, 3, v1
    v_lshlrev_b32 v5, 4, v5
    s_mul_i32 s18, s16, 64
    v_add_u32 v7, s18, v6
    s_mov_b32 s18, 1024
    v_mul_lo_u32 v7, v7, s18
    v_add_u32 v10, v7, v5
    v_add_u32 v11, 15360, v10
    v_add_u32 v12, 30720, v10
    v_add_u32 v13, 46080, v10
    v_lshrrev_b32 v5, 5, v1
    s_lshl_b32 s19, s22, 15
    s_lshl_b32 s23, s17, 11
    s_add_u32 s19, s19, s23
    s_add_u32 s19, s19, 83886080
    buffer_load_dwordx4 v[96:99], v2, s[32:35], s19 offen offset:0 sc1
    buffer_load_dwordx4 v[100:103], v2, s[32:35], s19 offen offset:1024 sc1
    v_lshlrev_b32 v7, 4, v5
    s_lshl_b32 s19, s17, 7
    s_add_u32 s19, s19, 10240
    buffer_load_dwordx4 v[104:107], v7, s[32:35], s19 offen offset:0
    buffer_load_dwordx4 v[108:111], v7, s[32:35], s19 offen offset:32
    buffer_load_dwordx4 v[112:115], v7, s[32:35], s19 offen offset:64
    buffer_load_dwordx4 v[116:119], v7, s[32:35], s19 offen offset:96
    s_add_u32 s47, s21, 0
    buffer_load_dwordx4 a[0:3], v2, s[32:35], s47 offen offset:0 sc1
    s_add_u32 s47, s21, 0
    buffer_load_dwordx4 a[4:7], v2, s[32:35], s47 offen offset:1024 sc1
    s_add_u32 s47, s21, 0
    buffer_load_dwordx4 a[8:11], v2, s[32:35], s47 offen offset:2048 sc1
    s_add_u32 s47, s21, 0
    buffer_load_dwordx4 a[12:15], v2, s[32:35], s47 offen offset:3072 sc1
    s_add_u32 s47, s21, 4096
    buffer_load_dwordx4 a[16:19], v2, s[32:35], s47 offen offset:0 sc1
    s_add_u32 s47, s21, 4096
    buffer_load_dwordx4 a[20:23], v2, s[32:35], s47 offen offset:1024 sc1
    s_add_u32 s47, s21, 4096
    buffer_load_dwordx4 a[24:27], v2, s[32:35], s47 offen offset:2048 sc1
    s_add_u32 s47, s21, 4096
    buffer_load_dwordx4 a[28:31], v2, s[32:35], s47 offen offset:3072 sc1
    v_lshrrev_b32 v4, 4, v1
    v_bfe_u32 v5, v1, 2, 2
    v_and_b32 v6, 3, v1
    v_lshrrev_b32 v7, 1, v4
    v_lshlrev_b32 v7, 2, v7
    v_add_u32 v7, v7, v5
    v_mul_u32_u24 v7, 64, v7
    v_and_b32 v8, 1, v4
    v_lshlrev_b32 v8, 1, v8
    v_lshrrev_b32 v9, 1, v6
    v_add_u32 v8, v8, v9
    v_lshlrev_b32 v8, 4, v8
    v_and_b32 v9, 1, v6
    v_lshlrev_b32 v9, 3, v9
    v_add_u32 v8, v8, v9
    v_add_u32 v7, v7, v8
    v_mov_b32 v16, v7
    v_add_u32 v17, 65536, v16
    ds_read_b64_tr_b16 v[32:33], v16 offset:0
    ds_read_b64_tr_b16 v[34:35], v16 offset:512
    ds_read_b64_tr_b16 v[36:37], v16 offset:1024
    ds_read_b64_tr_b16 v[38:39], v16 offset:1536
    ds_read_b64_tr_b16 v[40:41], v16 offset:2048
    ds_read_b64_tr_b16 v[42:43], v16 offset:2560
    ds_read_b64_tr_b16 v[44:45], v16 offset:3072
    ds_read_b64_tr_b16 v[46:47], v16 offset:3584
    ds_read_b64_tr_b16 v[48:49], v16 offset:4096
    ds_read_b64_tr_b16 v[50:51], v16 offset:4608
    s_waitcnt vmcnt(7)
    s_waitcnt lgkmcnt(8)
    v_mfma_f32_32x32x16_bf16 v[128:143], v[32:35], a[0:3], 0
    ds_read_b64_tr_b16 v[52:53], v16 offset:5120
    ds_read_b64_tr_b16 v[54:55], v16 offset:5632
    s_add_u32 s47, s21, 8192
    buffer_load_dwordx4 a[32:35], v2, s[32:35], s47 offen offset:0 sc1
    s_add_u32 s47, s21, 8192
    buffer_load_dwordx4 a[36:39], v2, s[32:35], s47 offen offset:1024 sc1
    s_waitcnt vmcnt(8)
    s_waitcnt lgkmcnt(8)
    v_mfma_f32_32x32x16_bf16 v[128:143], v[36:39], a[4:7], v[128:143]
    ds_read_b64_tr_b16 v[32:33], v16 offset:6144
    ds_read_b64_tr_b16 v[34:35], v16 offset:6656
    s_add_u32 s47, s21, 8192
    buffer_load_dwordx4 a[40:43], v2, s[32:35], s47 offen offset:2048 sc1
    s_add_u32 s47, s21, 8192
    buffer_load_dwordx4 a[44:47], v2, s[32:35], s47 offen offset:3072 sc1
    s_waitcnt vmcnt(9)
    s_waitcnt lgkmcnt(8)
    v_mfma_f32_32x32x16_bf16 v[128:143], v[40:43], a[8:11], v[128:143]
    ds_read_b64_tr_b16 v[36:37], v16 offset:7168
    ds_read_b64_tr_b16 v[38:39], v16 offset:7680
    s_add_u32 s47, s21, 12288
    buffer_load_dwordx4 a[48:51], v2, s[32:35], s47 offen offset:0 sc1
    s_add_u32 s47, s21, 12288
    buffer_load_dwordx4 a[52:55], v2, s[32:35], s47 offen offset:1024 sc1
    s_waitcnt vmcnt(10)
    s_waitcnt lgkmcnt(8)
    v_mfma_f32_32x32x16_bf16 v[128:143], v[44:47], a[12:15], v[128:143]
    ds_read_b64_tr_b16 v[40:41], v16 offset:8192
    ds_read_b64_tr_b16 v[42:43], v16 offset:8704
    s_add_u32 s47, s21, 12288
    buffer_load_dwordx4 a[56:59], v2, s[32:35], s47 offen offset:2048 sc1
    s_add_u32 s47, s21, 12288
    buffer_load_dwordx4 a[60:63], v2, s[32:35], s47 offen offset:3072 sc1
    s_waitcnt vmcnt(11)
    s_waitcnt lgkmcnt(8)
    v_mfma_f32_32x32x16_bf16 v[128:143], v[48:51], a[16:19], v[128:143]
    ds_read_b64_tr_b16 v[44:45], v16 offset:9216
    ds_read_b64_tr_b16 v[46:47], v16 offset:9728
    s_add_u32 s47, s21, 16384
    buffer_load_dwordx4 a[64:67], v2, s[32:35], s47 offen offset:0 sc1
    s_add_u32 s47, s21, 16384
    buffer_load_dwordx4 a[68:71], v2, s[32:35], s47 offen offset:1024 sc1
    s_waitcnt vmcnt(12)
    s_waitcnt lgkmcnt(8)
    v_mfma_f32_32x32x16_bf16 v[128:143], v[52:55], a[20:23], v[128:143]
    ds_read_b64_tr_b16 v[48:49], v16 offset:10240
    ds_read_b64_tr_b16 v[50:51], v16 offset:10752
    s_add_u32 s47, s21, 16384
    buffer_load_dwordx4 a[72:75], v2, s[32:35], s47 offen offset:2048 sc1
    s_add_u32 s47, s21, 16384
    buffer_load_dwordx4 a[76:79], v2, s[32:35], s47 offen offset:3072 sc1
    s_waitcnt vmcnt(13)
    s_waitcnt lgkmcnt(8)
    v_mfma_f32_32x32x16_bf16 v[128:143], v[32:35], a[24:27], v[128:143]
    ds_read_b64_tr_b16 v[52:53], v16 offset:11264
    ds_read_b64_tr_b16 v[54:55], v16 offset:11776
    s_add_u32 s47, s21, 20480
    buffer_load_dwordx4 a[80:83], v2, s[32:35], s47 offen offset:0 sc1
    s_add_u32 s47, s21, 20480
    buffer_load_dwordx4 a[84:87], v2, s[32:35], s47 offen offset:1024 sc1
    s_waitcnt vmcnt(14)
    s_waitcnt lgkmcnt(8)
    v_mfma_f32_32x32x16_bf16 v[128:143], v[36:39], a[28:31], v[128:143]
    ds_read_b64_tr_b16 v[32:33], v16 offset:12288
    ds_read_b64_tr_b16 v[34:35], v16 offset:12800
    s_add_u32 s47, s21, 20480
    buffer_load_dwordx4 a[88:91], v2, s[32:35], s47 offen offset:2048 sc1
    s_add_u32 s47, s21, 20480
    buffer_load_dwordx4 a[92:95], v2, s[32:35], s47 offen offset:3072 sc1
    s_waitcnt vmcnt(15)
    s_waitcnt lgkmcnt(8)
    v_mfma_f32_32x32x16_bf16 v[128:143], v[40:43], a[32:35], v[128:143]
    ds_read_b64_tr_b16 v[36:37], v16 offset:13312
    ds_read_b64_tr_b16 v[38:39], v16 offset:13824
    s_add_u32 s47, s21, 24576
    buffer_load_dwordx4 a[96:99], v2, s[32:35], s47 offen offset:0 sc1
    s_add_u32 s47, s21, 24576
    buffer_load_dwordx4 a[100:103], v2, s[32:35], s47 offen offset:1024 sc1
    s_waitcnt vmcnt(16)
    s_waitcnt lgkmcnt(8)
    v_mfma_f32_32x32x16_bf16 v[128:143], v[44:47], a[36:39], v[128:143]
    ds_read_b64_tr_b16 v[40:41], v16 offset:14336
    ds_read_b64_tr_b16 v[42:43], v16 offset:14848
    s_add_u32 s47, s21, 24576
    buffer_load_dwordx4 a[104:107], v2, s[32:35], s47 offen offset:2048 sc1
    s_add_u32 s47, s21, 24576
    buffer_load_dwordx4 a[108:111], v2, s[32:35], s47 offen offset:3072 sc1
    s_waitcnt vmcnt(17)
    s_waitcnt lgkmcnt(8)
    v_mfma_f32_32x32x16_bf16 v[128:143], v[48:51], a[40:43], v[128:143]
    ds_read_b64_tr_b16 v[44:45], v16 offset:15360
    ds_read_b64_tr_b16 v[46:47], v16 offset:15872
    s_add_u32 s47, s21, 28672
    buffer_load_dwordx4 a[112:115], v2, s[32:35], s47 offen offset:0 sc1
    s_add_u32 s47, s21, 28672
    buffer_load_dwordx4 a[116:119], v2, s[32:35], s47 offen offset:1024 sc1
    s_waitcnt vmcnt(18)
    s_waitcnt lgkmcnt(8)
    v_mfma_f32_32x32x16_bf16 v[128:143], v[52:55], a[44:47], v[128:143]
    ds_read_b64_tr_b16 v[48:49], v16 offset:16384
    ds_read_b64_tr_b16 v[50:51], v16 offset:16896
    s_add_u32 s47, s21, 28672
    buffer_load_dwordx4 a[120:123], v2, s[32:35], s47 offen offset:2048 sc1
    s_add_u32 s47, s21, 28672
    buffer_load_dwordx4 a[124:127], v2, s[32:35], s47 offen offset:3072 sc1
    s_waitcnt vmcnt(19)
    s_waitcnt lgkmcnt(8)
    v_mfma_f32_32x32x16_bf16 v[128:143], v[32:35], a[48:51], v[128:143]
    ds_read_b64_tr_b16 v[52:53], v16 offset:17408
    ds_read_b64_tr_b16 v[54:55], v16 offset:17920
    s_add_u32 s47, s21, 32768
    buffer_load_dwordx4 a[0:3], v2, s[32:35], s47 offen offset:0 sc1
    s_waitcnt vmcnt(19)
    s_waitcnt lgkmcnt(8)
    v_mfma_f32_32x32x16_bf16 v[128:143], v[36:39], a[52:55], v[128:143]
    ds_read_b64_tr_b16 v[32:33], v16 offset:18432
    ds_read_b64_tr_b16 v[34:35], v16 offset:18944
    s_add_u32 s47, s21, 32768
    buffer_load_dwordx4 a[4:7], v2, s[32:35], s47 offen offset:1024 sc1
    s_waitcnt vmcnt(19)
    s_waitcnt lgkmcnt(8)
    v_mfma_f32_32x32x16_bf16 v[128:143], v[40:43], a[56:59], v[128:143]
    ds_read_b64_tr_b16 v[36:37], v16 offset:19456
    ds_read_b64_tr_b16 v[38:39], v16 offset:19968
    s_add_u32 s47, s21, 32768
    buffer_load_dwordx4 a[8:11], v2, s[32:35], s47 offen offset:2048 sc1
    s_waitcnt vmcnt(19)
    s_waitcnt lgkmcnt(8)
    v_mfma_f32_32x32x16_bf16 v[128:143], v[44:47], a[60:63], v[128:143]
    ds_read_b64_tr_b16 v[40:41], v16 offset:20480
    ds_read_b64_tr_b16 v[42:43], v16 offset:20992
    s_add_u32 s47, s21, 32768
    buffer_load_dwordx4 a[12:15], v2, s[32:35], s47 offen offset:3072 sc1
    s_waitcnt vmcnt(19)
    s_waitcnt lgkmcnt(8)
    v_mfma_f32_32x32x16_bf16 v[128:143], v[48:51], a[64:67], v[128:143]
    ds_read_b64_tr_b16 v[44:45], v16 offset:21504
    ds_read_b64_tr_b16 v[46:47], v16 offset:22016
    s_add_u32 s47, s21, 36864
    buffer_load_dwordx4 a[16:19], v2, s[32:35], s47 offen offset:0 sc1
    s_waitcnt vmcnt(19)
    s_waitcnt lgkmcnt(8)
    v_mfma_f32_32x32x16_bf16 v[128:143], v[52:55], a[68:71], v[128:143]
    ds_read_b64_tr_b16 v[48:49], v16 offset:22528
    ds_read_b64_tr_b16 v[50:51], v16 offset:23040
    s_add_u32 s47, s21, 36864
    buffer_load_dwordx4 a[20:23], v2, s[32:35], s47 offen offset:1024 sc1
    s_waitcnt vmcnt(19)
    s_waitcnt lgkmcnt(8)
    v_mfma_f32_32x32x16_bf16 v[128:143], v[32:35], a[72:75], v[128:143]
    ds_read_b64_tr_b16 v[52:53], v16 offset:23552
    ds_read_b64_tr_b16 v[54:55], v16 offset:24064
    s_add_u32 s47, s21, 36864
    buffer_load_dwordx4 a[24:27], v2, s[32:35], s47 offen offset:2048 sc1
    s_waitcnt vmcnt(19)
    s_waitcnt lgkmcnt(8)
    v_mfma_f32_32x32x16_bf16 v[128:143], v[36:39], a[76:79], v[128:143]
    ds_read_b64_tr_b16 v[32:33], v16 offset:24576
    ds_read_b64_tr_b16 v[34:35], v16 offset:25088
    s_add_u32 s47, s21, 36864
    buffer_load_dwordx4 a[28:31], v2, s[32:35], s47 offen offset:3072 sc1
    s_waitcnt vmcnt(19)
    s_waitcnt lgkmcnt(8)
    v_mfma_f32_32x32x16_bf16 v[128:143], v[40:43], a[80:83], v[128:143]
    ds_read_b64_tr_b16 v[36:37], v16 offset:25600
    ds_read_b64_tr_b16 v[38:39], v16 offset:26112
    s_add_u32 s47, s21, 40960
    buffer_load_dwordx4 a[32:35], v2, s[32:35], s47 offen offset:0 sc1
    s_waitcnt vmcnt(19)
    s_waitcnt lgkmcnt(8)
    v_mfma_f32_32x32x16_bf16 v[128:143], v[44:47], a[84:87], v[128:143]
    ds_read_b64_tr_b16 v[40:41], v16 offset:26624
    ds_read_b64_tr_b16 v[42:43], v16 offset:27136
    s_add_u32 s47, s21, 40960
    buffer_load_dwordx4 a[36:39], v2, s[32:35], s47 offen offset:1024 sc1
    s_waitcnt vmcnt(19)
    s_waitcnt lgkmcnt(8)
    v_mfma_f32_32x32x16_bf16 v[128:143], v[48:51], a[88:91], v[128:143]
    ds_read_b64_tr_b16 v[44:45], v16 offset:27648
    ds_read_b64_tr_b16 v[46:47], v16 offset:28160
    s_add_u32 s47, s21, 40960
    buffer_load_dwordx4 a[40:43], v2, s[32:35], s47 offen offset:2048 sc1
    s_waitcnt vmcnt(19)
    s_waitcnt lgkmcnt(8)
    v_mfma_f32_32x32x16_bf16 v[128:143], v[52:55], a[92:95], v[128:143]
    ds_read_b64_tr_b16 v[48:49], v16 offset:28672
    ds_read_b64_tr_b16 v[50:51], v16 offset:29184
    s_add_u32 s47, s21, 40960
    buffer_load_dwordx4 a[44:47], v2, s[32:35], s47 offen offset:3072 sc1
    s_waitcnt vmcnt(19)
    s_waitcnt lgkmcnt(8)
    v_mfma_f32_32x32x16_bf16 v[128:143], v[32:35], a[96:99], v[128:143]
    ds_read_b64_tr_b16 v[52:53], v16 offset:29696
    ds_read_b64_tr_b16 v[54:55], v16 offset:30208
    s_add_u32 s47, s21, 45056
    buffer_load_dwordx4 a[48:51], v2, s[32:35], s47 offen offset:0 sc1
    s_waitcnt vmcnt(19)
    s_waitcnt lgkmcnt(8)
    v_mfma_f32_32x32x16_bf16 v[128:143], v[36:39], a[100:103], v[128:143]
    ds_read_b64_tr_b16 v[32:33], v16 offset:30720
    ds_read_b64_tr_b16 v[34:35], v16 offset:31232
    s_add_u32 s47, s21, 45056
    buffer_load_dwordx4 a[52:55], v2, s[32:35], s47 offen offset:1024 sc1
    s_waitcnt vmcnt(19)
    s_waitcnt lgkmcnt(8)
    v_mfma_f32_32x32x16_bf16 v[128:143], v[40:43], a[104:107], v[128:143]
    ds_read_b64_tr_b16 v[36:37], v16 offset:31744
    ds_read_b64_tr_b16 v[38:39], v16 offset:32256
    s_add_u32 s47, s21, 45056
    buffer_load_dwordx4 a[56:59], v2, s[32:35], s47 offen offset:2048 sc1
    s_waitcnt vmcnt(19)
    s_waitcnt lgkmcnt(8)
    v_mfma_f32_32x32x16_bf16 v[128:143], v[44:47], a[108:111], v[128:143]
    ds_read_b64_tr_b16 v[40:41], v16 offset:32768
    ds_read_b64_tr_b16 v[42:43], v16 offset:33280
    s_add_u32 s47, s21, 45056
    buffer_load_dwordx4 a[60:63], v2, s[32:35], s47 offen offset:3072 sc1
    s_waitcnt vmcnt(19)
    s_waitcnt lgkmcnt(8)
    v_mfma_f32_32x32x16_bf16 v[128:143], v[48:51], a[112:115], v[128:143]
    ds_read_b64_tr_b16 v[44:45], v16 offset:33792
    ds_read_b64_tr_b16 v[46:47], v16 offset:34304
    s_add_u32 s47, s21, 49152
    buffer_load_dwordx4 a[64:67], v2, s[32:35], s47 offen offset:0 sc1
    s_waitcnt vmcnt(19)
    s_waitcnt lgkmcnt(8)
    v_mfma_f32_32x32x16_bf16 v[128:143], v[52:55], a[116:119], v[128:143]
    ds_read_b64_tr_b16 v[48:49], v16 offset:34816
    ds_read_b64_tr_b16 v[50:51], v16 offset:35328
    s_add_u32 s47, s21, 49152
    buffer_load_dwordx4 a[68:71], v2, s[32:35], s47 offen offset:1024 sc1
    s_waitcnt vmcnt(19)
    s_waitcnt lgkmcnt(8)
    v_mfma_f32_32x32x16_bf16 v[128:143], v[32:35], a[120:123], v[128:143]
    ds_read_b64_tr_b16 v[52:53], v16 offset:35840
    ds_read_b64_tr_b16 v[54:55], v16 offset:36352
    s_add_u32 s47, s21, 49152
    buffer_load_dwordx4 a[72:75], v2, s[32:35], s47 offen offset:2048 sc1
    s_waitcnt vmcnt(19)
    s_waitcnt lgkmcnt(8)
    v_mfma_f32_32x32x16_bf16 v[128:143], v[36:39], a[124:127], v[128:143]
    ds_read_b64_tr_b16 v[32:33], v16 offset:36864
    ds_read_b64_tr_b16 v[34:35], v16 offset:37376
    s_add_u32 s47, s21, 49152
    buffer_load_dwordx4 a[76:79], v2, s[32:35], s47 offen offset:3072 sc1
    s_waitcnt vmcnt(19)
    s_waitcnt lgkmcnt(8)
    v_mfma_f32_32x32x16_bf16 v[128:143], v[40:43], a[0:3], v[128:143]
    ds_read_b64_tr_b16 v[36:37], v16 offset:37888
    ds_read_b64_tr_b16 v[38:39], v16 offset:38400
    s_add_u32 s47, s21, 53248
    buffer_load_dwordx4 a[80:83], v2, s[32:35], s47 offen offset:0 sc1
    s_waitcnt vmcnt(19)
    s_waitcnt lgkmcnt(8)
    v_mfma_f32_32x32x16_bf16 v[128:143], v[44:47], a[4:7], v[128:143]
    ds_read_b64_tr_b16 v[40:41], v16 offset:38912
    ds_read_b64_tr_b16 v[42:43], v16 offset:39424
    s_add_u32 s47, s21, 53248
    buffer_load_dwordx4 a[84:87], v2, s[32:35], s47 offen offset:1024 sc1
    s_waitcnt vmcnt(19)
    s_waitcnt lgkmcnt(8)
    v_mfma_f32_32x32x16_bf16 v[128:143], v[48:51], a[8:11], v[128:143]
    ds_read_b64_tr_b16 v[44:45], v16 offset:39936
    ds_read_b64_tr_b16 v[46:47], v16 offset:40448
    s_add_u32 s47, s21, 53248
    buffer_load_dwordx4 a[88:91], v2, s[32:35], s47 offen offset:2048 sc1
    s_waitcnt vmcnt(19)
    s_waitcnt lgkmcnt(8)
    v_mfma_f32_32x32x16_bf16 v[128:143], v[52:55], a[12:15], v[128:143]
    ds_read_b64_tr_b16 v[48:49], v16 offset:40960
    ds_read_b64_tr_b16 v[50:51], v16 offset:41472
    s_add_u32 s47, s21, 53248
    buffer_load_dwordx4 a[92:95], v2, s[32:35], s47 offen offset:3072 sc1
    s_waitcnt vmcnt(19)
    s_waitcnt lgkmcnt(8)
    v_mfma_f32_32x32x16_bf16 v[128:143], v[32:35], a[16:19], v[128:143]
    ds_read_b64_tr_b16 v[52:53], v16 offset:41984
    ds_read_b64_tr_b16 v[54:55], v16 offset:42496
    s_add_u32 s47, s21, 57344
    buffer_load_dwordx4 a[96:99], v2, s[32:35], s47 offen offset:0 sc1
    s_waitcnt vmcnt(19)
    s_waitcnt lgkmcnt(8)
    v_mfma_f32_32x32x16_bf16 v[128:143], v[36:39], a[20:23], v[128:143]
    ds_read_b64_tr_b16 v[32:33], v16 offset:43008
    ds_read_b64_tr_b16 v[34:35], v16 offset:43520
    s_add_u32 s47, s21, 57344
    buffer_load_dwordx4 a[100:103], v2, s[32:35], s47 offen offset:1024 sc1
    s_waitcnt vmcnt(19)
    s_waitcnt lgkmcnt(8)
    v_mfma_f32_32x32x16_bf16 v[128:143], v[40:43], a[24:27], v[128:143]
    ds_read_b64_tr_b16 v[36:37], v16 offset:44032
    ds_read_b64_tr_b16 v[38:39], v16 offset:44544
    s_add_u32 s47, s21, 57344
    buffer_load_dwordx4 a[104:107], v2, s[32:35], s47 offen offset:2048 sc1
    s_waitcnt vmcnt(19)
    s_waitcnt lgkmcnt(8)
    v_mfma_f32_32x32x16_bf16 v[128:143], v[44:47], a[28:31], v[128:143]
    ds_read_b64_tr_b16 v[40:41], v16 offset:45056
    ds_read_b64_tr_b16 v[42:43], v16 offset:45568
    s_add_u32 s47, s21, 57344
    buffer_load_dwordx4 a[108:111], v2, s[32:35], s47 offen offset:3072 sc1
    s_waitcnt vmcnt(19)
    s_waitcnt lgkmcnt(8)
    v_mfma_f32_32x32x16_bf16 v[128:143], v[48:51], a[32:35], v[128:143]
    ds_read_b64_tr_b16 v[44:45], v16 offset:46080
    ds_read_b64_tr_b16 v[46:47], v16 offset:46592
    s_add_u32 s47, s21, 61440
    buffer_load_dwordx4 a[112:115], v2, s[32:35], s47 offen offset:0 sc1
    s_waitcnt vmcnt(19)
    s_waitcnt lgkmcnt(8)
    v_mfma_f32_32x32x16_bf16 v[128:143], v[52:55], a[36:39], v[128:143]
    ds_read_b64_tr_b16 v[48:49], v16 offset:47104
    ds_read_b64_tr_b16 v[50:51], v16 offset:47616
    s_add_u32 s47, s21, 61440
    buffer_load_dwordx4 a[116:119], v2, s[32:35], s47 offen offset:1024 sc1
    s_waitcnt vmcnt(19)
    s_waitcnt lgkmcnt(8)
    v_mfma_f32_32x32x16_bf16 v[128:143], v[32:35], a[40:43], v[128:143]
    ds_read_b64_tr_b16 v[52:53], v16 offset:48128
    ds_read_b64_tr_b16 v[54:55], v16 offset:48640
    s_add_u32 s47, s21, 61440
    buffer_load_dwordx4 a[120:123], v2, s[32:35], s47 offen offset:2048 sc1
    s_waitcnt vmcnt(19)
    s_waitcnt lgkmcnt(8)
    v_mfma_f32_32x32x16_bf16 v[128:143], v[36:39], a[44:47], v[128:143]
    ds_read_b64_tr_b16 v[32:33], v16 offset:49152
    ds_read_b64_tr_b16 v[34:35], v16 offset:49664
    s_add_u32 s47, s21, 61440
    buffer_load_dwordx4 a[124:127], v2, s[32:35], s47 offen offset:3072 sc1
    s_waitcnt vmcnt(19)
    s_waitcnt lgkmcnt(8)
    v_mfma_f32_32x32x16_bf16 v[128:143], v[40:43], a[48:51], v[128:143]
    ds_read_b64_tr_b16 v[36:37], v16 offset:50176
    ds_read_b64_tr_b16 v[38:39], v16 offset:50688
    s_add_u32 s47, s21, 65536
    buffer_load_dwordx4 a[0:3], v2, s[32:35], s47 offen offset:0 sc1
    s_waitcnt vmcnt(19)
    s_waitcnt lgkmcnt(8)
    v_mfma_f32_32x32x16_bf16 v[128:143], v[44:47], a[52:55], v[128:143]
    ds_read_b64_tr_b16 v[40:41], v16 offset:51200
    ds_read_b64_tr_b16 v[42:43], v16 offset:51712
    s_add_u32 s47, s21, 65536
    buffer_load_dwordx4 a[4:7], v2, s[32:35], s47 offen offset:1024 sc1
    s_waitcnt vmcnt(19)
    s_waitcnt lgkmcnt(8)
    v_mfma_f32_32x32x16_bf16 v[128:143], v[48:51], a[56:59], v[128:143]
    ds_read_b64_tr_b16 v[44:45], v16 offset:52224
    ds_read_b64_tr_b16 v[46:47], v16 offset:52736
    s_add_u32 s47, s21, 65536
    buffer_load_dwordx4 a[8:11], v2, s[32:35], s47 offen offset:2048 sc1
    s_waitcnt vmcnt(19)
    s_waitcnt lgkmcnt(8)
    v_mfma_f32_32x32x16_bf16 v[128:143], v[52:55], a[60:63], v[128:143]
    ds_read_b64_tr_b16 v[48:49], v16 offset:53248
    ds_read_b64_tr_b16 v[50:51], v16 offset:53760
    s_add_u32 s47, s21, 65536
    buffer_load_dwordx4 a[12:15], v2, s[32:35], s47 offen offset:3072 sc1
    s_waitcnt vmcnt(19)
    s_waitcnt lgkmcnt(8)
    v_mfma_f32_32x32x16_bf16 v[128:143], v[32:35], a[64:67], v[128:143]
    ds_read_b64_tr_b16 v[52:53], v16 offset:54272
    ds_read_b64_tr_b16 v[54:55], v16 offset:54784
    s_add_u32 s47, s21, 69632
    buffer_load_dwordx4 a[16:19], v2, s[32:35], s47 offen offset:0 sc1
    s_waitcnt vmcnt(19)
    s_waitcnt lgkmcnt(8)
    v_mfma_f32_32x32x16_bf16 v[128:143], v[36:39], a[68:71], v[128:143]
    ds_read_b64_tr_b16 v[32:33], v16 offset:55296
    ds_read_b64_tr_b16 v[34:35], v16 offset:55808
    s_add_u32 s47, s21, 69632
    buffer_load_dwordx4 a[20:23], v2, s[32:35], s47 offen offset:1024 sc1
    s_waitcnt vmcnt(19)
    s_waitcnt lgkmcnt(8)
    v_mfma_f32_32x32x16_bf16 v[128:143], v[40:43], a[72:75], v[128:143]
    ds_read_b64_tr_b16 v[36:37], v16 offset:56320
    ds_read_b64_tr_b16 v[38:39], v16 offset:56832
    s_add_u32 s47, s21, 69632
    buffer_load_dwordx4 a[24:27], v2, s[32:35], s47 offen offset:2048 sc1
    s_waitcnt vmcnt(19)
    s_waitcnt lgkmcnt(8)
    v_mfma_f32_32x32x16_bf16 v[128:143], v[44:47], a[76:79], v[128:143]
    ds_read_b64_tr_b16 v[40:41], v16 offset:57344
    ds_read_b64_tr_b16 v[42:43], v16 offset:57856
    s_add_u32 s47, s21, 69632
    buffer_load_dwordx4 a[28:31], v2, s[32:35], s47 offen offset:3072 sc1
    s_waitcnt vmcnt(19)
    s_waitcnt lgkmcnt(8)
    v_mfma_f32_32x32x16_bf16 v[128:143], v[48:51], a[80:83], v[128:143]
    ds_read_b64_tr_b16 v[44:45], v16 offset:58368
    ds_read_b64_tr_b16 v[46:47], v16 offset:58880
    s_add_u32 s47, s21, 73728
    buffer_load_dwordx4 a[32:35], v2, s[32:35], s47 offen offset:0 sc1
    s_waitcnt vmcnt(19)
    s_waitcnt lgkmcnt(8)
    v_mfma_f32_32x32x16_bf16 v[128:143], v[52:55], a[84:87], v[128:143]
    ds_read_b64_tr_b16 v[48:49], v16 offset:59392
    ds_read_b64_tr_b16 v[50:51], v16 offset:59904
    s_add_u32 s47, s21, 73728
    buffer_load_dwordx4 a[36:39], v2, s[32:35], s47 offen offset:1024 sc1
    s_waitcnt vmcnt(19)
    s_waitcnt lgkmcnt(8)
    v_mfma_f32_32x32x16_bf16 v[128:143], v[32:35], a[88:91], v[128:143]
    ds_read_b64_tr_b16 v[52:53], v16 offset:60416
    ds_read_b64_tr_b16 v[54:55], v16 offset:60928
    s_add_u32 s47, s21, 73728
    buffer_load_dwordx4 a[40:43], v2, s[32:35], s47 offen offset:2048 sc1
    s_waitcnt vmcnt(19)
    s_waitcnt lgkmcnt(8)
    v_mfma_f32_32x32x16_bf16 v[128:143], v[36:39], a[92:95], v[128:143]
    ds_read_b64_tr_b16 v[32:33], v16 offset:61440
    ds_read_b64_tr_b16 v[34:35], v16 offset:61952
    s_add_u32 s47, s21, 73728
    buffer_load_dwordx4 a[44:47], v2, s[32:35], s47 offen offset:3072 sc1
    s_waitcnt vmcnt(19)
    s_waitcnt lgkmcnt(8)
    v_mfma_f32_32x32x16_bf16 v[128:143], v[40:43], a[96:99], v[128:143]
    ds_read_b64_tr_b16 v[36:37], v16 offset:62464
    ds_read_b64_tr_b16 v[38:39], v16 offset:62976
    s_add_u32 s47, s21, 77824
    buffer_load_dwordx4 a[48:51], v2, s[32:35], s47 offen offset:0 sc1
    s_waitcnt vmcnt(19)
    s_waitcnt lgkmcnt(8)
    v_mfma_f32_32x32x16_bf16 v[128:143], v[44:47], a[100:103], v[128:143]
    ds_read_b64_tr_b16 v[40:41], v16 offset:63488
    ds_read_b64_tr_b16 v[42:43], v16 offset:64000
    s_add_u32 s47, s21, 77824
    buffer_load_dwordx4 a[52:55], v2, s[32:35], s47 offen offset:1024 sc1
    s_waitcnt vmcnt(19)
    s_waitcnt lgkmcnt(8)
    v_mfma_f32_32x32x16_bf16 v[128:143], v[48:51], a[104:107], v[128:143]
    ds_read_b64_tr_b16 v[44:45], v16 offset:64512
    ds_read_b64_tr_b16 v[46:47], v16 offset:65024
    s_add_u32 s47, s21, 77824
    buffer_load_dwordx4 a[56:59], v2, s[32:35], s47 offen offset:2048 sc1
    s_waitcnt vmcnt(19)
    s_waitcnt lgkmcnt(8)
    v_mfma_f32_32x32x16_bf16 v[128:143], v[52:55], a[108:111], v[128:143]
    ds_read_b64_tr_b16 v[48:49], v17 offset:0
    ds_read_b64_tr_b16 v[50:51], v17 offset:512
    s_add_u32 s47, s21, 77824
    buffer_load_dwordx4 a[60:63], v2, s[32:35], s47 offen offset:3072 sc1
    s_waitcnt vmcnt(19)
    s_waitcnt lgkmcnt(8)
    v_mfma_f32_32x32x16_bf16 v[128:143], v[32:35], a[112:115], v[128:143]
    ds_read_b64_tr_b16 v[52:53], v17 offset:1024
    ds_read_b64_tr_b16 v[54:55], v17 offset:1536
    s_add_u32 s47, s21, 81920
    buffer_load_dwordx4 a[64:67], v2, s[32:35], s47 offen offset:0 sc1
    s_waitcnt vmcnt(19)
    s_waitcnt lgkmcnt(8)
    v_mfma_f32_32x32x16_bf16 v[128:143], v[36:39], a[116:119], v[128:143]
    ds_read_b64_tr_b16 v[32:33], v17 offset:2048
    ds_read_b64_tr_b16 v[34:35], v17 offset:2560
    s_add_u32 s47, s21, 81920
    buffer_load_dwordx4 a[68:71], v2, s[32:35], s47 offen offset:1024 sc1
    s_waitcnt vmcnt(19)
    s_waitcnt lgkmcnt(8)
    v_mfma_f32_32x32x16_bf16 v[128:143], v[40:43], a[120:123], v[128:143]
    ds_read_b64_tr_b16 v[36:37], v17 offset:3072
    ds_read_b64_tr_b16 v[38:39], v17 offset:3584
    s_add_u32 s47, s21, 81920
    buffer_load_dwordx4 a[72:75], v2, s[32:35], s47 offen offset:2048 sc1
    s_waitcnt vmcnt(19)
    s_waitcnt lgkmcnt(8)
    v_mfma_f32_32x32x16_bf16 v[128:143], v[44:47], a[124:127], v[128:143]
    ds_read_b64_tr_b16 v[40:41], v17 offset:4096
    ds_read_b64_tr_b16 v[42:43], v17 offset:4608
    s_add_u32 s47, s21, 81920
    buffer_load_dwordx4 a[76:79], v2, s[32:35], s47 offen offset:3072 sc1
    s_waitcnt vmcnt(19)
    s_waitcnt lgkmcnt(8)
    v_mfma_f32_32x32x16_bf16 v[128:143], v[48:51], a[0:3], v[128:143]
    ds_read_b64_tr_b16 v[44:45], v17 offset:5120
    ds_read_b64_tr_b16 v[46:47], v17 offset:5632
    s_add_u32 s47, s21, 86016
    buffer_load_dwordx4 a[80:83], v2, s[32:35], s47 offen offset:0 sc1
    s_waitcnt vmcnt(19)
    s_waitcnt lgkmcnt(8)
    v_mfma_f32_32x32x16_bf16 v[128:143], v[52:55], a[4:7], v[128:143]
    ds_read_b64_tr_b16 v[48:49], v17 offset:6144
    ds_read_b64_tr_b16 v[50:51], v17 offset:6656
    s_add_u32 s47, s21, 86016
    buffer_load_dwordx4 a[84:87], v2, s[32:35], s47 offen offset:1024 sc1
    s_waitcnt vmcnt(19)
    s_waitcnt lgkmcnt(8)
    v_mfma_f32_32x32x16_bf16 v[128:143], v[32:35], a[8:11], v[128:143]
    ds_read_b64_tr_b16 v[52:53], v17 offset:7168
    ds_read_b64_tr_b16 v[54:55], v17 offset:7680
    s_add_u32 s47, s21, 86016
    buffer_load_dwordx4 a[88:91], v2, s[32:35], s47 offen offset:2048 sc1
    s_waitcnt vmcnt(19)
    s_waitcnt lgkmcnt(8)
    v_mfma_f32_32x32x16_bf16 v[128:143], v[36:39], a[12:15], v[128:143]
    ds_read_b64_tr_b16 v[32:33], v17 offset:8192
    ds_read_b64_tr_b16 v[34:35], v17 offset:8704
    s_add_u32 s47, s21, 86016
    buffer_load_dwordx4 a[92:95], v2, s[32:35], s47 offen offset:3072 sc1
    s_waitcnt vmcnt(19)
    s_waitcnt lgkmcnt(8)
    v_mfma_f32_32x32x16_bf16 v[128:143], v[40:43], a[16:19], v[128:143]
    ds_read_b64_tr_b16 v[36:37], v17 offset:9216
    ds_read_b64_tr_b16 v[38:39], v17 offset:9728
    s_add_u32 s47, s21, 90112
    buffer_load_dwordx4 a[96:99], v2, s[32:35], s47 offen offset:0 sc1
    s_waitcnt vmcnt(19)
    s_waitcnt lgkmcnt(8)
    v_mfma_f32_32x32x16_bf16 v[128:143], v[44:47], a[20:23], v[128:143]
    ds_read_b64_tr_b16 v[40:41], v17 offset:10240
    ds_read_b64_tr_b16 v[42:43], v17 offset:10752
    s_add_u32 s47, s21, 90112
    buffer_load_dwordx4 a[100:103], v2, s[32:35], s47 offen offset:1024 sc1
    s_waitcnt vmcnt(19)
    s_waitcnt lgkmcnt(8)
    v_mfma_f32_32x32x16_bf16 v[128:143], v[48:51], a[24:27], v[128:143]
    ds_read_b64_tr_b16 v[44:45], v17 offset:11264
    ds_read_b64_tr_b16 v[46:47], v17 offset:11776
    s_add_u32 s47, s21, 90112
    buffer_load_dwordx4 a[104:107], v2, s[32:35], s47 offen offset:2048 sc1
    s_waitcnt vmcnt(19)
    s_waitcnt lgkmcnt(8)
    v_mfma_f32_32x32x16_bf16 v[128:143], v[52:55], a[28:31], v[128:143]
    ds_read_b64_tr_b16 v[48:49], v17 offset:12288
    ds_read_b64_tr_b16 v[50:51], v17 offset:12800
    s_add_u32 s47, s21, 90112
    buffer_load_dwordx4 a[108:111], v2, s[32:35], s47 offen offset:3072 sc1
    s_waitcnt vmcnt(19)
    s_waitcnt lgkmcnt(8)
    v_mfma_f32_32x32x16_bf16 v[128:143], v[32:35], a[32:35], v[128:143]
    ds_read_b64_tr_b16 v[52:53], v17 offset:13312
    ds_read_b64_tr_b16 v[54:55], v17 offset:13824
    s_add_u32 s47, s21, 94208
    buffer_load_dwordx4 a[112:115], v2, s[32:35], s47 offen offset:0 sc1
    s_waitcnt vmcnt(19)
    s_waitcnt lgkmcnt(8)
    v_mfma_f32_32x32x16_bf16 v[128:143], v[36:39], a[36:39], v[128:143]
    ds_read_b64_tr_b16 v[32:33], v17 offset:14336
    ds_read_b64_tr_b16 v[34:35], v17 offset:14848
    s_add_u32 s47, s21, 94208
    buffer_load_dwordx4 a[116:119], v2, s[32:35], s47 offen offset:1024 sc1
    s_waitcnt vmcnt(19)
    s_waitcnt lgkmcnt(8)
    v_mfma_f32_32x32x16_bf16 v[128:143], v[40:43], a[40:43], v[128:143]
    ds_read_b64_tr_b16 v[36:37], v17 offset:15360
    ds_read_b64_tr_b16 v[38:39], v17 offset:15872
    s_add_u32 s47, s21, 94208
    buffer_load_dwordx4 a[120:123], v2, s[32:35], s47 offen offset:2048 sc1
    s_waitcnt vmcnt(19)
    s_waitcnt lgkmcnt(8)
    v_mfma_f32_32x32x16_bf16 v[128:143], v[44:47], a[44:47], v[128:143]
    ds_read_b64_tr_b16 v[40:41], v17 offset:16384
    ds_read_b64_tr_b16 v[42:43], v17 offset:16896
    s_add_u32 s47, s21, 94208
    buffer_load_dwordx4 a[124:127], v2, s[32:35], s47 offen offset:3072 sc1
    s_waitcnt vmcnt(19)
    s_waitcnt lgkmcnt(8)
    v_mfma_f32_32x32x16_bf16 v[128:143], v[48:51], a[48:51], v[128:143]
    ds_read_b64_tr_b16 v[44:45], v17 offset:17408
    ds_read_b64_tr_b16 v[46:47], v17 offset:17920
    s_add_u32 s47, s21, 98304
    buffer_load_dwordx4 a[0:3], v2, s[32:35], s47 offen offset:0 sc1
    s_waitcnt vmcnt(19)
    s_waitcnt lgkmcnt(8)
    v_mfma_f32_32x32x16_bf16 v[128:143], v[52:55], a[52:55], v[128:143]
    ds_read_b64_tr_b16 v[48:49], v17 offset:18432
    ds_read_b64_tr_b16 v[50:51], v17 offset:18944
    s_add_u32 s47, s21, 98304
    buffer_load_dwordx4 a[4:7], v2, s[32:35], s47 offen offset:1024 sc1
    s_waitcnt vmcnt(19)
    s_waitcnt lgkmcnt(8)
    v_mfma_f32_32x32x16_bf16 v[128:143], v[32:35], a[56:59], v[128:143]
    ds_read_b64_tr_b16 v[52:53], v17 offset:19456
    ds_read_b64_tr_b16 v[54:55], v17 offset:19968
    s_add_u32 s47, s21, 98304
    buffer_load_dwordx4 a[8:11], v2, s[32:35], s47 offen offset:2048 sc1
    s_waitcnt vmcnt(19)
    s_waitcnt lgkmcnt(8)
    v_mfma_f32_32x32x16_bf16 v[128:143], v[36:39], a[60:63], v[128:143]
    ds_read_b64_tr_b16 v[32:33], v17 offset:20480
    ds_read_b64_tr_b16 v[34:35], v17 offset:20992
    s_add_u32 s47, s21, 98304
    buffer_load_dwordx4 a[12:15], v2, s[32:35], s47 offen offset:3072 sc1
    s_waitcnt vmcnt(19)
    s_waitcnt lgkmcnt(8)
    v_mfma_f32_32x32x16_bf16 v[128:143], v[40:43], a[64:67], v[128:143]
    ds_read_b64_tr_b16 v[36:37], v17 offset:21504
    ds_read_b64_tr_b16 v[38:39], v17 offset:22016
    s_add_u32 s47, s21, 102400
    buffer_load_dwordx4 a[16:19], v2, s[32:35], s47 offen offset:0 sc1
    s_waitcnt vmcnt(19)
    s_waitcnt lgkmcnt(8)
    v_mfma_f32_32x32x16_bf16 v[128:143], v[44:47], a[68:71], v[128:143]
    ds_read_b64_tr_b16 v[40:41], v17 offset:22528
    ds_read_b64_tr_b16 v[42:43], v17 offset:23040
    s_add_u32 s47, s21, 102400
    buffer_load_dwordx4 a[20:23], v2, s[32:35], s47 offen offset:1024 sc1
    s_waitcnt vmcnt(19)
    s_waitcnt lgkmcnt(8)
    v_mfma_f32_32x32x16_bf16 v[128:143], v[48:51], a[72:75], v[128:143]
    ds_read_b64_tr_b16 v[44:45], v17 offset:23552
    ds_read_b64_tr_b16 v[46:47], v17 offset:24064
    s_add_u32 s47, s21, 102400
    buffer_load_dwordx4 a[24:27], v2, s[32:35], s47 offen offset:2048 sc1
    s_waitcnt vmcnt(19)
    s_waitcnt lgkmcnt(8)
    v_mfma_f32_32x32x16_bf16 v[128:143], v[52:55], a[76:79], v[128:143]
    ds_read_b64_tr_b16 v[48:49], v17 offset:24576
    ds_read_b64_tr_b16 v[50:51], v17 offset:25088
    s_add_u32 s47, s21, 102400
    buffer_load_dwordx4 a[28:31], v2, s[32:35], s47 offen offset:3072 sc1
    s_waitcnt vmcnt(19)
    s_waitcnt lgkmcnt(8)
    v_mfma_f32_32x32x16_bf16 v[128:143], v[32:35], a[80:83], v[128:143]
    ds_read_b64_tr_b16 v[52:53], v17 offset:25600
    ds_read_b64_tr_b16 v[54:55], v17 offset:26112
    s_add_u32 s47, s21, 106496
    buffer_load_dwordx4 a[32:35], v2, s[32:35], s47 offen offset:0 sc1
    s_waitcnt vmcnt(19)
    s_waitcnt lgkmcnt(8)
    v_mfma_f32_32x32x16_bf16 v[128:143], v[36:39], a[84:87], v[128:143]
    ds_read_b64_tr_b16 v[32:33], v17 offset:26624
    ds_read_b64_tr_b16 v[34:35], v17 offset:27136
    s_add_u32 s47, s21, 106496
    buffer_load_dwordx4 a[36:39], v2, s[32:35], s47 offen offset:1024 sc1
    s_waitcnt vmcnt(19)
    s_waitcnt lgkmcnt(8)
    v_mfma_f32_32x32x16_bf16 v[128:143], v[40:43], a[88:91], v[128:143]
    ds_read_b64_tr_b16 v[36:37], v17 offset:27648
    ds_read_b64_tr_b16 v[38:39], v17 offset:28160
    s_add_u32 s47, s21, 106496
    buffer_load_dwordx4 a[40:43], v2, s[32:35], s47 offen offset:2048 sc1
    s_waitcnt vmcnt(19)
    s_waitcnt lgkmcnt(8)
    v_mfma_f32_32x32x16_bf16 v[128:143], v[44:47], a[92:95], v[128:143]
    ds_read_b64_tr_b16 v[40:41], v17 offset:28672
    ds_read_b64_tr_b16 v[42:43], v17 offset:29184
    s_add_u32 s47, s21, 106496
    buffer_load_dwordx4 a[44:47], v2, s[32:35], s47 offen offset:3072 sc1
    s_waitcnt vmcnt(19)
    s_waitcnt lgkmcnt(8)
    v_mfma_f32_32x32x16_bf16 v[128:143], v[48:51], a[96:99], v[128:143]
    ds_read_b64_tr_b16 v[44:45], v17 offset:29696
    ds_read_b64_tr_b16 v[46:47], v17 offset:30208
    s_add_u32 s47, s21, 110592
    buffer_load_dwordx4 a[48:51], v2, s[32:35], s47 offen offset:0 sc1
    s_waitcnt vmcnt(19)
    s_waitcnt lgkmcnt(8)
    v_mfma_f32_32x32x16_bf16 v[128:143], v[52:55], a[100:103], v[128:143]
    ds_read_b64_tr_b16 v[48:49], v17 offset:30720
    ds_read_b64_tr_b16 v[50:51], v17 offset:31232
    s_add_u32 s47, s21, 110592
    buffer_load_dwordx4 a[52:55], v2, s[32:35], s47 offen offset:1024 sc1
    s_waitcnt vmcnt(19)
    s_waitcnt lgkmcnt(8)
    v_mfma_f32_32x32x16_bf16 v[128:143], v[32:35], a[104:107], v[128:143]
    ds_read_b64_tr_b16 v[52:53], v17 offset:31744
    ds_read_b64_tr_b16 v[54:55], v17 offset:32256
    s_add_u32 s47, s21, 110592
    buffer_load_dwordx4 a[56:59], v2, s[32:35], s47 offen offset:2048 sc1
    s_waitcnt vmcnt(19)
    s_waitcnt lgkmcnt(8)
    v_mfma_f32_32x32x16_bf16 v[128:143], v[36:39], a[108:111], v[128:143]
    ds_read_b64_tr_b16 v[32:33], v17 offset:32768
    ds_read_b64_tr_b16 v[34:35], v17 offset:33280
    s_add_u32 s47, s21, 110592
    buffer_load_dwordx4 a[60:63], v2, s[32:35], s47 offen offset:3072 sc1
    s_waitcnt vmcnt(19)
    s_waitcnt lgkmcnt(8)
    v_mfma_f32_32x32x16_bf16 v[128:143], v[40:43], a[112:115], v[128:143]
    ds_read_b64_tr_b16 v[36:37], v17 offset:33792
    ds_read_b64_tr_b16 v[38:39], v17 offset:34304
    s_waitcnt vmcnt(18)
    s_waitcnt lgkmcnt(8)
    v_mfma_f32_32x32x16_bf16 v[128:143], v[44:47], a[116:119], v[128:143]
    ds_read_b64_tr_b16 v[40:41], v17 offset:34816
    ds_read_b64_tr_b16 v[42:43], v17 offset:35328
    s_waitcnt vmcnt(17)
    s_waitcnt lgkmcnt(8)
    v_mfma_f32_32x32x16_bf16 v[128:143], v[48:51], a[120:123], v[128:143]
    ds_read_b64_tr_b16 v[44:45], v17 offset:35840
    ds_read_b64_tr_b16 v[46:47], v17 offset:36352
    s_waitcnt vmcnt(16)
    s_waitcnt lgkmcnt(8)
    v_mfma_f32_32x32x16_bf16 v[128:143], v[52:55], a[124:127], v[128:143]
    ds_read_b64_tr_b16 v[48:49], v17 offset:36864
    ds_read_b64_tr_b16 v[50:51], v17 offset:37376
    s_waitcnt vmcnt(15)
    s_waitcnt lgkmcnt(8)
    v_mfma_f32_32x32x16_bf16 v[128:143], v[32:35], a[0:3], v[128:143]
    ds_read_b64_tr_b16 v[52:53], v17 offset:37888
    ds_read_b64_tr_b16 v[54:55], v17 offset:38400
    s_waitcnt vmcnt(14)
    s_waitcnt lgkmcnt(8)
    v_mfma_f32_32x32x16_bf16 v[128:143], v[36:39], a[4:7], v[128:143]
    ds_read_b64_tr_b16 v[32:33], v17 offset:38912
    ds_read_b64_tr_b16 v[34:35], v17 offset:39424
    s_waitcnt vmcnt(13)
    s_waitcnt lgkmcnt(8)
    v_mfma_f32_32x32x16_bf16 v[128:143], v[40:43], a[8:11], v[128:143]
    ds_read_b64_tr_b16 v[36:37], v17 offset:39936
    ds_read_b64_tr_b16 v[38:39], v17 offset:40448
    s_waitcnt vmcnt(12)
    s_waitcnt lgkmcnt(8)
    v_mfma_f32_32x32x16_bf16 v[128:143], v[44:47], a[12:15], v[128:143]
    ds_read_b64_tr_b16 v[40:41], v17 offset:40960
    ds_read_b64_tr_b16 v[42:43], v17 offset:41472
    s_waitcnt vmcnt(11)
    s_waitcnt lgkmcnt(8)
    v_mfma_f32_32x32x16_bf16 v[128:143], v[48:51], a[16:19], v[128:143]
    ds_read_b64_tr_b16 v[44:45], v17 offset:41984
    ds_read_b64_tr_b16 v[46:47], v17 offset:42496
    s_waitcnt vmcnt(10)
    s_waitcnt lgkmcnt(8)
    v_mfma_f32_32x32x16_bf16 v[128:143], v[52:55], a[20:23], v[128:143]
    ds_read_b64_tr_b16 v[48:49], v17 offset:43008
    ds_read_b64_tr_b16 v[50:51], v17 offset:43520
    s_waitcnt vmcnt(9)
    s_waitcnt lgkmcnt(8)
    v_mfma_f32_32x32x16_bf16 v[128:143], v[32:35], a[24:27], v[128:143]
    ds_read_b64_tr_b16 v[52:53], v17 offset:44032
    ds_read_b64_tr_b16 v[54:55], v17 offset:44544
    s_waitcnt vmcnt(8)
    s_waitcnt lgkmcnt(8)
    v_mfma_f32_32x32x16_bf16 v[128:143], v[36:39], a[28:31], v[128:143]
    ds_read_b64_tr_b16 v[32:33], v17 offset:45056
    ds_read_b64_tr_b16 v[34:35], v17 offset:45568
    s_waitcnt vmcnt(7)
    s_waitcnt lgkmcnt(8)
    v_mfma_f32_32x32x16_bf16 v[128:143], v[40:43], a[32:35], v[128:143]
    ds_read_b64_tr_b16 v[36:37], v17 offset:46080
    ds_read_b64_tr_b16 v[38:39], v17 offset:46592
    s_waitcnt vmcnt(6)
    s_waitcnt lgkmcnt(8)
    v_mfma_f32_32x32x16_bf16 v[128:143], v[44:47], a[36:39], v[128:143]
    ds_read_b64_tr_b16 v[40:41], v17 offset:47104
    ds_read_b64_tr_b16 v[42:43], v17 offset:47616
    s_waitcnt vmcnt(5)
    s_waitcnt lgkmcnt(8)
    v_mfma_f32_32x32x16_bf16 v[128:143], v[48:51], a[40:43], v[128:143]
    ds_read_b64_tr_b16 v[44:45], v17 offset:48128
    ds_read_b64_tr_b16 v[46:47], v17 offset:48640
    s_waitcnt vmcnt(4)
    s_waitcnt lgkmcnt(8)
    v_mfma_f32_32x32x16_bf16 v[128:143], v[52:55], a[44:47], v[128:143]
    s_waitcnt vmcnt(3)
    s_waitcnt lgkmcnt(6)
    v_mfma_f32_32x32x16_bf16 v[128:143], v[32:35], a[48:51], v[128:143]
    s_waitcnt vmcnt(2)
    s_waitcnt lgkmcnt(4)
    v_mfma_f32_32x32x16_bf16 v[128:143], v[36:39], a[52:55], v[128:143]
    s_waitcnt vmcnt(1)
    s_waitcnt lgkmcnt(2)
    v_mfma_f32_32x32x16_bf16 v[128:143], v[40:43], a[56:59], v[128:143]
    s_waitcnt vmcnt(0)
    s_waitcnt lgkmcnt(0)
    v_mfma_f32_32x32x16_bf16 v[128:143], v[44:47], a[60:63], v[128:143]
    s_nop 7
    s_nop 7
    v_and_b32 v4, 31, v1
    v_lshrrev_b32 v5, 5, v1
    v_lshlrev_b32 v6, 10, v4
    v_lshlrev_b32 v7, 3, v5
    v_add_u32 v6, v6, v7
    s_lshl_b32 s18, s22, 15
    s_lshl_b32 s19, s17, 6
    s_add_u32 s18, s18, s19
    v_cvt_pk_bf16_f32 v10, v128, v129
    v_lshlrev_b32 v128, 16, v10
    v_and_b32 v129, 0xffff0000, v10
    v_cvt_pk_bf16_f32 v10, v130, v131
    v_lshlrev_b32 v130, 16, v10
    v_and_b32 v131, 0xffff0000, v10
    v_cvt_pk_bf16_f32 v10, v132, v133
    v_lshlrev_b32 v132, 16, v10
    v_and_b32 v133, 0xffff0000, v10
    v_cvt_pk_bf16_f32 v10, v134, v135
    v_lshlrev_b32 v134, 16, v10
    v_and_b32 v135, 0xffff0000, v10
    v_cvt_pk_bf16_f32 v10, v136, v137
    v_lshlrev_b32 v136, 16, v10
    v_and_b32 v137, 0xffff0000, v10
    v_cvt_pk_bf16_f32 v10, v138, v139
    v_lshlrev_b32 v138, 16, v10
    v_and_b32 v139, 0xffff0000, v10
    v_cvt_pk_bf16_f32 v10, v140, v141
    v_lshlrev_b32 v140, 16, v10
    v_and_b32 v141, 0xffff0000, v10
    v_cvt_pk_bf16_f32 v10, v142, v143
    v_lshlrev_b32 v142, 16, v10
    v_and_b32 v143, 0xffff0000, v10
    v_mul_f32 v128, v128, v104
    v_mul_f32 v129, v129, v105
    v_mul_f32 v130, v130, v106
    v_mul_f32 v131, v131, v107
    v_mul_f32 v132, v132, v108
    v_mul_f32 v133, v133, v109
    v_mul_f32 v134, v134, v110
    v_mul_f32 v135, v135, v111
    v_mul_f32 v136, v136, v112
    v_mul_f32 v137, v137, v113
    v_mul_f32 v138, v138, v114
    v_mul_f32 v139, v139, v115
    v_mul_f32 v140, v140, v116
    v_mul_f32 v141, v141, v117
    v_mul_f32 v142, v142, v118
    v_mul_f32 v143, v143, v119
    v_cvt_pk_bf16_f32 v10, v128, v129
    v_lshlrev_b32 v128, 16, v10
    v_and_b32 v129, 0xffff0000, v10
    v_cvt_pk_bf16_f32 v10, v130, v131
    v_lshlrev_b32 v130, 16, v10
    v_and_b32 v131, 0xffff0000, v10
    v_cvt_pk_bf16_f32 v10, v132, v133
    v_lshlrev_b32 v132, 16, v10
    v_and_b32 v133, 0xffff0000, v10
    v_cvt_pk_bf16_f32 v10, v134, v135
    v_lshlrev_b32 v134, 16, v10
    v_and_b32 v135, 0xffff0000, v10
    v_cvt_pk_bf16_f32 v10, v136, v137
    v_lshlrev_b32 v136, 16, v10
    v_and_b32 v137, 0xffff0000, v10
    v_cvt_pk_bf16_f32 v10, v138, v139
    v_lshlrev_b32 v138, 16, v10
    v_and_b32 v139, 0xffff0000, v10
    v_cvt_pk_bf16_f32 v10, v140, v141
    v_lshlrev_b32 v140, 16, v10
    v_and_b32 v141, 0xffff0000, v10
    v_cvt_pk_bf16_f32 v10, v142, v143
    v_lshlrev_b32 v142, 16, v10
    v_and_b32 v143, 0xffff0000, v10
    v_lshlrev_b32 v64, 16, v96
    v_and_b32 v65, 0xffff0000, v96
    v_lshlrev_b32 v66, 16, v97
    v_and_b32 v67, 0xffff0000, v97
    v_lshlrev_b32 v68, 16, v98
    v_and_b32 v69, 0xffff0000, v98
    v_lshlrev_b32 v70, 16, v99
    v_and_b32 v71, 0xffff0000, v99
    v_lshlrev_b32 v72, 16, v100
    v_and_b32 v73, 0xffff0000, v100
    v_lshlrev_b32 v74, 16, v101
    v_and_b32 v75, 0xffff0000, v101
    v_lshlrev_b32 v76, 16, v102
    v_and_b32 v77, 0xffff0000, v102
    v_lshlrev_b32 v78, 16, v103
    v_and_b32 v79, 0xffff0000, v103
    v_add_f32 v128, v128, v64
    v_add_f32 v129, v129, v65
    v_add_f32 v130, v130, v66
    v_add_f32 v131, v131, v67
    v_add_f32 v132, v132, v68
    v_add_f32 v133, v133, v69
    v_add_f32 v134, v134, v70
    v_add_f32 v135, v135, v71
    v_add_f32 v136, v136, v72
    v_add_f32 v137, v137, v73
    v_add_f32 v138, v138, v74
    v_add_f32 v139, v139, v75
    v_add_f32 v140, v140, v76
    v_add_f32 v141, v141, v77
    v_add_f32 v142, v142, v78
    v_add_f32 v143, v143, v79
    v_cvt_pk_bf16_f32 v32, v128, v129
    v_cvt_pk_bf16_f32 v33, v130, v131
    v_cvt_pk_bf16_f32 v34, v132, v133
    v_cvt_pk_bf16_f32 v35, v134, v135
    v_cvt_pk_bf16_f32 v36, v136, v137
    v_cvt_pk_bf16_f32 v37, v138, v139
    v_cvt_pk_bf16_f32 v38, v140, v141
    v_cvt_pk_bf16_f32 v39, v142, v143
    buffer_store_dwordx2 v[32:33], v6, s[36:39], s18 offen offset:0
    buffer_store_dwordx2 v[34:35], v6, s[36:39], s18 offen offset:16
    buffer_store_dwordx2 v[36:37], v6, s[36:39], s18 offen offset:32
    buffer_store_dwordx2 v[38:39], v6, s[36:39], s18 offen offset:48
tail_kernel_end:
    s_endpgm
.section .rodata,"a"
.p2align 6
.amdhsa_kernel tail_kernel
  .amdhsa_next_free_vgpr 512
  .amdhsa_next_free_sgpr 102
  .amdhsa_accum_offset 256
  .amdhsa_group_segment_fixed_size 0
  .amdhsa_kernarg_size 112
  .amdhsa_user_sgpr_count 2
  .amdhsa_user_sgpr_kernarg_segment_ptr 1
  .amdhsa_system_sgpr_workgroup_id_x 1
.end_amdhsa_kernel
.text
```
